```python
import torch

def _softmax(x, axis=-1):
    return torch.softmax(x, dim=axis)

def _gelu(x):
    return torch.nn.functional.gelu(x, approximate='tanh')

def _silu(x):
    return torch.nn.functional.silu(x)

def _sigmoid(x):
    return torch.sigmoid(x)

def _layernorm(x, axis=-1, eps=1e-05):
    m = x.mean(dim=axis, keepdim=True)
    v = x.var(dim=axis, keepdim=True, unbiased=False)
    return (x - m) / torch.sqrt(v + eps)

def _scatter_add(tgt, idx, src, axis=0):
    return tgt.clone().index_add_(axis, idx, src)

def _segment_sum(src, seg, n):
    out = torch.zeros((n,) + src.shape[1:], dtype=src.dtype)
    return out.index_add_(0, seg, src)

def _pad(x, pw):
    flat = tuple((v for pair in reversed(pw) for v in pair))
    return torch.nn.functional.pad(x, flat)
kernel_name = 'sequential_preLN__ssm_conv_s4__mixer_gmlp__prompt'

def setup_inputs():

    _w = lambda a: (lambda t: t.to(torch.bfloat16) if t.is_floating_point() else t)(torch.as_tensor(a))

    def _A_setup():
        B, L, D, N = (1, 2048, 576, 128)
        A_re = -(lambda _x: torch.exp(torch.as_tensor(_x)))((lambda *s: torch.randn(*s, dtype=torch.bfloat16) * 6.4)(D, N))
        A_im = torch.pi * (lambda *s: torch.randn(*s, dtype=torch.bfloat16) * 0.05)(D, N)
        B_re = (lambda *s: torch.randn(*s, dtype=torch.bfloat16) * 0.05)(D, N)
        B_im = (lambda *s: torch.randn(*s, dtype=torch.bfloat16) * 0.05)(D, N)
        C_re = (lambda *s: torch.randn(*s, dtype=torch.bfloat16) * 0.05)(D, N)
        C_im = (lambda *s: torch.randn(*s, dtype=torch.bfloat16) * 0.05)(D, N)
        log_dt = (lambda *s: torch.randn(*s, dtype=torch.bfloat16) * 0.05)(D) * 0.5 - 4.0
        Dskip = (lambda *s: torch.randn(*s, dtype=torch.bfloat16) * 0.05)(D)
        return {'u': _w((lambda *s: torch.randn(*s, dtype=torch.bfloat16) * 0.05)(B, L, D)), 'A_re': _w(A_re), 'A_im': _w(A_im), 'B_re': _w(B_re), 'B_im': _w(B_im), 'C_re': _w(C_re), 'C_im': _w(C_im), 'log_dt': _w(log_dt), 'Dskip': _w(Dskip)}
    _A_in = _A_setup()

    def _B_setup():
        B, S, D, F = (1, 2048, 576, 4608)
        Fh = F // 2
        return {'x': _w((lambda *s: torch.randn(*s, dtype=torch.bfloat16) * 0.05)(B, S, D)), 'w_in': _w((lambda *s: torch.randn(*s, dtype=torch.bfloat16) * 0.4)(D, 2 * Fh)), 'w_sp': _w(0.01 * (lambda *s: torch.randn(*s, dtype=torch.bfloat16) * 0.4)(S, S)), 'b_sp': _w(1.0 + 0.01 * (lambda *s: torch.randn(*s, dtype=torch.bfloat16) * 0.05)(S)), 'w_out': _w((lambda *s: torch.randn(*s, dtype=torch.bfloat16) * 0.05)(Fh, D))}
    _B_in = _B_setup()
    return {'A_u': _A_in['u'], 'A_A_re': _A_in['A_re'], 'A_A_im': _A_in['A_im'], 'A_B_re': _A_in['B_re'], 'A_B_im': _A_in['B_im'], 'A_C_re': _A_in['C_re'], 'A_C_im': _A_in['C_im'], 'A_log_dt': _A_in['log_dt'], 'A_Dskip': _A_in['Dskip'], 'B_x': _B_in['x'], 'B_w_in': _B_in['w_in'], 'B_w_sp': _B_in['w_sp'], 'B_b_sp': _B_in['b_sp'], 'B_w_out': _B_in['w_out']}

def reference(A_u, A_A_re, A_A_im, A_B_re, A_B_im, A_C_re, A_C_im, A_log_dt, A_Dskip, B_x, B_w_in, B_w_sp, B_b_sp, B_w_out):

    def _A_ref(u, A_re, A_im, B_re, B_im, C_re, C_im, log_dt, Dskip):
        Bsz, L, D = u.shape
        dt = torch.exp(log_dt)[:, None]
        A = A_re + 1j * A_im
        Bc = B_re + 1j * B_im
        Cc = C_re + 1j * C_im
        logdA = dt * A
        dB = dt * Bc
        l = (lambda x, dt: x.to(dt))(torch.arange(L), A_re.dtype)
        P = torch.exp(logdA[:, :, None] * l[None, None, :])
        K = torch.einsum('dn,dnl,dn->dl', Cc, P, dB).real
        L2 = 2 * L
        Kp = _pad(K, ((0, 0), (0, L)))
        up = (lambda x, *d: x.permute(*d))(u, 0, 2, 1)
        up = _pad(up, ((0, 0), (0, 0), (0, L)))
        Kf = (lambda x, axes=(-2, -1): torch.fft.rfft2(x.float(), dim=axes))(Kp[:, None, :], axes=(-2, -1))
        Uf = (lambda x, axes=(-2, -1): torch.fft.rfft2(x.float(), dim=axes))(up[:, :, None, :], axes=(-2, -1))
        Yf = Uf * Kf[None, :, :, :]
        y = (lambda x, s, axes=(-2, -1): torch.fft.irfft2(x, s=s, dim=axes).to(torch.bfloat16))(Yf, (1, L2), axes=(-2, -1))[:, :, 0, :L]
        y = (lambda x, *d: x.permute(*d))(y, 0, 2, 1) + u * Dskip[None, None, :]
        return y

    def _B_ref(x, w_in, w_sp, b_sp, w_out):
        B, S, D = x.shape
        F = w_in.shape[-1]
        Fh = F // 2
        z = _gelu(torch.einsum('bsd,df->bsf', x, w_in))
        z1 = z[..., :Fh].clone()
        z2 = _layernorm(z[..., Fh:], axis=-1)
        g = torch.einsum('ts,bsf->btf', w_sp, z2) + b_sp[None, :, None]
        return torch.einsum('bsf,fd->bsd', z1 * g, w_out)
    x = A_u
    h = x + _A_ref(_layernorm(x, axis=-1), A_A_re, A_A_im, A_B_re, A_B_im, A_C_re, A_C_im, A_log_dt, A_Dskip)
    h2 = h + _B_ref(_layernorm(h, axis=-1), B_w_in, B_w_sp, B_b_sp, B_w_out)
    return h2
```

```asm
; @launch kernel=sequential_preLN__ssm_conv_s4__mixer_gmlp__prompt_kernel grid=(256,1,1) block=(512,1,1) lds=139520
.amdgcn_target "amdgcn-amd-amdhsa--gfx950"
.text
.globl sequential_preLN__ssm_conv_s4__mixer_gmlp__prompt_kernel
.p2align 8
.type sequential_preLN__ssm_conv_s4__mixer_gmlp__prompt_kernel,@function
sequential_preLN__ssm_conv_s4__mixer_gmlp__prompt_kernel:
    s_cmp_ge_u32 s2, 256
    s_cbranch_scc1 Lend
    s_load_dwordx2 s[30:31], s[0:1], 128
    s_load_dwordx16 s[4:19], s[0:1], 0
    s_load_dwordx2 s[20:21], s[0:1], 64
    s_load_dwordx2 s[22:23], s[0:1], 80
    s_load_dwordx2 s[24:25], s[0:1], 88
    s_load_dwordx2 s[26:27], s[0:1], 104
    s_load_dwordx2 s[28:29], s[0:1], 120
    v_lshrrev_b32 v2, 6, v0
    v_and_b32 v1, 63, v0
    s_mov_b32 s3, 49315840
    v_readfirstlane_b32 s101, v2
    v_and_b32 v20, 15, v1
    v_lshrrev_b32 v21, 4, v1
    s_waitcnt lgkmcnt(0)
    s_load_dword s100, s[30:31], s3
    s_mov_b32 s3, s101
    s_mov_b32 s83, 0
    s_mov_b32 s32, s4
    s_and_b32 s33, s5, 0xffff
    s_mov_b32 s34, 2359296
    s_mov_b32 s35, 0x20000
    s_mov_b32 s96, s30
    s_and_b32 s97, s31, 0xffff
    s_mov_b32 s98, 268435456
    s_mov_b32 s99, 0x20000
    s_cmp_ge_u32 s2, 144
    s_cbranch_scc1 Lpack
    s_cmp_ge_u32 s3, 4
    s_cbranch_scc1 Lhelp
    s_lshl_b32 s40, s2, 2
    s_add_u32 s40, s40, s3
    s_lshl_b32 s41, s40, 8
    v_lshlrev_b32 v2, 1, v1
    v_add_u32 v2, s41, v2
    s_lshl_b32 s41, s40, 1
    v_mov_b32 v3, s41
    global_load_ushort v4, v3, s[18:19]
    global_load_ushort v8, v2, s[6:7] offset:0
    global_load_ushort v9, v2, s[6:7] offset:128
    global_load_ushort v10, v2, s[8:9] offset:0
    global_load_ushort v11, v2, s[8:9] offset:128
    global_load_ushort v12, v2, s[10:11] offset:0
    global_load_ushort v13, v2, s[10:11] offset:128
    global_load_ushort v14, v2, s[12:13] offset:0
    global_load_ushort v15, v2, s[12:13] offset:128
    global_load_ushort v16, v2, s[14:15] offset:0
    global_load_ushort v17, v2, s[14:15] offset:128
    global_load_ushort v18, v2, s[16:17] offset:0
    global_load_ushort v19, v2, s[16:17] offset:128
    s_getpc_b64 s[64:65]
Lpc1:
    s_add_u32 s64, s64, LK1 - Lpc1
    s_addc_u32 s65, s65, 0
    s_mul_i32 s66, s3, 4096
    v_lshlrev_b32 v249, 4, v1
    v_add_u32 v249, s66, v249
    v_min_u32 v248, Lpack - LK1 - 16, v249
    global_load_dwordx4 v[252:255], v248, s[64:65]
    v_add_u32 v249, 1024, v249
    v_min_u32 v248, Lpack - LK1 - 16, v249
    global_load_dwordx4 v[252:255], v248, s[64:65]
    v_add_u32 v249, 1024, v249
    v_min_u32 v248, Lpack - LK1 - 16, v249
    global_load_dwordx4 v[252:255], v248, s[64:65]
    v_add_u32 v249, 1024, v249
    v_min_u32 v248, Lpack - LK1 - 16, v249
    global_load_dwordx4 v[252:255], v248, s[64:65]
    v_add_u32 v249, 1024, v249
LK1:
    s_mul_i32 s43, s3, 18432
    s_movk_i32 s42, 272
    v_mul_lo_u32 v7, v1, s42
    v_add_u32 v7, s43, v7
    v_lshrrev_b32 v22, 2, v1
    v_mul_lo_u32 v22, v22, s42
    v_and_b32 v23, 3, v1
    v_lshl_add_u32 v22, v23, 3, v22
    v_add_u32 v22, s43, v22
    s_mul_i32 s46, s3, 4608
    s_add_u32 s46, s46, 73728
    v_mov_b32 v24, 0
    v_mov_b32 v25, 0
    v_lshlrev_b32 v23, 3, v1
    v_add_u32 v23, s46, v23
    ds_write_b64 v23, v[24:25]
    v_and_b32 v43, 7, v20
    v_lshrrev_b32 v44, 3, v20
    v_lshl_add_u32 v40, v44, 7, v43
    v_and_b32 v43, 3, v20
    v_lshlrev_b32 v43, 1, v43
    v_lshrrev_b32 v44, 2, v20
    v_lshl_add_u32 v41, v44, 7, v43
    v_add_u32 v41, 256, v41
    v_and_b32 v43, 1, v20
    v_lshlrev_b32 v43, 2, v43
    v_lshrrev_b32 v44, 1, v20
    v_lshl_add_u32 v45, v44, 7, v43
    v_cmp_gt_u32 vcc, 8, v20
    v_lshlrev_b32 v42, 7, v20
    v_add_u32 v42, 1024, v42
    v_cndmask_b32 v41, v45, v41, vcc
    v_lshlrev_b32 v43, 5, v21
    v_add_u32 v40, v40, v43
    v_add_u32 v41, v41, v43
    v_add_u32 v42, v42, v43
    v_cvt_f32_u32 v40, v40
    v_cvt_f32_u32 v41, v41
    v_cvt_f32_u32 v42, v42
    s_sub_u32 s47, s43, 32256
    v_mov_b32 v46, s47
    v_mov_b32 v47, 0x45800000
    v_add_f32 v200, 0x0, v40
    v_max_f32 v200, 0.5, v200
    v_mad_u32_u16 v200, v200, 2, v46 op_sel:[1,0,0,0]
    v_add_f32 v201, 0x41000000, v40
    v_mad_u32_u16 v201, v201, 2, v46 op_sel:[1,0,0,0]
    v_add_f32 v202, 0x41800000, v40
    v_mad_u32_u16 v202, v202, 2, v46 op_sel:[1,0,0,0]
    v_add_f32 v203, 0x41c00000, v40
    v_mad_u32_u16 v203, v203, 2, v46 op_sel:[1,0,0,0]
    v_add_f32 v204, 0x0, v41
    v_mad_u32_u16 v204, v204, 2, v46 op_sel:[1,0,0,0]
    v_add_f32 v205, 0x41000000, v41
    v_mad_u32_u16 v205, v205, 2, v46 op_sel:[1,0,0,0]
    v_add_f32 v206, 0x41800000, v41
    v_mad_u32_u16 v206, v206, 2, v46 op_sel:[1,0,0,0]
    v_add_f32 v207, 0x41c00000, v41
    v_mad_u32_u16 v207, v207, 2, v46 op_sel:[1,0,0,0]
    v_add_f32 v208, 0x0, v42
    v_cmp_lt_f32 vcc, 0x45000000, v208
    s_nop 1
    v_cndmask_b32 v208, v208, v47, vcc
    v_mad_u32_u16 v208, v208, 2, v46 op_sel:[1,0,0,0]
    v_add_f32 v209, 0x41000000, v42
    v_cmp_lt_f32 vcc, 0x45000000, v209
    s_nop 1
    v_cndmask_b32 v209, v209, v47, vcc
    v_mad_u32_u16 v209, v209, 2, v46 op_sel:[1,0,0,0]
    v_add_f32 v210, 0x41800000, v42
    v_cmp_lt_f32 vcc, 0x45000000, v210
    s_nop 1
    v_cndmask_b32 v210, v210, v47, vcc
    v_mad_u32_u16 v210, v210, 2, v46 op_sel:[1,0,0,0]
    v_add_f32 v211, 0x41c00000, v42
    v_cmp_lt_f32 vcc, 0x45000000, v211
    s_nop 1
    v_cndmask_b32 v211, v211, v47, vcc
    v_mad_u32_u16 v211, v211, 2, v46 op_sel:[1,0,0,0]
    v_lshlrev_b32 v40, 3, v1
    v_sub_u32 v40, 2047, v40
    v_cvt_f32_i32 v40, v40
    v_add_f32 v56, 0x80000000, v40
    v_add_f32 v57, 0xbf800000, v40
    v_cvt_pk_bf16_f32 v56, v56, v57
    v_mad_u32_u16 v212, v56, 2, v46
    v_mad_u32_u16 v213, v56, 2, v46 op_sel:[1,0,0,0]
    v_add_f32 v56, 0xc0000000, v40
    v_add_f32 v57, 0xc0400000, v40
    v_cvt_pk_bf16_f32 v56, v56, v57
    v_mad_u32_u16 v214, v56, 2, v46
    v_mad_u32_u16 v215, v56, 2, v46 op_sel:[1,0,0,0]
    v_add_f32 v56, 0xc0800000, v40
    v_add_f32 v57, 0xc0a00000, v40
    v_cvt_pk_bf16_f32 v56, v56, v57
    v_mad_u32_u16 v216, v56, 2, v46
    v_mad_u32_u16 v217, v56, 2, v46 op_sel:[1,0,0,0]
    v_add_f32 v56, 0xc0c00000, v40
    v_add_f32 v57, 0xc0e00000, v40
    v_cvt_pk_bf16_f32 v56, v56, v57
    v_mad_u32_u16 v218, v56, 2, v46
    v_mad_u32_u16 v219, v56, 2, v46 op_sel:[1,0,0,0]
    v_add_f32 v56, 0xc1000000, v40
    v_add_f32 v57, 0xc1100000, v40
    v_cvt_pk_bf16_f32 v56, v56, v57
    v_mad_u32_u16 v220, v56, 2, v46
    v_add_f32 v56, 0xc4000000, v40
    v_add_f32 v57, 0xc4004000, v40
    v_cvt_pk_bf16_f32 v56, v56, v57
    v_mad_u32_u16 v221, v56, 2, v46
    v_mad_u32_u16 v222, v56, 2, v46 op_sel:[1,0,0,0]
    v_add_f32 v56, 0xc4008000, v40
    v_add_f32 v57, 0xc400c000, v40
    v_cvt_pk_bf16_f32 v56, v56, v57
    v_mad_u32_u16 v223, v56, 2, v46
    v_mad_u32_u16 v224, v56, 2, v46 op_sel:[1,0,0,0]
    v_add_f32 v56, 0xc4010000, v40
    v_add_f32 v57, 0xc4014000, v40
    v_cvt_pk_bf16_f32 v56, v56, v57
    v_mad_u32_u16 v225, v56, 2, v46
    v_mad_u32_u16 v226, v56, 2, v46 op_sel:[1,0,0,0]
    v_add_f32 v56, 0xc4018000, v40
    v_add_f32 v57, 0xc401c000, v40
    v_cvt_pk_bf16_f32 v56, v56, v57
    v_mad_u32_u16 v227, v56, 2, v46
    v_mad_u32_u16 v228, v56, 2, v46 op_sel:[1,0,0,0]
    v_add_f32 v56, 0xc4020000, v40
    v_add_f32 v57, 0xc4024000, v40
    v_cvt_pk_bf16_f32 v56, v56, v57
    v_mad_u32_u16 v229, v56, 2, v46
    v_add_f32 v56, 0xc4800000, v40
    v_add_f32 v57, 0xc4802000, v40
    v_cvt_pk_bf16_f32 v56, v56, v57
    v_mad_u32_u16 v230, v56, 2, v46
    v_mad_u32_u16 v231, v56, 2, v46 op_sel:[1,0,0,0]
    v_add_f32 v56, 0xc4804000, v40
    v_add_f32 v57, 0xc4806000, v40
    v_cvt_pk_bf16_f32 v56, v56, v57
    v_mad_u32_u16 v232, v56, 2, v46
    v_mad_u32_u16 v233, v56, 2, v46 op_sel:[1,0,0,0]
    v_add_f32 v56, 0xc4808000, v40
    v_add_f32 v57, 0xc480a000, v40
    v_cvt_pk_bf16_f32 v56, v56, v57
    v_mad_u32_u16 v234, v56, 2, v46
    v_mad_u32_u16 v235, v56, 2, v46 op_sel:[1,0,0,0]
    v_add_f32 v56, 0xc480c000, v40
    v_add_f32 v57, 0xc480e000, v40
    v_cvt_pk_bf16_f32 v56, v56, v57
    v_mad_u32_u16 v236, v56, 2, v46
    v_mad_u32_u16 v237, v56, 2, v46 op_sel:[1,0,0,0]
    v_add_f32 v56, 0xc4810000, v40
    v_add_f32 v57, 0xc4812000, v40
    v_cvt_pk_bf16_f32 v56, v56, v57
    v_mad_u32_u16 v238, v56, 2, v46
    v_add_f32 v56, 0xc4c00000, v40
    v_add_f32 v57, 0xc4c02000, v40
    v_cvt_pk_bf16_f32 v56, v56, v57
    v_mad_u32_u16 v239, v56, 2, v46
    v_mad_u32_u16 v240, v56, 2, v46 op_sel:[1,0,0,0]
    v_add_f32 v56, 0xc4c04000, v40
    v_add_f32 v57, 0xc4c06000, v40
    v_cvt_pk_bf16_f32 v56, v56, v57
    v_mad_u32_u16 v241, v56, 2, v46
    v_mad_u32_u16 v242, v56, 2, v46 op_sel:[1,0,0,0]
    v_add_f32 v56, 0xc4c08000, v40
    v_add_f32 v57, 0xc4c0a000, v40
    v_cvt_pk_bf16_f32 v56, v56, v57
    v_mad_u32_u16 v243, v56, 2, v46
    v_mad_u32_u16 v244, v56, 2, v46 op_sel:[1,0,0,0]
    v_add_f32 v56, 0xc4c0c000, v40
    v_add_f32 v57, 0xc4c0e000, v40
    v_fma_f32 v58, v56, -0.5, 1.0
    v_mul_f32 v58, 0.5, v58
    v_max_f32 v56, v56, v58
    v_fma_f32 v58, v57, -0.5, 1.0
    v_mul_f32 v58, 0.5, v58
    v_max_f32 v57, v57, v58
    v_cvt_pk_bf16_f32 v56, v56, v57
    v_mad_u32_u16 v245, v56, 2, v46
    v_mad_u32_u16 v246, v56, 2, v46 op_sel:[1,0,0,0]
    v_add_f32 v56, 0xc4c10000, v40
    v_add_f32 v57, 0xc4c12000, v40
    v_fma_f32 v58, v56, -0.5, 1.0
    v_mul_f32 v58, 0.5, v58
    v_max_f32 v56, v56, v58
    v_fma_f32 v58, v57, -0.5, 1.0
    v_mul_f32 v58, 0.5, v58
    v_max_f32 v57, v57, v58
    v_cvt_pk_bf16_f32 v56, v56, v57
    v_mad_u32_u16 v247, v56, 2, v46
    s_waitcnt vmcnt(4) lgkmcnt(0)
    s_add_u32 s100, s100, 1
    s_max_u32 s100, s100, 1
    s_mul_i32 s100, s100, 0x9e3779b1
    v_lshlrev_b32 v4, 16, v4
    v_mul_f32 v4, 0x3fb8aa3b, v4
    v_exp_f32 v4, v4
    v_lshlrev_b32 v8, 16, v8
    v_lshlrev_b32 v9, 16, v9
    v_lshlrev_b32 v10, 16, v10
    v_lshlrev_b32 v11, 16, v11
    v_lshlrev_b32 v12, 16, v12
    v_lshlrev_b32 v13, 16, v13
    v_lshlrev_b32 v14, 16, v14
    v_lshlrev_b32 v15, 16, v15
    v_lshlrev_b32 v16, 16, v16
    v_lshlrev_b32 v17, 16, v17
    v_lshlrev_b32 v18, 16, v18
    v_lshlrev_b32 v19, 16, v19
    v_cvt_pk_bf16_f32 v4, v4, v4
    v_and_b32 v4, 0xffff0000, v4
    v_mul_f32 v26, v4, v8
    v_mul_f32 v28, v4, v10
    v_mul_f32 v12, v4, v12
    v_mul_f32 v14, v4, v14
    v_mul_f32 v26, 0x3fb8aa3b, v26
    v_mul_f32 v28, 0x3e22f983, v28
    v_mul_f32 v30, v16, v12
    v_mul_f32 v32, v16, v14
    v_fma_f32 v30, -v18, v14, v30
    v_fma_f32 v32, v18, v12, v32
    v_mul_f32 v27, v4, v9
    v_mul_f32 v29, v4, v11
    v_mul_f32 v13, v4, v13
    v_mul_f32 v15, v4, v15
    v_mul_f32 v27, 0x3fb8aa3b, v27
    v_mul_f32 v29, 0x3e22f983, v29
    v_mul_f32 v31, v17, v13
    v_mul_f32 v33, v17, v15
    v_fma_f32 v31, -v19, v15, v31
    v_fma_f32 v33, v19, v13, v33
    v_max3_f32 v34, |v30|, |v31|, |v32|
    v_max_f32 v34, v34, |v33|
    s_nop 1
    v_max_f32_dpp v34, v34, v34 quad_perm:[1,0,3,2] row_mask:0xf bank_mask:0xf
    s_nop 1
    v_max_f32_dpp v34, v34, v34 quad_perm:[2,3,0,1] row_mask:0xf bank_mask:0xf
    s_nop 1
    v_max_f32_dpp v34, v34, v34 row_half_mirror row_mask:0xf bank_mask:0xf
    s_nop 1
    v_max_f32_dpp v34, v34, v34 row_mirror row_mask:0xf bank_mask:0xf
    s_nop 1
    v_mov_b32 v35, v34
    s_nop 1
    v_permlane16_swap_b32 v34, v35
    s_nop 1
    v_max_f32 v34, v34, v35
    v_mov_b32 v35, v34
    s_nop 1
    v_permlane32_swap_b32 v34, v35
    s_nop 1
    v_max_f32 v34, v34, v35
    v_frexp_exp_i32_f32 v34, v34
    v_sub_u32 v35, 0, v34
    v_ldexp_f32 v30, v30, v35
    v_ldexp_f32 v31, v31, v35
    v_ldexp_f32 v32, v32, v35
    v_ldexp_f32 v33, v33, v35
    v_mov_b32 v60, 1.0
    v_mov_b32 v61, 0
    v_mul_f32 v196, 0x41000000, v26
    v_mul_f32 v197, 0x41000000, v28
    v_mul_f32 v198, 0x42000000, v26
    v_exp_f32 v196, v196
    v_fract_f32 v197, v197
    v_mul_f32 v199, 0x42000000, v28
    v_exp_f32 v198, v198
    v_cos_f32 v42, v197
    v_sin_f32 v43, v197
    v_fract_f32 v199, v199
    v_mul_f32 v42, v42, v196
    v_mul_f32 v43, v43, v196
    v_cos_f32 v44, v199
    v_sin_f32 v45, v199
    v_mul_f32 v196, 0x3f800000, v26
    v_mul_f32 v44, v44, v198
    v_mul_f32 v45, v45, v198
    v_mul_f32 v197, 0x3f800000, v28
    v_exp_f32 v196, v196
    v_mul_f32 v198, 0x43000000, v26
    v_fract_f32 v197, v197
    v_mul_f32 v199, 0x43000000, v28
    v_exp_f32 v198, v198
    v_cos_f32 v40, v197
    v_sin_f32 v41, v197
    v_fract_f32 v199, v199
    v_mul_f32 v40, v40, v196
    v_mul_f32 v41, v41, v196
    v_cos_f32 v46, v199
    v_sin_f32 v47, v199
    v_mul_f32 v46, v46, v198
    v_mul_f32 v47, v47, v198
    v_mov_b32 v64, v30
    v_mov_b32 v65, v32
    v_mov_b32 v98, v40
    v_mov_b32 v99, v41
    v_mov_b32 v112, v46
    v_mov_b32 v113, v47
    v_pk_mul_f32 v[72:73], v[64:65], v[44:45] op_sel:[0,0] op_sel_hi:[0,1]
    v_pk_mul_f32 v[100:101], v[40:41], v[40:41] op_sel:[0,0] op_sel_hi:[0,1]
    v_pk_mul_f32 v[128:129], v[46:47], v[46:47] op_sel:[0,0] op_sel_hi:[0,1]
    v_pk_fma_f32 v[72:73], v[64:65], v[44:45], v[72:73] op_sel:[1,1,0] op_sel_hi:[1,0,1] neg_lo:[1,0,0]
    v_pk_fma_f32 v[100:101], v[40:41], v[40:41], v[100:101] op_sel:[1,1,0] op_sel_hi:[1,0,1] neg_lo:[1,0,0]
    v_pk_fma_f32 v[128:129], v[46:47], v[46:47], v[128:129] op_sel:[1,1,0] op_sel_hi:[1,0,1] neg_lo:[1,0,0]
    v_pk_mul_f32 v[66:67], v[64:65], v[42:43] op_sel:[0,0] op_sel_hi:[0,1]
    v_pk_mul_f32 v[80:81], v[72:73], v[44:45] op_sel:[0,0] op_sel_hi:[0,1]
    v_pk_mul_f32 v[102:103], v[100:101], v[40:41] op_sel:[0,0] op_sel_hi:[0,1]
    v_pk_fma_f32 v[66:67], v[64:65], v[42:43], v[66:67] op_sel:[1,1,0] op_sel_hi:[1,0,1] neg_lo:[1,0,0]
    v_pk_fma_f32 v[80:81], v[72:73], v[44:45], v[80:81] op_sel:[1,1,0] op_sel_hi:[1,0,1] neg_lo:[1,0,0]
    v_pk_fma_f32 v[102:103], v[100:101], v[40:41], v[102:103] op_sel:[1,1,0] op_sel_hi:[1,0,1] neg_lo:[1,0,0]
    v_pk_mul_f32 v[104:105], v[100:101], v[100:101] op_sel:[0,0] op_sel_hi:[0,1]
    v_pk_mul_f32 v[136:137], v[128:129], v[46:47] op_sel:[0,0] op_sel_hi:[0,1]
    v_pk_mul_f32 v[144:145], v[128:129], v[128:129] op_sel:[0,0] op_sel_hi:[0,1]
    v_pk_fma_f32 v[104:105], v[100:101], v[100:101], v[104:105] op_sel:[1,1,0] op_sel_hi:[1,0,1] neg_lo:[1,0,0]
    v_pk_fma_f32 v[136:137], v[128:129], v[46:47], v[136:137] op_sel:[1,1,0] op_sel_hi:[1,0,1] neg_lo:[1,0,0]
    v_pk_fma_f32 v[144:145], v[128:129], v[128:129], v[144:145] op_sel:[1,1,0] op_sel_hi:[1,0,1] neg_lo:[1,0,0]
    v_pk_mul_f32 v[68:69], v[66:67], v[42:43] op_sel:[0,0] op_sel_hi:[0,1]
    v_pk_mul_f32 v[74:75], v[72:73], v[42:43] op_sel:[0,0] op_sel_hi:[0,1]
    v_pk_mul_f32 v[88:89], v[80:81], v[44:45] op_sel:[0,0] op_sel_hi:[0,1]
    v_pk_fma_f32 v[68:69], v[66:67], v[42:43], v[68:69] op_sel:[1,1,0] op_sel_hi:[1,0,1] neg_lo:[1,0,0]
    v_pk_fma_f32 v[74:75], v[72:73], v[42:43], v[74:75] op_sel:[1,1,0] op_sel_hi:[1,0,1] neg_lo:[1,0,0]
    v_pk_fma_f32 v[88:89], v[80:81], v[44:45], v[88:89] op_sel:[1,1,0] op_sel_hi:[1,0,1] neg_lo:[1,0,0]
    v_pk_mul_f32 v[70:71], v[68:69], v[42:43] op_sel:[0,0] op_sel_hi:[0,1]
    v_pk_mul_f32 v[76:77], v[74:75], v[42:43] op_sel:[0,0] op_sel_hi:[0,1]
    v_pk_mul_f32 v[82:83], v[80:81], v[42:43] op_sel:[0,0] op_sel_hi:[0,1]
    v_pk_fma_f32 v[70:71], v[68:69], v[42:43], v[70:71] op_sel:[1,1,0] op_sel_hi:[1,0,1] neg_lo:[1,0,0]
    v_pk_fma_f32 v[76:77], v[74:75], v[42:43], v[76:77] op_sel:[1,1,0] op_sel_hi:[1,0,1] neg_lo:[1,0,0]
    v_pk_fma_f32 v[82:83], v[80:81], v[42:43], v[82:83] op_sel:[1,1,0] op_sel_hi:[1,0,1] neg_lo:[1,0,0]
    v_pk_mul_f32 v[106:107], v[104:105], v[40:41] op_sel:[0,0] op_sel_hi:[0,1]
    v_pk_mul_f32 v[108:109], v[104:105], v[100:101] op_sel:[0,0] op_sel_hi:[0,1]
    v_pk_mul_f32 v[110:111], v[104:105], v[102:103] op_sel:[0,0] op_sel_hi:[0,1]
    v_pk_fma_f32 v[106:107], v[104:105], v[40:41], v[106:107] op_sel:[1,1,0] op_sel_hi:[1,0,1] neg_lo:[1,0,0]
    v_pk_fma_f32 v[108:109], v[104:105], v[100:101], v[108:109] op_sel:[1,1,0] op_sel_hi:[1,0,1] neg_lo:[1,0,0]
    v_pk_fma_f32 v[110:111], v[104:105], v[102:103], v[110:111] op_sel:[1,1,0] op_sel_hi:[1,0,1] neg_lo:[1,0,0]
    v_pk_mul_f32 v[78:79], v[76:77], v[42:43] op_sel:[0,0] op_sel_hi:[0,1]
    v_pk_mul_f32 v[84:85], v[82:83], v[42:43] op_sel:[0,0] op_sel_hi:[0,1]
    v_pk_mul_f32 v[90:91], v[88:89], v[42:43] op_sel:[0,0] op_sel_hi:[0,1]
    v_pk_fma_f32 v[78:79], v[76:77], v[42:43], v[78:79] op_sel:[1,1,0] op_sel_hi:[1,0,1] neg_lo:[1,0,0]
    v_pk_fma_f32 v[84:85], v[82:83], v[42:43], v[84:85] op_sel:[1,1,0] op_sel_hi:[1,0,1] neg_lo:[1,0,0]
    v_pk_fma_f32 v[90:91], v[88:89], v[42:43], v[90:91] op_sel:[1,1,0] op_sel_hi:[1,0,1] neg_lo:[1,0,0]
    v_pk_mul_f32 v[148:149], v[144:145], v[46:47] op_sel:[0,0] op_sel_hi:[0,1]
    v_pk_mul_f32 v[152:153], v[144:145], v[128:129] op_sel:[0,0] op_sel_hi:[0,1]
    v_pk_mul_f32 v[156:157], v[144:145], v[136:137] op_sel:[0,0] op_sel_hi:[0,1]
    v_pk_fma_f32 v[148:149], v[144:145], v[46:47], v[148:149] op_sel:[1,1,0] op_sel_hi:[1,0,1] neg_lo:[1,0,0]
    v_pk_fma_f32 v[152:153], v[144:145], v[128:129], v[152:153] op_sel:[1,1,0] op_sel_hi:[1,0,1] neg_lo:[1,0,0]
    v_pk_fma_f32 v[156:157], v[144:145], v[136:137], v[156:157] op_sel:[1,1,0] op_sel_hi:[1,0,1] neg_lo:[1,0,0]
    v_pk_mul_f32 v[160:161], v[144:145], v[144:145] op_sel:[0,0] op_sel_hi:[0,1]
    v_cvt_pk_f16_f32 v180, v64, v66
    v_cvt_pk_f16_f32 v184, -v65, -v67
    v_pk_fma_f32 v[160:161], v[144:145], v[144:145], v[160:161] op_sel:[1,1,0] op_sel_hi:[1,0,1] neg_lo:[1,0,0]
    v_cvt_pk_f16_f32 v181, v68, v70
    v_cvt_pk_f16_f32 v185, -v69, -v71
    v_cvt_pk_f16_f32 v182, v72, v74
    v_cvt_pk_f16_f32 v186, -v73, -v75
    v_cvt_pk_f16_f32 v183, v76, v78
    v_cvt_pk_f16_f32 v187, -v77, -v79
    v_pk_mul_f32 v[86:87], v[84:85], v[42:43] op_sel:[0,0] op_sel_hi:[0,1]
    ds_write_b128 v7, v[180:183] offset:0
    ds_write_b128 v7, v[184:187] offset:128
    v_pk_fma_f32 v[86:87], v[84:85], v[42:43], v[86:87] op_sel:[1,1,0] op_sel_hi:[1,0,1] neg_lo:[1,0,0]
    v_pk_mul_f32 v[92:93], v[90:91], v[42:43] op_sel:[0,0] op_sel_hi:[0,1]
    v_cvt_pk_f16_f32 v180, v60, v98
    v_cvt_pk_f16_f32 v184, v61, v99
    v_pk_fma_f32 v[92:93], v[90:91], v[42:43], v[92:93] op_sel:[1,1,0] op_sel_hi:[1,0,1] neg_lo:[1,0,0]
    v_cvt_pk_f16_f32 v181, v100, v102
    v_cvt_pk_f16_f32 v185, v101, v103
    v_cvt_pk_f16_f32 v182, v104, v106
    v_cvt_pk_f16_f32 v186, v105, v107
    v_cvt_pk_f16_f32 v183, v108, v110
    v_cvt_pk_f16_f32 v187, v109, v111
    v_pk_mul_f32 v[114:115], v[98:99], v[46:47] op_sel:[0,0] op_sel_hi:[0,1]
    ds_write_b128 v7, v[180:183] offset:32
    ds_write_b128 v7, v[184:187] offset:160
    v_pk_fma_f32 v[114:115], v[98:99], v[46:47], v[114:115] op_sel:[1,1,0] op_sel_hi:[1,0,1] neg_lo:[1,0,0]
    v_pk_mul_f32 v[116:117], v[100:101], v[46:47] op_sel:[0,0] op_sel_hi:[0,1]
    v_pk_mul_f32 v[118:119], v[102:103], v[46:47] op_sel:[0,0] op_sel_hi:[0,1]
    v_pk_mul_f32 v[120:121], v[104:105], v[46:47] op_sel:[0,0] op_sel_hi:[0,1]
    v_pk_fma_f32 v[116:117], v[100:101], v[46:47], v[116:117] op_sel:[1,1,0] op_sel_hi:[1,0,1] neg_lo:[1,0,0]
    v_pk_fma_f32 v[118:119], v[102:103], v[46:47], v[118:119] op_sel:[1,1,0] op_sel_hi:[1,0,1] neg_lo:[1,0,0]
    v_pk_fma_f32 v[120:121], v[104:105], v[46:47], v[120:121] op_sel:[1,1,0] op_sel_hi:[1,0,1] neg_lo:[1,0,0]
    v_pk_mul_f32 v[122:123], v[106:107], v[46:47] op_sel:[0,0] op_sel_hi:[0,1]
    v_pk_mul_f32 v[124:125], v[108:109], v[46:47] op_sel:[0,0] op_sel_hi:[0,1]
    v_pk_mul_f32 v[126:127], v[110:111], v[46:47] op_sel:[0,0] op_sel_hi:[0,1]
    v_pk_fma_f32 v[122:123], v[106:107], v[46:47], v[122:123] op_sel:[1,1,0] op_sel_hi:[1,0,1] neg_lo:[1,0,0]
    v_pk_fma_f32 v[124:125], v[108:109], v[46:47], v[124:125] op_sel:[1,1,0] op_sel_hi:[1,0,1] neg_lo:[1,0,0]
    v_pk_fma_f32 v[126:127], v[110:111], v[46:47], v[126:127] op_sel:[1,1,0] op_sel_hi:[1,0,1] neg_lo:[1,0,0]
    v_pk_mul_f32 v[94:95], v[92:93], v[42:43] op_sel:[0,0] op_sel_hi:[0,1]
    v_cvt_pk_f16_f32 v188, v112, v114
    v_cvt_pk_f16_f32 v192, v113, v115
    v_pk_fma_f32 v[94:95], v[92:93], v[42:43], v[94:95] op_sel:[1,1,0] op_sel_hi:[1,0,1] neg_lo:[1,0,0]
    v_cvt_pk_f16_f32 v189, v116, v118
    v_cvt_pk_f16_f32 v193, v117, v119
    v_cvt_pk_f16_f32 v190, v120, v122
    v_cvt_pk_f16_f32 v194, v121, v123
    v_cvt_pk_f16_f32 v191, v124, v126
    v_cvt_pk_f16_f32 v195, v125, v127
    v_pk_mul_f32 v[130:131], v[100:101], v[128:129] op_sel:[0,0] op_sel_hi:[0,1]
    ds_write_b128 v7, v[188:191] offset:48
    ds_write_b128 v7, v[192:195] offset:176
    v_pk_fma_f32 v[130:131], v[100:101], v[128:129], v[130:131] op_sel:[1,1,0] op_sel_hi:[1,0,1] neg_lo:[1,0,0]
    v_pk_mul_f32 v[132:133], v[104:105], v[128:129] op_sel:[0,0] op_sel_hi:[0,1]
    v_pk_mul_f32 v[134:135], v[108:109], v[128:129] op_sel:[0,0] op_sel_hi:[0,1]
    v_pk_mul_f32 v[138:139], v[100:101], v[136:137] op_sel:[0,0] op_sel_hi:[0,1]
    v_pk_fma_f32 v[132:133], v[104:105], v[128:129], v[132:133] op_sel:[1,1,0] op_sel_hi:[1,0,1] neg_lo:[1,0,0]
    v_pk_fma_f32 v[134:135], v[108:109], v[128:129], v[134:135] op_sel:[1,1,0] op_sel_hi:[1,0,1] neg_lo:[1,0,0]
    v_pk_fma_f32 v[138:139], v[100:101], v[136:137], v[138:139] op_sel:[1,1,0] op_sel_hi:[1,0,1] neg_lo:[1,0,0]
    v_pk_mul_f32 v[140:141], v[104:105], v[136:137] op_sel:[0,0] op_sel_hi:[0,1]
    v_pk_mul_f32 v[142:143], v[108:109], v[136:137] op_sel:[0,0] op_sel_hi:[0,1]
    v_cvt_pk_f16_f32 v188, v80, v82
    v_pk_fma_f32 v[140:141], v[104:105], v[136:137], v[140:141] op_sel:[1,1,0] op_sel_hi:[1,0,1] neg_lo:[1,0,0]
    v_pk_fma_f32 v[142:143], v[108:109], v[136:137], v[142:143] op_sel:[1,1,0] op_sel_hi:[1,0,1] neg_lo:[1,0,0]
    v_cvt_pk_f16_f32 v192, -v81, -v83
    v_cvt_pk_f16_f32 v189, v84, v86
    v_cvt_pk_f16_f32 v193, -v85, -v87
    v_cvt_pk_f16_f32 v190, v88, v90
    v_cvt_pk_f16_f32 v194, -v89, -v91
    v_cvt_pk_f16_f32 v191, v92, v94
    v_cvt_pk_f16_f32 v195, -v93, -v95
    v_cvt_pk_f16_f32 v180, v128, v130
    ds_write_b128 v7, v[188:191] offset:16
    ds_write_b128 v7, v[192:195] offset:144
    v_cvt_pk_f16_f32 v184, v129, v131
    v_cvt_pk_f16_f32 v181, v132, v134
    v_cvt_pk_f16_f32 v185, v133, v135
    v_cvt_pk_f16_f32 v182, v136, v138
    v_cvt_pk_f16_f32 v186, v137, v139
    v_cvt_pk_f16_f32 v183, v140, v142
    v_cvt_pk_f16_f32 v187, v141, v143
    v_pk_mul_f32 v[146:147], v[104:105], v[144:145] op_sel:[0,0] op_sel_hi:[0,1]
    ds_write_b128 v7, v[180:183] offset:64
    ds_write_b128 v7, v[184:187] offset:192
    v_pk_fma_f32 v[146:147], v[104:105], v[144:145], v[146:147] op_sel:[1,1,0] op_sel_hi:[1,0,1] neg_lo:[1,0,0]
    v_pk_mul_f32 v[150:151], v[104:105], v[148:149] op_sel:[0,0] op_sel_hi:[0,1]
    v_pk_mul_f32 v[154:155], v[104:105], v[152:153] op_sel:[0,0] op_sel_hi:[0,1]
    v_pk_mul_f32 v[158:159], v[104:105], v[156:157] op_sel:[0,0] op_sel_hi:[0,1]
    v_pk_fma_f32 v[150:151], v[104:105], v[148:149], v[150:151] op_sel:[1,1,0] op_sel_hi:[1,0,1] neg_lo:[1,0,0]
    v_pk_fma_f32 v[154:155], v[104:105], v[152:153], v[154:155] op_sel:[1,1,0] op_sel_hi:[1,0,1] neg_lo:[1,0,0]
    v_pk_fma_f32 v[158:159], v[104:105], v[156:157], v[158:159] op_sel:[1,1,0] op_sel_hi:[1,0,1] neg_lo:[1,0,0]
    v_cvt_pk_f16_f32 v188, v144, v146
    v_cvt_pk_f16_f32 v192, v145, v147
    v_cvt_pk_f16_f32 v189, v148, v150
    v_cvt_pk_f16_f32 v193, v149, v151
    v_cvt_pk_f16_f32 v190, v152, v154
    v_cvt_pk_f16_f32 v194, v153, v155
    v_cvt_pk_f16_f32 v191, v156, v158
    v_cvt_pk_f16_f32 v195, v157, v159
    v_pk_mul_f32 v[162:163], v[160:161], v[112:113] op_sel:[0,0] op_sel_hi:[0,1]
    ds_write_b128 v7, v[188:191] offset:80
    ds_write_b128 v7, v[192:195] offset:208
    v_pk_fma_f32 v[162:163], v[160:161], v[112:113], v[162:163] op_sel:[1,1,0] op_sel_hi:[1,0,1] neg_lo:[1,0,0]
    v_pk_mul_f32 v[164:165], v[160:161], v[128:129] op_sel:[0,0] op_sel_hi:[0,1]
    v_pk_mul_f32 v[166:167], v[160:161], v[136:137] op_sel:[0,0] op_sel_hi:[0,1]
    v_pk_mul_f32 v[168:169], v[160:161], v[144:145] op_sel:[0,0] op_sel_hi:[0,1]
    v_pk_fma_f32 v[164:165], v[160:161], v[128:129], v[164:165] op_sel:[1,1,0] op_sel_hi:[1,0,1] neg_lo:[1,0,0]
    v_pk_fma_f32 v[166:167], v[160:161], v[136:137], v[166:167] op_sel:[1,1,0] op_sel_hi:[1,0,1] neg_lo:[1,0,0]
    v_pk_fma_f32 v[168:169], v[160:161], v[144:145], v[168:169] op_sel:[1,1,0] op_sel_hi:[1,0,1] neg_lo:[1,0,0]
    v_pk_mul_f32 v[170:171], v[160:161], v[148:149] op_sel:[0,0] op_sel_hi:[0,1]
    v_pk_mul_f32 v[172:173], v[160:161], v[152:153] op_sel:[0,0] op_sel_hi:[0,1]
    v_pk_mul_f32 v[174:175], v[160:161], v[156:157] op_sel:[0,0] op_sel_hi:[0,1]
    v_pk_fma_f32 v[170:171], v[160:161], v[148:149], v[170:171] op_sel:[1,1,0] op_sel_hi:[1,0,1] neg_lo:[1,0,0]
    v_pk_fma_f32 v[172:173], v[160:161], v[152:153], v[172:173] op_sel:[1,1,0] op_sel_hi:[1,0,1] neg_lo:[1,0,0]
    v_pk_fma_f32 v[174:175], v[160:161], v[156:157], v[174:175] op_sel:[1,1,0] op_sel_hi:[1,0,1] neg_lo:[1,0,0]
    v_pk_mul_f32 v[176:177], v[160:161], v[160:161] op_sel:[0,0] op_sel_hi:[0,1]
    v_cvt_pk_f16_f32 v180, v160, v162
    v_cvt_pk_f16_f32 v184, v161, v163
    v_pk_fma_f32 v[176:177], v[160:161], v[160:161], v[176:177] op_sel:[1,1,0] op_sel_hi:[1,0,1] neg_lo:[1,0,0]
    v_cvt_pk_f16_f32 v181, v164, v166
    v_cvt_pk_f16_f32 v185, v165, v167
    v_cvt_pk_f16_f32 v182, v168, v170
    v_cvt_pk_f16_f32 v186, v169, v171
    v_cvt_pk_f16_f32 v183, v172, v174
    v_cvt_pk_f16_f32 v187, v173, v175
    v_cvt_pk_f16_f32 v188, v176, v176
    ds_write_b128 v7, v[180:183] offset:96
    ds_write_b128 v7, v[184:187] offset:224
    v_cvt_pk_f16_f32 v192, v177, v177
    ds_write_b32 v7, v188 offset:112
    ds_write_b32 v7, v192 offset:240
    ds_read_b64_tr_b16 v[64:65], v22 offset:0
    ds_read_b64_tr_b16 v[66:67], v22 offset:128
    ds_read_b64_tr_b16 v[68:69], v22 offset:32
    ds_read_b64_tr_b16 v[70:71], v22 offset:160
    ds_read_b64_tr_b16 v[72:73], v22 offset:64
    ds_read_b64_tr_b16 v[74:75], v22 offset:192
    ds_read_b64_tr_b16 v[76:77], v22 offset:96
    ds_read_b64_tr_b16 v[78:79], v22 offset:224
    ds_read_b64_tr_b16 v[80:81], v22 offset:4352
    ds_read_b64_tr_b16 v[82:83], v22 offset:4480
    ds_read_b64_tr_b16 v[84:85], v22 offset:4384
    ds_read_b64_tr_b16 v[86:87], v22 offset:4512
    ds_read_b64_tr_b16 v[88:89], v22 offset:4416
    ds_read_b64_tr_b16 v[90:91], v22 offset:4544
    ds_read_b64_tr_b16 v[92:93], v22 offset:4448
    ds_read_b64_tr_b16 v[94:95], v22 offset:4576
    ds_read_b64_tr_b16 v[96:97], v22 offset:8704
    ds_read_b64_tr_b16 v[98:99], v22 offset:8832
    ds_read_b64_tr_b16 v[100:101], v22 offset:8736
    ds_read_b64_tr_b16 v[102:103], v22 offset:8864
    ds_read_b64_tr_b16 v[104:105], v22 offset:8768
    ds_read_b64_tr_b16 v[106:107], v22 offset:8896
    ds_read_b64_tr_b16 v[108:109], v22 offset:8800
    ds_read_b64_tr_b16 v[110:111], v22 offset:8928
    ds_read_b64_tr_b16 v[112:113], v22 offset:13056
    ds_read_b64_tr_b16 v[114:115], v22 offset:13184
    ds_read_b64_tr_b16 v[116:117], v22 offset:13088
    ds_read_b64_tr_b16 v[118:119], v22 offset:13216
    ds_read_b64_tr_b16 v[120:121], v22 offset:13120
    ds_read_b64_tr_b16 v[122:123], v22 offset:13248
    ds_read_b64_tr_b16 v[124:125], v22 offset:13152
    ds_read_b64_tr_b16 v[126:127], v22 offset:13280
    v_mul_f32 v196, 0x41000000, v27
    v_mul_f32 v197, 0x41000000, v29
    v_mul_f32 v198, 0x42000000, v27
    v_exp_f32 v196, v196
    v_fract_f32 v197, v197
    v_mul_f32 v199, 0x42000000, v29
    v_exp_f32 v198, v198
    v_cos_f32 v42, v197
    v_sin_f32 v43, v197
    v_fract_f32 v199, v199
    v_mul_f32 v42, v42, v196
    v_mul_f32 v43, v43, v196
    v_cos_f32 v44, v199
    v_sin_f32 v45, v199
    v_mul_f32 v196, 0x3f800000, v27
    v_mul_f32 v44, v44, v198
    v_mul_f32 v45, v45, v198
    v_mul_f32 v197, 0x3f800000, v29
    v_exp_f32 v196, v196
    v_mul_f32 v198, 0x43000000, v27
    v_fract_f32 v197, v197
    v_mul_f32 v199, 0x43000000, v29
    v_exp_f32 v198, v198
    v_cos_f32 v40, v197
    v_sin_f32 v41, v197
    v_fract_f32 v199, v199
    v_mul_f32 v40, v40, v196
    v_mul_f32 v41, v41, v196
    v_cos_f32 v46, v199
    v_sin_f32 v47, v199
    v_mul_f32 v46, v46, v198
    v_mul_f32 v47, v47, v198
    s_waitcnt lgkmcnt(0)
    v_mfma_f32_16x16x32_f16 v[48:51], v[64:67], v[68:71], 0
    v_mfma_f32_16x16x32_f16 v[52:55], v[64:67], v[72:75], 0
    v_mfma_f32_16x16x32_f16 v[56:59], v[64:67], v[76:79], 0
    v_mfma_f32_16x16x32_f16 v[48:51], v[80:83], v[84:87], v[48:51]
    v_mfma_f32_16x16x32_f16 v[52:55], v[80:83], v[88:91], v[52:55]
    v_mfma_f32_16x16x32_f16 v[56:59], v[80:83], v[92:95], v[56:59]
    v_mfma_f32_16x16x32_f16 v[48:51], v[96:99], v[100:103], v[48:51]
    v_mfma_f32_16x16x32_f16 v[52:55], v[96:99], v[104:107], v[52:55]
    v_mfma_f32_16x16x32_f16 v[56:59], v[96:99], v[108:111], v[56:59]
    v_mfma_f32_16x16x32_f16 v[48:51], v[112:115], v[116:119], v[48:51]
    v_mfma_f32_16x16x32_f16 v[52:55], v[112:115], v[120:123], v[52:55]
    v_mfma_f32_16x16x32_f16 v[56:59], v[112:115], v[124:127], v[56:59]
    v_mov_b32 v64, v31
    v_mov_b32 v65, v33
    v_mov_b32 v98, v40
    v_mov_b32 v99, v41
    v_mov_b32 v112, v46
    v_mov_b32 v113, v47
    v_pk_mul_f32 v[72:73], v[64:65], v[44:45] op_sel:[0,0] op_sel_hi:[0,1]
    v_pk_mul_f32 v[100:101], v[40:41], v[40:41] op_sel:[0,0] op_sel_hi:[0,1]
    v_pk_mul_f32 v[128:129], v[46:47], v[46:47] op_sel:[0,0] op_sel_hi:[0,1]
    v_pk_fma_f32 v[72:73], v[64:65], v[44:45], v[72:73] op_sel:[1,1,0] op_sel_hi:[1,0,1] neg_lo:[1,0,0]
    v_pk_fma_f32 v[100:101], v[40:41], v[40:41], v[100:101] op_sel:[1,1,0] op_sel_hi:[1,0,1] neg_lo:[1,0,0]
    v_pk_fma_f32 v[128:129], v[46:47], v[46:47], v[128:129] op_sel:[1,1,0] op_sel_hi:[1,0,1] neg_lo:[1,0,0]
    v_pk_mul_f32 v[66:67], v[64:65], v[42:43] op_sel:[0,0] op_sel_hi:[0,1]
    v_pk_mul_f32 v[80:81], v[72:73], v[44:45] op_sel:[0,0] op_sel_hi:[0,1]
    v_pk_mul_f32 v[102:103], v[100:101], v[40:41] op_sel:[0,0] op_sel_hi:[0,1]
    v_pk_fma_f32 v[66:67], v[64:65], v[42:43], v[66:67] op_sel:[1,1,0] op_sel_hi:[1,0,1] neg_lo:[1,0,0]
    v_pk_fma_f32 v[80:81], v[72:73], v[44:45], v[80:81] op_sel:[1,1,0] op_sel_hi:[1,0,1] neg_lo:[1,0,0]
    v_pk_fma_f32 v[102:103], v[100:101], v[40:41], v[102:103] op_sel:[1,1,0] op_sel_hi:[1,0,1] neg_lo:[1,0,0]
    v_pk_mul_f32 v[104:105], v[100:101], v[100:101] op_sel:[0,0] op_sel_hi:[0,1]
    v_pk_mul_f32 v[136:137], v[128:129], v[46:47] op_sel:[0,0] op_sel_hi:[0,1]
    v_pk_mul_f32 v[144:145], v[128:129], v[128:129] op_sel:[0,0] op_sel_hi:[0,1]
    v_pk_fma_f32 v[104:105], v[100:101], v[100:101], v[104:105] op_sel:[1,1,0] op_sel_hi:[1,0,1] neg_lo:[1,0,0]
    v_pk_fma_f32 v[136:137], v[128:129], v[46:47], v[136:137] op_sel:[1,1,0] op_sel_hi:[1,0,1] neg_lo:[1,0,0]
    v_pk_fma_f32 v[144:145], v[128:129], v[128:129], v[144:145] op_sel:[1,1,0] op_sel_hi:[1,0,1] neg_lo:[1,0,0]
    v_pk_mul_f32 v[68:69], v[66:67], v[42:43] op_sel:[0,0] op_sel_hi:[0,1]
    v_pk_mul_f32 v[74:75], v[72:73], v[42:43] op_sel:[0,0] op_sel_hi:[0,1]
    v_pk_mul_f32 v[88:89], v[80:81], v[44:45] op_sel:[0,0] op_sel_hi:[0,1]
    v_pk_fma_f32 v[68:69], v[66:67], v[42:43], v[68:69] op_sel:[1,1,0] op_sel_hi:[1,0,1] neg_lo:[1,0,0]
    v_pk_fma_f32 v[74:75], v[72:73], v[42:43], v[74:75] op_sel:[1,1,0] op_sel_hi:[1,0,1] neg_lo:[1,0,0]
    v_pk_fma_f32 v[88:89], v[80:81], v[44:45], v[88:89] op_sel:[1,1,0] op_sel_hi:[1,0,1] neg_lo:[1,0,0]
    v_pk_mul_f32 v[70:71], v[68:69], v[42:43] op_sel:[0,0] op_sel_hi:[0,1]
    v_pk_mul_f32 v[76:77], v[74:75], v[42:43] op_sel:[0,0] op_sel_hi:[0,1]
    v_pk_mul_f32 v[82:83], v[80:81], v[42:43] op_sel:[0,0] op_sel_hi:[0,1]
    v_pk_fma_f32 v[70:71], v[68:69], v[42:43], v[70:71] op_sel:[1,1,0] op_sel_hi:[1,0,1] neg_lo:[1,0,0]
    v_pk_fma_f32 v[76:77], v[74:75], v[42:43], v[76:77] op_sel:[1,1,0] op_sel_hi:[1,0,1] neg_lo:[1,0,0]
    v_pk_fma_f32 v[82:83], v[80:81], v[42:43], v[82:83] op_sel:[1,1,0] op_sel_hi:[1,0,1] neg_lo:[1,0,0]
    v_pk_mul_f32 v[106:107], v[104:105], v[40:41] op_sel:[0,0] op_sel_hi:[0,1]
    v_pk_mul_f32 v[108:109], v[104:105], v[100:101] op_sel:[0,0] op_sel_hi:[0,1]
    v_pk_mul_f32 v[110:111], v[104:105], v[102:103] op_sel:[0,0] op_sel_hi:[0,1]
    v_pk_fma_f32 v[106:107], v[104:105], v[40:41], v[106:107] op_sel:[1,1,0] op_sel_hi:[1,0,1] neg_lo:[1,0,0]
    v_pk_fma_f32 v[108:109], v[104:105], v[100:101], v[108:109] op_sel:[1,1,0] op_sel_hi:[1,0,1] neg_lo:[1,0,0]
    v_pk_fma_f32 v[110:111], v[104:105], v[102:103], v[110:111] op_sel:[1,1,0] op_sel_hi:[1,0,1] neg_lo:[1,0,0]
    v_pk_mul_f32 v[78:79], v[76:77], v[42:43] op_sel:[0,0] op_sel_hi:[0,1]
    v_pk_mul_f32 v[84:85], v[82:83], v[42:43] op_sel:[0,0] op_sel_hi:[0,1]
    v_pk_mul_f32 v[90:91], v[88:89], v[42:43] op_sel:[0,0] op_sel_hi:[0,1]
    v_pk_fma_f32 v[78:79], v[76:77], v[42:43], v[78:79] op_sel:[1,1,0] op_sel_hi:[1,0,1] neg_lo:[1,0,0]
    v_pk_fma_f32 v[84:85], v[82:83], v[42:43], v[84:85] op_sel:[1,1,0] op_sel_hi:[1,0,1] neg_lo:[1,0,0]
    v_pk_fma_f32 v[90:91], v[88:89], v[42:43], v[90:91] op_sel:[1,1,0] op_sel_hi:[1,0,1] neg_lo:[1,0,0]
    v_pk_mul_f32 v[148:149], v[144:145], v[46:47] op_sel:[0,0] op_sel_hi:[0,1]
    v_pk_mul_f32 v[152:153], v[144:145], v[128:129] op_sel:[0,0] op_sel_hi:[0,1]
    v_pk_mul_f32 v[156:157], v[144:145], v[136:137] op_sel:[0,0] op_sel_hi:[0,1]
    v_pk_fma_f32 v[148:149], v[144:145], v[46:47], v[148:149] op_sel:[1,1,0] op_sel_hi:[1,0,1] neg_lo:[1,0,0]
    v_pk_fma_f32 v[152:153], v[144:145], v[128:129], v[152:153] op_sel:[1,1,0] op_sel_hi:[1,0,1] neg_lo:[1,0,0]
    v_pk_fma_f32 v[156:157], v[144:145], v[136:137], v[156:157] op_sel:[1,1,0] op_sel_hi:[1,0,1] neg_lo:[1,0,0]
    v_pk_mul_f32 v[160:161], v[144:145], v[144:145] op_sel:[0,0] op_sel_hi:[0,1]
    v_cvt_pk_f16_f32 v180, v64, v66
    v_cvt_pk_f16_f32 v184, -v65, -v67
    v_pk_fma_f32 v[160:161], v[144:145], v[144:145], v[160:161] op_sel:[1,1,0] op_sel_hi:[1,0,1] neg_lo:[1,0,0]
    v_cvt_pk_f16_f32 v181, v68, v70
    v_cvt_pk_f16_f32 v185, -v69, -v71
    v_cvt_pk_f16_f32 v182, v72, v74
    v_cvt_pk_f16_f32 v186, -v73, -v75
    v_cvt_pk_f16_f32 v183, v76, v78
    v_cvt_pk_f16_f32 v187, -v77, -v79
    v_pk_mul_f32 v[86:87], v[84:85], v[42:43] op_sel:[0,0] op_sel_hi:[0,1]
    ds_write_b128 v7, v[180:183] offset:0
    ds_write_b128 v7, v[184:187] offset:128
    v_pk_fma_f32 v[86:87], v[84:85], v[42:43], v[86:87] op_sel:[1,1,0] op_sel_hi:[1,0,1] neg_lo:[1,0,0]
    v_pk_mul_f32 v[92:93], v[90:91], v[42:43] op_sel:[0,0] op_sel_hi:[0,1]
    v_cvt_pk_f16_f32 v180, v60, v98
    v_cvt_pk_f16_f32 v184, v61, v99
    v_pk_fma_f32 v[92:93], v[90:91], v[42:43], v[92:93] op_sel:[1,1,0] op_sel_hi:[1,0,1] neg_lo:[1,0,0]
    v_cvt_pk_f16_f32 v181, v100, v102
    v_cvt_pk_f16_f32 v185, v101, v103
    v_cvt_pk_f16_f32 v182, v104, v106
    v_cvt_pk_f16_f32 v186, v105, v107
    v_cvt_pk_f16_f32 v183, v108, v110
    v_cvt_pk_f16_f32 v187, v109, v111
    v_pk_mul_f32 v[114:115], v[98:99], v[46:47] op_sel:[0,0] op_sel_hi:[0,1]
    ds_write_b128 v7, v[180:183] offset:32
    ds_write_b128 v7, v[184:187] offset:160
    v_pk_fma_f32 v[114:115], v[98:99], v[46:47], v[114:115] op_sel:[1,1,0] op_sel_hi:[1,0,1] neg_lo:[1,0,0]
    v_pk_mul_f32 v[116:117], v[100:101], v[46:47] op_sel:[0,0] op_sel_hi:[0,1]
    v_pk_mul_f32 v[118:119], v[102:103], v[46:47] op_sel:[0,0] op_sel_hi:[0,1]
    v_pk_mul_f32 v[120:121], v[104:105], v[46:47] op_sel:[0,0] op_sel_hi:[0,1]
    v_pk_fma_f32 v[116:117], v[100:101], v[46:47], v[116:117] op_sel:[1,1,0] op_sel_hi:[1,0,1] neg_lo:[1,0,0]
    v_pk_fma_f32 v[118:119], v[102:103], v[46:47], v[118:119] op_sel:[1,1,0] op_sel_hi:[1,0,1] neg_lo:[1,0,0]
    v_pk_fma_f32 v[120:121], v[104:105], v[46:47], v[120:121] op_sel:[1,1,0] op_sel_hi:[1,0,1] neg_lo:[1,0,0]
    v_pk_mul_f32 v[122:123], v[106:107], v[46:47] op_sel:[0,0] op_sel_hi:[0,1]
    v_pk_mul_f32 v[124:125], v[108:109], v[46:47] op_sel:[0,0] op_sel_hi:[0,1]
    v_pk_mul_f32 v[126:127], v[110:111], v[46:47] op_sel:[0,0] op_sel_hi:[0,1]
    v_pk_fma_f32 v[122:123], v[106:107], v[46:47], v[122:123] op_sel:[1,1,0] op_sel_hi:[1,0,1] neg_lo:[1,0,0]
    v_pk_fma_f32 v[124:125], v[108:109], v[46:47], v[124:125] op_sel:[1,1,0] op_sel_hi:[1,0,1] neg_lo:[1,0,0]
    v_pk_fma_f32 v[126:127], v[110:111], v[46:47], v[126:127] op_sel:[1,1,0] op_sel_hi:[1,0,1] neg_lo:[1,0,0]
    v_pk_mul_f32 v[94:95], v[92:93], v[42:43] op_sel:[0,0] op_sel_hi:[0,1]
    v_cvt_pk_f16_f32 v188, v112, v114
    v_cvt_pk_f16_f32 v192, v113, v115
    v_pk_fma_f32 v[94:95], v[92:93], v[42:43], v[94:95] op_sel:[1,1,0] op_sel_hi:[1,0,1] neg_lo:[1,0,0]
    v_cvt_pk_f16_f32 v189, v116, v118
    v_cvt_pk_f16_f32 v193, v117, v119
    v_cvt_pk_f16_f32 v190, v120, v122
    v_cvt_pk_f16_f32 v194, v121, v123
    v_cvt_pk_f16_f32 v191, v124, v126
    v_cvt_pk_f16_f32 v195, v125, v127
    v_pk_mul_f32 v[130:131], v[100:101], v[128:129] op_sel:[0,0] op_sel_hi:[0,1]
    ds_write_b128 v7, v[188:191] offset:48
    ds_write_b128 v7, v[192:195] offset:176
    v_pk_fma_f32 v[130:131], v[100:101], v[128:129], v[130:131] op_sel:[1,1,0] op_sel_hi:[1,0,1] neg_lo:[1,0,0]
    v_pk_mul_f32 v[132:133], v[104:105], v[128:129] op_sel:[0,0] op_sel_hi:[0,1]
    v_pk_mul_f32 v[134:135], v[108:109], v[128:129] op_sel:[0,0] op_sel_hi:[0,1]
    v_pk_mul_f32 v[138:139], v[100:101], v[136:137] op_sel:[0,0] op_sel_hi:[0,1]
    v_pk_fma_f32 v[132:133], v[104:105], v[128:129], v[132:133] op_sel:[1,1,0] op_sel_hi:[1,0,1] neg_lo:[1,0,0]
    v_pk_fma_f32 v[134:135], v[108:109], v[128:129], v[134:135] op_sel:[1,1,0] op_sel_hi:[1,0,1] neg_lo:[1,0,0]
    v_pk_fma_f32 v[138:139], v[100:101], v[136:137], v[138:139] op_sel:[1,1,0] op_sel_hi:[1,0,1] neg_lo:[1,0,0]
    v_pk_mul_f32 v[140:141], v[104:105], v[136:137] op_sel:[0,0] op_sel_hi:[0,1]
    v_pk_mul_f32 v[142:143], v[108:109], v[136:137] op_sel:[0,0] op_sel_hi:[0,1]
    v_cvt_pk_f16_f32 v188, v80, v82
    v_pk_fma_f32 v[140:141], v[104:105], v[136:137], v[140:141] op_sel:[1,1,0] op_sel_hi:[1,0,1] neg_lo:[1,0,0]
    v_pk_fma_f32 v[142:143], v[108:109], v[136:137], v[142:143] op_sel:[1,1,0] op_sel_hi:[1,0,1] neg_lo:[1,0,0]
    v_cvt_pk_f16_f32 v192, -v81, -v83
    v_cvt_pk_f16_f32 v189, v84, v86
    v_cvt_pk_f16_f32 v193, -v85, -v87
    v_cvt_pk_f16_f32 v190, v88, v90
    v_cvt_pk_f16_f32 v194, -v89, -v91
    v_cvt_pk_f16_f32 v191, v92, v94
    v_cvt_pk_f16_f32 v195, -v93, -v95
    v_cvt_pk_f16_f32 v180, v128, v130
    ds_write_b128 v7, v[188:191] offset:16
    ds_write_b128 v7, v[192:195] offset:144
    v_cvt_pk_f16_f32 v184, v129, v131
    v_cvt_pk_f16_f32 v181, v132, v134
    v_cvt_pk_f16_f32 v185, v133, v135
    v_cvt_pk_f16_f32 v182, v136, v138
    v_cvt_pk_f16_f32 v186, v137, v139
    v_cvt_pk_f16_f32 v183, v140, v142
    v_cvt_pk_f16_f32 v187, v141, v143
    v_pk_mul_f32 v[146:147], v[104:105], v[144:145] op_sel:[0,0] op_sel_hi:[0,1]
    ds_write_b128 v7, v[180:183] offset:64
    ds_write_b128 v7, v[184:187] offset:192
    v_pk_fma_f32 v[146:147], v[104:105], v[144:145], v[146:147] op_sel:[1,1,0] op_sel_hi:[1,0,1] neg_lo:[1,0,0]
    v_pk_mul_f32 v[150:151], v[104:105], v[148:149] op_sel:[0,0] op_sel_hi:[0,1]
    v_pk_mul_f32 v[154:155], v[104:105], v[152:153] op_sel:[0,0] op_sel_hi:[0,1]
    v_pk_mul_f32 v[158:159], v[104:105], v[156:157] op_sel:[0,0] op_sel_hi:[0,1]
    v_pk_fma_f32 v[150:151], v[104:105], v[148:149], v[150:151] op_sel:[1,1,0] op_sel_hi:[1,0,1] neg_lo:[1,0,0]
    v_pk_fma_f32 v[154:155], v[104:105], v[152:153], v[154:155] op_sel:[1,1,0] op_sel_hi:[1,0,1] neg_lo:[1,0,0]
    v_pk_fma_f32 v[158:159], v[104:105], v[156:157], v[158:159] op_sel:[1,1,0] op_sel_hi:[1,0,1] neg_lo:[1,0,0]
    v_cvt_pk_f16_f32 v188, v144, v146
    v_cvt_pk_f16_f32 v192, v145, v147
    v_cvt_pk_f16_f32 v189, v148, v150
    v_cvt_pk_f16_f32 v193, v149, v151
    v_cvt_pk_f16_f32 v190, v152, v154
    v_cvt_pk_f16_f32 v194, v153, v155
    v_cvt_pk_f16_f32 v191, v156, v158
    v_cvt_pk_f16_f32 v195, v157, v159
    v_pk_mul_f32 v[162:163], v[160:161], v[112:113] op_sel:[0,0] op_sel_hi:[0,1]
    ds_write_b128 v7, v[188:191] offset:80
    ds_write_b128 v7, v[192:195] offset:208
    v_pk_fma_f32 v[162:163], v[160:161], v[112:113], v[162:163] op_sel:[1,1,0] op_sel_hi:[1,0,1] neg_lo:[1,0,0]
    v_pk_mul_f32 v[164:165], v[160:161], v[128:129] op_sel:[0,0] op_sel_hi:[0,1]
    v_pk_mul_f32 v[166:167], v[160:161], v[136:137] op_sel:[0,0] op_sel_hi:[0,1]
    v_pk_mul_f32 v[168:169], v[160:161], v[144:145] op_sel:[0,0] op_sel_hi:[0,1]
    v_pk_fma_f32 v[164:165], v[160:161], v[128:129], v[164:165] op_sel:[1,1,0] op_sel_hi:[1,0,1] neg_lo:[1,0,0]
    v_pk_fma_f32 v[166:167], v[160:161], v[136:137], v[166:167] op_sel:[1,1,0] op_sel_hi:[1,0,1] neg_lo:[1,0,0]
    v_pk_fma_f32 v[168:169], v[160:161], v[144:145], v[168:169] op_sel:[1,1,0] op_sel_hi:[1,0,1] neg_lo:[1,0,0]
    v_pk_mul_f32 v[170:171], v[160:161], v[148:149] op_sel:[0,0] op_sel_hi:[0,1]
    v_pk_mul_f32 v[172:173], v[160:161], v[152:153] op_sel:[0,0] op_sel_hi:[0,1]
    v_pk_mul_f32 v[174:175], v[160:161], v[156:157] op_sel:[0,0] op_sel_hi:[0,1]
    v_pk_fma_f32 v[170:171], v[160:161], v[148:149], v[170:171] op_sel:[1,1,0] op_sel_hi:[1,0,1] neg_lo:[1,0,0]
    v_pk_fma_f32 v[172:173], v[160:161], v[152:153], v[172:173] op_sel:[1,1,0] op_sel_hi:[1,0,1] neg_lo:[1,0,0]
    v_pk_fma_f32 v[174:175], v[160:161], v[156:157], v[174:175] op_sel:[1,1,0] op_sel_hi:[1,0,1] neg_lo:[1,0,0]
    v_pk_mul_f32 v[176:177], v[160:161], v[160:161] op_sel:[0,0] op_sel_hi:[0,1]
    v_cvt_pk_f16_f32 v180, v160, v162
    v_cvt_pk_f16_f32 v184, v161, v163
    v_pk_fma_f32 v[176:177], v[160:161], v[160:161], v[176:177] op_sel:[1,1,0] op_sel_hi:[1,0,1] neg_lo:[1,0,0]
    v_cvt_pk_f16_f32 v181, v164, v166
    v_cvt_pk_f16_f32 v185, v165, v167
    v_cvt_pk_f16_f32 v182, v168, v170
    v_cvt_pk_f16_f32 v186, v169, v171
    v_cvt_pk_f16_f32 v183, v172, v174
    v_cvt_pk_f16_f32 v187, v173, v175
    v_cvt_pk_f16_f32 v188, v176, v176
    ds_write_b128 v7, v[180:183] offset:96
    ds_write_b128 v7, v[184:187] offset:224
    v_cvt_pk_f16_f32 v192, v177, v177
    ds_write_b32 v7, v188 offset:112
    ds_write_b32 v7, v192 offset:240
    ds_read_b64_tr_b16 v[64:65], v22 offset:0
    ds_read_b64_tr_b16 v[66:67], v22 offset:128
    ds_read_b64_tr_b16 v[68:69], v22 offset:32
    ds_read_b64_tr_b16 v[70:71], v22 offset:160
    ds_read_b64_tr_b16 v[72:73], v22 offset:64
    ds_read_b64_tr_b16 v[74:75], v22 offset:192
    ds_read_b64_tr_b16 v[76:77], v22 offset:96
    ds_read_b64_tr_b16 v[78:79], v22 offset:224
    ds_read_b64_tr_b16 v[80:81], v22 offset:4352
    ds_read_b64_tr_b16 v[82:83], v22 offset:4480
    ds_read_b64_tr_b16 v[84:85], v22 offset:4384
    ds_read_b64_tr_b16 v[86:87], v22 offset:4512
    ds_read_b64_tr_b16 v[88:89], v22 offset:4416
    ds_read_b64_tr_b16 v[90:91], v22 offset:4544
    ds_read_b64_tr_b16 v[92:93], v22 offset:4448
    ds_read_b64_tr_b16 v[94:95], v22 offset:4576
    ds_read_b64_tr_b16 v[96:97], v22 offset:8704
    ds_read_b64_tr_b16 v[98:99], v22 offset:8832
    ds_read_b64_tr_b16 v[100:101], v22 offset:8736
    ds_read_b64_tr_b16 v[102:103], v22 offset:8864
    ds_read_b64_tr_b16 v[104:105], v22 offset:8768
    ds_read_b64_tr_b16 v[106:107], v22 offset:8896
    ds_read_b64_tr_b16 v[108:109], v22 offset:8800
    ds_read_b64_tr_b16 v[110:111], v22 offset:8928
    ds_read_b64_tr_b16 v[112:113], v22 offset:13056
    ds_read_b64_tr_b16 v[114:115], v22 offset:13184
    ds_read_b64_tr_b16 v[116:117], v22 offset:13088
    ds_read_b64_tr_b16 v[118:119], v22 offset:13216
    ds_read_b64_tr_b16 v[120:121], v22 offset:13120
    ds_read_b64_tr_b16 v[122:123], v22 offset:13248
    ds_read_b64_tr_b16 v[124:125], v22 offset:13152
    ds_read_b64_tr_b16 v[126:127], v22 offset:13280
    s_waitcnt lgkmcnt(0)
    v_mfma_f32_16x16x32_f16 v[48:51], v[64:67], v[68:71], v[48:51]
    v_mfma_f32_16x16x32_f16 v[52:55], v[64:67], v[72:75], v[52:55]
    v_mfma_f32_16x16x32_f16 v[56:59], v[64:67], v[76:79], v[56:59]
    v_mfma_f32_16x16x32_f16 v[48:51], v[80:83], v[84:87], v[48:51]
    v_mfma_f32_16x16x32_f16 v[52:55], v[80:83], v[88:91], v[52:55]
    v_mfma_f32_16x16x32_f16 v[56:59], v[80:83], v[92:95], v[56:59]
    v_mfma_f32_16x16x32_f16 v[48:51], v[96:99], v[100:103], v[48:51]
    v_mfma_f32_16x16x32_f16 v[52:55], v[96:99], v[104:107], v[52:55]
    v_mfma_f32_16x16x32_f16 v[56:59], v[96:99], v[108:111], v[56:59]
    v_mfma_f32_16x16x32_f16 v[48:51], v[112:115], v[116:119], v[48:51]
    v_mfma_f32_16x16x32_f16 v[52:55], v[112:115], v[120:123], v[52:55]
    v_mfma_f32_16x16x32_f16 v[56:59], v[112:115], v[124:127], v[56:59]
    v_mov_b32 v180, 0
    v_mov_b32 v181, 0
    v_mov_b32 v182, 0
    v_mov_b32 v183, 0
    s_add_u32 s48, s43, 128
    v_mov_b32 v184, s48
    ds_write_b16 v184, v180
    v_lshlrev_b32 v41, 4, v1
    v_add_u32 v41, s43, v41
    v_min_u32 v42, 3, v1
    v_lshlrev_b32 v42, 4, v42
    v_add_u32 v42, s43, v42
    ds_write_b128 v42, v[180:183] offset:8704
    ds_write_b128 v42, v[180:183] offset:12864
    v_ldexp_f32 v48, v48, v34
    v_ldexp_f32 v49, v49, v34
    v_ldexp_f32 v50, v50, v34
    v_ldexp_f32 v51, v51, v34
    v_cvt_pk_bf16_f32 v48, v48, v49
    ds_write_b16 v200, v48
    ds_write_b16_d16_hi v201, v48
    v_cvt_pk_bf16_f32 v50, v50, v51
    ds_write_b16 v202, v50
    ds_write_b16_d16_hi v203, v50
    v_ldexp_f32 v52, v52, v34
    v_ldexp_f32 v53, v53, v34
    v_ldexp_f32 v54, v54, v34
    v_ldexp_f32 v55, v55, v34
    v_cvt_pk_bf16_f32 v52, v52, v53
    ds_write_b16 v204, v52
    ds_write_b16_d16_hi v205, v52
    v_cvt_pk_bf16_f32 v54, v54, v55
    ds_write_b16 v206, v54
    ds_write_b16_d16_hi v207, v54
    v_ldexp_f32 v56, v56, v34
    v_ldexp_f32 v57, v57, v34
    v_ldexp_f32 v58, v58, v34
    v_ldexp_f32 v59, v59, v34
    v_cvt_pk_bf16_f32 v56, v56, v57
    ds_write_b16 v208, v56
    ds_write_b16_d16_hi v209, v56
    v_cvt_pk_bf16_f32 v58, v58, v59
    ds_write_b16 v210, v58
    ds_write_b16_d16_hi v211, v58
    ds_read_u16 v100, v212
    ds_read_u16 v101, v213
    ds_read_u16 v102, v214
    ds_read_u16 v103, v215
    ds_read_u16 v104, v216
    ds_read_u16 v105, v217
    ds_read_u16 v106, v218
    ds_read_u16 v107, v219
    ds_read_u16 v108, v220
    ds_read_u16 v110, v221
    ds_read_u16 v111, v222
    ds_read_u16 v112, v223
    ds_read_u16 v113, v224
    ds_read_u16 v114, v225
    ds_read_u16 v115, v226
    ds_read_u16 v116, v227
    ds_read_u16 v117, v228
    ds_read_u16 v118, v229
    ds_read_u16 v120, v230
    ds_read_u16 v121, v231
    ds_read_u16 v122, v232
    ds_read_u16 v123, v233
    ds_read_u16 v124, v234
    ds_read_u16 v125, v235
    ds_read_u16 v126, v236
    ds_read_u16 v127, v237
    ds_read_u16 v128, v238
    ds_read_u16 v130, v239
    ds_read_u16 v131, v240
    ds_read_u16 v132, v241
    ds_read_u16 v133, v242
    ds_read_u16 v134, v243
    ds_read_u16 v135, v244
    ds_read_u16 v136, v245
    ds_read_u16 v137, v246
    ds_read_u16 v138, v247
    v_lshlrev_b32 v40, 3, v21
    v_sub_u32 v40, v40, v20
    v_add_u32 v40, 1807, v40
    v_and_b32 v44, 1, v20
    v_cmp_eq_u32 vcc, 1, v44
    v_mov_b32 v42, 8766
    v_mov_b32 v43, 4608
    v_cndmask_b32 v42, v42, v43, vcc
    v_lshl_add_u32 v40, v40, 1, v42
    v_add_u32 v8, s43, v40
    v_subrev_u32 v9, 512, v8
    v_subrev_u32 v10, 1024, v8
    v_subrev_u32 v11, 1536, v8
    v_subrev_u32 v12, 2048, v8
    v_subrev_u32 v13, 2560, v8
    v_subrev_u32 v14, 3072, v8
    v_subrev_u32 v15, 3584, v8
    v_lshlrev_b32 v16, 5, v20
    v_lshl_add_u32 v16, v21, 4, v16
    s_add_u32 s48, s46, 32
    v_add_u32 v16, s48, v16
    s_lshl_b32 s48, s3, 6
    s_add_u32 s48, s48, s43
    v_lshlrev_b32 v17, 5, v20
    v_lshl_add_u32 v17, v21, 3, v17
    v_add_u32 v17, s48, v17
    s_waitcnt lgkmcnt(15)
    v_lshl_or_b32 v144, v101, 16, v100
    v_lshl_or_b32 v145, v103, 16, v102
    v_lshl_or_b32 v146, v105, 16, v104
    v_lshl_or_b32 v147, v107, 16, v106
    v_lshl_or_b32 v148, v102, 16, v101
    v_lshl_or_b32 v149, v104, 16, v103
    v_lshl_or_b32 v150, v106, 16, v105
    v_lshl_or_b32 v151, v108, 16, v107
    ds_write_b128 v41, v[144:147] offset:4608
    ds_write_b128 v41, v[148:151] offset:8768
    s_waitcnt lgkmcnt(15)
    v_lshl_or_b32 v152, v111, 16, v110
    v_lshl_or_b32 v153, v113, 16, v112
    v_lshl_or_b32 v154, v115, 16, v114
    v_lshl_or_b32 v155, v117, 16, v116
    v_lshl_or_b32 v156, v112, 16, v111
    v_lshl_or_b32 v157, v114, 16, v113
    v_lshl_or_b32 v158, v116, 16, v115
    v_lshl_or_b32 v159, v118, 16, v117
    ds_write_b128 v41, v[152:155] offset:5632
    ds_write_b128 v41, v[156:159] offset:9792
    s_waitcnt lgkmcnt(13)
    v_lshl_or_b32 v160, v121, 16, v120
    v_lshl_or_b32 v161, v123, 16, v122
    v_lshl_or_b32 v162, v125, 16, v124
    v_lshl_or_b32 v163, v127, 16, v126
    v_lshl_or_b32 v164, v122, 16, v121
    v_lshl_or_b32 v165, v124, 16, v123
    v_lshl_or_b32 v166, v126, 16, v125
    v_lshl_or_b32 v167, v128, 16, v127
    ds_write_b128 v41, v[160:163] offset:6656
    ds_write_b128 v41, v[164:167] offset:10816
    s_waitcnt lgkmcnt(6)
    v_lshl_or_b32 v168, v131, 16, v130
    v_lshl_or_b32 v169, v133, 16, v132
    v_lshl_or_b32 v170, v135, 16, v134
    v_lshl_or_b32 v171, v137, 16, v136
    v_lshl_or_b32 v172, v132, 16, v131
    v_lshl_or_b32 v173, v134, 16, v133
    v_lshl_or_b32 v174, v136, 16, v135
    v_lshl_or_b32 v175, v138, 16, v137
    ds_write_b128 v41, v[168:171] offset:7680
    ds_write_b128 v41, v[172:175] offset:11840
    ds_read2_b32 v[56:57], v8 offset0:112 offset1:113
    ds_read2_b32 v[58:59], v8 offset0:114 offset1:115
    ds_read2_b32 v[60:61], v9 offset0:112 offset1:113
    ds_read2_b32 v[62:63], v9 offset0:114 offset1:115
    ds_read2_b32 v[64:65], v10 offset0:112 offset1:113
    ds_read2_b32 v[66:67], v10 offset0:114 offset1:115
    ds_read2_b32 v[68:69], v11 offset0:112 offset1:113
    ds_read2_b32 v[70:71], v11 offset0:114 offset1:115
    ds_read2_b32 v[72:73], v12 offset0:112 offset1:113
    ds_read2_b32 v[74:75], v12 offset0:114 offset1:115
    ds_read2_b32 v[76:77], v13 offset0:112 offset1:113
    ds_read2_b32 v[78:79], v13 offset0:114 offset1:115
    ds_read2_b32 v[80:81], v14 offset0:112 offset1:113
    ds_read2_b32 v[82:83], v14 offset0:114 offset1:115
    ds_read2_b32 v[84:85], v15 offset0:112 offset1:113
    ds_read2_b32 v[86:87], v15 offset0:114 offset1:115
    s_waitcnt lgkmcnt(0)
    s_barrier
    s_cmp_eq_u32 s101, 0
    s_cbranch_scc0 Lci2
    s_waitcnt vmcnt(0)
    s_getreg_b32 s85, hwreg(HW_REG_XCC_ID)
    s_and_b32 s85, s85, 7
    s_lshl_b32 s84, s85, 5
    v_mov_b32 v250, s84
    v_mov_b32 v251, 1
    s_mov_b64 exec, 1
    global_atomic_add v252, v250, v251, s[28:29] sc0 sc1
    s_mov_b64 exec, -1
Lci2:
    s_setprio 2
    ds_read_b128 v[184:187], v16 offset:448
    ds_read_b128 v[188:191], v16 offset:960
    ds_read_b128 v[192:195], v16 offset:1472
    ds_read_b128 v[196:199], v16 offset:1984
    s_waitcnt lgkmcnt(0)
    v_mfma_f32_16x16x32_bf16 v[24:27], v[56:59], v[184:187], 0
    ds_read_b128 v[200:203], v16 offset:384
    v_mfma_f32_16x16x32_bf16 v[28:31], v[60:63], v[184:187], 0
    ds_read_b128 v[204:207], v16 offset:896
    v_mfma_f32_16x16x32_bf16 v[32:35], v[64:67], v[184:187], 0
    ds_read_b128 v[208:211], v16 offset:1408
    v_mfma_f32_16x16x32_bf16 v[36:39], v[68:71], v[184:187], 0
    ds_read_b128 v[212:215], v16 offset:1920
    v_mfma_f32_16x16x32_bf16 v[40:43], v[72:75], v[184:187], 0
    ds_read2_b32 v[88:89], v8 offset0:96 offset1:97
    v_mfma_f32_16x16x32_bf16 v[44:47], v[76:79], v[184:187], 0
    ds_read2_b32 v[90:91], v8 offset0:98 offset1:99
    v_mfma_f32_16x16x32_bf16 v[48:51], v[80:83], v[184:187], 0
    ds_read2_b32 v[92:93], v9 offset0:96 offset1:97
    v_mfma_f32_16x16x32_bf16 v[52:55], v[84:87], v[184:187], 0
    ds_read2_b32 v[94:95], v9 offset0:98 offset1:99
    v_mfma_f32_16x16x32_bf16 v[28:31], v[56:59], v[188:191], v[28:31]
    ds_read2_b32 v[96:97], v10 offset0:96 offset1:97
    v_mfma_f32_16x16x32_bf16 v[32:35], v[60:63], v[188:191], v[32:35]
    ds_read2_b32 v[98:99], v10 offset0:98 offset1:99
    v_mfma_f32_16x16x32_bf16 v[36:39], v[64:67], v[188:191], v[36:39]
    ds_read2_b32 v[100:101], v11 offset0:96 offset1:97
    v_mfma_f32_16x16x32_bf16 v[40:43], v[68:71], v[188:191], v[40:43]
    ds_read2_b32 v[102:103], v11 offset0:98 offset1:99
    v_mfma_f32_16x16x32_bf16 v[44:47], v[72:75], v[188:191], v[44:47]
    ds_read2_b32 v[104:105], v12 offset0:96 offset1:97
    v_mfma_f32_16x16x32_bf16 v[48:51], v[76:79], v[188:191], v[48:51]
    ds_read2_b32 v[106:107], v12 offset0:98 offset1:99
    v_mfma_f32_16x16x32_bf16 v[52:55], v[80:83], v[188:191], v[52:55]
    ds_read2_b32 v[108:109], v13 offset0:96 offset1:97
    v_mfma_f32_16x16x32_bf16 v[32:35], v[56:59], v[192:195], v[32:35]
    ds_read2_b32 v[110:111], v13 offset0:98 offset1:99
    v_mfma_f32_16x16x32_bf16 v[36:39], v[60:63], v[192:195], v[36:39]
    ds_read2_b32 v[112:113], v14 offset0:96 offset1:97
    v_mfma_f32_16x16x32_bf16 v[40:43], v[64:67], v[192:195], v[40:43]
    ds_read2_b32 v[114:115], v14 offset0:98 offset1:99
    v_mfma_f32_16x16x32_bf16 v[44:47], v[68:71], v[192:195], v[44:47]
    ds_read2_b32 v[116:117], v15 offset0:96 offset1:97
    v_mfma_f32_16x16x32_bf16 v[48:51], v[72:75], v[192:195], v[48:51]
    ds_read2_b32 v[118:119], v15 offset0:98 offset1:99
    v_mfma_f32_16x16x32_bf16 v[52:55], v[76:79], v[192:195], v[52:55]
    v_mfma_f32_16x16x32_bf16 v[36:39], v[56:59], v[196:199], v[36:39]
    v_mfma_f32_16x16x32_bf16 v[40:43], v[60:63], v[196:199], v[40:43]
    v_mfma_f32_16x16x32_bf16 v[44:47], v[64:67], v[196:199], v[44:47]
    v_mfma_f32_16x16x32_bf16 v[48:51], v[68:71], v[196:199], v[48:51]
    v_mfma_f32_16x16x32_bf16 v[52:55], v[72:75], v[196:199], v[52:55]
    s_waitcnt lgkmcnt(0)
    v_mfma_f32_16x16x32_bf16 v[24:27], v[88:91], v[200:203], v[24:27]
    ds_read_b128 v[184:187], v16 offset:320
    v_mfma_f32_16x16x32_bf16 v[28:31], v[92:95], v[200:203], v[28:31]
    ds_read_b128 v[188:191], v16 offset:832
    v_mfma_f32_16x16x32_bf16 v[32:35], v[96:99], v[200:203], v[32:35]
    ds_read_b128 v[192:195], v16 offset:1344
    v_mfma_f32_16x16x32_bf16 v[36:39], v[100:103], v[200:203], v[36:39]
    ds_read_b128 v[196:199], v16 offset:1856
    v_mfma_f32_16x16x32_bf16 v[40:43], v[104:107], v[200:203], v[40:43]
    ds_read2_b32 v[56:57], v8 offset0:80 offset1:81
    v_mfma_f32_16x16x32_bf16 v[44:47], v[108:111], v[200:203], v[44:47]
    ds_read2_b32 v[58:59], v8 offset0:82 offset1:83
    v_mfma_f32_16x16x32_bf16 v[48:51], v[112:115], v[200:203], v[48:51]
    ds_read2_b32 v[60:61], v9 offset0:80 offset1:81
    v_mfma_f32_16x16x32_bf16 v[52:55], v[116:119], v[200:203], v[52:55]
    ds_read2_b32 v[62:63], v9 offset0:82 offset1:83
    v_mfma_f32_16x16x32_bf16 v[28:31], v[88:91], v[204:207], v[28:31]
    ds_read2_b32 v[64:65], v10 offset0:80 offset1:81
    v_mfma_f32_16x16x32_bf16 v[32:35], v[92:95], v[204:207], v[32:35]
    ds_read2_b32 v[66:67], v10 offset0:82 offset1:83
    v_mfma_f32_16x16x32_bf16 v[36:39], v[96:99], v[204:207], v[36:39]
    ds_read2_b32 v[68:69], v11 offset0:80 offset1:81
    v_mfma_f32_16x16x32_bf16 v[40:43], v[100:103], v[204:207], v[40:43]
    ds_read2_b32 v[70:71], v11 offset0:82 offset1:83
    v_mfma_f32_16x16x32_bf16 v[44:47], v[104:107], v[204:207], v[44:47]
    ds_read2_b32 v[72:73], v12 offset0:80 offset1:81
    v_mfma_f32_16x16x32_bf16 v[48:51], v[108:111], v[204:207], v[48:51]
    ds_read2_b32 v[74:75], v12 offset0:82 offset1:83
    v_mfma_f32_16x16x32_bf16 v[52:55], v[112:115], v[204:207], v[52:55]
    ds_read2_b32 v[76:77], v13 offset0:80 offset1:81
    v_mfma_f32_16x16x32_bf16 v[32:35], v[88:91], v[208:211], v[32:35]
    ds_read2_b32 v[78:79], v13 offset0:82 offset1:83
    v_mfma_f32_16x16x32_bf16 v[36:39], v[92:95], v[208:211], v[36:39]
    ds_read2_b32 v[80:81], v14 offset0:80 offset1:81
    v_mfma_f32_16x16x32_bf16 v[40:43], v[96:99], v[208:211], v[40:43]
    ds_read2_b32 v[82:83], v14 offset0:82 offset1:83
    v_mfma_f32_16x16x32_bf16 v[44:47], v[100:103], v[208:211], v[44:47]
    ds_read2_b32 v[84:85], v15 offset0:80 offset1:81
    v_mfma_f32_16x16x32_bf16 v[48:51], v[104:107], v[208:211], v[48:51]
    ds_read2_b32 v[86:87], v15 offset0:82 offset1:83
    v_mfma_f32_16x16x32_bf16 v[52:55], v[108:111], v[208:211], v[52:55]
    v_mfma_f32_16x16x32_bf16 v[36:39], v[88:91], v[212:215], v[36:39]
    v_mfma_f32_16x16x32_bf16 v[40:43], v[92:95], v[212:215], v[40:43]
    v_mfma_f32_16x16x32_bf16 v[44:47], v[96:99], v[212:215], v[44:47]
    v_mfma_f32_16x16x32_bf16 v[48:51], v[100:103], v[212:215], v[48:51]
    v_mfma_f32_16x16x32_bf16 v[52:55], v[104:107], v[212:215], v[52:55]
    s_waitcnt lgkmcnt(0)
    v_mfma_f32_16x16x32_bf16 v[24:27], v[56:59], v[184:187], v[24:27]
    ds_read_b128 v[200:203], v16 offset:256
    v_mfma_f32_16x16x32_bf16 v[28:31], v[60:63], v[184:187], v[28:31]
    ds_read_b128 v[204:207], v16 offset:768
    v_mfma_f32_16x16x32_bf16 v[32:35], v[64:67], v[184:187], v[32:35]
    ds_read_b128 v[208:211], v16 offset:1280
    v_mfma_f32_16x16x32_bf16 v[36:39], v[68:71], v[184:187], v[36:39]
    ds_read_b128 v[212:215], v16 offset:1792
    v_mfma_f32_16x16x32_bf16 v[40:43], v[72:75], v[184:187], v[40:43]
    ds_read2_b32 v[88:89], v8 offset0:64 offset1:65
    v_mfma_f32_16x16x32_bf16 v[44:47], v[76:79], v[184:187], v[44:47]
    ds_read2_b32 v[90:91], v8 offset0:66 offset1:67
    v_mfma_f32_16x16x32_bf16 v[48:51], v[80:83], v[184:187], v[48:51]
    ds_read2_b32 v[92:93], v9 offset0:64 offset1:65
    v_mfma_f32_16x16x32_bf16 v[52:55], v[84:87], v[184:187], v[52:55]
    ds_read2_b32 v[94:95], v9 offset0:66 offset1:67
    v_mfma_f32_16x16x32_bf16 v[28:31], v[56:59], v[188:191], v[28:31]
    ds_read2_b32 v[96:97], v10 offset0:64 offset1:65
    v_mfma_f32_16x16x32_bf16 v[32:35], v[60:63], v[188:191], v[32:35]
    ds_read2_b32 v[98:99], v10 offset0:66 offset1:67
    v_mfma_f32_16x16x32_bf16 v[36:39], v[64:67], v[188:191], v[36:39]
    ds_read2_b32 v[100:101], v11 offset0:64 offset1:65
    v_mfma_f32_16x16x32_bf16 v[40:43], v[68:71], v[188:191], v[40:43]
    ds_read2_b32 v[102:103], v11 offset0:66 offset1:67
    v_mfma_f32_16x16x32_bf16 v[44:47], v[72:75], v[188:191], v[44:47]
    ds_read2_b32 v[104:105], v12 offset0:64 offset1:65
    v_mfma_f32_16x16x32_bf16 v[48:51], v[76:79], v[188:191], v[48:51]
    ds_read2_b32 v[106:107], v12 offset0:66 offset1:67
    v_mfma_f32_16x16x32_bf16 v[52:55], v[80:83], v[188:191], v[52:55]
    ds_read2_b32 v[108:109], v13 offset0:64 offset1:65
    v_mfma_f32_16x16x32_bf16 v[32:35], v[56:59], v[192:195], v[32:35]
    ds_read2_b32 v[110:111], v13 offset0:66 offset1:67
    v_mfma_f32_16x16x32_bf16 v[36:39], v[60:63], v[192:195], v[36:39]
    ds_read2_b32 v[112:113], v14 offset0:64 offset1:65
    v_mfma_f32_16x16x32_bf16 v[40:43], v[64:67], v[192:195], v[40:43]
    ds_read2_b32 v[114:115], v14 offset0:66 offset1:67
    v_mfma_f32_16x16x32_bf16 v[44:47], v[68:71], v[192:195], v[44:47]
    ds_read2_b32 v[116:117], v15 offset0:64 offset1:65
    v_mfma_f32_16x16x32_bf16 v[48:51], v[72:75], v[192:195], v[48:51]
    ds_read2_b32 v[118:119], v15 offset0:66 offset1:67
    v_mfma_f32_16x16x32_bf16 v[52:55], v[76:79], v[192:195], v[52:55]
    v_mfma_f32_16x16x32_bf16 v[36:39], v[56:59], v[196:199], v[36:39]
    v_mfma_f32_16x16x32_bf16 v[40:43], v[60:63], v[196:199], v[40:43]
    v_mfma_f32_16x16x32_bf16 v[44:47], v[64:67], v[196:199], v[44:47]
    v_mfma_f32_16x16x32_bf16 v[48:51], v[68:71], v[196:199], v[48:51]
    v_mfma_f32_16x16x32_bf16 v[52:55], v[72:75], v[196:199], v[52:55]
    s_waitcnt lgkmcnt(0)
    v_mfma_f32_16x16x32_bf16 v[24:27], v[88:91], v[200:203], v[24:27]
    ds_read_b128 v[184:187], v16 offset:192
    v_mfma_f32_16x16x32_bf16 v[28:31], v[92:95], v[200:203], v[28:31]
    ds_read_b128 v[188:191], v16 offset:704
    v_mfma_f32_16x16x32_bf16 v[32:35], v[96:99], v[200:203], v[32:35]
    ds_read_b128 v[192:195], v16 offset:1216
    v_mfma_f32_16x16x32_bf16 v[36:39], v[100:103], v[200:203], v[36:39]
    ds_read_b128 v[196:199], v16 offset:1728
    v_mfma_f32_16x16x32_bf16 v[40:43], v[104:107], v[200:203], v[40:43]
    ds_read2_b32 v[56:57], v8 offset0:48 offset1:49
    v_mfma_f32_16x16x32_bf16 v[44:47], v[108:111], v[200:203], v[44:47]
    ds_read2_b32 v[58:59], v8 offset0:50 offset1:51
    v_mfma_f32_16x16x32_bf16 v[48:51], v[112:115], v[200:203], v[48:51]
    ds_read2_b32 v[60:61], v9 offset0:48 offset1:49
    v_mfma_f32_16x16x32_bf16 v[52:55], v[116:119], v[200:203], v[52:55]
    ds_read2_b32 v[62:63], v9 offset0:50 offset1:51
    v_mfma_f32_16x16x32_bf16 v[28:31], v[88:91], v[204:207], v[28:31]
    ds_read2_b32 v[64:65], v10 offset0:48 offset1:49
    v_mfma_f32_16x16x32_bf16 v[32:35], v[92:95], v[204:207], v[32:35]
    ds_read2_b32 v[66:67], v10 offset0:50 offset1:51
    v_mfma_f32_16x16x32_bf16 v[36:39], v[96:99], v[204:207], v[36:39]
    ds_read2_b32 v[68:69], v11 offset0:48 offset1:49
    v_mfma_f32_16x16x32_bf16 v[40:43], v[100:103], v[204:207], v[40:43]
    ds_read2_b32 v[70:71], v11 offset0:50 offset1:51
    v_mfma_f32_16x16x32_bf16 v[44:47], v[104:107], v[204:207], v[44:47]
    ds_read2_b32 v[72:73], v12 offset0:48 offset1:49
    v_mfma_f32_16x16x32_bf16 v[48:51], v[108:111], v[204:207], v[48:51]
    ds_read2_b32 v[74:75], v12 offset0:50 offset1:51
    v_mfma_f32_16x16x32_bf16 v[52:55], v[112:115], v[204:207], v[52:55]
    ds_read2_b32 v[76:77], v13 offset0:48 offset1:49
    v_mfma_f32_16x16x32_bf16 v[32:35], v[88:91], v[208:211], v[32:35]
    ds_read2_b32 v[78:79], v13 offset0:50 offset1:51
    v_mfma_f32_16x16x32_bf16 v[36:39], v[92:95], v[208:211], v[36:39]
    ds_read2_b32 v[80:81], v14 offset0:48 offset1:49
    v_mfma_f32_16x16x32_bf16 v[40:43], v[96:99], v[208:211], v[40:43]
    ds_read2_b32 v[82:83], v14 offset0:50 offset1:51
    v_mfma_f32_16x16x32_bf16 v[44:47], v[100:103], v[208:211], v[44:47]
    ds_read2_b32 v[84:85], v15 offset0:48 offset1:49
    v_mfma_f32_16x16x32_bf16 v[48:51], v[104:107], v[208:211], v[48:51]
    ds_read2_b32 v[86:87], v15 offset0:50 offset1:51
    v_mfma_f32_16x16x32_bf16 v[52:55], v[108:111], v[208:211], v[52:55]
    v_mfma_f32_16x16x32_bf16 v[36:39], v[88:91], v[212:215], v[36:39]
    v_mfma_f32_16x16x32_bf16 v[40:43], v[92:95], v[212:215], v[40:43]
    v_mfma_f32_16x16x32_bf16 v[44:47], v[96:99], v[212:215], v[44:47]
    v_mfma_f32_16x16x32_bf16 v[48:51], v[100:103], v[212:215], v[48:51]
    v_mfma_f32_16x16x32_bf16 v[52:55], v[104:107], v[212:215], v[52:55]
    s_waitcnt lgkmcnt(0)
    v_mfma_f32_16x16x32_bf16 v[24:27], v[56:59], v[184:187], v[24:27]
    ds_read_b128 v[200:203], v16 offset:128
    v_mfma_f32_16x16x32_bf16 v[28:31], v[60:63], v[184:187], v[28:31]
    ds_read_b128 v[204:207], v16 offset:640
    v_mfma_f32_16x16x32_bf16 v[32:35], v[64:67], v[184:187], v[32:35]
    ds_read_b128 v[208:211], v16 offset:1152
    v_mfma_f32_16x16x32_bf16 v[36:39], v[68:71], v[184:187], v[36:39]
    ds_read_b128 v[212:215], v16 offset:1664
    v_mfma_f32_16x16x32_bf16 v[40:43], v[72:75], v[184:187], v[40:43]
    ds_read2_b32 v[88:89], v8 offset0:32 offset1:33
    v_mfma_f32_16x16x32_bf16 v[44:47], v[76:79], v[184:187], v[44:47]
    ds_read2_b32 v[90:91], v8 offset0:34 offset1:35
    v_mfma_f32_16x16x32_bf16 v[48:51], v[80:83], v[184:187], v[48:51]
    ds_read2_b32 v[92:93], v9 offset0:32 offset1:33
    v_mfma_f32_16x16x32_bf16 v[52:55], v[84:87], v[184:187], v[52:55]
    ds_read2_b32 v[94:95], v9 offset0:34 offset1:35
    v_mfma_f32_16x16x32_bf16 v[28:31], v[56:59], v[188:191], v[28:31]
    ds_read2_b32 v[96:97], v10 offset0:32 offset1:33
    v_mfma_f32_16x16x32_bf16 v[32:35], v[60:63], v[188:191], v[32:35]
    ds_read2_b32 v[98:99], v10 offset0:34 offset1:35
    v_mfma_f32_16x16x32_bf16 v[36:39], v[64:67], v[188:191], v[36:39]
    ds_read2_b32 v[100:101], v11 offset0:32 offset1:33
    v_mfma_f32_16x16x32_bf16 v[40:43], v[68:71], v[188:191], v[40:43]
    ds_read2_b32 v[102:103], v11 offset0:34 offset1:35
    v_mfma_f32_16x16x32_bf16 v[44:47], v[72:75], v[188:191], v[44:47]
    ds_read2_b32 v[104:105], v12 offset0:32 offset1:33
    v_mfma_f32_16x16x32_bf16 v[48:51], v[76:79], v[188:191], v[48:51]
    ds_read2_b32 v[106:107], v12 offset0:34 offset1:35
    v_mfma_f32_16x16x32_bf16 v[52:55], v[80:83], v[188:191], v[52:55]
    ds_read2_b32 v[108:109], v13 offset0:32 offset1:33
    v_mfma_f32_16x16x32_bf16 v[32:35], v[56:59], v[192:195], v[32:35]
    ds_read2_b32 v[110:111], v13 offset0:34 offset1:35
    v_mfma_f32_16x16x32_bf16 v[36:39], v[60:63], v[192:195], v[36:39]
    ds_read2_b32 v[112:113], v14 offset0:32 offset1:33
    v_mfma_f32_16x16x32_bf16 v[40:43], v[64:67], v[192:195], v[40:43]
    ds_read2_b32 v[114:115], v14 offset0:34 offset1:35
    v_mfma_f32_16x16x32_bf16 v[44:47], v[68:71], v[192:195], v[44:47]
    ds_read2_b32 v[116:117], v15 offset0:32 offset1:33
    v_mfma_f32_16x16x32_bf16 v[48:51], v[72:75], v[192:195], v[48:51]
    ds_read2_b32 v[118:119], v15 offset0:34 offset1:35
    v_mfma_f32_16x16x32_bf16 v[52:55], v[76:79], v[192:195], v[52:55]
    v_mfma_f32_16x16x32_bf16 v[36:39], v[56:59], v[196:199], v[36:39]
    v_mfma_f32_16x16x32_bf16 v[40:43], v[60:63], v[196:199], v[40:43]
    v_mfma_f32_16x16x32_bf16 v[44:47], v[64:67], v[196:199], v[44:47]
    v_mfma_f32_16x16x32_bf16 v[48:51], v[68:71], v[196:199], v[48:51]
    v_mfma_f32_16x16x32_bf16 v[52:55], v[72:75], v[196:199], v[52:55]
    s_waitcnt lgkmcnt(0)
    v_mfma_f32_16x16x32_bf16 v[24:27], v[88:91], v[200:203], v[24:27]
    ds_read_b128 v[184:187], v16 offset:64
    v_mfma_f32_16x16x32_bf16 v[28:31], v[92:95], v[200:203], v[28:31]
    ds_read_b128 v[188:191], v16 offset:576
    v_mfma_f32_16x16x32_bf16 v[32:35], v[96:99], v[200:203], v[32:35]
    ds_read_b128 v[192:195], v16 offset:1088
    v_mfma_f32_16x16x32_bf16 v[36:39], v[100:103], v[200:203], v[36:39]
    ds_read_b128 v[196:199], v16 offset:1600
    v_mfma_f32_16x16x32_bf16 v[40:43], v[104:107], v[200:203], v[40:43]
    ds_read2_b32 v[56:57], v8 offset0:16 offset1:17
    v_mfma_f32_16x16x32_bf16 v[44:47], v[108:111], v[200:203], v[44:47]
    ds_read2_b32 v[58:59], v8 offset0:18 offset1:19
    v_mfma_f32_16x16x32_bf16 v[48:51], v[112:115], v[200:203], v[48:51]
    ds_read2_b32 v[60:61], v9 offset0:16 offset1:17
    v_mfma_f32_16x16x32_bf16 v[52:55], v[116:119], v[200:203], v[52:55]
    ds_read2_b32 v[62:63], v9 offset0:18 offset1:19
    v_mfma_f32_16x16x32_bf16 v[28:31], v[88:91], v[204:207], v[28:31]
    ds_read2_b32 v[64:65], v10 offset0:16 offset1:17
    v_mfma_f32_16x16x32_bf16 v[32:35], v[92:95], v[204:207], v[32:35]
    ds_read2_b32 v[66:67], v10 offset0:18 offset1:19
    v_mfma_f32_16x16x32_bf16 v[36:39], v[96:99], v[204:207], v[36:39]
    ds_read2_b32 v[68:69], v11 offset0:16 offset1:17
    v_mfma_f32_16x16x32_bf16 v[40:43], v[100:103], v[204:207], v[40:43]
    ds_read2_b32 v[70:71], v11 offset0:18 offset1:19
    v_mfma_f32_16x16x32_bf16 v[44:47], v[104:107], v[204:207], v[44:47]
    ds_read2_b32 v[72:73], v12 offset0:16 offset1:17
    v_mfma_f32_16x16x32_bf16 v[48:51], v[108:111], v[204:207], v[48:51]
    ds_read2_b32 v[74:75], v12 offset0:18 offset1:19
    v_mfma_f32_16x16x32_bf16 v[52:55], v[112:115], v[204:207], v[52:55]
    ds_read2_b32 v[76:77], v13 offset0:16 offset1:17
    v_mfma_f32_16x16x32_bf16 v[32:35], v[88:91], v[208:211], v[32:35]
    ds_read2_b32 v[78:79], v13 offset0:18 offset1:19
    v_mfma_f32_16x16x32_bf16 v[36:39], v[92:95], v[208:211], v[36:39]
    ds_read2_b32 v[80:81], v14 offset0:16 offset1:17
    v_mfma_f32_16x16x32_bf16 v[40:43], v[96:99], v[208:211], v[40:43]
    ds_read2_b32 v[82:83], v14 offset0:18 offset1:19
    v_mfma_f32_16x16x32_bf16 v[44:47], v[100:103], v[208:211], v[44:47]
    ds_read2_b32 v[84:85], v15 offset0:16 offset1:17
    v_mfma_f32_16x16x32_bf16 v[48:51], v[104:107], v[208:211], v[48:51]
    ds_read2_b32 v[86:87], v15 offset0:18 offset1:19
    v_mfma_f32_16x16x32_bf16 v[52:55], v[108:111], v[208:211], v[52:55]
    v_mfma_f32_16x16x32_bf16 v[36:39], v[88:91], v[212:215], v[36:39]
    v_mfma_f32_16x16x32_bf16 v[40:43], v[92:95], v[212:215], v[40:43]
    v_mfma_f32_16x16x32_bf16 v[44:47], v[96:99], v[212:215], v[44:47]
    v_mfma_f32_16x16x32_bf16 v[48:51], v[100:103], v[212:215], v[48:51]
    v_mfma_f32_16x16x32_bf16 v[52:55], v[104:107], v[212:215], v[52:55]
    s_waitcnt lgkmcnt(0)
    v_mfma_f32_16x16x32_bf16 v[24:27], v[56:59], v[184:187], v[24:27]
    ds_read_b128 v[200:203], v16 offset:0
    v_mfma_f32_16x16x32_bf16 v[28:31], v[60:63], v[184:187], v[28:31]
    ds_read_b128 v[204:207], v16 offset:512
    v_mfma_f32_16x16x32_bf16 v[32:35], v[64:67], v[184:187], v[32:35]
    ds_read_b128 v[208:211], v16 offset:1024
    v_mfma_f32_16x16x32_bf16 v[36:39], v[68:71], v[184:187], v[36:39]
    ds_read_b128 v[212:215], v16 offset:1536
    v_mfma_f32_16x16x32_bf16 v[40:43], v[72:75], v[184:187], v[40:43]
    ds_read2_b32 v[88:89], v8 offset0:0 offset1:1
    v_mfma_f32_16x16x32_bf16 v[44:47], v[76:79], v[184:187], v[44:47]
    ds_read2_b32 v[90:91], v8 offset0:2 offset1:3
    v_mfma_f32_16x16x32_bf16 v[48:51], v[80:83], v[184:187], v[48:51]
    ds_read2_b32 v[92:93], v9 offset0:0 offset1:1
    v_mfma_f32_16x16x32_bf16 v[52:55], v[84:87], v[184:187], v[52:55]
    ds_read2_b32 v[94:95], v9 offset0:2 offset1:3
    v_mfma_f32_16x16x32_bf16 v[28:31], v[56:59], v[188:191], v[28:31]
    ds_read2_b32 v[96:97], v10 offset0:0 offset1:1
    v_mfma_f32_16x16x32_bf16 v[32:35], v[60:63], v[188:191], v[32:35]
    ds_read2_b32 v[98:99], v10 offset0:2 offset1:3
    v_mfma_f32_16x16x32_bf16 v[36:39], v[64:67], v[188:191], v[36:39]
    ds_read2_b32 v[100:101], v11 offset0:0 offset1:1
    v_mfma_f32_16x16x32_bf16 v[40:43], v[68:71], v[188:191], v[40:43]
    ds_read2_b32 v[102:103], v11 offset0:2 offset1:3
    v_mfma_f32_16x16x32_bf16 v[44:47], v[72:75], v[188:191], v[44:47]
    ds_read2_b32 v[104:105], v12 offset0:0 offset1:1
    v_mfma_f32_16x16x32_bf16 v[48:51], v[76:79], v[188:191], v[48:51]
    ds_read2_b32 v[106:107], v12 offset0:2 offset1:3
    v_mfma_f32_16x16x32_bf16 v[52:55], v[80:83], v[188:191], v[52:55]
    ds_read2_b32 v[108:109], v13 offset0:0 offset1:1
    v_mfma_f32_16x16x32_bf16 v[32:35], v[56:59], v[192:195], v[32:35]
    ds_read2_b32 v[110:111], v13 offset0:2 offset1:3
    v_mfma_f32_16x16x32_bf16 v[36:39], v[60:63], v[192:195], v[36:39]
    ds_read2_b32 v[112:113], v14 offset0:0 offset1:1
    v_mfma_f32_16x16x32_bf16 v[40:43], v[64:67], v[192:195], v[40:43]
    ds_read2_b32 v[114:115], v14 offset0:2 offset1:3
    v_mfma_f32_16x16x32_bf16 v[44:47], v[68:71], v[192:195], v[44:47]
    ds_read2_b32 v[116:117], v15 offset0:0 offset1:1
    v_mfma_f32_16x16x32_bf16 v[48:51], v[72:75], v[192:195], v[48:51]
    ds_read2_b32 v[118:119], v15 offset0:2 offset1:3
    v_mfma_f32_16x16x32_bf16 v[52:55], v[76:79], v[192:195], v[52:55]
    v_mfma_f32_16x16x32_bf16 v[36:39], v[56:59], v[196:199], v[36:39]
    v_mfma_f32_16x16x32_bf16 v[40:43], v[60:63], v[196:199], v[40:43]
    v_mfma_f32_16x16x32_bf16 v[44:47], v[64:67], v[196:199], v[44:47]
    v_mfma_f32_16x16x32_bf16 v[48:51], v[68:71], v[196:199], v[48:51]
    v_mfma_f32_16x16x32_bf16 v[52:55], v[72:75], v[196:199], v[52:55]
    s_waitcnt lgkmcnt(0)
    v_mfma_f32_16x16x32_bf16 v[24:27], v[88:91], v[200:203], v[24:27]
    ds_read2_b32 v[120:121], v8 offset0:112 offset1:113
    v_mfma_f32_16x16x32_bf16 v[28:31], v[92:95], v[200:203], v[28:31]
    ds_read2_b32 v[122:123], v8 offset0:114 offset1:115
    v_mfma_f32_16x16x32_bf16 v[32:35], v[96:99], v[200:203], v[32:35]
    ds_read2_b32 v[124:125], v9 offset0:112 offset1:113
    v_mfma_f32_16x16x32_bf16 v[36:39], v[100:103], v[200:203], v[36:39]
    ds_read2_b32 v[126:127], v9 offset0:114 offset1:115
    v_mfma_f32_16x16x32_bf16 v[40:43], v[104:107], v[200:203], v[40:43]
    ds_read2_b32 v[128:129], v10 offset0:112 offset1:113
    v_mfma_f32_16x16x32_bf16 v[44:47], v[108:111], v[200:203], v[44:47]
    ds_read2_b32 v[130:131], v10 offset0:114 offset1:115
    v_mfma_f32_16x16x32_bf16 v[48:51], v[112:115], v[200:203], v[48:51]
    ds_read2_b32 v[132:133], v11 offset0:112 offset1:113
    v_mfma_f32_16x16x32_bf16 v[52:55], v[116:119], v[200:203], v[52:55]
    ds_read2_b32 v[134:135], v11 offset0:114 offset1:115
    v_mfma_f32_16x16x32_bf16 v[28:31], v[88:91], v[204:207], v[28:31]
    ds_read2_b32 v[136:137], v8 offset0:96 offset1:97
    v_mfma_f32_16x16x32_bf16 v[32:35], v[92:95], v[204:207], v[32:35]
    ds_read2_b32 v[138:139], v8 offset0:98 offset1:99
    v_mfma_f32_16x16x32_bf16 v[36:39], v[96:99], v[204:207], v[36:39]
    ds_read2_b32 v[140:141], v9 offset0:96 offset1:97
    v_mfma_f32_16x16x32_bf16 v[40:43], v[100:103], v[204:207], v[40:43]
    ds_read2_b32 v[142:143], v9 offset0:98 offset1:99
    v_mfma_f32_16x16x32_bf16 v[44:47], v[104:107], v[204:207], v[44:47]
    ds_read2_b32 v[144:145], v10 offset0:96 offset1:97
    v_mfma_f32_16x16x32_bf16 v[48:51], v[108:111], v[204:207], v[48:51]
    ds_read2_b32 v[146:147], v10 offset0:98 offset1:99
    v_mfma_f32_16x16x32_bf16 v[52:55], v[112:115], v[204:207], v[52:55]
    ds_read2_b32 v[148:149], v11 offset0:96 offset1:97
    v_mfma_f32_16x16x32_bf16 v[32:35], v[88:91], v[208:211], v[32:35]
    ds_read2_b32 v[150:151], v11 offset0:98 offset1:99
    v_mfma_f32_16x16x32_bf16 v[36:39], v[92:95], v[208:211], v[36:39]
    ds_read2_b32 v[152:153], v8 offset0:80 offset1:81
    v_mfma_f32_16x16x32_bf16 v[40:43], v[96:99], v[208:211], v[40:43]
    ds_read2_b32 v[154:155], v8 offset0:82 offset1:83
    v_mfma_f32_16x16x32_bf16 v[44:47], v[100:103], v[208:211], v[44:47]
    ds_read2_b32 v[156:157], v9 offset0:80 offset1:81
    v_mfma_f32_16x16x32_bf16 v[48:51], v[104:107], v[208:211], v[48:51]
    ds_read2_b32 v[158:159], v9 offset0:82 offset1:83
    v_mfma_f32_16x16x32_bf16 v[52:55], v[108:111], v[208:211], v[52:55]
    ds_read2_b32 v[160:161], v10 offset0:80 offset1:81
    v_mfma_f32_16x16x32_bf16 v[36:39], v[88:91], v[212:215], v[36:39]
    ds_read2_b32 v[162:163], v10 offset0:82 offset1:83
    v_mfma_f32_16x16x32_bf16 v[40:43], v[92:95], v[212:215], v[40:43]
    ds_read2_b32 v[164:165], v11 offset0:80 offset1:81
    v_mfma_f32_16x16x32_bf16 v[44:47], v[96:99], v[212:215], v[44:47]
    ds_read2_b32 v[166:167], v11 offset0:82 offset1:83
    v_mfma_f32_16x16x32_bf16 v[48:51], v[100:103], v[212:215], v[48:51]
    v_mfma_f32_16x16x32_bf16 v[52:55], v[104:107], v[212:215], v[52:55]
    s_nop 3
    v_cvt_pk_bf16_f32 v24, v24, v25
    v_cvt_pk_bf16_f32 v25, v26, v27
    ds_write_b64 v17, v[24:25] offset:0
    v_cvt_pk_bf16_f32 v28, v28, v29
    v_cvt_pk_bf16_f32 v29, v30, v31
    ds_write_b64 v17, v[28:29] offset:512
    v_cvt_pk_bf16_f32 v32, v32, v33
    v_cvt_pk_bf16_f32 v33, v34, v35
    ds_write_b64 v17, v[32:33] offset:1024
    v_cvt_pk_bf16_f32 v36, v36, v37
    v_cvt_pk_bf16_f32 v37, v38, v39
    ds_write_b64 v17, v[36:37] offset:1536
    s_waitcnt lgkmcnt(0)
    s_barrier
    ds_read_b128 v[184:187], v16 offset:2496
    ds_read_b128 v[188:191], v16 offset:3008
    ds_read_b128 v[192:195], v16 offset:3520
    ds_read_b128 v[196:199], v16 offset:4032
    ds_read_b128 v[200:203], v16 offset:2432
    ds_read_b128 v[204:207], v16 offset:2944
    ds_read_b128 v[208:211], v16 offset:3456
    ds_read_b128 v[212:215], v16 offset:3968
    ds_read_b128 v[216:219], v16 offset:2368
    ds_read_b128 v[220:223], v16 offset:2880
    ds_read_b128 v[224:227], v16 offset:3392
    ds_read_b128 v[228:231], v16 offset:3904
    s_waitcnt lgkmcnt(8)
    v_mfma_f32_16x16x32_bf16 v[40:43], v[120:123], v[184:187], v[40:43]
    ds_read_b128 v[232:235], v16 offset:2304
    ds_read_b128 v[236:239], v16 offset:2816
    v_mfma_f32_16x16x32_bf16 v[44:47], v[124:127], v[184:187], v[44:47]
    ds_read_b128 v[240:243], v16 offset:3328
    ds_read_b128 v[244:247], v16 offset:3840
    v_mfma_f32_16x16x32_bf16 v[48:51], v[128:131], v[184:187], v[48:51]
    ds_read2_b32 v[168:169], v8 offset0:64 offset1:65
    v_mfma_f32_16x16x32_bf16 v[52:55], v[132:135], v[184:187], v[52:55]
    ds_read2_b32 v[170:171], v8 offset0:66 offset1:67
    v_mfma_f32_16x16x32_bf16 v[44:47], v[120:123], v[188:191], v[44:47]
    ds_read2_b32 v[172:173], v9 offset0:64 offset1:65
    v_mfma_f32_16x16x32_bf16 v[48:51], v[124:127], v[188:191], v[48:51]
    ds_read2_b32 v[174:175], v9 offset0:66 offset1:67
    v_mfma_f32_16x16x32_bf16 v[52:55], v[128:131], v[188:191], v[52:55]
    ds_read2_b32 v[176:177], v10 offset0:64 offset1:65
    v_mfma_f32_16x16x32_bf16 v[48:51], v[120:123], v[192:195], v[48:51]
    ds_read2_b32 v[178:179], v10 offset0:66 offset1:67
    v_mfma_f32_16x16x32_bf16 v[52:55], v[124:127], v[192:195], v[52:55]
    ds_read2_b32 v[180:181], v11 offset0:64 offset1:65
    v_mfma_f32_16x16x32_bf16 v[52:55], v[120:123], v[196:199], v[52:55]
    ds_read2_b32 v[182:183], v11 offset0:66 offset1:67
    s_waitcnt lgkmcnt(15)
    v_mfma_f32_16x16x32_bf16 v[40:43], v[136:139], v[200:203], v[40:43]
    ds_read_b128 v[184:187], v16 offset:2240
    ds_read_b128 v[188:191], v16 offset:2752
    v_mfma_f32_16x16x32_bf16 v[44:47], v[140:143], v[200:203], v[44:47]
    ds_read_b128 v[192:195], v16 offset:3264
    ds_read_b128 v[196:199], v16 offset:3776
    v_mfma_f32_16x16x32_bf16 v[48:51], v[144:147], v[200:203], v[48:51]
    ds_read2_b32 v[56:57], v8 offset0:48 offset1:49
    v_mfma_f32_16x16x32_bf16 v[52:55], v[148:151], v[200:203], v[52:55]
    ds_read2_b32 v[58:59], v8 offset0:50 offset1:51
    v_mfma_f32_16x16x32_bf16 v[44:47], v[136:139], v[204:207], v[44:47]
    ds_read2_b32 v[60:61], v9 offset0:48 offset1:49
    v_mfma_f32_16x16x32_bf16 v[48:51], v[140:143], v[204:207], v[48:51]
    ds_read2_b32 v[62:63], v9 offset0:50 offset1:51
    v_mfma_f32_16x16x32_bf16 v[52:55], v[144:147], v[204:207], v[52:55]
    ds_read2_b32 v[64:65], v10 offset0:48 offset1:49
    v_mfma_f32_16x16x32_bf16 v[48:51], v[136:139], v[208:211], v[48:51]
    ds_read2_b32 v[66:67], v10 offset0:50 offset1:51
    v_mfma_f32_16x16x32_bf16 v[52:55], v[140:143], v[208:211], v[52:55]
    ds_read2_b32 v[68:69], v11 offset0:48 offset1:49
    v_mfma_f32_16x16x32_bf16 v[52:55], v[136:139], v[212:215], v[52:55]
    ds_read2_b32 v[70:71], v11 offset0:50 offset1:51
    s_waitcnt lgkmcnt(15)
    v_mfma_f32_16x16x32_bf16 v[40:43], v[152:155], v[216:219], v[40:43]
    ds_read_b128 v[200:203], v16 offset:2176
    ds_read_b128 v[204:207], v16 offset:2688
    v_mfma_f32_16x16x32_bf16 v[44:47], v[156:159], v[216:219], v[44:47]
    ds_read_b128 v[208:211], v16 offset:3200
    ds_read_b128 v[212:215], v16 offset:3712
    v_mfma_f32_16x16x32_bf16 v[48:51], v[160:163], v[216:219], v[48:51]
    ds_read2_b32 v[72:73], v8 offset0:32 offset1:33
    v_mfma_f32_16x16x32_bf16 v[52:55], v[164:167], v[216:219], v[52:55]
    ds_read2_b32 v[74:75], v8 offset0:34 offset1:35
    v_mfma_f32_16x16x32_bf16 v[44:47], v[152:155], v[220:223], v[44:47]
    ds_read2_b32 v[76:77], v9 offset0:32 offset1:33
    v_mfma_f32_16x16x32_bf16 v[48:51], v[156:159], v[220:223], v[48:51]
    ds_read2_b32 v[78:79], v9 offset0:34 offset1:35
    v_mfma_f32_16x16x32_bf16 v[52:55], v[160:163], v[220:223], v[52:55]
    ds_read2_b32 v[80:81], v10 offset0:32 offset1:33
    v_mfma_f32_16x16x32_bf16 v[48:51], v[152:155], v[224:227], v[48:51]
    ds_read2_b32 v[82:83], v10 offset0:34 offset1:35
    v_mfma_f32_16x16x32_bf16 v[52:55], v[156:159], v[224:227], v[52:55]
    ds_read2_b32 v[84:85], v11 offset0:32 offset1:33
    v_mfma_f32_16x16x32_bf16 v[52:55], v[152:155], v[228:231], v[52:55]
    ds_read2_b32 v[86:87], v11 offset0:34 offset1:35
    s_waitcnt lgkmcnt(15)
    v_mfma_f32_16x16x32_bf16 v[40:43], v[168:171], v[232:235], v[40:43]
    ds_read_b128 v[216:219], v16 offset:2112
    ds_read_b128 v[220:223], v16 offset:2624
    v_mfma_f32_16x16x32_bf16 v[44:47], v[172:175], v[232:235], v[44:47]
    ds_read_b128 v[224:227], v16 offset:3136
    ds_read_b128 v[228:231], v16 offset:3648
    v_mfma_f32_16x16x32_bf16 v[48:51], v[176:179], v[232:235], v[48:51]
    ds_read2_b32 v[88:89], v8 offset0:16 offset1:17
    v_mfma_f32_16x16x32_bf16 v[52:55], v[180:183], v[232:235], v[52:55]
    ds_read2_b32 v[90:91], v8 offset0:18 offset1:19
    v_mfma_f32_16x16x32_bf16 v[44:47], v[168:171], v[236:239], v[44:47]
    ds_read2_b32 v[92:93], v9 offset0:16 offset1:17
    v_mfma_f32_16x16x32_bf16 v[48:51], v[172:175], v[236:239], v[48:51]
    ds_read2_b32 v[94:95], v9 offset0:18 offset1:19
    v_mfma_f32_16x16x32_bf16 v[52:55], v[176:179], v[236:239], v[52:55]
    ds_read2_b32 v[96:97], v10 offset0:16 offset1:17
    v_mfma_f32_16x16x32_bf16 v[48:51], v[168:171], v[240:243], v[48:51]
    ds_read2_b32 v[98:99], v10 offset0:18 offset1:19
    v_mfma_f32_16x16x32_bf16 v[52:55], v[172:175], v[240:243], v[52:55]
    ds_read2_b32 v[100:101], v11 offset0:16 offset1:17
    v_mfma_f32_16x16x32_bf16 v[52:55], v[168:171], v[244:247], v[52:55]
    ds_read2_b32 v[102:103], v11 offset0:18 offset1:19
    s_waitcnt lgkmcnt(15)
    v_mfma_f32_16x16x32_bf16 v[40:43], v[56:59], v[184:187], v[40:43]
    ds_read_b128 v[232:235], v16 offset:2048
    ds_read_b128 v[236:239], v16 offset:2560
    v_mfma_f32_16x16x32_bf16 v[44:47], v[60:63], v[184:187], v[44:47]
    ds_read_b128 v[240:243], v16 offset:3072
    ds_read_b128 v[244:247], v16 offset:3584
    v_mfma_f32_16x16x32_bf16 v[48:51], v[64:67], v[184:187], v[48:51]
    ds_read2_b32 v[104:105], v8 offset0:0 offset1:1
    v_mfma_f32_16x16x32_bf16 v[52:55], v[68:71], v[184:187], v[52:55]
    ds_read2_b32 v[106:107], v8 offset0:2 offset1:3
    v_mfma_f32_16x16x32_bf16 v[44:47], v[56:59], v[188:191], v[44:47]
    ds_read2_b32 v[108:109], v9 offset0:0 offset1:1
    v_mfma_f32_16x16x32_bf16 v[48:51], v[60:63], v[188:191], v[48:51]
    ds_read2_b32 v[110:111], v9 offset0:2 offset1:3
    v_mfma_f32_16x16x32_bf16 v[52:55], v[64:67], v[188:191], v[52:55]
    ds_read2_b32 v[112:113], v10 offset0:0 offset1:1
    v_mfma_f32_16x16x32_bf16 v[48:51], v[56:59], v[192:195], v[48:51]
    ds_read2_b32 v[114:115], v10 offset0:2 offset1:3
    v_mfma_f32_16x16x32_bf16 v[52:55], v[60:63], v[192:195], v[52:55]
    ds_read2_b32 v[116:117], v11 offset0:0 offset1:1
    v_mfma_f32_16x16x32_bf16 v[52:55], v[56:59], v[196:199], v[52:55]
    ds_read2_b32 v[118:119], v11 offset0:2 offset1:3
    s_waitcnt lgkmcnt(15)
    v_mfma_f32_16x16x32_bf16 v[40:43], v[72:75], v[200:203], v[40:43]
    v_mfma_f32_16x16x32_bf16 v[44:47], v[76:79], v[200:203], v[44:47]
    v_mfma_f32_16x16x32_bf16 v[48:51], v[80:83], v[200:203], v[48:51]
    v_mfma_f32_16x16x32_bf16 v[52:55], v[84:87], v[200:203], v[52:55]
    v_mfma_f32_16x16x32_bf16 v[44:47], v[72:75], v[204:207], v[44:47]
    v_mfma_f32_16x16x32_bf16 v[48:51], v[76:79], v[204:207], v[48:51]
    v_mfma_f32_16x16x32_bf16 v[52:55], v[80:83], v[204:207], v[52:55]
    v_mfma_f32_16x16x32_bf16 v[48:51], v[72:75], v[208:211], v[48:51]
    v_mfma_f32_16x16x32_bf16 v[52:55], v[76:79], v[208:211], v[52:55]
    v_mfma_f32_16x16x32_bf16 v[52:55], v[72:75], v[212:215], v[52:55]
    s_waitcnt lgkmcnt(12)
    v_mfma_f32_16x16x32_bf16 v[40:43], v[88:91], v[216:219], v[40:43]
    v_mfma_f32_16x16x32_bf16 v[44:47], v[92:95], v[216:219], v[44:47]
    v_mfma_f32_16x16x32_bf16 v[48:51], v[96:99], v[216:219], v[48:51]
    v_mfma_f32_16x16x32_bf16 v[52:55], v[100:103], v[216:219], v[52:55]
    v_mfma_f32_16x16x32_bf16 v[44:47], v[88:91], v[220:223], v[44:47]
    v_mfma_f32_16x16x32_bf16 v[48:51], v[92:95], v[220:223], v[48:51]
    v_mfma_f32_16x16x32_bf16 v[52:55], v[96:99], v[220:223], v[52:55]
    v_mfma_f32_16x16x32_bf16 v[48:51], v[88:91], v[224:227], v[48:51]
    v_mfma_f32_16x16x32_bf16 v[52:55], v[92:95], v[224:227], v[52:55]
    v_mfma_f32_16x16x32_bf16 v[52:55], v[88:91], v[228:231], v[52:55]
    s_waitcnt lgkmcnt(0)
    v_mfma_f32_16x16x32_bf16 v[40:43], v[104:107], v[232:235], v[40:43]
    v_mfma_f32_16x16x32_bf16 v[44:47], v[108:111], v[232:235], v[44:47]
    v_mfma_f32_16x16x32_bf16 v[48:51], v[112:115], v[232:235], v[48:51]
    v_mfma_f32_16x16x32_bf16 v[52:55], v[116:119], v[232:235], v[52:55]
    v_mfma_f32_16x16x32_bf16 v[44:47], v[104:107], v[236:239], v[44:47]
    v_mfma_f32_16x16x32_bf16 v[48:51], v[108:111], v[236:239], v[48:51]
    v_mfma_f32_16x16x32_bf16 v[52:55], v[112:115], v[236:239], v[52:55]
    v_mfma_f32_16x16x32_bf16 v[48:51], v[104:107], v[240:243], v[48:51]
    v_mfma_f32_16x16x32_bf16 v[52:55], v[108:111], v[240:243], v[52:55]
    v_mfma_f32_16x16x32_bf16 v[52:55], v[104:107], v[244:247], v[52:55]
    s_nop 7
    v_cvt_pk_bf16_f32 v40, v40, v41
    v_cvt_pk_bf16_f32 v41, v42, v43
    ds_write_b64 v17, v[40:41] offset:2048
    v_cvt_pk_bf16_f32 v44, v44, v45
    v_cvt_pk_bf16_f32 v45, v46, v47
    ds_write_b64 v17, v[44:45] offset:2560
    v_cvt_pk_bf16_f32 v48, v48, v49
    v_cvt_pk_bf16_f32 v49, v50, v51
    ds_write_b64 v17, v[48:49] offset:3072
    v_cvt_pk_bf16_f32 v52, v52, v53
    v_cvt_pk_bf16_f32 v53, v54, v55
    ds_write_b64 v17, v[52:53] offset:3584
    s_waitcnt lgkmcnt(0)
    s_barrier
    s_setprio 0
    s_cmp_eq_u32 s101, 0
    s_cbranch_scc0 Lcf3
    s_mov_b32 s90, 0
Lcl4:
    s_waitcnt vmcnt(0)
    v_readfirstlane_b32 s84, v252
    s_add_u32 s90, s90, 1
    s_nop 3
    s_cmp_lt_u32 s84, 32
    s_cbranch_scc1 Lco5
    s_and_b32 s84, s84, 31
    s_cmp_gt_u32 s90, 8
    s_cbranch_scc1 Lco5
    s_add_u32 s85, s85, 1
    s_and_b32 s85, s85, 7
    s_lshl_b32 s84, s85, 5
    v_mov_b32 v250, s84
    s_mov_b64 exec, 1
    global_atomic_add v252, v250, v251, s[28:29] sc0 sc1
    s_mov_b64 exec, -1
    s_branch Lcl4
Lco5:
    s_lshl_b32 s84, s84, 3
    s_or_b32 s84, s84, s85
    v_mov_b32 v250, 139264
    v_mov_b32 v251, s84
    ds_write_b32 v250, v251
    s_waitcnt lgkmcnt(0)
Lcf3:
    s_barrier
    s_branch P1
Lhelp:
    s_sub_u32 s40, s3, 4
    s_lshl_b32 s41, s2, 3
    s_load_dwordx2 s[44:45], s[20:21], s41
    s_lshl_b32 s42, s40, 6
    v_add_u32 v5, s42, v1
    s_movk_i32 s42, 1152
    v_mul_lo_u32 v6, v5, s42
    v_lshlrev_b32 v8, 3, v5
    s_mov_b32 s49, 49283072
    s_mov_b32 s54, 49287168
    s_mov_b32 s55, 49291264
    s_mov_b32 s56, 49295360
    buffer_load_dwordx2 v[32:33], v6, s[32:35], s41 offen
    s_add_u32 s41, s41, 294912
    buffer_load_dwordx2 v[34:35], v6, s[32:35], s41 offen
    s_add_u32 s41, s41, 294912
    buffer_load_dwordx2 v[36:37], v6, s[32:35], s41 offen
    s_add_u32 s41, s41, 294912
    buffer_load_dwordx2 v[38:39], v6, s[32:35], s41 offen
    s_add_u32 s41, s41, 294912
    buffer_load_dwordx2 v[48:49], v8, s[96:99], s49 offen offset:0 sc1
    buffer_load_dwordx2 v[50:51], v8, s[96:99], s49 offen offset:2048 sc1
    buffer_load_dwordx2 v[52:53], v8, s[96:99], s54 offen offset:0 sc1
    buffer_load_dwordx2 v[54:55], v8, s[96:99], s54 offen offset:2048 sc1
    buffer_load_dwordx2 v[56:57], v8, s[96:99], s55 offen offset:0 sc1
    buffer_load_dwordx2 v[58:59], v8, s[96:99], s55 offen offset:2048 sc1
    buffer_load_dwordx2 v[60:61], v8, s[96:99], s56 offen offset:0 sc1
    buffer_load_dwordx2 v[62:63], v8, s[96:99], s56 offen offset:2048 sc1
    v_lshlrev_b32 v11, 1, v5
    v_add_u32 v11, 74240, v11
    s_waitcnt lgkmcnt(0)
    s_add_u32 s100, s100, 1
    s_max_u32 s100, s100, 1
    s_mul_i32 s100, s100, 0x9e3779b1
    s_lshl_b32 s50, s44, 16
    s_and_b32 s51, s44, 0xffff0000
    s_lshl_b32 s52, s45, 16
    s_and_b32 s53, s45, 0xffff0000
    v_bfe_u32 v9, v1, 2, 2
    s_movk_i32 s48, 18496
    v_mul_lo_u32 v9, v9, s48
    v_lshrrev_b32 v10, 4, v1
    v_lshl_add_u32 v9, v10, 5, v9
    v_and_b32 v10, 3, v1
    v_lshl_add_u32 v9, v10, 3, v9
    s_lshl_b32 s48, s40, 7
    v_add_u32 v9, s48, v9
    v_lshrrev_b32 v10, 5, v1
    s_mov_b32 s48, 36864
    v_mul_lo_u32 v10, v10, s48
    v_and_b32 v7, 15, v1
    v_lshl_add_u32 v10, v7, 4, v10
    v_bfe_u32 v7, v1, 4, 1
    v_lshl_add_u32 v10, v7, 3, v10
    s_mul_i32 s48, s40, 73728
    s_lshl_b32 s47, s2, 8
    s_add_u32 s48, s48, s47
    s_add_u32 s48, s48, 12582912
    s_lshr_b32 s57, s2, 1
    s_lshl_b32 s57, s57, 14
    s_and_b32 s58, s2, 1
    s_lshl_b32 s58, s58, 3
    s_add_u32 s57, s57, s58
    s_add_u32 s57, s57, 9437184
    v_lshlrev_b32 v6, 4, v5
    s_waitcnt vmcnt(0)
    s_mov_b32 s90, 0
Lsc6:
    v_xor_b32 v12, v48, v49
    v_xor_b32 v12, s100, v12
    v_xor_b32 v13, v50, v51
    v_xor_b32 v13, s100, v13
    v_or_b32 v12, v12, v13
    v_xor_b32 v13, v52, v53
    v_xor_b32 v13, s100, v13
    v_or_b32 v12, v12, v13
    v_xor_b32 v13, v54, v55
    v_xor_b32 v13, s100, v13
    v_or_b32 v12, v12, v13
    v_cmp_ne_u32 vcc, 0, v12
    s_add_u32 s90, s90, 1
    s_cmp_eq_u64 vcc, 0
    s_cbranch_scc1 Lso7
    s_cmp_ge_u32 s90, 0x20000
    s_cbranch_scc1 Lso7
    s_sleep 4
    buffer_load_dwordx2 v[48:49], v8, s[96:99], s49 offen offset:0 sc1
    buffer_load_dwordx2 v[50:51], v8, s[96:99], s49 offen offset:2048 sc1
    buffer_load_dwordx2 v[52:53], v8, s[96:99], s54 offen offset:0 sc1
    buffer_load_dwordx2 v[54:55], v8, s[96:99], s54 offen offset:2048 sc1
    s_waitcnt vmcnt(0)
    s_branch Lsc6
Lso7:
    v_lshlrev_b32 v49, 16, v48
    v_and_b32 v48, 0xffff0000, v48
    v_rcp_f32 v49, v49
    v_lshlrev_b32 v51, 16, v50
    v_and_b32 v50, 0xffff0000, v50
    v_rcp_f32 v51, v51
    v_lshlrev_b32 v53, 16, v52
    v_and_b32 v52, 0xffff0000, v52
    v_rcp_f32 v53, v53
    v_lshlrev_b32 v55, 16, v54
    v_and_b32 v54, 0xffff0000, v54
    v_rcp_f32 v55, v55
    v_lshlrev_b32 v64, 16, v32
    v_and_b32 v65, 0xffff0000, v32
    v_lshlrev_b32 v66, 16, v33
    v_and_b32 v67, 0xffff0000, v33
    v_sub_f32 v12, v64, v48
    v_sub_f32 v13, v65, v48
    v_sub_f32 v14, v66, v48
    v_sub_f32 v15, v67, v48
    v_cvt_pk_bf16_f32 v16, v12, v13
    v_cvt_pk_bf16_f32 v17, v14, v15
    v_lshlrev_b32 v12, 16, v16
    v_and_b32 v13, 0xffff0000, v16
    v_lshlrev_b32 v14, 16, v17
    v_and_b32 v15, 0xffff0000, v17
    v_mul_f32 v12, v12, v49
    v_mul_f32 v13, v13, v49
    v_mul_f32 v14, v14, v49
    v_mul_f32 v15, v15, v49
    v_cvt_pk_bf16_f32 v32, v12, v13
    v_cvt_pk_bf16_f32 v33, v14, v15
    ds_write_b16 v11, v32 offset:0
    ds_write_b16_d16_hi v11, v32 offset:4608
    ds_write_b16 v11, v33 offset:9216
    ds_write_b16_d16_hi v11, v33 offset:13824
    v_lshlrev_b32 v68, 16, v34
    v_and_b32 v69, 0xffff0000, v34
    v_lshlrev_b32 v70, 16, v35
    v_and_b32 v71, 0xffff0000, v35
    v_sub_f32 v20, v68, v50
    v_sub_f32 v21, v69, v50
    v_sub_f32 v22, v70, v50
    v_sub_f32 v23, v71, v50
    v_cvt_pk_bf16_f32 v24, v20, v21
    v_cvt_pk_bf16_f32 v25, v22, v23
    v_lshlrev_b32 v20, 16, v24
    v_and_b32 v21, 0xffff0000, v24
    v_lshlrev_b32 v22, 16, v25
    v_and_b32 v23, 0xffff0000, v25
    v_mul_f32 v20, v20, v51
    v_mul_f32 v21, v21, v51
    v_mul_f32 v22, v22, v51
    v_mul_f32 v23, v23, v51
    v_cvt_pk_bf16_f32 v34, v20, v21
    v_cvt_pk_bf16_f32 v35, v22, v23
    ds_write_b16 v11, v34 offset:512
    ds_write_b16_d16_hi v11, v34 offset:5120
    ds_write_b16 v11, v35 offset:9728
    ds_write_b16_d16_hi v11, v35 offset:14336
    v_lshlrev_b32 v72, 16, v36
    v_and_b32 v73, 0xffff0000, v36
    v_lshlrev_b32 v74, 16, v37
    v_and_b32 v75, 0xffff0000, v37
    v_sub_f32 v12, v72, v52
    v_sub_f32 v13, v73, v52
    v_sub_f32 v14, v74, v52
    v_sub_f32 v15, v75, v52
    v_cvt_pk_bf16_f32 v16, v12, v13
    v_cvt_pk_bf16_f32 v17, v14, v15
    v_lshlrev_b32 v12, 16, v16
    v_and_b32 v13, 0xffff0000, v16
    v_lshlrev_b32 v14, 16, v17
    v_and_b32 v15, 0xffff0000, v17
    v_mul_f32 v12, v12, v53
    v_mul_f32 v13, v13, v53
    v_mul_f32 v14, v14, v53
    v_mul_f32 v15, v15, v53
    v_cvt_pk_bf16_f32 v36, v12, v13
    v_cvt_pk_bf16_f32 v37, v14, v15
    ds_write_b16 v11, v36 offset:1024
    ds_write_b16_d16_hi v11, v36 offset:5632
    ds_write_b16 v11, v37 offset:10240
    ds_write_b16_d16_hi v11, v37 offset:14848
    v_lshlrev_b32 v76, 16, v38
    v_and_b32 v77, 0xffff0000, v38
    v_lshlrev_b32 v78, 16, v39
    v_and_b32 v79, 0xffff0000, v39
    v_sub_f32 v20, v76, v54
    v_sub_f32 v21, v77, v54
    v_sub_f32 v22, v78, v54
    v_sub_f32 v23, v79, v54
    v_cvt_pk_bf16_f32 v24, v20, v21
    v_cvt_pk_bf16_f32 v25, v22, v23
    v_lshlrev_b32 v20, 16, v24
    v_and_b32 v21, 0xffff0000, v24
    v_lshlrev_b32 v22, 16, v25
    v_and_b32 v23, 0xffff0000, v25
    v_mul_f32 v20, v20, v55
    v_mul_f32 v21, v21, v55
    v_mul_f32 v22, v22, v55
    v_mul_f32 v23, v23, v55
    v_cvt_pk_bf16_f32 v38, v20, v21
    v_cvt_pk_bf16_f32 v39, v22, v23
    ds_write_b16 v11, v38 offset:1536
    ds_write_b16_d16_hi v11, v38 offset:6144
    ds_write_b16 v11, v39 offset:10752
    ds_write_b16_d16_hi v11, v39 offset:15360
    s_waitcnt lgkmcnt(0)
    s_barrier
    s_mov_b32 s90, 0
Lsc8:
    v_xor_b32 v12, v56, v57
    v_xor_b32 v12, s100, v12
    v_xor_b32 v13, v58, v59
    v_xor_b32 v13, s100, v13
    v_or_b32 v12, v12, v13
    v_xor_b32 v13, v60, v61
    v_xor_b32 v13, s100, v13
    v_or_b32 v12, v12, v13
    v_xor_b32 v13, v62, v63
    v_xor_b32 v13, s100, v13
    v_or_b32 v12, v12, v13
    v_cmp_ne_u32 vcc, 0, v12
    s_add_u32 s90, s90, 1
    s_cmp_eq_u64 vcc, 0
    s_cbranch_scc1 Lso9
    s_cmp_ge_u32 s90, 0x20000
    s_cbranch_scc1 Lso9
    s_sleep 4
    buffer_load_dwordx2 v[56:57], v8, s[96:99], s55 offen offset:0 sc1
    buffer_load_dwordx2 v[58:59], v8, s[96:99], s55 offen offset:2048 sc1
    buffer_load_dwordx2 v[60:61], v8, s[96:99], s56 offen offset:0 sc1
    buffer_load_dwordx2 v[62:63], v8, s[96:99], s56 offen offset:2048 sc1
    s_waitcnt vmcnt(0)
    s_branch Lsc8
Lso9:
    v_lshlrev_b32 v57, 16, v56
    v_and_b32 v56, 0xffff0000, v56
    v_rcp_f32 v57, v57
    v_lshlrev_b32 v59, 16, v58
    v_and_b32 v58, 0xffff0000, v58
    v_rcp_f32 v59, v59
    v_lshlrev_b32 v61, 16, v60
    v_and_b32 v60, 0xffff0000, v60
    v_rcp_f32 v61, v61
    v_lshlrev_b32 v63, 16, v62
    v_and_b32 v62, 0xffff0000, v62
    v_rcp_f32 v63, v63
    buffer_load_dwordx2 v[40:41], v6, s[96:99], s57 offen sc1
    s_add_u32 s57, s57, 4096
    buffer_load_dwordx2 v[42:43], v6, s[96:99], s57 offen sc1
    s_add_u32 s57, s57, 4096
    buffer_load_dwordx2 v[44:45], v6, s[96:99], s57 offen sc1
    s_add_u32 s57, s57, 4096
    buffer_load_dwordx2 v[46:47], v6, s[96:99], s57 offen sc1
    s_add_u32 s57, s57, 4096
    v_lshlrev_b32 v96, 16, v32
    v_and_b32 v97, 0xffff0000, v32
    v_lshlrev_b32 v98, 16, v33
    v_and_b32 v99, 0xffff0000, v33
    v_mul_f32 v96, s50, v96
    v_mul_f32 v97, s51, v97
    v_mul_f32 v98, s52, v98
    v_mul_f32 v99, s53, v99
    v_cvt_pk_bf16_f32 v32, v96, v97
    v_cvt_pk_bf16_f32 v33, v98, v99
    v_lshlrev_b32 v96, 16, v32
    v_and_b32 v97, 0xffff0000, v32
    v_lshlrev_b32 v98, 16, v33
    v_and_b32 v99, 0xffff0000, v33
    v_lshlrev_b32 v100, 16, v34
    v_and_b32 v101, 0xffff0000, v34
    v_lshlrev_b32 v102, 16, v35
    v_and_b32 v103, 0xffff0000, v35
    v_mul_f32 v100, s50, v100
    v_mul_f32 v101, s51, v101
    v_mul_f32 v102, s52, v102
    v_mul_f32 v103, s53, v103
    v_cvt_pk_bf16_f32 v34, v100, v101
    v_cvt_pk_bf16_f32 v35, v102, v103
    v_lshlrev_b32 v100, 16, v34
    v_and_b32 v101, 0xffff0000, v34
    v_lshlrev_b32 v102, 16, v35
    v_and_b32 v103, 0xffff0000, v35
    v_lshlrev_b32 v104, 16, v36
    v_and_b32 v105, 0xffff0000, v36
    v_lshlrev_b32 v106, 16, v37
    v_and_b32 v107, 0xffff0000, v37
    v_mul_f32 v104, s50, v104
    v_mul_f32 v105, s51, v105
    v_mul_f32 v106, s52, v106
    v_mul_f32 v107, s53, v107
    v_cvt_pk_bf16_f32 v36, v104, v105
    v_cvt_pk_bf16_f32 v37, v106, v107
    v_lshlrev_b32 v104, 16, v36
    v_and_b32 v105, 0xffff0000, v36
    v_lshlrev_b32 v106, 16, v37
    v_and_b32 v107, 0xffff0000, v37
    v_lshlrev_b32 v108, 16, v38
    v_and_b32 v109, 0xffff0000, v38
    v_lshlrev_b32 v110, 16, v39
    v_and_b32 v111, 0xffff0000, v39
    v_mul_f32 v108, s50, v108
    v_mul_f32 v109, s51, v109
    v_mul_f32 v110, s52, v110
    v_mul_f32 v111, s53, v111
    v_cvt_pk_bf16_f32 v38, v108, v109
    v_cvt_pk_bf16_f32 v39, v110, v111
    v_lshlrev_b32 v108, 16, v38
    v_and_b32 v109, 0xffff0000, v38
    v_lshlrev_b32 v110, 16, v39
    v_and_b32 v111, 0xffff0000, v39
    s_waitcnt vmcnt(3)
    v_lshlrev_b32 v80, 16, v40
    v_and_b32 v81, 0xffff0000, v40
    v_lshlrev_b32 v82, 16, v41
    v_and_b32 v83, 0xffff0000, v41
    v_sub_f32 v12, v80, v56
    v_sub_f32 v13, v81, v56
    v_sub_f32 v14, v82, v56
    v_sub_f32 v15, v83, v56
    v_cvt_pk_bf16_f32 v16, v12, v13
    v_cvt_pk_bf16_f32 v17, v14, v15
    v_lshlrev_b32 v12, 16, v16
    v_and_b32 v13, 0xffff0000, v16
    v_lshlrev_b32 v14, 16, v17
    v_and_b32 v15, 0xffff0000, v17
    v_mul_f32 v12, v12, v57
    v_mul_f32 v13, v13, v57
    v_mul_f32 v14, v14, v57
    v_mul_f32 v15, v15, v57
    v_cvt_pk_bf16_f32 v40, v12, v13
    v_cvt_pk_bf16_f32 v41, v14, v15
    ds_write_b16 v11, v40 offset:2048
    ds_write_b16_d16_hi v11, v40 offset:6656
    ds_write_b16 v11, v41 offset:11264
    ds_write_b16_d16_hi v11, v41 offset:15872
    s_waitcnt vmcnt(2)
    v_lshlrev_b32 v84, 16, v42
    v_and_b32 v85, 0xffff0000, v42
    v_lshlrev_b32 v86, 16, v43
    v_and_b32 v87, 0xffff0000, v43
    v_sub_f32 v20, v84, v58
    v_sub_f32 v21, v85, v58
    v_sub_f32 v22, v86, v58
    v_sub_f32 v23, v87, v58
    v_cvt_pk_bf16_f32 v24, v20, v21
    v_cvt_pk_bf16_f32 v25, v22, v23
    v_lshlrev_b32 v20, 16, v24
    v_and_b32 v21, 0xffff0000, v24
    v_lshlrev_b32 v22, 16, v25
    v_and_b32 v23, 0xffff0000, v25
    v_mul_f32 v20, v20, v59
    v_mul_f32 v21, v21, v59
    v_mul_f32 v22, v22, v59
    v_mul_f32 v23, v23, v59
    v_cvt_pk_bf16_f32 v42, v20, v21
    v_cvt_pk_bf16_f32 v43, v22, v23
    ds_write_b16 v11, v42 offset:2560
    ds_write_b16_d16_hi v11, v42 offset:7168
    ds_write_b16 v11, v43 offset:11776
    ds_write_b16_d16_hi v11, v43 offset:16384
    s_waitcnt vmcnt(1)
    v_lshlrev_b32 v88, 16, v44
    v_and_b32 v89, 0xffff0000, v44
    v_lshlrev_b32 v90, 16, v45
    v_and_b32 v91, 0xffff0000, v45
    v_sub_f32 v12, v88, v60
    v_sub_f32 v13, v89, v60
    v_sub_f32 v14, v90, v60
    v_sub_f32 v15, v91, v60
    v_cvt_pk_bf16_f32 v16, v12, v13
    v_cvt_pk_bf16_f32 v17, v14, v15
    v_lshlrev_b32 v12, 16, v16
    v_and_b32 v13, 0xffff0000, v16
    v_lshlrev_b32 v14, 16, v17
    v_and_b32 v15, 0xffff0000, v17
    v_mul_f32 v12, v12, v61
    v_mul_f32 v13, v13, v61
    v_mul_f32 v14, v14, v61
    v_mul_f32 v15, v15, v61
    v_cvt_pk_bf16_f32 v44, v12, v13
    v_cvt_pk_bf16_f32 v45, v14, v15
    ds_write_b16 v11, v44 offset:3072
    ds_write_b16_d16_hi v11, v44 offset:7680
    ds_write_b16 v11, v45 offset:12288
    ds_write_b16_d16_hi v11, v45 offset:16896
    s_waitcnt vmcnt(0)
    v_lshlrev_b32 v92, 16, v46
    v_and_b32 v93, 0xffff0000, v46
    v_lshlrev_b32 v94, 16, v47
    v_and_b32 v95, 0xffff0000, v47
    v_sub_f32 v20, v92, v62
    v_sub_f32 v21, v93, v62
    v_sub_f32 v22, v94, v62
    v_sub_f32 v23, v95, v62
    v_cvt_pk_bf16_f32 v24, v20, v21
    v_cvt_pk_bf16_f32 v25, v22, v23
    v_lshlrev_b32 v20, 16, v24
    v_and_b32 v21, 0xffff0000, v24
    v_lshlrev_b32 v22, 16, v25
    v_and_b32 v23, 0xffff0000, v25
    v_mul_f32 v20, v20, v63
    v_mul_f32 v21, v21, v63
    v_mul_f32 v22, v22, v63
    v_mul_f32 v23, v23, v63
    v_cvt_pk_bf16_f32 v46, v20, v21
    v_cvt_pk_bf16_f32 v47, v22, v23
    ds_write_b16 v11, v46 offset:3584
    ds_write_b16_d16_hi v11, v46 offset:8192
    ds_write_b16 v11, v47 offset:12800
    ds_write_b16_d16_hi v11, v47 offset:17408
    s_waitcnt lgkmcnt(0)
    s_barrier
    s_lshl_b32 s41, s40, 8
    s_or_b32 s41, s41, s2
    s_cmp_lt_u32 s41, 8
    s_cbranch_scc0 Lef10
    s_lshl_b32 s41, s2, 7
    s_add_u32 s41, s41, 49373184
    v_mov_b32 v12, s100
    v_mov_b32 v13, 0
    s_mov_b64 exec, 1
    buffer_store_dword v12, v13, s[96:99], s41 offen sc1
    s_mov_b64 exec, -1
Lef10:
    ds_read_b64_tr_b16 v[128:129], v9 offset:0
    ds_read_b64_tr_b16 v[130:131], v9 offset:512
    ds_read_b64_tr_b16 v[132:133], v9 offset:1024
    ds_read_b64_tr_b16 v[134:135], v9 offset:1536
    v_lshlrev_b32 v112, 16, v40
    v_and_b32 v113, 0xffff0000, v40
    v_lshlrev_b32 v114, 16, v41
    v_and_b32 v115, 0xffff0000, v41
    v_mul_f32 v112, s50, v112
    v_mul_f32 v113, s51, v113
    v_mul_f32 v114, s52, v114
    v_mul_f32 v115, s53, v115
    v_cvt_pk_bf16_f32 v40, v112, v113
    v_cvt_pk_bf16_f32 v41, v114, v115
    v_lshlrev_b32 v112, 16, v40
    v_and_b32 v113, 0xffff0000, v40
    v_lshlrev_b32 v114, 16, v41
    v_and_b32 v115, 0xffff0000, v41
    v_lshlrev_b32 v116, 16, v42
    v_and_b32 v117, 0xffff0000, v42
    v_lshlrev_b32 v118, 16, v43
    v_and_b32 v119, 0xffff0000, v43
    v_mul_f32 v116, s50, v116
    v_mul_f32 v117, s51, v117
    v_mul_f32 v118, s52, v118
    v_mul_f32 v119, s53, v119
    v_cvt_pk_bf16_f32 v42, v116, v117
    v_cvt_pk_bf16_f32 v43, v118, v119
    v_lshlrev_b32 v116, 16, v42
    v_and_b32 v117, 0xffff0000, v42
    v_lshlrev_b32 v118, 16, v43
    v_and_b32 v119, 0xffff0000, v43
    v_lshlrev_b32 v120, 16, v44
    v_and_b32 v121, 0xffff0000, v44
    v_lshlrev_b32 v122, 16, v45
    v_and_b32 v123, 0xffff0000, v45
    v_mul_f32 v120, s50, v120
    v_mul_f32 v121, s51, v121
    v_mul_f32 v122, s52, v122
    v_mul_f32 v123, s53, v123
    v_cvt_pk_bf16_f32 v44, v120, v121
    v_cvt_pk_bf16_f32 v45, v122, v123
    v_lshlrev_b32 v120, 16, v44
    v_and_b32 v121, 0xffff0000, v44
    v_lshlrev_b32 v122, 16, v45
    v_and_b32 v123, 0xffff0000, v45
    v_lshlrev_b32 v124, 16, v46
    v_and_b32 v125, 0xffff0000, v46
    v_lshlrev_b32 v126, 16, v47
    v_and_b32 v127, 0xffff0000, v47
    v_mul_f32 v124, s50, v124
    v_mul_f32 v125, s51, v125
    v_mul_f32 v126, s52, v126
    v_mul_f32 v127, s53, v127
    v_cvt_pk_bf16_f32 v46, v124, v125
    v_cvt_pk_bf16_f32 v47, v126, v127
    v_lshlrev_b32 v124, 16, v46
    v_and_b32 v125, 0xffff0000, v46
    v_lshlrev_b32 v126, 16, v47
    v_and_b32 v127, 0xffff0000, v47
    s_waitcnt lgkmcnt(0)
    v_lshlrev_b32 v12, 16, v128
    v_and_b32 v13, 0xffff0000, v128
    v_lshlrev_b32 v14, 16, v129
    v_and_b32 v15, 0xffff0000, v129
    v_add_f32 v12, v12, v96
    v_add_f32 v13, v13, v97
    v_add_f32 v14, v14, v98
    v_add_f32 v15, v15, v99
    v_cvt_pk_bf16_f32 v16, v12, v13
    v_cvt_pk_bf16_f32 v17, v14, v15
    v_lshlrev_b32 v12, 16, v16
    v_and_b32 v13, 0xffff0000, v16
    v_lshlrev_b32 v14, 16, v17
    v_and_b32 v15, 0xffff0000, v17
    v_add_f32 v12, v12, v64
    v_add_f32 v13, v13, v65
    v_add_f32 v14, v14, v66
    v_add_f32 v15, v15, v67
    v_cvt_pk_bf16_f32 v128, v12, v13
    v_cvt_pk_bf16_f32 v129, v14, v15
    buffer_store_dwordx2 v[128:129], v10, s[96:99], s48 offen sc1
    s_add_u32 s48, s48, 294912
    v_lshlrev_b32 v20, 16, v130
    v_and_b32 v21, 0xffff0000, v130
    v_lshlrev_b32 v22, 16, v131
    v_and_b32 v23, 0xffff0000, v131
    v_add_f32 v20, v20, v100
    v_add_f32 v21, v21, v101
    v_add_f32 v22, v22, v102
    v_add_f32 v23, v23, v103
    v_cvt_pk_bf16_f32 v24, v20, v21
    v_cvt_pk_bf16_f32 v25, v22, v23
    v_lshlrev_b32 v20, 16, v24
    v_and_b32 v21, 0xffff0000, v24
    v_lshlrev_b32 v22, 16, v25
    v_and_b32 v23, 0xffff0000, v25
    v_add_f32 v20, v20, v68
    v_add_f32 v21, v21, v69
    v_add_f32 v22, v22, v70
    v_add_f32 v23, v23, v71
    v_cvt_pk_bf16_f32 v130, v20, v21
    v_cvt_pk_bf16_f32 v131, v22, v23
    buffer_store_dwordx2 v[130:131], v10, s[96:99], s48 offen sc1
    s_add_u32 s48, s48, 294912
    v_lshlrev_b32 v12, 16, v132
    v_and_b32 v13, 0xffff0000, v132
    v_lshlrev_b32 v14, 16, v133
    v_and_b32 v15, 0xffff0000, v133
    v_add_f32 v12, v12, v104
    v_add_f32 v13, v13, v105
    v_add_f32 v14, v14, v106
    v_add_f32 v15, v15, v107
    v_cvt_pk_bf16_f32 v16, v12, v13
    v_cvt_pk_bf16_f32 v17, v14, v15
    v_lshlrev_b32 v12, 16, v16
    v_and_b32 v13, 0xffff0000, v16
    v_lshlrev_b32 v14, 16, v17
    v_and_b32 v15, 0xffff0000, v17
    v_add_f32 v12, v12, v72
    v_add_f32 v13, v13, v73
    v_add_f32 v14, v14, v74
    v_add_f32 v15, v15, v75
    v_cvt_pk_bf16_f32 v132, v12, v13
    v_cvt_pk_bf16_f32 v133, v14, v15
    buffer_store_dwordx2 v[132:133], v10, s[96:99], s48 offen sc1
    s_add_u32 s48, s48, 294912
    v_lshlrev_b32 v20, 16, v134
    v_and_b32 v21, 0xffff0000, v134
    v_lshlrev_b32 v22, 16, v135
    v_and_b32 v23, 0xffff0000, v135
    v_add_f32 v20, v20, v108
    v_add_f32 v21, v21, v109
    v_add_f32 v22, v22, v110
    v_add_f32 v23, v23, v111
    v_cvt_pk_bf16_f32 v24, v20, v21
    v_cvt_pk_bf16_f32 v25, v22, v23
    v_lshlrev_b32 v20, 16, v24
    v_and_b32 v21, 0xffff0000, v24
    v_lshlrev_b32 v22, 16, v25
    v_and_b32 v23, 0xffff0000, v25
    v_add_f32 v20, v20, v76
    v_add_f32 v21, v21, v77
    v_add_f32 v22, v22, v78
    v_add_f32 v23, v23, v79
    v_cvt_pk_bf16_f32 v134, v20, v21
    v_cvt_pk_bf16_f32 v135, v22, v23
    buffer_store_dwordx2 v[134:135], v10, s[96:99], s48 offen sc1
    s_add_u32 s48, s48, 294912
    s_barrier
    ds_read_b64_tr_b16 v[136:137], v9 offset:2048
    ds_read_b64_tr_b16 v[138:139], v9 offset:2560
    ds_read_b64_tr_b16 v[140:141], v9 offset:3072
    ds_read_b64_tr_b16 v[142:143], v9 offset:3584
    s_lshl_b32 s41, s40, 10
    s_lshl_b32 s42, s2, 2
    s_add_u32 s41, s41, s42
    s_add_u32 s41, s41, 49348608
    s_waitcnt lgkmcnt(0)
    v_lshlrev_b32 v12, 16, v136
    v_and_b32 v13, 0xffff0000, v136
    v_lshlrev_b32 v14, 16, v137
    v_and_b32 v15, 0xffff0000, v137
    v_add_f32 v12, v12, v112
    v_add_f32 v13, v13, v113
    v_add_f32 v14, v14, v114
    v_add_f32 v15, v15, v115
    v_cvt_pk_bf16_f32 v16, v12, v13
    v_cvt_pk_bf16_f32 v17, v14, v15
    v_lshlrev_b32 v12, 16, v16
    v_and_b32 v13, 0xffff0000, v16
    v_lshlrev_b32 v14, 16, v17
    v_and_b32 v15, 0xffff0000, v17
    v_add_f32 v12, v12, v80
    v_add_f32 v13, v13, v81
    v_add_f32 v14, v14, v82
    v_add_f32 v15, v15, v83
    v_cvt_pk_bf16_f32 v136, v12, v13
    v_cvt_pk_bf16_f32 v137, v14, v15
    buffer_store_dwordx2 v[136:137], v10, s[96:99], s48 offen sc1
    s_add_u32 s48, s48, 294912
    v_lshlrev_b32 v20, 16, v138
    v_and_b32 v21, 0xffff0000, v138
    v_lshlrev_b32 v22, 16, v139
    v_and_b32 v23, 0xffff0000, v139
    v_add_f32 v20, v20, v116
    v_add_f32 v21, v21, v117
    v_add_f32 v22, v22, v118
    v_add_f32 v23, v23, v119
    v_cvt_pk_bf16_f32 v24, v20, v21
    v_cvt_pk_bf16_f32 v25, v22, v23
    v_lshlrev_b32 v20, 16, v24
    v_and_b32 v21, 0xffff0000, v24
    v_lshlrev_b32 v22, 16, v25
    v_and_b32 v23, 0xffff0000, v25
    v_add_f32 v20, v20, v84
    v_add_f32 v21, v21, v85
    v_add_f32 v22, v22, v86
    v_add_f32 v23, v23, v87
    v_cvt_pk_bf16_f32 v138, v20, v21
    v_cvt_pk_bf16_f32 v139, v22, v23
    buffer_store_dwordx2 v[138:139], v10, s[96:99], s48 offen sc1
    s_add_u32 s48, s48, 294912
    v_lshlrev_b32 v12, 16, v140
    v_and_b32 v13, 0xffff0000, v140
    v_lshlrev_b32 v14, 16, v141
    v_and_b32 v15, 0xffff0000, v141
    v_add_f32 v12, v12, v120
    v_add_f32 v13, v13, v121
    v_add_f32 v14, v14, v122
    v_add_f32 v15, v15, v123
    v_cvt_pk_bf16_f32 v16, v12, v13
    v_cvt_pk_bf16_f32 v17, v14, v15
    v_lshlrev_b32 v12, 16, v16
    v_and_b32 v13, 0xffff0000, v16
    v_lshlrev_b32 v14, 16, v17
    v_and_b32 v15, 0xffff0000, v17
    v_add_f32 v12, v12, v88
    v_add_f32 v13, v13, v89
    v_add_f32 v14, v14, v90
    v_add_f32 v15, v15, v91
    v_cvt_pk_bf16_f32 v140, v12, v13
    v_cvt_pk_bf16_f32 v141, v14, v15
    buffer_store_dwordx2 v[140:141], v10, s[96:99], s48 offen sc1
    s_add_u32 s48, s48, 294912
    v_lshlrev_b32 v20, 16, v142
    v_and_b32 v21, 0xffff0000, v142
    v_lshlrev_b32 v22, 16, v143
    v_and_b32 v23, 0xffff0000, v143
    v_add_f32 v20, v20, v124
    v_add_f32 v21, v21, v125
    v_add_f32 v22, v22, v126
    v_add_f32 v23, v23, v127
    v_cvt_pk_bf16_f32 v24, v20, v21
    v_cvt_pk_bf16_f32 v25, v22, v23
    v_lshlrev_b32 v20, 16, v24
    v_and_b32 v21, 0xffff0000, v24
    v_lshlrev_b32 v22, 16, v25
    v_and_b32 v23, 0xffff0000, v25
    v_add_f32 v20, v20, v92
    v_add_f32 v21, v21, v93
    v_add_f32 v22, v22, v94
    v_add_f32 v23, v23, v95
    v_cvt_pk_bf16_f32 v142, v20, v21
    v_cvt_pk_bf16_f32 v143, v22, v23
    buffer_store_dwordx2 v[142:143], v10, s[96:99], s48 offen sc1
    s_add_u32 s48, s48, 294912
    v_mov_b32 v12, s100
    v_lshlrev_b32 v13, 10, v1
    s_lshl_b32 s41, s2, 2
    s_add_u32 s41, s41, 49381376
    s_waitcnt vmcnt(0)
    s_barrier
    s_cmp_eq_u32 s101, 4
    s_cbranch_scc0 Lrs11
    s_mov_b64 exec, 65535
    buffer_store_dword v12, v13, s[96:99], s41 offen sc1
    s_mov_b64 exec, -1
Lrs11:
    s_branch P1
Lpack:
    s_sub_u32 s40, s2, 144
    s_lshr_b32 s54, s3, 2
    s_and_b32 s55, s3, 3
    v_lshlrev_b32 v8, 4, v1
    s_mul_i32 s41, s3, 40
    s_add_u32 s41, s41, s40
    s_sub_u32 s41, s41, 72
    s_cmp_lt_u32 s40, 72
    s_cbranch_scc1 Lnoln
    s_cmp_ge_u32 s41, 256
    s_cbranch_scc1 Lnoln
    v_lshrrev_b32 v2, 3, v1
    s_lshl_b32 s42, s41, 3
    v_add_u32 v2, s42, v2
    s_movk_i32 s42, 1152
    v_mul_lo_u32 v3, v2, s42
    v_and_b32 v4, 7, v1
    v_lshl_add_u32 v3, v4, 4, v3
    buffer_load_dwordx4 v[32:35], v3, s[32:35], 0 offen offset:0
    buffer_load_dwordx4 v[36:39], v3, s[32:35], 0 offen offset:128
    buffer_load_dwordx4 v[40:43], v3, s[32:35], 0 offen offset:256
    buffer_load_dwordx4 v[44:47], v3, s[32:35], 0 offen offset:384
    buffer_load_dwordx4 v[48:51], v3, s[32:35], 0 offen offset:512
    buffer_load_dwordx4 v[52:55], v3, s[32:35], 0 offen offset:640
    buffer_load_dwordx4 v[56:59], v3, s[32:35], 0 offen offset:768
    buffer_load_dwordx4 v[60:63], v3, s[32:35], 0 offen offset:896
    buffer_load_dwordx4 v[64:67], v3, s[32:35], 0 offen offset:1024
    v_mov_b32 v28, 0x3f803f80
    v_mov_b32 v12, 0
    v_mov_b32 v13, 0
    v_mov_b32 v14, 0
    v_mov_b32 v15, 0
    v_mov_b32 v16, 0
    v_mov_b32 v17, 0
    v_mov_b32 v18, 0
    v_mov_b32 v19, 0
    v_subrev_u32 v5, 1024, v2
    v_lshlrev_b32 v5, 4, v5
    v_lshl_add_u32 v5, v4, 14, v5
    s_mov_b32 s43, 9437184
    s_cmp_ge_u32 s41, 128
    s_cbranch_scc1 Llnx
    s_waitcnt vmcnt(8)
    v_dot2c_f32_bf16 v12, v32, v28
    v_dot2c_f32_bf16 v16, v32, v32
    v_dot2c_f32_bf16 v13, v33, v28
    v_dot2c_f32_bf16 v17, v33, v33
    v_dot2c_f32_bf16 v14, v34, v28
    v_dot2c_f32_bf16 v18, v34, v34
    v_dot2c_f32_bf16 v15, v35, v28
    v_dot2c_f32_bf16 v19, v35, v35
    s_waitcnt vmcnt(7)
    v_dot2c_f32_bf16 v12, v36, v28
    v_dot2c_f32_bf16 v16, v36, v36
    v_dot2c_f32_bf16 v13, v37, v28
    v_dot2c_f32_bf16 v17, v37, v37
    v_dot2c_f32_bf16 v14, v38, v28
    v_dot2c_f32_bf16 v18, v38, v38
    v_dot2c_f32_bf16 v15, v39, v28
    v_dot2c_f32_bf16 v19, v39, v39
    s_waitcnt vmcnt(6)
    v_dot2c_f32_bf16 v12, v40, v28
    v_dot2c_f32_bf16 v16, v40, v40
    v_dot2c_f32_bf16 v13, v41, v28
    v_dot2c_f32_bf16 v17, v41, v41
    v_dot2c_f32_bf16 v14, v42, v28
    v_dot2c_f32_bf16 v18, v42, v42
    v_dot2c_f32_bf16 v15, v43, v28
    v_dot2c_f32_bf16 v19, v43, v43
    s_waitcnt vmcnt(5)
    v_dot2c_f32_bf16 v12, v44, v28
    v_dot2c_f32_bf16 v16, v44, v44
    v_dot2c_f32_bf16 v13, v45, v28
    v_dot2c_f32_bf16 v17, v45, v45
    v_dot2c_f32_bf16 v14, v46, v28
    v_dot2c_f32_bf16 v18, v46, v46
    v_dot2c_f32_bf16 v15, v47, v28
    v_dot2c_f32_bf16 v19, v47, v47
    s_waitcnt vmcnt(4)
    v_dot2c_f32_bf16 v12, v48, v28
    v_dot2c_f32_bf16 v16, v48, v48
    v_dot2c_f32_bf16 v13, v49, v28
    v_dot2c_f32_bf16 v17, v49, v49
    v_dot2c_f32_bf16 v14, v50, v28
    v_dot2c_f32_bf16 v18, v50, v50
    v_dot2c_f32_bf16 v15, v51, v28
    v_dot2c_f32_bf16 v19, v51, v51
    s_waitcnt vmcnt(3)
    v_dot2c_f32_bf16 v12, v52, v28
    v_dot2c_f32_bf16 v16, v52, v52
    v_dot2c_f32_bf16 v13, v53, v28
    v_dot2c_f32_bf16 v17, v53, v53
    v_dot2c_f32_bf16 v14, v54, v28
    v_dot2c_f32_bf16 v18, v54, v54
    v_dot2c_f32_bf16 v15, v55, v28
    v_dot2c_f32_bf16 v19, v55, v55
    s_waitcnt vmcnt(2)
    v_dot2c_f32_bf16 v12, v56, v28
    v_dot2c_f32_bf16 v16, v56, v56
    v_dot2c_f32_bf16 v13, v57, v28
    v_dot2c_f32_bf16 v17, v57, v57
    v_dot2c_f32_bf16 v14, v58, v28
    v_dot2c_f32_bf16 v18, v58, v58
    v_dot2c_f32_bf16 v15, v59, v28
    v_dot2c_f32_bf16 v19, v59, v59
    s_waitcnt vmcnt(1)
    v_dot2c_f32_bf16 v12, v60, v28
    v_dot2c_f32_bf16 v16, v60, v60
    v_dot2c_f32_bf16 v13, v61, v28
    v_dot2c_f32_bf16 v17, v61, v61
    v_dot2c_f32_bf16 v14, v62, v28
    v_dot2c_f32_bf16 v18, v62, v62
    v_dot2c_f32_bf16 v15, v63, v28
    v_dot2c_f32_bf16 v19, v63, v63
    s_waitcnt vmcnt(0)
    v_dot2c_f32_bf16 v12, v64, v28
    v_dot2c_f32_bf16 v16, v64, v64
    v_dot2c_f32_bf16 v13, v65, v28
    v_dot2c_f32_bf16 v17, v65, v65
    v_dot2c_f32_bf16 v14, v66, v28
    v_dot2c_f32_bf16 v18, v66, v66
    v_dot2c_f32_bf16 v15, v67, v28
    v_dot2c_f32_bf16 v19, v67, v67
    s_branch Llny
Llnx:
    s_waitcnt vmcnt(8)
    buffer_store_dwordx4 v[32:35], v5, s[96:99], s43 offen sc1
    s_add_u32 s43, s43, 131072
    v_dot2c_f32_bf16 v12, v32, v28
    v_dot2c_f32_bf16 v16, v32, v32
    v_dot2c_f32_bf16 v13, v33, v28
    v_dot2c_f32_bf16 v17, v33, v33
    v_dot2c_f32_bf16 v14, v34, v28
    v_dot2c_f32_bf16 v18, v34, v34
    v_dot2c_f32_bf16 v15, v35, v28
    v_dot2c_f32_bf16 v19, v35, v35
    s_waitcnt vmcnt(8)
    buffer_store_dwordx4 v[36:39], v5, s[96:99], s43 offen sc1
    s_add_u32 s43, s43, 131072
    v_dot2c_f32_bf16 v12, v36, v28
    v_dot2c_f32_bf16 v16, v36, v36
    v_dot2c_f32_bf16 v13, v37, v28
    v_dot2c_f32_bf16 v17, v37, v37
    v_dot2c_f32_bf16 v14, v38, v28
    v_dot2c_f32_bf16 v18, v38, v38
    v_dot2c_f32_bf16 v15, v39, v28
    v_dot2c_f32_bf16 v19, v39, v39
    s_waitcnt vmcnt(8)
    buffer_store_dwordx4 v[40:43], v5, s[96:99], s43 offen sc1
    s_add_u32 s43, s43, 131072
    v_dot2c_f32_bf16 v12, v40, v28
    v_dot2c_f32_bf16 v16, v40, v40
    v_dot2c_f32_bf16 v13, v41, v28
    v_dot2c_f32_bf16 v17, v41, v41
    v_dot2c_f32_bf16 v14, v42, v28
    v_dot2c_f32_bf16 v18, v42, v42
    v_dot2c_f32_bf16 v15, v43, v28
    v_dot2c_f32_bf16 v19, v43, v43
    s_waitcnt vmcnt(8)
    buffer_store_dwordx4 v[44:47], v5, s[96:99], s43 offen sc1
    s_add_u32 s43, s43, 131072
    v_dot2c_f32_bf16 v12, v44, v28
    v_dot2c_f32_bf16 v16, v44, v44
    v_dot2c_f32_bf16 v13, v45, v28
    v_dot2c_f32_bf16 v17, v45, v45
    v_dot2c_f32_bf16 v14, v46, v28
    v_dot2c_f32_bf16 v18, v46, v46
    v_dot2c_f32_bf16 v15, v47, v28
    v_dot2c_f32_bf16 v19, v47, v47
    s_waitcnt vmcnt(8)
    buffer_store_dwordx4 v[48:51], v5, s[96:99], s43 offen sc1
    s_add_u32 s43, s43, 131072
    v_dot2c_f32_bf16 v12, v48, v28
    v_dot2c_f32_bf16 v16, v48, v48
    v_dot2c_f32_bf16 v13, v49, v28
    v_dot2c_f32_bf16 v17, v49, v49
    v_dot2c_f32_bf16 v14, v50, v28
    v_dot2c_f32_bf16 v18, v50, v50
    v_dot2c_f32_bf16 v15, v51, v28
    v_dot2c_f32_bf16 v19, v51, v51
    s_waitcnt vmcnt(8)
    buffer_store_dwordx4 v[52:55], v5, s[96:99], s43 offen sc1
    s_add_u32 s43, s43, 131072
    v_dot2c_f32_bf16 v12, v52, v28
    v_dot2c_f32_bf16 v16, v52, v52
    v_dot2c_f32_bf16 v13, v53, v28
    v_dot2c_f32_bf16 v17, v53, v53
    v_dot2c_f32_bf16 v14, v54, v28
    v_dot2c_f32_bf16 v18, v54, v54
    v_dot2c_f32_bf16 v15, v55, v28
    v_dot2c_f32_bf16 v19, v55, v55
    s_waitcnt vmcnt(8)
    buffer_store_dwordx4 v[56:59], v5, s[96:99], s43 offen sc1
    s_add_u32 s43, s43, 131072
    v_dot2c_f32_bf16 v12, v56, v28
    v_dot2c_f32_bf16 v16, v56, v56
    v_dot2c_f32_bf16 v13, v57, v28
    v_dot2c_f32_bf16 v17, v57, v57
    v_dot2c_f32_bf16 v14, v58, v28
    v_dot2c_f32_bf16 v18, v58, v58
    v_dot2c_f32_bf16 v15, v59, v28
    v_dot2c_f32_bf16 v19, v59, v59
    s_waitcnt vmcnt(8)
    buffer_store_dwordx4 v[60:63], v5, s[96:99], s43 offen sc1
    s_add_u32 s43, s43, 131072
    v_dot2c_f32_bf16 v12, v60, v28
    v_dot2c_f32_bf16 v16, v60, v60
    v_dot2c_f32_bf16 v13, v61, v28
    v_dot2c_f32_bf16 v17, v61, v61
    v_dot2c_f32_bf16 v14, v62, v28
    v_dot2c_f32_bf16 v18, v62, v62
    v_dot2c_f32_bf16 v15, v63, v28
    v_dot2c_f32_bf16 v19, v63, v63
    s_waitcnt vmcnt(8)
    buffer_store_dwordx4 v[64:67], v5, s[96:99], s43 offen sc1
    s_add_u32 s43, s43, 131072
    v_dot2c_f32_bf16 v12, v64, v28
    v_dot2c_f32_bf16 v16, v64, v64
    v_dot2c_f32_bf16 v13, v65, v28
    v_dot2c_f32_bf16 v17, v65, v65
    v_dot2c_f32_bf16 v14, v66, v28
    v_dot2c_f32_bf16 v18, v66, v66
    v_dot2c_f32_bf16 v15, v67, v28
    v_dot2c_f32_bf16 v19, v67, v67
Llny:
    s_nop 2
    v_add_f32 v12, v12, v13
    v_add_f32 v14, v14, v15
    v_add_f32 v16, v16, v17
    v_add_f32 v18, v18, v19
    v_add_f32 v24, v12, v14
    v_add_f32 v25, v16, v18
    s_nop 1
    v_add_f32_dpp v24, v24, v24 quad_perm:[1,0,3,2] row_mask:0xf bank_mask:0xf
    v_add_f32_dpp v25, v25, v25 quad_perm:[1,0,3,2] row_mask:0xf bank_mask:0xf
    s_nop 1
    v_add_f32_dpp v24, v24, v24 quad_perm:[2,3,0,1] row_mask:0xf bank_mask:0xf
    v_add_f32_dpp v25, v25, v25 quad_perm:[2,3,0,1] row_mask:0xf bank_mask:0xf
    s_nop 1
    v_add_f32_dpp v24, v24, v24 row_half_mirror row_mask:0xf bank_mask:0xf
    v_add_f32_dpp v25, v25, v25 row_half_mirror row_mask:0xf bank_mask:0xf
    s_nop 1
    v_mul_f32 v24, 0x3ae38e39, v24
    v_mul_f32 v25, 0x3ae38e39, v25
    v_fma_f32 v25, -v24, v24, v25
    v_max_f32 v25, 0, v25
    v_cvt_pk_bf16_f32 v26, v24, v24
    v_cvt_pk_bf16_f32 v29, v25, v25
    v_and_b32 v26, 0xffff0000, v26
    v_and_b32 v29, 0xffff0000, v29
    v_add_f32 v29, 0x3727c5ac, v29
    v_cvt_pk_bf16_f32 v29, v29, v29
    v_and_b32 v29, 0xffff0000, v29
    v_sqrt_f32 v29, v29
    s_nop 0
    v_cvt_pk_bf16_f32 v29, v29, v29
    v_and_b32 v29, 0xffff0000, v29
    s_waitcnt lgkmcnt(0)
    s_add_u32 s42, s100, 1
    s_max_u32 s42, s42, 1
    s_mul_i32 s42, s42, 0x9e3779b1
    v_lshrrev_b32 v29, 16, v29
    v_or_b32 v26, v26, v29
    v_xor_b32 v27, s42, v26
    v_lshlrev_b32 v2, 3, v2
    s_mov_b32 s42, 49283072
    v_cmp_eq_u32 vcc, 0, v4
    s_waitcnt vmcnt(0)
    s_mov_b64 exec, vcc
    buffer_store_dwordx2 v[26:27], v2, s[96:99], s42 offen sc1
    s_mov_b64 exec, -1
Lnoln:
    s_barrier
    s_waitcnt lgkmcnt(0)
    s_add_u32 s100, s100, 1
    s_max_u32 s100, s100, 1
    s_mul_i32 s100, s100, 0x9e3779b1
    s_mov_b32 s83, 0
    s_sub_u32 s42, s40, 72
    s_cmp_ge_u32 s40, 108
    s_cbranch_scc1 Lwarm
    s_cmp_ge_u32 s40, 72
    s_cbranch_scc1 Lw3
    s_mov_b32 s48, s22
    s_and_b32 s49, s23, 0xffff
    s_mov_b32 s50, 5308416
    s_mov_b32 s51, 0x20000
    s_lshl_b32 s42, s40, 1
    s_add_u32 s42, s42, s54
    v_lshrrev_b32 v2, 2, v1
    s_movk_i32 s43, 9216
    v_mul_lo_u32 v2, v2, s43
    v_and_b32 v3, 3, v1
    v_lshl_add_u32 v2, v3, 4, v2
    s_lshl_b32 s43, s42, 6
    s_mul_i32 s46, s55, 1327104
    s_add_u32 s43, s43, s46
    s_mul_i32 s46, s3, 9216
    s_add_u32 m0, s46, 0
    s_nop 0
    buffer_load_dwordx4 v2, s[48:51], s43 offen lds
    s_add_u32 s43, s43, 147456
    s_add_u32 m0, s46, 1024
    s_nop 0
    buffer_load_dwordx4 v2, s[48:51], s43 offen lds
    s_add_u32 s43, s43, 147456
    s_add_u32 m0, s46, 2048
    s_nop 0
    buffer_load_dwordx4 v2, s[48:51], s43 offen lds
    s_add_u32 s43, s43, 147456
    s_add_u32 m0, s46, 3072
    s_nop 0
    buffer_load_dwordx4 v2, s[48:51], s43 offen lds
    s_add_u32 s43, s43, 147456
    s_add_u32 m0, s46, 4096
    s_nop 0
    buffer_load_dwordx4 v2, s[48:51], s43 offen lds
    s_add_u32 s43, s43, 147456
    s_add_u32 m0, s46, 5120
    s_nop 0
    buffer_load_dwordx4 v2, s[48:51], s43 offen lds
    s_add_u32 s43, s43, 147456
    s_add_u32 m0, s46, 6144
    s_nop 0
    buffer_load_dwordx4 v2, s[48:51], s43 offen lds
    s_add_u32 s43, s43, 147456
    s_add_u32 m0, s46, 7168
    s_nop 0
    buffer_load_dwordx4 v2, s[48:51], s43 offen lds
    s_add_u32 s43, s43, 147456
    s_add_u32 m0, s46, 8192
    s_nop 0
    buffer_load_dwordx4 v2, s[48:51], s43 offen lds
    s_add_u32 s43, s43, 147456
    v_lshrrev_b32 v4, 5, v1
    v_lshlrev_b32 v4, 9, v4
    v_bfe_u32 v5, v1, 2, 2
    v_lshl_add_u32 v4, v5, 6, v4
    v_bfe_u32 v5, v1, 4, 1
    v_lshl_add_u32 v4, v5, 5, v4
    v_lshl_add_u32 v4, v3, 3, v4
    v_add_u32 v4, s46, v4
    s_mul_i32 s47, s42, 37888
    s_add_u32 s47, s47, 0
    s_add_u32 s56, s47, 36864
    s_mul_i32 s46, s55, 9216
    s_add_u32 s47, s47, s46
    v_mov_b32 v28, 0x3f803f80
    v_mov_b32 v16, 0
    v_mov_b32 v17, 0
    v_mov_b32 v18, 0
    v_mov_b32 v19, 0
    s_waitcnt vmcnt(8)
    ds_read_b64_tr_b16 v[32:33], v4 offset:0
    ds_read_b64_tr_b16 v[34:35], v4 offset:256
    s_waitcnt lgkmcnt(0)
    buffer_store_dwordx4 v[32:35], v8, s[96:99], s47 offen sc1
    s_add_u32 s47, s47, 1024
    v_dot2c_f32_bf16 v16, v32, v28
    v_dot2c_f32_bf16 v17, v33, v28
    v_dot2c_f32_bf16 v18, v34, v28
    v_dot2c_f32_bf16 v19, v35, v28
    s_waitcnt vmcnt(8)
    ds_read_b64_tr_b16 v[36:37], v4 offset:1024
    ds_read_b64_tr_b16 v[38:39], v4 offset:1280
    s_waitcnt lgkmcnt(0)
    buffer_store_dwordx4 v[36:39], v8, s[96:99], s47 offen sc1
    s_add_u32 s47, s47, 1024
    v_dot2c_f32_bf16 v16, v36, v28
    v_dot2c_f32_bf16 v17, v37, v28
    v_dot2c_f32_bf16 v18, v38, v28
    v_dot2c_f32_bf16 v19, v39, v28
    s_waitcnt vmcnt(8)
    ds_read_b64_tr_b16 v[40:41], v4 offset:2048
    ds_read_b64_tr_b16 v[42:43], v4 offset:2304
    s_waitcnt lgkmcnt(0)
    buffer_store_dwordx4 v[40:43], v8, s[96:99], s47 offen sc1
    s_add_u32 s47, s47, 1024
    v_dot2c_f32_bf16 v16, v40, v28
    v_dot2c_f32_bf16 v17, v41, v28
    v_dot2c_f32_bf16 v18, v42, v28
    v_dot2c_f32_bf16 v19, v43, v28
    s_waitcnt vmcnt(8)
    ds_read_b64_tr_b16 v[44:45], v4 offset:3072
    ds_read_b64_tr_b16 v[46:47], v4 offset:3328
    s_waitcnt lgkmcnt(0)
    buffer_store_dwordx4 v[44:47], v8, s[96:99], s47 offen sc1
    s_add_u32 s47, s47, 1024
    v_dot2c_f32_bf16 v16, v44, v28
    v_dot2c_f32_bf16 v17, v45, v28
    v_dot2c_f32_bf16 v18, v46, v28
    v_dot2c_f32_bf16 v19, v47, v28
    s_waitcnt vmcnt(8)
    ds_read_b64_tr_b16 v[48:49], v4 offset:4096
    ds_read_b64_tr_b16 v[50:51], v4 offset:4352
    s_waitcnt lgkmcnt(0)
    buffer_store_dwordx4 v[48:51], v8, s[96:99], s47 offen sc1
    s_add_u32 s47, s47, 1024
    v_dot2c_f32_bf16 v16, v48, v28
    v_dot2c_f32_bf16 v17, v49, v28
    v_dot2c_f32_bf16 v18, v50, v28
    v_dot2c_f32_bf16 v19, v51, v28
    s_waitcnt vmcnt(8)
    ds_read_b64_tr_b16 v[52:53], v4 offset:5120
    ds_read_b64_tr_b16 v[54:55], v4 offset:5376
    s_waitcnt lgkmcnt(0)
    buffer_store_dwordx4 v[52:55], v8, s[96:99], s47 offen sc1
    s_add_u32 s47, s47, 1024
    v_dot2c_f32_bf16 v16, v52, v28
    v_dot2c_f32_bf16 v17, v53, v28
    v_dot2c_f32_bf16 v18, v54, v28
    v_dot2c_f32_bf16 v19, v55, v28
    s_waitcnt vmcnt(8)
    ds_read_b64_tr_b16 v[56:57], v4 offset:6144
    ds_read_b64_tr_b16 v[58:59], v4 offset:6400
    s_waitcnt lgkmcnt(0)
    buffer_store_dwordx4 v[56:59], v8, s[96:99], s47 offen sc1
    s_add_u32 s47, s47, 1024
    v_dot2c_f32_bf16 v16, v56, v28
    v_dot2c_f32_bf16 v17, v57, v28
    v_dot2c_f32_bf16 v18, v58, v28
    v_dot2c_f32_bf16 v19, v59, v28
    s_waitcnt vmcnt(8)
    ds_read_b64_tr_b16 v[60:61], v4 offset:7168
    ds_read_b64_tr_b16 v[62:63], v4 offset:7424
    s_waitcnt lgkmcnt(0)
    buffer_store_dwordx4 v[60:63], v8, s[96:99], s47 offen sc1
    s_add_u32 s47, s47, 1024
    v_dot2c_f32_bf16 v16, v60, v28
    v_dot2c_f32_bf16 v17, v61, v28
    v_dot2c_f32_bf16 v18, v62, v28
    v_dot2c_f32_bf16 v19, v63, v28
    s_waitcnt vmcnt(8)
    ds_read_b64_tr_b16 v[64:65], v4 offset:8192
    ds_read_b64_tr_b16 v[66:67], v4 offset:8448
    s_waitcnt lgkmcnt(0)
    buffer_store_dwordx4 v[64:67], v8, s[96:99], s47 offen sc1
    s_add_u32 s47, s47, 1024
    v_dot2c_f32_bf16 v16, v64, v28
    v_dot2c_f32_bf16 v17, v65, v28
    v_dot2c_f32_bf16 v18, v66, v28
    v_dot2c_f32_bf16 v19, v67, v28
    s_nop 2
    v_add_f32 v16, v16, v17
    v_add_f32 v18, v18, v19
    v_add_f32 v16, v16, v18
    s_lshl_b32 s46, s3, 8
    s_add_u32 s46, s46, 73728
    v_lshlrev_b32 v5, 2, v1
    v_add_u32 v5, s46, v5
    ds_write_b32 v5, v16
    s_lshl_b32 s41, s42, 4
    s_lshl_b32 s43, s55, 2
    s_add_u32 s41, s41, s43
    s_add_u32 s41, s41, 49352704
    s_waitcnt lgkmcnt(0)
    s_barrier
    s_cmp_eq_u32 s55, 0
    s_cbranch_scc0 Lpsig
    ds_read_b32 v17, v5 offset:256
    ds_read_b32 v18, v5 offset:512
    ds_read_b32 v19, v5 offset:768
    s_waitcnt lgkmcnt(0)
    v_add_f32 v16, v16, v17
    v_add_f32 v18, v18, v19
    v_add_f32 v16, v16, v18
    v_mov_b32 v17, v16
    s_nop 1
    v_permlane32_swap_b32 v16, v17
    s_nop 1
    v_add_f32 v16, v16, v17
    v_sub_f32 v16, 0, v16
    v_cvt_pk_bf16_f32 v17, v16, v16
    v_and_b32 v17, 0xffff0000, v17
    v_sub_f32 v16, v16, v17
    v_cvt_pk_bf16_f32 v18, v16, v16
    v_and_b32 v18, 0xffff0000, v18
    v_sub_f32 v16, v16, v18
    v_cvt_pk_bf16_f32 v19, v16, v16
    v_lshrrev_b32 v17, 16, v17
    v_or_b32 v24, v17, v18
    v_and_b32 v25, 0xffff, v19
    v_cmp_gt_u32 vcc, 32, v1
    v_mov_b32 v26, 0
    v_mov_b32 v27, 0
    v_cndmask_b32 v24, 0, v24, vcc
    v_cndmask_b32 v25, 0, v25, vcc
    buffer_store_dwordx4 v[24:27], v8, s[96:99], s56 offen sc1
    s_branch Lpsig
Lw3:
    s_mov_b32 s48, s26
    s_and_b32 s49, s27, 0xffff
    s_mov_b32 s50, 2654208
    s_mov_b32 s51, 0x20000
    s_mul_i32 s43, s42, 73728
    s_mul_i32 s46, s3, 9216
    s_add_u32 s43, s43, s46
    s_add_u32 m0, s46, 0
    s_nop 0
    buffer_load_dwordx4 v8, s[48:51], s43 offen lds
    s_add_u32 s43, s43, 1024
    s_add_u32 m0, s46, 1024
    s_nop 0
    buffer_load_dwordx4 v8, s[48:51], s43 offen lds
    s_add_u32 s43, s43, 1024
    s_add_u32 m0, s46, 2048
    s_nop 0
    buffer_load_dwordx4 v8, s[48:51], s43 offen lds
    s_add_u32 s43, s43, 1024
    s_add_u32 m0, s46, 3072
    s_nop 0
    buffer_load_dwordx4 v8, s[48:51], s43 offen lds
    s_add_u32 s43, s43, 1024
    s_add_u32 m0, s46, 4096
    s_nop 0
    buffer_load_dwordx4 v8, s[48:51], s43 offen lds
    s_add_u32 s43, s43, 1024
    s_add_u32 m0, s46, 5120
    s_nop 0
    buffer_load_dwordx4 v8, s[48:51], s43 offen lds
    s_add_u32 s43, s43, 1024
    s_add_u32 m0, s46, 6144
    s_nop 0
    buffer_load_dwordx4 v8, s[48:51], s43 offen lds
    s_add_u32 s43, s43, 1024
    s_add_u32 m0, s46, 7168
    s_nop 0
    buffer_load_dwordx4 v8, s[48:51], s43 offen lds
    s_add_u32 s43, s43, 1024
    s_add_u32 m0, s46, 8192
    s_nop 0
    buffer_load_dwordx4 v8, s[48:51], s43 offen lds
    s_add_u32 s43, s43, 1024
    v_lshrrev_b32 v4, 2, v1
    s_movk_i32 s47, 1152
    v_mul_lo_u32 v4, v4, s47
    v_and_b32 v5, 3, v1
    v_lshl_add_u32 v4, v5, 3, v4
    s_mul_i32 s46, s54, 36864
    s_mul_i32 s47, s55, 288
    s_add_u32 s46, s46, s47
    v_add_u32 v4, s46, v4
    s_lshl_b32 s47, s42, 1
    s_add_u32 s47, s47, s54
    s_lshl_b32 s41, s47, 4
    s_lshl_b32 s43, s55, 2
    s_add_u32 s41, s41, s43
    s_add_u32 s41, s41, 49356800
    s_lshl_b32 s47, s47, 10
    s_mul_i32 s46, s55, 663552
    s_add_u32 s47, s47, s46
    s_add_u32 s47, s47, 6291456
    s_waitcnt vmcnt(0)
    s_barrier
    ds_read_b64_tr_b16 v[32:33], v4 offset:0
    ds_read_b64_tr_b16 v[34:35], v4 offset:18432
    ds_read_b64_tr_b16 v[36:37], v4 offset:32
    ds_read_b64_tr_b16 v[38:39], v4 offset:18464
    ds_read_b64_tr_b16 v[40:41], v4 offset:64
    ds_read_b64_tr_b16 v[42:43], v4 offset:18496
    ds_read_b64_tr_b16 v[44:45], v4 offset:96
    ds_read_b64_tr_b16 v[46:47], v4 offset:18528
    ds_read_b64_tr_b16 v[48:49], v4 offset:128
    ds_read_b64_tr_b16 v[50:51], v4 offset:18560
    ds_read_b64_tr_b16 v[52:53], v4 offset:160
    ds_read_b64_tr_b16 v[54:55], v4 offset:18592
    ds_read_b64_tr_b16 v[56:57], v4 offset:192
    ds_read_b64_tr_b16 v[58:59], v4 offset:18624
    ds_read_b64_tr_b16 v[60:61], v4 offset:224
    ds_read_b64_tr_b16 v[62:63], v4 offset:18656
    ds_read_b64_tr_b16 v[64:65], v4 offset:256
    ds_read_b64_tr_b16 v[66:67], v4 offset:18688
    s_waitcnt lgkmcnt(15)
    buffer_store_dwordx4 v[32:35], v8, s[96:99], s47 offen sc1
    s_add_u32 s47, s47, 73728
    s_waitcnt lgkmcnt(14)
    buffer_store_dwordx4 v[36:39], v8, s[96:99], s47 offen sc1
    s_add_u32 s47, s47, 73728
    s_waitcnt lgkmcnt(12)
    buffer_store_dwordx4 v[40:43], v8, s[96:99], s47 offen sc1
    s_add_u32 s47, s47, 73728
    s_waitcnt lgkmcnt(10)
    buffer_store_dwordx4 v[44:47], v8, s[96:99], s47 offen sc1
    s_add_u32 s47, s47, 73728
    s_waitcnt lgkmcnt(8)
    buffer_store_dwordx4 v[48:51], v8, s[96:99], s47 offen sc1
    s_add_u32 s47, s47, 73728
    s_waitcnt lgkmcnt(6)
    buffer_store_dwordx4 v[52:55], v8, s[96:99], s47 offen sc1
    s_add_u32 s47, s47, 73728
    s_waitcnt lgkmcnt(4)
    buffer_store_dwordx4 v[56:59], v8, s[96:99], s47 offen sc1
    s_add_u32 s47, s47, 73728
    s_waitcnt lgkmcnt(2)
    buffer_store_dwordx4 v[60:63], v8, s[96:99], s47 offen sc1
    s_add_u32 s47, s47, 73728
    s_waitcnt lgkmcnt(0)
    buffer_store_dwordx4 v[64:67], v8, s[96:99], s47 offen sc1
    s_add_u32 s47, s47, 73728
    s_mov_b32 s83, s41
    s_branch Lwarm
Lpsig:
    v_mov_b32 v12, s100
    v_mov_b32 v13, 0
    s_waitcnt vmcnt(0)
    s_mov_b64 exec, 1
    buffer_store_dword v12, v13, s[96:99], s41 offen sc1
    s_mov_b64 exec, -1
Lwarm:
    s_getpc_b64 s[64:65]
Lpc12:
    s_add_u32 s64, s64, P1 - Lpc12
    s_addc_u32 s65, s65, 0
    s_mul_i32 s66, s101, 9216
    v_lshlrev_b32 v249, 4, v1
    v_add_u32 v249, s66, v249
    v_min_u32 v248, Lend - P1 - 16, v249
    global_load_dwordx4 v[64:67], v248, s[64:65]
    v_add_u32 v249, 1024, v249
    v_min_u32 v248, Lend - P1 - 16, v249
    global_load_dwordx4 v[68:71], v248, s[64:65]
    v_add_u32 v249, 1024, v249
    v_min_u32 v248, Lend - P1 - 16, v249
    global_load_dwordx4 v[72:75], v248, s[64:65]
    v_add_u32 v249, 1024, v249
    v_min_u32 v248, Lend - P1 - 16, v249
    global_load_dwordx4 v[76:79], v248, s[64:65]
    v_add_u32 v249, 1024, v249
    v_min_u32 v248, Lend - P1 - 16, v249
    global_load_dwordx4 v[80:83], v248, s[64:65]
    v_add_u32 v249, 1024, v249
    v_min_u32 v248, Lend - P1 - 16, v249
    global_load_dwordx4 v[84:87], v248, s[64:65]
    v_add_u32 v249, 1024, v249
    v_min_u32 v248, Lend - P1 - 16, v249
    global_load_dwordx4 v[88:91], v248, s[64:65]
    v_add_u32 v249, 1024, v249
    v_min_u32 v248, Lend - P1 - 16, v249
    global_load_dwordx4 v[92:95], v248, s[64:65]
    v_add_u32 v249, 1024, v249
    v_min_u32 v248, Lend - P1 - 16, v249
    global_load_dwordx4 v[96:99], v248, s[64:65]
    v_add_u32 v249, 1024, v249
    s_cmp_eq_u32 s101, 0
    s_cbranch_scc0 Lci13
    s_waitcnt vmcnt(0)
    s_getreg_b32 s85, hwreg(HW_REG_XCC_ID)
    s_and_b32 s85, s85, 7
    s_lshl_b32 s84, s85, 5
    v_mov_b32 v250, s84
    v_mov_b32 v251, 1
    s_mov_b64 exec, 1
    global_atomic_add v252, v250, v251, s[28:29] sc0 sc1
    s_mov_b64 exec, -1
Lci13:
    s_cmp_eq_u32 s101, 0
    s_cbranch_scc0 Lcf14
    s_mov_b32 s90, 0
Lcl15:
    s_waitcnt vmcnt(0)
    v_readfirstlane_b32 s84, v252
    s_add_u32 s90, s90, 1
    s_nop 3
    s_cmp_lt_u32 s84, 32
    s_cbranch_scc1 Lco16
    s_and_b32 s84, s84, 31
    s_cmp_gt_u32 s90, 8
    s_cbranch_scc1 Lco16
    s_add_u32 s85, s85, 1
    s_and_b32 s85, s85, 7
    s_lshl_b32 s84, s85, 5
    v_mov_b32 v250, s84
    s_mov_b64 exec, 1
    global_atomic_add v252, v250, v251, s[28:29] sc0 sc1
    s_mov_b64 exec, -1
    s_branch Lcl15
Lco16:
    s_lshl_b32 s84, s84, 3
    s_or_b32 s84, s84, s85
    v_mov_b32 v250, 139264
    v_mov_b32 v251, s84
    ds_write_b32 v250, v251
    s_waitcnt lgkmcnt(0)
Lcf14:
    s_cmp_eq_u32 s101, 0
    s_cbranch_scc0 Lne17
    s_and_b32 s36, s2, 7
    s_lshl_b32 s36, s36, 7
    s_add_u32 s36, s36, 49373184
    v_mov_b32 v25, 0
    s_mov_b32 s90, 0
Lpl18:
    buffer_load_dword v28, v25, s[96:99], s36 offen sc1
    s_waitcnt vmcnt(0)
    v_cmp_ne_u32 vcc, s100, v28
    s_add_u32 s90, s90, 1
    s_cmp_eq_u64 vcc, 0
    s_cbranch_scc1 Lok19
    s_sleep 8
    s_cmp_lt_u32 s90, 0x20000
    s_cbranch_scc1 Lpl18
Lok19:
Lne17:
    s_barrier
    s_branch P1
P1:
    v_mov_b32 v2, 139264
    ds_read_b32 v2, v2
    s_waitcnt lgkmcnt(0)
    v_readfirstlane_b32 s91, v2
    s_nop 3
    s_and_b32 s10, s91, 7
    s_lshr_b32 s11, s91, 3
    s_and_b32 s12, s10, 1
    s_lshl_b32 s12, s12, 3
    s_and_b32 s13, s11, 7
    s_add_u32 s12, s12, s13
    s_lshr_b32 s13, s10, 1
    s_lshl_b32 s13, s13, 2
    s_lshr_b32 s14, s11, 3
    s_add_u32 s13, s13, s14
    s_and_b32 s14, s101, 3
    v_and_b32 v1, 63, v0
    v_lshlrev_b32 v8, 4, v1
    v_and_b32 v2, 31, v1
    v_lshrrev_b32 v3, 5, v1
    s_lshl_b32 s18, s12, 2
    s_add_u32 s18, s18, s14
    s_mul_i32 s20, s13, 9
    s_add_u32 s21, s20, 1
    s_lshr_b32 s21, s21, 1
    s_lshr_b32 s22, s20, 1
    s_and_b32 s32, s13, 1
    s_lshl_b32 s33, s14, 11
    s_add_u32 s33, s33, 116736
    v_add_u32 v7, s33, v8
    s_lshl_b32 s33, s14, 10
    s_add_u32 s33, s33, 133120
    v_add_u32 v6, s33, v8
    s_lshl_b32 s34, s13, 8
    s_lshl_b32 s33, s18, 2
    s_add_u32 s34, s34, s33
    s_cmp_lt_u32 s101, 4
    s_cbranch_scc1 Lg1h
    s_setprio 1
    v_lshrrev_b32 v24, 4, v2
    s_lshl_b32 s33, s18, 1
    v_add_u32 v24, s33, v24
    s_mov_b32 s33, 73728
    v_mul_lo_u32 v5, v24, s33
    v_and_b32 v24, 15, v2
    v_lshl_add_u32 v5, v24, 4, v5
    v_lshl_add_u32 v5, v3, 8, v5
    s_lshl_b32 s35, s22, 10
    s_add_u32 s35, s35, 16777216
    s_mul_i32 s19, s18, 36864
    s_add_u32 s19, s19, 12582912
    v_add_u32 v4, 58368, v8
    v_cmp_eq_u32 s[74:75], 0, v3
    s_add_u32 s34, s34, 49364992
    s_bfe_u32 s33, s18, 0x20001
    s_lshl_b32 s33, s33, 10
    s_add_u32 s33, s33, 49348608
    v_min_u32 v24, 35, v1
    v_lshlrev_b32 v24, 4, v24
    v_mov_b32 v240, 0
    v_mov_b32 v176, 0x3f803f80
    v_mov_b32 v241, 0
    v_mov_b32 v177, 0x3f803f80
    v_mov_b32 v242, 0
    v_mov_b32 v178, 0x3f803f80
    v_mov_b32 v243, 0
    v_mov_b32 v179, 0x3f803f80
    s_load_dwordx2 s[56:57], s[0:1], 88
    s_cmp_eq_u32 s101, 4
    s_cbranch_scc0 Lng20
    s_and_b32 s36, s2, 15
    s_lshl_b32 s36, s36, 10
    s_add_u32 s36, s36, 49381376
    s_mov_b32 s90, 0
Lpl21:
    buffer_load_dwordx4 v[28:31], v24, s[96:99], s36 offen sc1
    s_waitcnt vmcnt(0)
    v_cmp_ne_u32 vcc, s100, v28
    v_cmp_ne_u32 s[88:89], s100, v29
    s_or_b64 vcc, vcc, s[88:89]
    v_cmp_ne_u32 s[88:89], s100, v30
    s_or_b64 vcc, vcc, s[88:89]
    v_cmp_ne_u32 s[88:89], s100, v31
    s_or_b64 vcc, vcc, s[88:89]
    s_add_u32 s90, s90, 1
    s_cmp_eq_u64 vcc, 0
    s_cbranch_scc1 Lok22
    s_sleep 8
    s_cmp_lt_u32 s90, 0x20000
    s_cbranch_scc1 Lpl21
Lok22:
Lng20:
    s_barrier
    buffer_load_dwordx4 v[32:35], v8, s[96:99], s19 offen offset:0 sc1
    buffer_load_dwordx4 v[36:39], v8, s[96:99], s19 offen offset:1024 sc1
    buffer_load_dwordx4 v[40:43], v8, s[96:99], s19 offen offset:2048 sc1
    buffer_load_dwordx4 v[44:47], v8, s[96:99], s19 offen offset:3072 sc1
    s_add_u32 s19, s19, 4096
    buffer_load_dwordx4 v[48:51], v8, s[96:99], s19 offen offset:0 sc1
    buffer_load_dwordx4 v[52:55], v8, s[96:99], s19 offen offset:1024 sc1
    buffer_load_dwordx4 v[56:59], v8, s[96:99], s19 offen offset:2048 sc1
    buffer_load_dwordx4 v[60:63], v8, s[96:99], s19 offen offset:3072 sc1
    s_waitcnt lgkmcnt(0)
    s_mov_b32 s60, s56
    s_and_b32 s61, s57, 0xffff
    s_mov_b32 s62, 8388608
    s_mov_b32 s63, 0x20000
    s_lshl_b32 s56, s2, 2
    s_add_u32 s56, s56, s14
    s_lshl_b32 s56, s56, 13
    s_mov_b32 m0, 137216
    v_subrev_u32 v9, 116736, v7
    s_barrier
    ds_read_b128 v[180:183], v8 offset:0
    ds_read_b128 v[184:187], v8 offset:1024
    ds_read_b128 v[188:191], v8 offset:2048
    ds_read_b128 v[192:195], v8 offset:3072
    ds_read_b128 v[196:199], v8 offset:4096
    s_add_u32 s19, s19, 4096
    buffer_load_dwordx4 v[64:67], v8, s[96:99], s19 offen offset:0 sc1
    buffer_load_dwordx4 v[68:71], v8, s[96:99], s19 offen offset:1024 sc1
    s_waitcnt vmcnt(9)
    v_permlane16_swap_b32 v32, v34
    v_permlane16_swap_b32 v33, v35
    s_waitcnt vmcnt(8)
    v_permlane16_swap_b32 v36, v38
    v_permlane16_swap_b32 v37, v39
    s_waitcnt lgkmcnt(4)
    v_mfma_f32_32x32x16_bf16 v[208:223], v[180:183], v[32:35], 0
    ds_read_b128 v[200:203], v8 offset:5120
    v_dot2c_f32_bf16 v240, v32, v32
    v_dot2c_f32_bf16 v241, v33, v33
    v_mfma_f32_32x32x16_bf16 v[224:239], v[176:179], v[32:35], 0
    v_dot2c_f32_bf16 v242, v34, v34
    v_dot2c_f32_bf16 v243, v35, v35
    buffer_load_dwordx4 v[72:75], v8, s[96:99], s19 offen offset:2048 sc1
    buffer_load_dwordx4 v[76:79], v8, s[96:99], s19 offen offset:3072 sc1
    s_waitcnt vmcnt(9)
    v_permlane16_swap_b32 v40, v42
    v_permlane16_swap_b32 v41, v43
    s_waitcnt lgkmcnt(3)
    v_mfma_f32_32x32x16_bf16 v[208:223], v[184:187], v[36:39], v[208:223]
    ds_read_b128 v[204:207], v8 offset:6144
    v_dot2c_f32_bf16 v240, v36, v36
    v_dot2c_f32_bf16 v241, v37, v37
    v_mfma_f32_32x32x16_bf16 v[224:239], v[176:179], v[36:39], v[224:239]
    v_dot2c_f32_bf16 v242, v38, v38
    v_dot2c_f32_bf16 v243, v39, v39
    s_add_u32 s19, s19, 4096
    buffer_load_dwordx4 v[80:83], v8, s[96:99], s19 offen offset:0 sc1
    buffer_load_dwordx4 v[84:87], v8, s[96:99], s19 offen offset:1024 sc1
    s_waitcnt vmcnt(10)
    v_permlane16_swap_b32 v44, v46
    v_permlane16_swap_b32 v45, v47
    v_mfma_f32_32x32x16_bf16 v[208:223], v[188:191], v[40:43], v[208:223]
    ds_read_b128 v[180:183], v8 offset:7168
    v_dot2c_f32_bf16 v240, v40, v40
    v_dot2c_f32_bf16 v241, v41, v41
    v_mfma_f32_32x32x16_bf16 v[224:239], v[176:179], v[40:43], v[224:239]
    v_dot2c_f32_bf16 v242, v42, v42
    v_dot2c_f32_bf16 v243, v43, v43
    buffer_load_dwordx4 v[88:91], v8, s[96:99], s19 offen offset:2048 sc1
    buffer_load_dwordx4 v[92:95], v8, s[96:99], s19 offen offset:3072 sc1
    s_waitcnt vmcnt(11)
    v_permlane16_swap_b32 v48, v50
    v_permlane16_swap_b32 v49, v51
    s_waitcnt lgkmcnt(3)
    v_mfma_f32_32x32x16_bf16 v[208:223], v[192:195], v[44:47], v[208:223]
    ds_read_b128 v[184:187], v8 offset:8192
    v_dot2c_f32_bf16 v240, v44, v44
    v_dot2c_f32_bf16 v241, v45, v45
    v_mfma_f32_32x32x16_bf16 v[224:239], v[176:179], v[44:47], v[224:239]
    v_dot2c_f32_bf16 v242, v46, v46
    v_dot2c_f32_bf16 v243, v47, v47
    s_add_u32 s19, s19, 4096
    buffer_load_dwordx4 v[96:99], v8, s[96:99], s19 offen offset:0 sc1
    buffer_load_dwordx4 v[100:103], v8, s[96:99], s19 offen offset:1024 sc1
    s_waitcnt vmcnt(12)
    v_permlane16_swap_b32 v52, v54
    v_permlane16_swap_b32 v53, v55
    v_mfma_f32_32x32x16_bf16 v[208:223], v[196:199], v[48:51], v[208:223]
    ds_read_b128 v[188:191], v8 offset:9216
    v_dot2c_f32_bf16 v240, v48, v48
    v_dot2c_f32_bf16 v241, v49, v49
    v_mfma_f32_32x32x16_bf16 v[224:239], v[176:179], v[48:51], v[224:239]
    v_dot2c_f32_bf16 v242, v50, v50
    v_dot2c_f32_bf16 v243, v51, v51
    buffer_load_dwordx4 v[104:107], v8, s[96:99], s19 offen offset:2048 sc1
    buffer_load_dwordx4 v[108:111], v8, s[96:99], s19 offen offset:3072 sc1
    s_waitcnt vmcnt(13)
    v_permlane16_swap_b32 v56, v58
    v_permlane16_swap_b32 v57, v59
    s_waitcnt lgkmcnt(3)
    v_mfma_f32_32x32x16_bf16 v[208:223], v[200:203], v[52:55], v[208:223]
    ds_read_b128 v[192:195], v8 offset:10240
    v_dot2c_f32_bf16 v240, v52, v52
    v_dot2c_f32_bf16 v241, v53, v53
    v_mfma_f32_32x32x16_bf16 v[224:239], v[176:179], v[52:55], v[224:239]
    v_dot2c_f32_bf16 v242, v54, v54
    v_dot2c_f32_bf16 v243, v55, v55
    s_add_u32 s19, s19, 4096
    buffer_load_dwordx4 v[112:115], v8, s[96:99], s19 offen offset:0 sc1
    buffer_load_dwordx4 v[116:119], v8, s[96:99], s19 offen offset:1024 sc1
    s_waitcnt vmcnt(14)
    v_permlane16_swap_b32 v60, v62
    v_permlane16_swap_b32 v61, v63
    v_mfma_f32_32x32x16_bf16 v[208:223], v[204:207], v[56:59], v[208:223]
    ds_read_b128 v[196:199], v8 offset:11264
    v_dot2c_f32_bf16 v240, v56, v56
    v_dot2c_f32_bf16 v241, v57, v57
    v_mfma_f32_32x32x16_bf16 v[224:239], v[176:179], v[56:59], v[224:239]
    v_dot2c_f32_bf16 v242, v58, v58
    v_dot2c_f32_bf16 v243, v59, v59
    buffer_load_dwordx4 v[120:123], v8, s[96:99], s19 offen offset:2048 sc1
    buffer_load_dwordx4 v[124:127], v8, s[96:99], s19 offen offset:3072 sc1
    s_waitcnt vmcnt(15)
    v_permlane16_swap_b32 v64, v66
    v_permlane16_swap_b32 v65, v67
    s_waitcnt lgkmcnt(3)
    v_mfma_f32_32x32x16_bf16 v[208:223], v[180:183], v[60:63], v[208:223]
    ds_read_b128 v[200:203], v8 offset:12288
    v_dot2c_f32_bf16 v240, v60, v60
    v_dot2c_f32_bf16 v241, v61, v61
    v_mfma_f32_32x32x16_bf16 v[224:239], v[176:179], v[60:63], v[224:239]
    v_dot2c_f32_bf16 v242, v62, v62
    v_dot2c_f32_bf16 v243, v63, v63
    s_add_u32 s19, s19, 4096
    buffer_load_dwordx4 v[128:131], v8, s[96:99], s19 offen offset:0 sc1
    buffer_load_dwordx4 v[132:135], v8, s[96:99], s19 offen offset:1024 sc1
    s_waitcnt vmcnt(16)
    v_permlane16_swap_b32 v68, v70
    v_permlane16_swap_b32 v69, v71
    v_mfma_f32_32x32x16_bf16 v[208:223], v[184:187], v[64:67], v[208:223]
    ds_read_b128 v[204:207], v8 offset:13312
    v_dot2c_f32_bf16 v240, v64, v64
    v_dot2c_f32_bf16 v241, v65, v65
    v_mfma_f32_32x32x16_bf16 v[224:239], v[176:179], v[64:67], v[224:239]
    v_dot2c_f32_bf16 v242, v66, v66
    v_dot2c_f32_bf16 v243, v67, v67
    buffer_load_dwordx4 v[136:139], v8, s[96:99], s19 offen offset:2048 sc1
    buffer_load_dwordx4 v[140:143], v8, s[96:99], s19 offen offset:3072 sc1
    s_waitcnt vmcnt(17)
    v_permlane16_swap_b32 v72, v74
    v_permlane16_swap_b32 v73, v75
    s_waitcnt lgkmcnt(3)
    v_mfma_f32_32x32x16_bf16 v[208:223], v[188:191], v[68:71], v[208:223]
    ds_read_b128 v[180:183], v8 offset:14336
    v_dot2c_f32_bf16 v240, v68, v68
    v_dot2c_f32_bf16 v241, v69, v69
    v_mfma_f32_32x32x16_bf16 v[224:239], v[176:179], v[68:71], v[224:239]
    v_dot2c_f32_bf16 v242, v70, v70
    v_dot2c_f32_bf16 v243, v71, v71
    s_add_u32 s19, s19, 4096
    buffer_load_dwordx4 v[144:147], v8, s[96:99], s19 offen offset:0 sc1
    buffer_load_dwordx4 v[148:151], v8, s[96:99], s19 offen offset:1024 sc1
    s_waitcnt vmcnt(18)
    v_permlane16_swap_b32 v76, v78
    v_permlane16_swap_b32 v77, v79
    v_mfma_f32_32x32x16_bf16 v[208:223], v[192:195], v[72:75], v[208:223]
    ds_read_b128 v[184:187], v8 offset:15360
    v_dot2c_f32_bf16 v240, v72, v72
    v_dot2c_f32_bf16 v241, v73, v73
    v_mfma_f32_32x32x16_bf16 v[224:239], v[176:179], v[72:75], v[224:239]
    v_dot2c_f32_bf16 v242, v74, v74
    v_dot2c_f32_bf16 v243, v75, v75
    buffer_load_dwordx4 v[152:155], v8, s[96:99], s19 offen offset:2048 sc1
    s_waitcnt vmcnt(18)
    v_permlane16_swap_b32 v80, v82
    v_permlane16_swap_b32 v81, v83
    s_waitcnt lgkmcnt(3)
    v_mfma_f32_32x32x16_bf16 v[208:223], v[196:199], v[76:79], v[208:223]
    ds_read_b128 v[188:191], v8 offset:16384
    v_dot2c_f32_bf16 v240, v76, v76
    v_dot2c_f32_bf16 v241, v77, v77
    v_mfma_f32_32x32x16_bf16 v[224:239], v[176:179], v[76:79], v[224:239]
    v_dot2c_f32_bf16 v242, v78, v78
    v_dot2c_f32_bf16 v243, v79, v79
    buffer_load_dwordx4 v[156:159], v8, s[96:99], s19 offen offset:3072 sc1
    s_waitcnt vmcnt(18)
    v_permlane16_swap_b32 v84, v86
    v_permlane16_swap_b32 v85, v87
    v_mfma_f32_32x32x16_bf16 v[208:223], v[200:203], v[80:83], v[208:223]
    ds_read_b128 v[192:195], v8 offset:17408
    v_dot2c_f32_bf16 v240, v80, v80
    v_dot2c_f32_bf16 v241, v81, v81
    v_mfma_f32_32x32x16_bf16 v[224:239], v[176:179], v[80:83], v[224:239]
    v_dot2c_f32_bf16 v242, v82, v82
    v_dot2c_f32_bf16 v243, v83, v83
    s_add_u32 s19, s19, 4096
    buffer_load_dwordx4 v[160:163], v8, s[96:99], s19 offen offset:0 sc1
    s_waitcnt vmcnt(18)
    v_permlane16_swap_b32 v88, v90
    v_permlane16_swap_b32 v89, v91
    s_waitcnt lgkmcnt(3)
    v_mfma_f32_32x32x16_bf16 v[208:223], v[204:207], v[84:87], v[208:223]
    v_dot2c_f32_bf16 v240, v84, v84
    v_dot2c_f32_bf16 v241, v85, v85
    v_mfma_f32_32x32x16_bf16 v[224:239], v[176:179], v[84:87], v[224:239]
    v_dot2c_f32_bf16 v242, v86, v86
    v_dot2c_f32_bf16 v243, v87, v87
    buffer_load_dwordx4 v[164:167], v8, s[96:99], s19 offen offset:1024 sc1
    s_waitcnt vmcnt(18)
    v_permlane16_swap_b32 v92, v94
    v_permlane16_swap_b32 v93, v95
    v_mfma_f32_32x32x16_bf16 v[208:223], v[180:183], v[88:91], v[208:223]
    v_dot2c_f32_bf16 v240, v88, v88
    v_dot2c_f32_bf16 v241, v89, v89
    v_mfma_f32_32x32x16_bf16 v[224:239], v[176:179], v[88:91], v[224:239]
    v_dot2c_f32_bf16 v242, v90, v90
    v_dot2c_f32_bf16 v243, v91, v91
    s_waitcnt lgkmcnt(0)
    s_barrier
    ds_read_b128 v[196:199], v8 offset:19456
    ds_read_b128 v[200:203], v8 offset:20480
    buffer_load_dwordx4 v[168:171], v8, s[96:99], s19 offen offset:2048 sc1
    s_waitcnt vmcnt(18)
    v_permlane16_swap_b32 v96, v98
    v_permlane16_swap_b32 v97, v99
    v_mfma_f32_32x32x16_bf16 v[208:223], v[184:187], v[92:95], v[208:223]
    ds_read_b128 v[204:207], v8 offset:21504
    v_dot2c_f32_bf16 v240, v92, v92
    v_dot2c_f32_bf16 v241, v93, v93
    v_mfma_f32_32x32x16_bf16 v[224:239], v[176:179], v[92:95], v[224:239]
    v_dot2c_f32_bf16 v242, v94, v94
    v_dot2c_f32_bf16 v243, v95, v95
    buffer_load_dwordx4 v[172:175], v8, s[96:99], s19 offen offset:3072 sc1
    s_waitcnt vmcnt(18)
    v_permlane16_swap_b32 v100, v102
    v_permlane16_swap_b32 v101, v103
    v_mfma_f32_32x32x16_bf16 v[208:223], v[188:191], v[96:99], v[208:223]
    ds_read_b128 v[180:183], v8 offset:22528
    v_dot2c_f32_bf16 v240, v96, v96
    v_dot2c_f32_bf16 v241, v97, v97
    v_mfma_f32_32x32x16_bf16 v[224:239], v[176:179], v[96:99], v[224:239]
    v_dot2c_f32_bf16 v242, v98, v98
    v_dot2c_f32_bf16 v243, v99, v99
    s_waitcnt vmcnt(17)
    v_permlane16_swap_b32 v104, v106
    v_permlane16_swap_b32 v105, v107
    s_waitcnt lgkmcnt(3)
    v_mfma_f32_32x32x16_bf16 v[208:223], v[192:195], v[100:103], v[208:223]
    ds_read_b128 v[184:187], v8 offset:23552
    v_dot2c_f32_bf16 v240, v100, v100
    v_dot2c_f32_bf16 v241, v101, v101
    v_mfma_f32_32x32x16_bf16 v[224:239], v[176:179], v[100:103], v[224:239]
    v_dot2c_f32_bf16 v242, v102, v102
    v_dot2c_f32_bf16 v243, v103, v103
    s_waitcnt vmcnt(16)
    v_permlane16_swap_b32 v108, v110
    v_permlane16_swap_b32 v109, v111
    v_mfma_f32_32x32x16_bf16 v[208:223], v[196:199], v[104:107], v[208:223]
    ds_read_b128 v[188:191], v8 offset:24576
    v_dot2c_f32_bf16 v240, v104, v104
    v_dot2c_f32_bf16 v241, v105, v105
    v_mfma_f32_32x32x16_bf16 v[224:239], v[176:179], v[104:107], v[224:239]
    v_dot2c_f32_bf16 v242, v106, v106
    v_dot2c_f32_bf16 v243, v107, v107
    s_waitcnt vmcnt(15)
    v_permlane16_swap_b32 v112, v114
    v_permlane16_swap_b32 v113, v115
    s_waitcnt lgkmcnt(3)
    v_mfma_f32_32x32x16_bf16 v[208:223], v[200:203], v[108:111], v[208:223]
    ds_read_b128 v[192:195], v8 offset:25600
    v_dot2c_f32_bf16 v240, v108, v108
    v_dot2c_f32_bf16 v241, v109, v109
    v_mfma_f32_32x32x16_bf16 v[224:239], v[176:179], v[108:111], v[224:239]
    v_dot2c_f32_bf16 v242, v110, v110
    v_dot2c_f32_bf16 v243, v111, v111
    s_waitcnt vmcnt(14)
    v_permlane16_swap_b32 v116, v118
    v_permlane16_swap_b32 v117, v119
    v_mfma_f32_32x32x16_bf16 v[208:223], v[204:207], v[112:115], v[208:223]
    ds_read_b128 v[196:199], v8 offset:26624
    v_dot2c_f32_bf16 v240, v112, v112
    v_dot2c_f32_bf16 v241, v113, v113
    v_mfma_f32_32x32x16_bf16 v[224:239], v[176:179], v[112:115], v[224:239]
    v_dot2c_f32_bf16 v242, v114, v114
    v_dot2c_f32_bf16 v243, v115, v115
    s_waitcnt vmcnt(13)
    v_permlane16_swap_b32 v120, v122
    v_permlane16_swap_b32 v121, v123
    s_waitcnt lgkmcnt(3)
    v_mfma_f32_32x32x16_bf16 v[208:223], v[180:183], v[116:119], v[208:223]
    ds_read_b128 v[200:203], v8 offset:27648
    v_dot2c_f32_bf16 v240, v116, v116
    v_dot2c_f32_bf16 v241, v117, v117
    v_mfma_f32_32x32x16_bf16 v[224:239], v[176:179], v[116:119], v[224:239]
    v_dot2c_f32_bf16 v242, v118, v118
    v_dot2c_f32_bf16 v243, v119, v119
    s_waitcnt vmcnt(12)
    v_permlane16_swap_b32 v124, v126
    v_permlane16_swap_b32 v125, v127
    v_mfma_f32_32x32x16_bf16 v[208:223], v[184:187], v[120:123], v[208:223]
    ds_read_b128 v[204:207], v8 offset:28672
    v_dot2c_f32_bf16 v240, v120, v120
    v_dot2c_f32_bf16 v241, v121, v121
    v_mfma_f32_32x32x16_bf16 v[224:239], v[176:179], v[120:123], v[224:239]
    v_dot2c_f32_bf16 v242, v122, v122
    v_dot2c_f32_bf16 v243, v123, v123
    s_waitcnt vmcnt(11)
    v_permlane16_swap_b32 v128, v130
    v_permlane16_swap_b32 v129, v131
    s_waitcnt lgkmcnt(3)
    v_mfma_f32_32x32x16_bf16 v[208:223], v[188:191], v[124:127], v[208:223]
    ds_read_b128 v[180:183], v8 offset:29696
    v_dot2c_f32_bf16 v240, v124, v124
    v_dot2c_f32_bf16 v241, v125, v125
    v_mfma_f32_32x32x16_bf16 v[224:239], v[176:179], v[124:127], v[224:239]
    v_dot2c_f32_bf16 v242, v126, v126
    v_dot2c_f32_bf16 v243, v127, v127
    s_waitcnt vmcnt(10)
    v_permlane16_swap_b32 v132, v134
    v_permlane16_swap_b32 v133, v135
    v_mfma_f32_32x32x16_bf16 v[208:223], v[192:195], v[128:131], v[208:223]
    ds_read_b128 v[184:187], v8 offset:30720
    v_dot2c_f32_bf16 v240, v128, v128
    v_dot2c_f32_bf16 v241, v129, v129
    v_mfma_f32_32x32x16_bf16 v[224:239], v[176:179], v[128:131], v[224:239]
    v_dot2c_f32_bf16 v242, v130, v130
    v_dot2c_f32_bf16 v243, v131, v131
    s_waitcnt vmcnt(9)
    v_permlane16_swap_b32 v136, v138
    v_permlane16_swap_b32 v137, v139
    s_waitcnt lgkmcnt(3)
    v_mfma_f32_32x32x16_bf16 v[208:223], v[196:199], v[132:135], v[208:223]
    ds_read_b128 v[188:191], v8 offset:31744
    v_dot2c_f32_bf16 v240, v132, v132
    v_dot2c_f32_bf16 v241, v133, v133
    v_mfma_f32_32x32x16_bf16 v[224:239], v[176:179], v[132:135], v[224:239]
    v_dot2c_f32_bf16 v242, v134, v134
    v_dot2c_f32_bf16 v243, v135, v135
    s_waitcnt vmcnt(8)
    v_permlane16_swap_b32 v140, v142
    v_permlane16_swap_b32 v141, v143
    v_mfma_f32_32x32x16_bf16 v[208:223], v[200:203], v[136:139], v[208:223]
    ds_read_b128 v[192:195], v8 offset:32768
    v_dot2c_f32_bf16 v240, v136, v136
    v_dot2c_f32_bf16 v241, v137, v137
    v_mfma_f32_32x32x16_bf16 v[224:239], v[176:179], v[136:139], v[224:239]
    v_dot2c_f32_bf16 v242, v138, v138
    v_dot2c_f32_bf16 v243, v139, v139
    s_waitcnt vmcnt(7)
    v_permlane16_swap_b32 v144, v146
    v_permlane16_swap_b32 v145, v147
    s_waitcnt lgkmcnt(3)
    v_mfma_f32_32x32x16_bf16 v[208:223], v[204:207], v[140:143], v[208:223]
    ds_read_b128 v[196:199], v8 offset:33792
    v_dot2c_f32_bf16 v240, v140, v140
    v_dot2c_f32_bf16 v241, v141, v141
    v_mfma_f32_32x32x16_bf16 v[224:239], v[176:179], v[140:143], v[224:239]
    v_dot2c_f32_bf16 v242, v142, v142
    v_dot2c_f32_bf16 v243, v143, v143
    s_waitcnt vmcnt(6)
    v_permlane16_swap_b32 v148, v150
    v_permlane16_swap_b32 v149, v151
    v_mfma_f32_32x32x16_bf16 v[208:223], v[180:183], v[144:147], v[208:223]
    ds_read_b128 v[200:203], v8 offset:34816
    v_dot2c_f32_bf16 v240, v144, v144
    v_dot2c_f32_bf16 v241, v145, v145
    v_mfma_f32_32x32x16_bf16 v[224:239], v[176:179], v[144:147], v[224:239]
    v_dot2c_f32_bf16 v242, v146, v146
    v_dot2c_f32_bf16 v243, v147, v147
    s_waitcnt vmcnt(5)
    v_permlane16_swap_b32 v152, v154
    v_permlane16_swap_b32 v153, v155
    s_waitcnt lgkmcnt(3)
    v_mfma_f32_32x32x16_bf16 v[208:223], v[184:187], v[148:151], v[208:223]
    ds_read_b128 v[204:207], v8 offset:35840
    v_dot2c_f32_bf16 v240, v148, v148
    v_dot2c_f32_bf16 v241, v149, v149
    v_mfma_f32_32x32x16_bf16 v[224:239], v[176:179], v[148:151], v[224:239]
    v_dot2c_f32_bf16 v242, v150, v150
    v_dot2c_f32_bf16 v243, v151, v151
    s_waitcnt vmcnt(4)
    v_permlane16_swap_b32 v156, v158
    v_permlane16_swap_b32 v157, v159
    v_mfma_f32_32x32x16_bf16 v[208:223], v[188:191], v[152:155], v[208:223]
    ds_read_b128 v[180:183], v8 offset:36864
    v_dot2c_f32_bf16 v240, v152, v152
    v_dot2c_f32_bf16 v241, v153, v153
    v_mfma_f32_32x32x16_bf16 v[224:239], v[176:179], v[152:155], v[224:239]
    v_dot2c_f32_bf16 v242, v154, v154
    v_dot2c_f32_bf16 v243, v155, v155
    s_waitcnt vmcnt(3)
    v_permlane16_swap_b32 v160, v162
    v_permlane16_swap_b32 v161, v163
    s_waitcnt lgkmcnt(3)
    v_mfma_f32_32x32x16_bf16 v[208:223], v[192:195], v[156:159], v[208:223]
    ds_read_b128 v[184:187], v8 offset:37888
    v_dot2c_f32_bf16 v240, v156, v156
    v_dot2c_f32_bf16 v241, v157, v157
    v_mfma_f32_32x32x16_bf16 v[224:239], v[176:179], v[156:159], v[224:239]
    v_dot2c_f32_bf16 v242, v158, v158
    v_dot2c_f32_bf16 v243, v159, v159
    s_waitcnt vmcnt(2)
    v_permlane16_swap_b32 v164, v166
    v_permlane16_swap_b32 v165, v167
    v_mfma_f32_32x32x16_bf16 v[208:223], v[196:199], v[160:163], v[208:223]
    ds_read_b128 v[188:191], v8 offset:38912
    v_dot2c_f32_bf16 v240, v160, v160
    v_dot2c_f32_bf16 v241, v161, v161
    v_mfma_f32_32x32x16_bf16 v[224:239], v[176:179], v[160:163], v[224:239]
    v_dot2c_f32_bf16 v242, v162, v162
    v_dot2c_f32_bf16 v243, v163, v163
    s_waitcnt vmcnt(1)
    v_permlane16_swap_b32 v168, v170
    v_permlane16_swap_b32 v169, v171
    s_waitcnt lgkmcnt(3)
    v_mfma_f32_32x32x16_bf16 v[208:223], v[200:203], v[164:167], v[208:223]
    ds_read_b128 v[192:195], v8 offset:39936
    v_dot2c_f32_bf16 v240, v164, v164
    v_dot2c_f32_bf16 v241, v165, v165
    v_mfma_f32_32x32x16_bf16 v[224:239], v[176:179], v[164:167], v[224:239]
    v_dot2c_f32_bf16 v242, v166, v166
    v_dot2c_f32_bf16 v243, v167, v167
    s_waitcnt vmcnt(0)
    v_permlane16_swap_b32 v172, v174
    v_permlane16_swap_b32 v173, v175
    v_mfma_f32_32x32x16_bf16 v[208:223], v[204:207], v[168:171], v[208:223]
    ds_read_b128 v[196:199], v8 offset:40960
    v_dot2c_f32_bf16 v240, v168, v168
    v_dot2c_f32_bf16 v241, v169, v169
    v_mfma_f32_32x32x16_bf16 v[224:239], v[176:179], v[168:171], v[224:239]
    v_dot2c_f32_bf16 v242, v170, v170
    v_dot2c_f32_bf16 v243, v171, v171
    s_waitcnt lgkmcnt(3)
    v_mfma_f32_32x32x16_bf16 v[208:223], v[180:183], v[172:175], v[208:223]
    ds_read_b128 v[200:203], v8 offset:41984
    v_dot2c_f32_bf16 v240, v172, v172
    v_dot2c_f32_bf16 v241, v173, v173
    v_mfma_f32_32x32x16_bf16 v[224:239], v[176:179], v[172:175], v[224:239]
    v_dot2c_f32_bf16 v242, v174, v174
    v_dot2c_f32_bf16 v243, v175, v175
    s_nop 2
    v_add_f32 v240, v240, v241
    v_add_f32 v242, v242, v243
    v_add_f32 v25, v240, v242
    v_mov_b32 v27, v25
    s_nop 1
    v_permlane32_swap_b32 v25, v27
    s_nop 1
    v_add_f32 v25, v25, v27
    v_mov_b32 v24, v224
    v_mul_f32 v24, 0x3ae38e39, v24
    v_mul_f32 v25, 0x3ae38e39, v25
    v_fma_f32 v25, -v24, v24, v25
    v_max_f32 v25, 0, v25
    v_cvt_pk_bf16_f32 v26, v24, v24
    v_cvt_pk_bf16_f32 v14, v25, v25
    v_and_b32 v26, 0xffff0000, v26
    v_and_b32 v14, 0xffff0000, v14
    v_add_f32 v14, 0x3727c5ac, v14
    v_cvt_pk_bf16_f32 v14, v14, v14
    v_and_b32 v14, 0xffff0000, v14
    v_sqrt_f32 v14, v14
    s_nop 0
    v_cvt_pk_bf16_f32 v14, v14, v14
    v_and_b32 v14, 0xffff0000, v14
    v_rcp_f32 v29, v14
    s_nop 0
    v_lshrrev_b32 v27, 16, v26
    v_or_b32 v26, v26, v27
    v_mov_b32 v178, 0
    v_mov_b32 v179, 0
    v_cndmask_b32 v176, 0, v26, s[74:75]
    v_cndmask_b32 v177, 0, v27, s[74:75]
    s_nop 1
    v_mfma_f32_32x32x16_bf16 v[208:223], v[184:187], v[176:179], v[208:223]
    ds_read_b128 v[204:207], v8 offset:43008
    s_waitcnt lgkmcnt(3)
    v_mfma_f32_32x32x16_bf16 v[224:239], v[188:191], v[32:35], 0
    ds_read_b128 v[180:183], v8 offset:44032
    v_mfma_f32_32x32x16_bf16 v[224:239], v[192:195], v[36:39], v[224:239]
    ds_read_b128 v[184:187], v8 offset:45056
    s_waitcnt lgkmcnt(3)
    v_mfma_f32_32x32x16_bf16 v[224:239], v[196:199], v[40:43], v[224:239]
    ds_read_b128 v[188:191], v8 offset:46080
    v_mfma_f32_32x32x16_bf16 v[224:239], v[200:203], v[44:47], v[224:239]
    ds_read_b128 v[192:195], v8 offset:47104
    s_waitcnt lgkmcnt(3)
    v_mfma_f32_32x32x16_bf16 v[224:239], v[204:207], v[48:51], v[224:239]
    ds_read_b128 v[196:199], v8 offset:48128
    s_nop 1
    v_mfma_f32_32x32x16_bf16 v[224:239], v[180:183], v[52:55], v[224:239]
    ds_read_b128 v[200:203], v8 offset:49152
    v_mul_f32 v240, v208, v29
    v_mul_f32 v241, v209, v29
    v_mul_f32 v242, v210, v29
    v_mul_f32 v243, v211, v29
    s_waitcnt lgkmcnt(3)
    v_mfma_f32_32x32x16_bf16 v[224:239], v[184:187], v[56:59], v[224:239]
    ds_read_b128 v[204:207], v8 offset:50176
    v_cvt_pk_bf16_f32 v16, v240, v241
    v_cvt_pk_bf16_f32 v17, v242, v243
    v_mul_f32 v244, v216, v29
    v_mul_f32 v245, v217, v29
    v_mfma_f32_32x32x16_bf16 v[224:239], v[188:191], v[60:63], v[224:239]
    ds_read_b128 v[180:183], v8 offset:51200
    v_mul_f32 v246, v218, v29
    v_mul_f32 v247, v219, v29
    v_cvt_pk_bf16_f32 v18, v244, v245
    s_waitcnt lgkmcnt(3)
    v_mfma_f32_32x32x16_bf16 v[224:239], v[192:195], v[64:67], v[224:239]
    ds_read_b128 v[184:187], v8 offset:52224
    v_cvt_pk_bf16_f32 v19, v246, v247
    ds_write_b128 v7, v[16:19] offset:0
    v_mul_f32 v248, v212, v29
    v_mfma_f32_32x32x16_bf16 v[224:239], v[196:199], v[68:71], v[224:239]
    ds_read_b128 v[188:191], v8 offset:53248
    v_mul_f32 v249, v213, v29
    v_mul_f32 v250, v214, v29
    v_mul_f32 v251, v215, v29
    s_waitcnt lgkmcnt(4)
    v_mfma_f32_32x32x16_bf16 v[224:239], v[200:203], v[72:75], v[224:239]
    ds_read_b128 v[192:195], v8 offset:54272
    v_cvt_pk_bf16_f32 v20, v248, v249
    v_cvt_pk_bf16_f32 v21, v250, v251
    v_mul_f32 v252, v220, v29
    v_mfma_f32_32x32x16_bf16 v[224:239], v[204:207], v[76:79], v[224:239]
    ds_read_b128 v[196:199], v8 offset:55296
    v_mul_f32 v253, v221, v29
    v_mul_f32 v254, v222, v29
    v_mul_f32 v255, v223, v29
    s_waitcnt lgkmcnt(4)
    v_mfma_f32_32x32x16_bf16 v[224:239], v[180:183], v[80:83], v[224:239]
    ds_read_b128 v[200:203], v8 offset:56320
    v_cvt_pk_bf16_f32 v22, v252, v253
    v_cvt_pk_bf16_f32 v23, v254, v255
    ds_write_b128 v7, v[20:23] offset:1024
    v_mfma_f32_32x32x16_bf16 v[224:239], v[184:187], v[84:87], v[224:239]
    s_waitcnt lgkmcnt(3)
    v_mfma_f32_32x32x16_bf16 v[224:239], v[188:191], v[88:91], v[224:239]
    s_waitcnt lgkmcnt(0)
    s_barrier
    ds_read_b128 v[204:207], v4 offset:0
    ds_read_b128 v[180:183], v4 offset:1024
    v_mfma_f32_32x32x16_bf16 v[224:239], v[192:195], v[92:95], v[224:239]
    ds_read_b128 v[184:187], v4 offset:2048
    buffer_load_dwordx4 v8, s[60:63], s56 offen lds
    s_add_u32 s56, s56, 1024
    v_mfma_f32_32x32x16_bf16 v[224:239], v[196:199], v[96:99], v[224:239]
    ds_read_b128 v[188:191], v4 offset:3072
    buffer_load_dwordx4 v8, s[60:63], s56 offen lds
    s_add_u32 s56, s56, 1024
    v_mfma_f32_32x32x16_bf16 v[224:239], v[200:203], v[100:103], v[224:239]
    ds_read_b128 v[192:195], v4 offset:4096
    s_waitcnt lgkmcnt(3)
    v_mfma_f32_32x32x16_bf16 v[224:239], v[204:207], v[104:107], v[224:239]
    ds_read_b128 v[196:199], v4 offset:5120
    v_mfma_f32_32x32x16_bf16 v[224:239], v[180:183], v[108:111], v[224:239]
    ds_read_b128 v[200:203], v4 offset:6144
    s_waitcnt lgkmcnt(3)
    v_mfma_f32_32x32x16_bf16 v[224:239], v[184:187], v[112:115], v[224:239]
    ds_read_b128 v[204:207], v4 offset:7168
    v_mfma_f32_32x32x16_bf16 v[224:239], v[188:191], v[116:119], v[224:239]
    ds_read_b128 v[180:183], v4 offset:8192
    s_waitcnt lgkmcnt(3)
    v_mfma_f32_32x32x16_bf16 v[224:239], v[192:195], v[120:123], v[224:239]
    ds_read_b128 v[184:187], v4 offset:9216
    v_mfma_f32_32x32x16_bf16 v[224:239], v[196:199], v[124:127], v[224:239]
    ds_read_b128 v[188:191], v4 offset:10240
    s_waitcnt lgkmcnt(3)
    v_mfma_f32_32x32x16_bf16 v[224:239], v[200:203], v[128:131], v[224:239]
    ds_read_b128 v[192:195], v4 offset:11264
    v_mfma_f32_32x32x16_bf16 v[224:239], v[204:207], v[132:135], v[224:239]
    ds_read_b128 v[196:199], v4 offset:12288
    s_waitcnt lgkmcnt(3)
    v_mfma_f32_32x32x16_bf16 v[224:239], v[180:183], v[136:139], v[224:239]
    ds_read_b128 v[200:203], v4 offset:13312
    v_mfma_f32_32x32x16_bf16 v[224:239], v[184:187], v[140:143], v[224:239]
    ds_read_b128 v[204:207], v4 offset:14336
    s_waitcnt lgkmcnt(3)
    v_mfma_f32_32x32x16_bf16 v[224:239], v[188:191], v[144:147], v[224:239]
    ds_read_b128 v[180:183], v4 offset:15360
    v_mfma_f32_32x32x16_bf16 v[224:239], v[192:195], v[148:151], v[224:239]
    ds_read_b128 v[184:187], v4 offset:16384
    s_waitcnt lgkmcnt(3)
    v_mfma_f32_32x32x16_bf16 v[224:239], v[196:199], v[152:155], v[224:239]
    ds_read_b128 v[188:191], v4 offset:17408
    v_mfma_f32_32x32x16_bf16 v[224:239], v[200:203], v[156:159], v[224:239]
    ds_read_b128 v[192:195], v4 offset:18432
    s_waitcnt lgkmcnt(3)
    v_mfma_f32_32x32x16_bf16 v[224:239], v[204:207], v[160:163], v[224:239]
    ds_read_b128 v[196:199], v4 offset:19456
    v_mfma_f32_32x32x16_bf16 v[224:239], v[180:183], v[164:167], v[224:239]
    ds_read_b128 v[200:203], v4 offset:20480
    s_waitcnt lgkmcnt(3)
    v_mfma_f32_32x32x16_bf16 v[224:239], v[184:187], v[168:171], v[224:239]
    ds_read_b128 v[204:207], v4 offset:21504
    v_mfma_f32_32x32x16_bf16 v[224:239], v[188:191], v[172:175], v[224:239]
    ds_read_b128 v[180:183], v4 offset:22528
    s_waitcnt lgkmcnt(3)
    v_mfma_f32_32x32x16_bf16 v[224:239], v[192:195], v[176:179], v[224:239]
    ds_read_b128 v[184:187], v4 offset:23552
    v_mfma_f32_32x32x16_bf16 v[208:223], v[196:199], v[32:35], 0
    ds_read_b128 v[188:191], v4 offset:24576
    s_waitcnt lgkmcnt(3)
    v_mfma_f32_32x32x16_bf16 v[208:223], v[200:203], v[36:39], v[208:223]
    ds_read_b128 v[192:195], v4 offset:25600
    v_mfma_f32_32x32x16_bf16 v[208:223], v[204:207], v[40:43], v[208:223]
    ds_read_b128 v[196:199], v4 offset:26624
    s_waitcnt lgkmcnt(3)
    v_mfma_f32_32x32x16_bf16 v[208:223], v[180:183], v[44:47], v[208:223]
    ds_read_b128 v[200:203], v4 offset:27648
    v_mfma_f32_32x32x16_bf16 v[208:223], v[184:187], v[48:51], v[208:223]
    ds_read_b128 v[204:207], v4 offset:28672
    s_nop 1
    s_waitcnt lgkmcnt(3)
    v_mfma_f32_32x32x16_bf16 v[208:223], v[188:191], v[52:55], v[208:223]
    ds_read_b128 v[180:183], v4 offset:29696
    v_mul_f32 v240, v224, v29
    v_mul_f32 v241, v225, v29
    v_mul_f32 v242, v226, v29
    v_mul_f32 v243, v227, v29
    v_mfma_f32_32x32x16_bf16 v[208:223], v[192:195], v[56:59], v[208:223]
    ds_read_b128 v[184:187], v4 offset:30720
    v_cvt_pk_bf16_f32 v16, v240, v241
    v_cvt_pk_bf16_f32 v17, v242, v243
    v_mul_f32 v244, v232, v29
    v_mul_f32 v245, v233, v29
    s_waitcnt lgkmcnt(3)
    v_mfma_f32_32x32x16_bf16 v[208:223], v[196:199], v[60:63], v[208:223]
    ds_read_b128 v[188:191], v4 offset:31744
    v_mul_f32 v246, v234, v29
    v_mul_f32 v247, v235, v29
    v_cvt_pk_bf16_f32 v18, v244, v245
    v_mfma_f32_32x32x16_bf16 v[208:223], v[200:203], v[64:67], v[208:223]
    ds_read_b128 v[192:195], v4 offset:32768
    v_cvt_pk_bf16_f32 v19, v246, v247
    ds_write_b128 v7, v[16:19] offset:8192
    v_mul_f32 v248, v228, v29
    s_waitcnt lgkmcnt(4)
    v_mfma_f32_32x32x16_bf16 v[208:223], v[204:207], v[68:71], v[208:223]
    ds_read_b128 v[196:199], v4 offset:33792
    v_mul_f32 v249, v229, v29
    v_mul_f32 v250, v230, v29
    v_mul_f32 v251, v231, v29
    v_mfma_f32_32x32x16_bf16 v[208:223], v[180:183], v[72:75], v[208:223]
    ds_read_b128 v[200:203], v4 offset:34816
    v_cvt_pk_bf16_f32 v20, v248, v249
    v_cvt_pk_bf16_f32 v21, v250, v251
    v_mul_f32 v252, v236, v29
    s_waitcnt lgkmcnt(4)
    v_mfma_f32_32x32x16_bf16 v[208:223], v[184:187], v[76:79], v[208:223]
    ds_read_b128 v[204:207], v4 offset:35840
    v_mul_f32 v253, v237, v29
    v_mul_f32 v254, v238, v29
    v_mul_f32 v255, v239, v29
    v_mfma_f32_32x32x16_bf16 v[208:223], v[188:191], v[80:83], v[208:223]
    ds_read_b128 v[180:183], v4 offset:36864
    v_cvt_pk_bf16_f32 v22, v252, v253
    v_cvt_pk_bf16_f32 v23, v254, v255
    ds_write_b128 v7, v[20:23] offset:9216
    s_waitcnt lgkmcnt(4)
    v_mfma_f32_32x32x16_bf16 v[208:223], v[192:195], v[84:87], v[208:223]
    v_mfma_f32_32x32x16_bf16 v[208:223], v[196:199], v[88:91], v[208:223]
    s_waitcnt lgkmcnt(0)
    s_barrier
    ds_read_b128 v[184:187], v4 offset:38912
    ds_read_b128 v[188:191], v4 offset:39936
    v_mfma_f32_32x32x16_bf16 v[208:223], v[200:203], v[92:95], v[208:223]
    ds_read_b128 v[192:195], v4 offset:40960
    buffer_load_dwordx4 v8, s[60:63], s56 offen lds
    s_add_u32 s56, s56, 1024
    v_mfma_f32_32x32x16_bf16 v[208:223], v[204:207], v[96:99], v[208:223]
    ds_read_b128 v[196:199], v4 offset:41984
    buffer_load_dwordx4 v8, s[60:63], s56 offen lds
    s_add_u32 s56, s56, 1024
    s_waitcnt lgkmcnt(3)
    v_mfma_f32_32x32x16_bf16 v[208:223], v[180:183], v[100:103], v[208:223]
    ds_read_b128 v[200:203], v4 offset:43008
    v_mfma_f32_32x32x16_bf16 v[208:223], v[184:187], v[104:107], v[208:223]
    ds_read_b128 v[204:207], v4 offset:44032
    s_waitcnt lgkmcnt(3)
    v_mfma_f32_32x32x16_bf16 v[208:223], v[188:191], v[108:111], v[208:223]
    ds_read_b128 v[180:183], v4 offset:45056
    v_mfma_f32_32x32x16_bf16 v[208:223], v[192:195], v[112:115], v[208:223]
    ds_read_b128 v[184:187], v4 offset:46080
    s_waitcnt lgkmcnt(3)
    v_mfma_f32_32x32x16_bf16 v[208:223], v[196:199], v[116:119], v[208:223]
    ds_read_b128 v[188:191], v4 offset:47104
    v_mfma_f32_32x32x16_bf16 v[208:223], v[200:203], v[120:123], v[208:223]
    ds_read_b128 v[192:195], v4 offset:48128
    s_waitcnt lgkmcnt(3)
    v_mfma_f32_32x32x16_bf16 v[208:223], v[204:207], v[124:127], v[208:223]
    ds_read_b128 v[196:199], v4 offset:49152
    v_mfma_f32_32x32x16_bf16 v[208:223], v[180:183], v[128:131], v[208:223]
    ds_read_b128 v[200:203], v4 offset:50176
    s_waitcnt lgkmcnt(3)
    v_mfma_f32_32x32x16_bf16 v[208:223], v[184:187], v[132:135], v[208:223]
    ds_read_b128 v[204:207], v4 offset:51200
    v_mfma_f32_32x32x16_bf16 v[208:223], v[188:191], v[136:139], v[208:223]
    ds_read_b128 v[180:183], v4 offset:52224
    s_waitcnt lgkmcnt(3)
    v_mfma_f32_32x32x16_bf16 v[208:223], v[192:195], v[140:143], v[208:223]
    ds_read_b128 v[184:187], v4 offset:53248
    v_mfma_f32_32x32x16_bf16 v[208:223], v[196:199], v[144:147], v[208:223]
    ds_read_b128 v[188:191], v4 offset:54272
    s_waitcnt lgkmcnt(3)
    v_mfma_f32_32x32x16_bf16 v[208:223], v[200:203], v[148:151], v[208:223]
    ds_read_b128 v[192:195], v4 offset:55296
    v_mfma_f32_32x32x16_bf16 v[208:223], v[204:207], v[152:155], v[208:223]
    ds_read_b128 v[196:199], v4 offset:56320
    s_waitcnt lgkmcnt(3)
    v_mfma_f32_32x32x16_bf16 v[208:223], v[180:183], v[156:159], v[208:223]
    ds_read_b128 v[200:203], v4 offset:57344
    v_mfma_f32_32x32x16_bf16 v[208:223], v[184:187], v[160:163], v[208:223]
    ds_read_b128 v[204:207], v8 offset:0
    s_waitcnt lgkmcnt(3)
    v_mfma_f32_32x32x16_bf16 v[208:223], v[188:191], v[164:167], v[208:223]
    ds_read_b128 v[180:183], v8 offset:1024
    v_mfma_f32_32x32x16_bf16 v[208:223], v[192:195], v[168:171], v[208:223]
    ds_read_b128 v[184:187], v8 offset:2048
    s_waitcnt lgkmcnt(3)
    v_mfma_f32_32x32x16_bf16 v[208:223], v[196:199], v[172:175], v[208:223]
    ds_read_b128 v[188:191], v8 offset:3072
    v_mfma_f32_32x32x16_bf16 v[208:223], v[200:203], v[176:179], v[208:223]
    ds_read_b128 v[192:195], v8 offset:4096
    s_waitcnt lgkmcnt(3)
    v_mfma_f32_32x32x16_bf16 v[224:239], v[204:207], v[32:35], 0
    ds_read_b128 v[196:199], v8 offset:5120
    v_mfma_f32_32x32x16_bf16 v[224:239], v[180:183], v[36:39], v[224:239]
    ds_read_b128 v[200:203], v8 offset:6144
    s_waitcnt lgkmcnt(3)
    v_mfma_f32_32x32x16_bf16 v[224:239], v[184:187], v[40:43], v[224:239]
    ds_read_b128 v[204:207], v8 offset:7168
    v_mfma_f32_32x32x16_bf16 v[224:239], v[188:191], v[44:47], v[224:239]
    ds_read_b128 v[180:183], v8 offset:8192
    s_waitcnt lgkmcnt(3)
    v_mfma_f32_32x32x16_bf16 v[224:239], v[192:195], v[48:51], v[224:239]
    ds_read_b128 v[184:187], v8 offset:9216
    s_nop 1
    v_mfma_f32_32x32x16_bf16 v[224:239], v[196:199], v[52:55], v[224:239]
    ds_read_b128 v[188:191], v8 offset:10240
    v_mul_f32 v240, v208, v29
    v_mul_f32 v241, v209, v29
    v_mul_f32 v242, v210, v29
    v_mul_f32 v243, v211, v29
    s_waitcnt lgkmcnt(3)
    v_mfma_f32_32x32x16_bf16 v[224:239], v[200:203], v[56:59], v[224:239]
    ds_read_b128 v[192:195], v8 offset:11264
    v_cvt_pk_bf16_f32 v16, v240, v241
    v_cvt_pk_bf16_f32 v17, v242, v243
    v_mul_f32 v244, v216, v29
    v_mul_f32 v245, v217, v29
    v_mfma_f32_32x32x16_bf16 v[224:239], v[204:207], v[60:63], v[224:239]
    ds_read_b128 v[196:199], v8 offset:12288
    v_mul_f32 v246, v218, v29
    v_mul_f32 v247, v219, v29
    v_cvt_pk_bf16_f32 v18, v244, v245
    s_waitcnt lgkmcnt(3)
    v_mfma_f32_32x32x16_bf16 v[224:239], v[180:183], v[64:67], v[224:239]
    ds_read_b128 v[200:203], v8 offset:13312
    v_cvt_pk_bf16_f32 v19, v246, v247
    ds_write_b128 v7, v[16:19] offset:0
    v_mul_f32 v248, v212, v29
    v_mfma_f32_32x32x16_bf16 v[224:239], v[184:187], v[68:71], v[224:239]
    ds_read_b128 v[204:207], v8 offset:14336
    v_mul_f32 v249, v213, v29
    v_mul_f32 v250, v214, v29
    v_mul_f32 v251, v215, v29
    s_waitcnt lgkmcnt(4)
    v_mfma_f32_32x32x16_bf16 v[224:239], v[188:191], v[72:75], v[224:239]
    ds_read_b128 v[180:183], v8 offset:15360
    v_cvt_pk_bf16_f32 v20, v248, v249
    v_cvt_pk_bf16_f32 v21, v250, v251
    v_mul_f32 v252, v220, v29
    v_mfma_f32_32x32x16_bf16 v[224:239], v[192:195], v[76:79], v[224:239]
    ds_read_b128 v[184:187], v8 offset:16384
    v_mul_f32 v253, v221, v29
    v_mul_f32 v254, v222, v29
    v_mul_f32 v255, v223, v29
    s_waitcnt lgkmcnt(4)
    v_mfma_f32_32x32x16_bf16 v[224:239], v[196:199], v[80:83], v[224:239]
    ds_read_b128 v[188:191], v8 offset:17408
    v_cvt_pk_bf16_f32 v22, v252, v253
    v_cvt_pk_bf16_f32 v23, v254, v255
    ds_write_b128 v7, v[20:23] offset:1024
    v_mfma_f32_32x32x16_bf16 v[224:239], v[200:203], v[84:87], v[224:239]
    s_waitcnt lgkmcnt(3)
    v_mfma_f32_32x32x16_bf16 v[224:239], v[204:207], v[88:91], v[224:239]
    s_waitcnt lgkmcnt(0)
    s_barrier
    ds_read_b128 v[192:195], v8 offset:19456
    ds_read_b128 v[196:199], v8 offset:20480
    v_mfma_f32_32x32x16_bf16 v[224:239], v[180:183], v[92:95], v[224:239]
    ds_read_b128 v[200:203], v8 offset:21504
    buffer_load_dwordx4 v8, s[60:63], s56 offen lds
    s_add_u32 s56, s56, 1024
    v_mfma_f32_32x32x16_bf16 v[224:239], v[184:187], v[96:99], v[224:239]
    ds_read_b128 v[204:207], v8 offset:22528
    buffer_load_dwordx4 v8, s[60:63], s56 offen lds
    s_add_u32 s56, s56, 1024
    v_mfma_f32_32x32x16_bf16 v[224:239], v[188:191], v[100:103], v[224:239]
    ds_read_b128 v[180:183], v8 offset:23552
    s_waitcnt lgkmcnt(3)
    v_mfma_f32_32x32x16_bf16 v[224:239], v[192:195], v[104:107], v[224:239]
    ds_read_b128 v[184:187], v8 offset:24576
    v_mfma_f32_32x32x16_bf16 v[224:239], v[196:199], v[108:111], v[224:239]
    ds_read_b128 v[188:191], v8 offset:25600
    s_waitcnt lgkmcnt(3)
    v_mfma_f32_32x32x16_bf16 v[224:239], v[200:203], v[112:115], v[224:239]
    ds_read_b128 v[192:195], v8 offset:26624
    v_mfma_f32_32x32x16_bf16 v[224:239], v[204:207], v[116:119], v[224:239]
    ds_read_b128 v[196:199], v8 offset:27648
    s_waitcnt lgkmcnt(3)
    v_mfma_f32_32x32x16_bf16 v[224:239], v[180:183], v[120:123], v[224:239]
    ds_read_b128 v[200:203], v8 offset:28672
    v_mfma_f32_32x32x16_bf16 v[224:239], v[184:187], v[124:127], v[224:239]
    ds_read_b128 v[204:207], v8 offset:29696
    s_waitcnt lgkmcnt(3)
    v_mfma_f32_32x32x16_bf16 v[224:239], v[188:191], v[128:131], v[224:239]
    ds_read_b128 v[180:183], v8 offset:30720
    v_mfma_f32_32x32x16_bf16 v[224:239], v[192:195], v[132:135], v[224:239]
    ds_read_b128 v[184:187], v8 offset:31744
    s_waitcnt lgkmcnt(3)
    v_mfma_f32_32x32x16_bf16 v[224:239], v[196:199], v[136:139], v[224:239]
    ds_read_b128 v[188:191], v8 offset:32768
    v_mfma_f32_32x32x16_bf16 v[224:239], v[200:203], v[140:143], v[224:239]
    ds_read_b128 v[192:195], v8 offset:33792
    s_waitcnt lgkmcnt(3)
    v_mfma_f32_32x32x16_bf16 v[224:239], v[204:207], v[144:147], v[224:239]
    ds_read_b128 v[196:199], v8 offset:34816
    v_mfma_f32_32x32x16_bf16 v[224:239], v[180:183], v[148:151], v[224:239]
    ds_read_b128 v[200:203], v8 offset:35840
    s_waitcnt lgkmcnt(3)
    v_mfma_f32_32x32x16_bf16 v[224:239], v[184:187], v[152:155], v[224:239]
    ds_read_b128 v[204:207], v8 offset:36864
    v_mfma_f32_32x32x16_bf16 v[224:239], v[188:191], v[156:159], v[224:239]
    ds_read_b128 v[180:183], v8 offset:37888
    s_waitcnt lgkmcnt(3)
    v_mfma_f32_32x32x16_bf16 v[224:239], v[192:195], v[160:163], v[224:239]
    ds_read_b128 v[184:187], v8 offset:38912
    v_mfma_f32_32x32x16_bf16 v[224:239], v[196:199], v[164:167], v[224:239]
    ds_read_b128 v[188:191], v8 offset:39936
    s_waitcnt lgkmcnt(3)
    v_mfma_f32_32x32x16_bf16 v[224:239], v[200:203], v[168:171], v[224:239]
    ds_read_b128 v[192:195], v8 offset:40960
    v_mfma_f32_32x32x16_bf16 v[224:239], v[204:207], v[172:175], v[224:239]
    ds_read_b128 v[196:199], v8 offset:41984
    s_waitcnt lgkmcnt(3)
    v_mfma_f32_32x32x16_bf16 v[224:239], v[180:183], v[176:179], v[224:239]
    ds_read_b128 v[200:203], v8 offset:43008
    v_mfma_f32_32x32x16_bf16 v[208:223], v[184:187], v[32:35], 0
    ds_read_b128 v[204:207], v8 offset:44032
    s_waitcnt lgkmcnt(3)
    v_mfma_f32_32x32x16_bf16 v[208:223], v[188:191], v[36:39], v[208:223]
    ds_read_b128 v[180:183], v8 offset:45056
    v_mfma_f32_32x32x16_bf16 v[208:223], v[192:195], v[40:43], v[208:223]
    ds_read_b128 v[184:187], v8 offset:46080
    s_waitcnt lgkmcnt(3)
    v_mfma_f32_32x32x16_bf16 v[208:223], v[196:199], v[44:47], v[208:223]
    ds_read_b128 v[188:191], v8 offset:47104
    v_mfma_f32_32x32x16_bf16 v[208:223], v[200:203], v[48:51], v[208:223]
    ds_read_b128 v[192:195], v8 offset:48128
    s_nop 1
    s_waitcnt lgkmcnt(3)
    v_mfma_f32_32x32x16_bf16 v[208:223], v[204:207], v[52:55], v[208:223]
    ds_read_b128 v[196:199], v8 offset:49152
    v_mul_f32 v240, v224, v29
    v_mul_f32 v241, v225, v29
    v_mul_f32 v242, v226, v29
    v_mul_f32 v243, v227, v29
    v_mfma_f32_32x32x16_bf16 v[208:223], v[180:183], v[56:59], v[208:223]
    ds_read_b128 v[200:203], v8 offset:50176
    v_cvt_pk_bf16_f32 v16, v240, v241
    v_cvt_pk_bf16_f32 v17, v242, v243
    v_mul_f32 v244, v232, v29
    v_mul_f32 v245, v233, v29
    s_waitcnt lgkmcnt(3)
    v_mfma_f32_32x32x16_bf16 v[208:223], v[184:187], v[60:63], v[208:223]
    ds_read_b128 v[204:207], v8 offset:51200
    v_mul_f32 v246, v234, v29
    v_mul_f32 v247, v235, v29
    v_cvt_pk_bf16_f32 v18, v244, v245
    v_mfma_f32_32x32x16_bf16 v[208:223], v[188:191], v[64:67], v[208:223]
    ds_read_b128 v[180:183], v8 offset:52224
    v_cvt_pk_bf16_f32 v19, v246, v247
    ds_write_b128 v7, v[16:19] offset:8192
    v_mul_f32 v248, v228, v29
    s_waitcnt lgkmcnt(4)
    v_mfma_f32_32x32x16_bf16 v[208:223], v[192:195], v[68:71], v[208:223]
    ds_read_b128 v[184:187], v8 offset:53248
    v_mul_f32 v249, v229, v29
    v_mul_f32 v250, v230, v29
    v_mul_f32 v251, v231, v29
    v_mfma_f32_32x32x16_bf16 v[208:223], v[196:199], v[72:75], v[208:223]
    ds_read_b128 v[188:191], v8 offset:54272
    v_cvt_pk_bf16_f32 v20, v248, v249
    v_cvt_pk_bf16_f32 v21, v250, v251
    v_mul_f32 v252, v236, v29
    s_waitcnt lgkmcnt(4)
    v_mfma_f32_32x32x16_bf16 v[208:223], v[200:203], v[76:79], v[208:223]
    ds_read_b128 v[192:195], v8 offset:55296
    v_mul_f32 v253, v237, v29
    v_mul_f32 v254, v238, v29
    v_mul_f32 v255, v239, v29
    v_mfma_f32_32x32x16_bf16 v[208:223], v[204:207], v[80:83], v[208:223]
    ds_read_b128 v[196:199], v8 offset:56320
    v_cvt_pk_bf16_f32 v22, v252, v253
    v_cvt_pk_bf16_f32 v23, v254, v255
    ds_write_b128 v7, v[20:23] offset:9216
    s_waitcnt lgkmcnt(4)
    v_mfma_f32_32x32x16_bf16 v[208:223], v[180:183], v[84:87], v[208:223]
    v_mfma_f32_32x32x16_bf16 v[208:223], v[184:187], v[88:91], v[208:223]
    s_waitcnt lgkmcnt(0)
    s_barrier
    ds_read_b128 v[200:203], v4 offset:0
    ds_read_b128 v[204:207], v4 offset:1024
    v_mfma_f32_32x32x16_bf16 v[208:223], v[188:191], v[92:95], v[208:223]
    ds_read_b128 v[180:183], v4 offset:2048
    buffer_load_dwordx4 v8, s[60:63], s56 offen lds
    s_add_u32 s56, s56, 1024
    v_mfma_f32_32x32x16_bf16 v[208:223], v[192:195], v[96:99], v[208:223]
    ds_read_b128 v[184:187], v4 offset:3072
    buffer_load_dwordx4 v8, s[60:63], s56 offen lds
    s_add_u32 s56, s56, 1024
    s_waitcnt lgkmcnt(3)
    v_mfma_f32_32x32x16_bf16 v[208:223], v[196:199], v[100:103], v[208:223]
    ds_read_b128 v[188:191], v4 offset:4096
    v_mfma_f32_32x32x16_bf16 v[208:223], v[200:203], v[104:107], v[208:223]
    ds_read_b128 v[192:195], v4 offset:5120
    s_waitcnt lgkmcnt(3)
    v_mfma_f32_32x32x16_bf16 v[208:223], v[204:207], v[108:111], v[208:223]
    ds_read_b128 v[196:199], v4 offset:6144
    v_mfma_f32_32x32x16_bf16 v[208:223], v[180:183], v[112:115], v[208:223]
    ds_read_b128 v[200:203], v4 offset:7168
    s_waitcnt lgkmcnt(3)
    v_mfma_f32_32x32x16_bf16 v[208:223], v[184:187], v[116:119], v[208:223]
    ds_read_b128 v[204:207], v4 offset:8192
    v_mfma_f32_32x32x16_bf16 v[208:223], v[188:191], v[120:123], v[208:223]
    ds_read_b128 v[180:183], v4 offset:9216
    s_waitcnt lgkmcnt(3)
    v_mfma_f32_32x32x16_bf16 v[208:223], v[192:195], v[124:127], v[208:223]
    ds_read_b128 v[184:187], v4 offset:10240
    v_mfma_f32_32x32x16_bf16 v[208:223], v[196:199], v[128:131], v[208:223]
    ds_read_b128 v[188:191], v4 offset:11264
    s_waitcnt lgkmcnt(3)
    v_mfma_f32_32x32x16_bf16 v[208:223], v[200:203], v[132:135], v[208:223]
    ds_read_b128 v[192:195], v4 offset:12288
    v_mfma_f32_32x32x16_bf16 v[208:223], v[204:207], v[136:139], v[208:223]
    ds_read_b128 v[196:199], v4 offset:13312
    s_waitcnt lgkmcnt(3)
    v_mfma_f32_32x32x16_bf16 v[208:223], v[180:183], v[140:143], v[208:223]
    ds_read_b128 v[200:203], v4 offset:14336
    v_mfma_f32_32x32x16_bf16 v[208:223], v[184:187], v[144:147], v[208:223]
    ds_read_b128 v[204:207], v4 offset:15360
    s_waitcnt lgkmcnt(3)
    v_mfma_f32_32x32x16_bf16 v[208:223], v[188:191], v[148:151], v[208:223]
    ds_read_b128 v[180:183], v4 offset:16384
    v_mfma_f32_32x32x16_bf16 v[208:223], v[192:195], v[152:155], v[208:223]
    ds_read_b128 v[184:187], v4 offset:17408
    s_waitcnt lgkmcnt(3)
    v_mfma_f32_32x32x16_bf16 v[208:223], v[196:199], v[156:159], v[208:223]
    ds_read_b128 v[188:191], v4 offset:18432
    v_mfma_f32_32x32x16_bf16 v[208:223], v[200:203], v[160:163], v[208:223]
    ds_read_b128 v[192:195], v4 offset:19456
    s_waitcnt lgkmcnt(3)
    v_mfma_f32_32x32x16_bf16 v[208:223], v[204:207], v[164:167], v[208:223]
    ds_read_b128 v[196:199], v4 offset:20480
    v_mfma_f32_32x32x16_bf16 v[208:223], v[180:183], v[168:171], v[208:223]
    ds_read_b128 v[200:203], v4 offset:21504
    s_waitcnt lgkmcnt(3)
    v_mfma_f32_32x32x16_bf16 v[208:223], v[184:187], v[172:175], v[208:223]
    ds_read_b128 v[204:207], v4 offset:22528
    v_mfma_f32_32x32x16_bf16 v[208:223], v[188:191], v[176:179], v[208:223]
    ds_read_b128 v[180:183], v4 offset:23552
    s_waitcnt lgkmcnt(3)
    v_mfma_f32_32x32x16_bf16 v[224:239], v[192:195], v[32:35], 0
    ds_read_b128 v[184:187], v4 offset:24576
    v_mfma_f32_32x32x16_bf16 v[224:239], v[196:199], v[36:39], v[224:239]
    ds_read_b128 v[188:191], v4 offset:25600
    s_waitcnt lgkmcnt(3)
    v_mfma_f32_32x32x16_bf16 v[224:239], v[200:203], v[40:43], v[224:239]
    ds_read_b128 v[192:195], v4 offset:26624
    v_mfma_f32_32x32x16_bf16 v[224:239], v[204:207], v[44:47], v[224:239]
    ds_read_b128 v[196:199], v4 offset:27648
    s_waitcnt lgkmcnt(3)
    v_mfma_f32_32x32x16_bf16 v[224:239], v[180:183], v[48:51], v[224:239]
    ds_read_b128 v[200:203], v4 offset:28672
    s_nop 1
    v_mfma_f32_32x32x16_bf16 v[224:239], v[184:187], v[52:55], v[224:239]
    ds_read_b128 v[204:207], v4 offset:29696
    v_mul_f32 v240, v208, v29
    v_mul_f32 v241, v209, v29
    v_mul_f32 v242, v210, v29
    v_mul_f32 v243, v211, v29
    s_waitcnt lgkmcnt(3)
    v_mfma_f32_32x32x16_bf16 v[224:239], v[188:191], v[56:59], v[224:239]
    ds_read_b128 v[180:183], v4 offset:30720
    v_cvt_pk_bf16_f32 v16, v240, v241
    v_cvt_pk_bf16_f32 v17, v242, v243
    v_mul_f32 v244, v216, v29
    v_mul_f32 v245, v217, v29
    v_mfma_f32_32x32x16_bf16 v[224:239], v[192:195], v[60:63], v[224:239]
    ds_read_b128 v[184:187], v4 offset:31744
    v_mul_f32 v246, v218, v29
    v_mul_f32 v247, v219, v29
    v_cvt_pk_bf16_f32 v18, v244, v245
    v_cvt_pk_bf16_f32 v19, v246, v247
    s_waitcnt lgkmcnt(3)
    v_mfma_f32_32x32x16_bf16 v[224:239], v[196:199], v[64:67], v[224:239]
    ds_read_b128 v[188:191], v4 offset:32768
    ds_write_b128 v7, v[16:19] offset:0
    v_mul_f32 v248, v212, v29
    v_mul_f32 v249, v213, v29
    v_mul_f32 v250, v214, v29
    v_mfma_f32_32x32x16_bf16 v[224:239], v[200:203], v[68:71], v[224:239]
    ds_read_b128 v[192:195], v4 offset:33792
    v_mul_f32 v251, v215, v29
    v_cvt_pk_bf16_f32 v20, v248, v249
    v_cvt_pk_bf16_f32 v21, v250, v251
    v_mul_f32 v252, v220, v29
    s_waitcnt lgkmcnt(4)
    v_mfma_f32_32x32x16_bf16 v[224:239], v[204:207], v[72:75], v[224:239]
    ds_read_b128 v[196:199], v4 offset:34816
    v_mul_f32 v253, v221, v29
    v_mul_f32 v254, v222, v29
    v_mul_f32 v255, v223, v29
    v_mfma_f32_32x32x16_bf16 v[224:239], v[180:183], v[76:79], v[224:239]
    ds_read_b128 v[200:203], v4 offset:35840
    v_cvt_pk_bf16_f32 v22, v252, v253
    v_cvt_pk_bf16_f32 v23, v254, v255
    ds_write_b128 v7, v[20:23] offset:1024
    s_waitcnt lgkmcnt(5)
    v_mfma_f32_32x32x16_bf16 v[224:239], v[184:187], v[80:83], v[224:239]
    ds_read_b128 v[204:207], v4 offset:36864
    v_mfma_f32_32x32x16_bf16 v[224:239], v[188:191], v[84:87], v[224:239]
    s_waitcnt lgkmcnt(3)
    v_mfma_f32_32x32x16_bf16 v[224:239], v[192:195], v[88:91], v[224:239]
    s_cmp_eq_u32 s32, 0
    s_cbranch_scc1 Lt423
    buffer_store_dwordx4 v[16:19], v5, s[96:99], s35 offen offset:0 sc1
    buffer_store_dwordx4 v[20:23], v5, s[96:99], s35 offen offset:512 sc1
Lt423:
    s_waitcnt lgkmcnt(0)
    s_barrier
    ds_read_b128 v[180:183], v4 offset:38912
    ds_read_b128 v[184:187], v4 offset:39936
    v_mfma_f32_32x32x16_bf16 v[224:239], v[196:199], v[92:95], v[224:239]
    ds_read_b128 v[188:191], v4 offset:40960
    v_mfma_f32_32x32x16_bf16 v[224:239], v[200:203], v[96:99], v[224:239]
    ds_read_b128 v[192:195], v4 offset:41984
    v_mfma_f32_32x32x16_bf16 v[224:239], v[204:207], v[100:103], v[224:239]
    ds_read_b128 v[196:199], v4 offset:43008
    s_waitcnt lgkmcnt(3)
    v_mfma_f32_32x32x16_bf16 v[224:239], v[180:183], v[104:107], v[224:239]
    ds_read_b128 v[200:203], v4 offset:44032
    v_mfma_f32_32x32x16_bf16 v[224:239], v[184:187], v[108:111], v[224:239]
    ds_read_b128 v[204:207], v4 offset:45056
    s_waitcnt lgkmcnt(3)
    v_mfma_f32_32x32x16_bf16 v[224:239], v[188:191], v[112:115], v[224:239]
    ds_read_b128 v[180:183], v4 offset:46080
    v_mfma_f32_32x32x16_bf16 v[224:239], v[192:195], v[116:119], v[224:239]
    ds_read_b128 v[184:187], v4 offset:47104
    s_waitcnt lgkmcnt(3)
    v_mfma_f32_32x32x16_bf16 v[224:239], v[196:199], v[120:123], v[224:239]
    ds_read_b128 v[188:191], v4 offset:48128
    v_mfma_f32_32x32x16_bf16 v[224:239], v[200:203], v[124:127], v[224:239]
    ds_read_b128 v[192:195], v4 offset:49152
    s_waitcnt lgkmcnt(3)
    v_mfma_f32_32x32x16_bf16 v[224:239], v[204:207], v[128:131], v[224:239]
    ds_read_b128 v[196:199], v4 offset:50176
    v_mfma_f32_32x32x16_bf16 v[224:239], v[180:183], v[132:135], v[224:239]
    ds_read_b128 v[200:203], v4 offset:51200
    s_waitcnt lgkmcnt(3)
    v_mfma_f32_32x32x16_bf16 v[224:239], v[184:187], v[136:139], v[224:239]
    ds_read_b128 v[204:207], v4 offset:52224
    v_mfma_f32_32x32x16_bf16 v[224:239], v[188:191], v[140:143], v[224:239]
    ds_read_b128 v[180:183], v4 offset:53248
    s_waitcnt lgkmcnt(3)
    v_mfma_f32_32x32x16_bf16 v[224:239], v[192:195], v[144:147], v[224:239]
    ds_read_b128 v[184:187], v4 offset:54272
    v_mfma_f32_32x32x16_bf16 v[224:239], v[196:199], v[148:151], v[224:239]
    ds_read_b128 v[188:191], v4 offset:55296
    s_waitcnt lgkmcnt(3)
    v_mfma_f32_32x32x16_bf16 v[224:239], v[200:203], v[152:155], v[224:239]
    ds_read_b128 v[192:195], v4 offset:56320
    v_mfma_f32_32x32x16_bf16 v[224:239], v[204:207], v[156:159], v[224:239]
    ds_read_b128 v[196:199], v4 offset:57344
    s_waitcnt lgkmcnt(3)
    v_mfma_f32_32x32x16_bf16 v[224:239], v[180:183], v[160:163], v[224:239]
    ds_read_b128 v[200:203], v8 offset:0
    v_mfma_f32_32x32x16_bf16 v[224:239], v[184:187], v[164:167], v[224:239]
    ds_read_b128 v[204:207], v8 offset:1024
    s_waitcnt lgkmcnt(3)
    v_mfma_f32_32x32x16_bf16 v[224:239], v[188:191], v[168:171], v[224:239]
    ds_read_b128 v[180:183], v8 offset:2048
    v_mfma_f32_32x32x16_bf16 v[224:239], v[192:195], v[172:175], v[224:239]
    ds_read_b128 v[184:187], v8 offset:3072
    s_waitcnt lgkmcnt(3)
    v_mfma_f32_32x32x16_bf16 v[224:239], v[196:199], v[176:179], v[224:239]
    ds_read_b128 v[188:191], v8 offset:4096
    v_mfma_f32_32x32x16_bf16 v[208:223], v[200:203], v[32:35], 0
    ds_read_b128 v[192:195], v8 offset:5120
    s_waitcnt lgkmcnt(3)
    v_mfma_f32_32x32x16_bf16 v[208:223], v[204:207], v[36:39], v[208:223]
    ds_read_b128 v[196:199], v8 offset:6144
    v_mfma_f32_32x32x16_bf16 v[208:223], v[180:183], v[40:43], v[208:223]
    ds_read_b128 v[200:203], v8 offset:7168
    s_waitcnt lgkmcnt(3)
    v_mfma_f32_32x32x16_bf16 v[208:223], v[184:187], v[44:47], v[208:223]
    ds_read_b128 v[204:207], v8 offset:8192
    v_mfma_f32_32x32x16_bf16 v[208:223], v[188:191], v[48:51], v[208:223]
    ds_read_b128 v[180:183], v8 offset:9216
    s_nop 1
    s_waitcnt lgkmcnt(3)
    v_mfma_f32_32x32x16_bf16 v[208:223], v[192:195], v[52:55], v[208:223]
    ds_read_b128 v[184:187], v8 offset:10240
    v_mul_f32 v240, v224, v29
    v_mul_f32 v241, v225, v29
    v_mul_f32 v242, v226, v29
    v_mul_f32 v243, v227, v29
    v_mfma_f32_32x32x16_bf16 v[208:223], v[196:199], v[56:59], v[208:223]
    ds_read_b128 v[188:191], v8 offset:11264
    v_cvt_pk_bf16_f32 v16, v240, v241
    v_cvt_pk_bf16_f32 v17, v242, v243
    v_mul_f32 v244, v232, v29
    v_mul_f32 v245, v233, v29
    s_waitcnt lgkmcnt(3)
    v_mfma_f32_32x32x16_bf16 v[208:223], v[200:203], v[60:63], v[208:223]
    ds_read_b128 v[192:195], v8 offset:12288
    v_mul_f32 v246, v234, v29
    v_mul_f32 v247, v235, v29
    v_cvt_pk_bf16_f32 v18, v244, v245
    v_mfma_f32_32x32x16_bf16 v[208:223], v[204:207], v[64:67], v[208:223]
    ds_read_b128 v[196:199], v8 offset:13312
    v_cvt_pk_bf16_f32 v19, v246, v247
    ds_write_b128 v7, v[16:19] offset:8192
    v_mul_f32 v248, v228, v29
    s_waitcnt lgkmcnt(4)
    v_mfma_f32_32x32x16_bf16 v[208:223], v[180:183], v[68:71], v[208:223]
    ds_read_b128 v[200:203], v8 offset:14336
    v_mul_f32 v249, v229, v29
    v_mul_f32 v250, v230, v29
    v_mul_f32 v251, v231, v29
    v_mfma_f32_32x32x16_bf16 v[208:223], v[184:187], v[72:75], v[208:223]
    ds_read_b128 v[204:207], v8 offset:15360
    v_cvt_pk_bf16_f32 v20, v248, v249
    v_cvt_pk_bf16_f32 v21, v250, v251
    v_mul_f32 v252, v236, v29
    s_waitcnt lgkmcnt(4)
    v_mfma_f32_32x32x16_bf16 v[208:223], v[188:191], v[76:79], v[208:223]
    ds_read_b128 v[180:183], v8 offset:16384
    v_mul_f32 v253, v237, v29
    v_mul_f32 v254, v238, v29
    v_mul_f32 v255, v239, v29
    v_mfma_f32_32x32x16_bf16 v[208:223], v[192:195], v[80:83], v[208:223]
    ds_read_b128 v[184:187], v8 offset:17408
    v_cvt_pk_bf16_f32 v22, v252, v253
    v_cvt_pk_bf16_f32 v23, v254, v255
    ds_write_b128 v7, v[20:23] offset:9216
    s_waitcnt lgkmcnt(4)
    v_mfma_f32_32x32x16_bf16 v[208:223], v[196:199], v[84:87], v[208:223]
    v_mfma_f32_32x32x16_bf16 v[208:223], v[200:203], v[88:91], v[208:223]
    s_waitcnt lgkmcnt(0)
    s_barrier
    ds_read_b128 v[188:191], v8 offset:19456
    ds_read_b128 v[192:195], v8 offset:20480
    v_mfma_f32_32x32x16_bf16 v[208:223], v[204:207], v[92:95], v[208:223]
    ds_read_b128 v[196:199], v8 offset:21504
    v_mfma_f32_32x32x16_bf16 v[208:223], v[180:183], v[96:99], v[208:223]
    ds_read_b128 v[200:203], v8 offset:22528
    s_waitcnt lgkmcnt(3)
    v_mfma_f32_32x32x16_bf16 v[208:223], v[184:187], v[100:103], v[208:223]
    ds_read_b128 v[204:207], v8 offset:23552
    v_mfma_f32_32x32x16_bf16 v[208:223], v[188:191], v[104:107], v[208:223]
    ds_read_b128 v[180:183], v8 offset:24576
    s_waitcnt lgkmcnt(3)
    v_mfma_f32_32x32x16_bf16 v[208:223], v[192:195], v[108:111], v[208:223]
    ds_read_b128 v[184:187], v8 offset:25600
    v_mfma_f32_32x32x16_bf16 v[208:223], v[196:199], v[112:115], v[208:223]
    ds_read_b128 v[188:191], v8 offset:26624
    s_waitcnt lgkmcnt(3)
    v_mfma_f32_32x32x16_bf16 v[208:223], v[200:203], v[116:119], v[208:223]
    ds_read_b128 v[192:195], v8 offset:27648
    v_mfma_f32_32x32x16_bf16 v[208:223], v[204:207], v[120:123], v[208:223]
    ds_read_b128 v[196:199], v8 offset:28672
    s_waitcnt lgkmcnt(3)
    v_mfma_f32_32x32x16_bf16 v[208:223], v[180:183], v[124:127], v[208:223]
    ds_read_b128 v[200:203], v8 offset:29696
    v_mfma_f32_32x32x16_bf16 v[208:223], v[184:187], v[128:131], v[208:223]
    ds_read_b128 v[204:207], v8 offset:30720
    s_waitcnt lgkmcnt(3)
    v_mfma_f32_32x32x16_bf16 v[208:223], v[188:191], v[132:135], v[208:223]
    ds_read_b128 v[180:183], v8 offset:31744
    v_mfma_f32_32x32x16_bf16 v[208:223], v[192:195], v[136:139], v[208:223]
    ds_read_b128 v[184:187], v8 offset:32768
    s_waitcnt lgkmcnt(3)
    v_mfma_f32_32x32x16_bf16 v[208:223], v[196:199], v[140:143], v[208:223]
    ds_read_b128 v[188:191], v8 offset:33792
    v_mfma_f32_32x32x16_bf16 v[208:223], v[200:203], v[144:147], v[208:223]
    ds_read_b128 v[192:195], v8 offset:34816
    s_waitcnt lgkmcnt(3)
    v_mfma_f32_32x32x16_bf16 v[208:223], v[204:207], v[148:151], v[208:223]
    ds_read_b128 v[196:199], v8 offset:35840
    v_mfma_f32_32x32x16_bf16 v[208:223], v[180:183], v[152:155], v[208:223]
    ds_read_b128 v[200:203], v8 offset:36864
    s_waitcnt lgkmcnt(3)
    v_mfma_f32_32x32x16_bf16 v[208:223], v[184:187], v[156:159], v[208:223]
    ds_read_b128 v[204:207], v8 offset:37888
    v_mfma_f32_32x32x16_bf16 v[208:223], v[188:191], v[160:163], v[208:223]
    ds_read_b128 v[180:183], v8 offset:38912
    s_waitcnt lgkmcnt(3)
    v_mfma_f32_32x32x16_bf16 v[208:223], v[192:195], v[164:167], v[208:223]
    ds_read_b128 v[184:187], v8 offset:39936
    v_mfma_f32_32x32x16_bf16 v[208:223], v[196:199], v[168:171], v[208:223]
    ds_read_b128 v[188:191], v8 offset:40960
    s_waitcnt lgkmcnt(3)
    v_mfma_f32_32x32x16_bf16 v[208:223], v[200:203], v[172:175], v[208:223]
    ds_read_b128 v[192:195], v8 offset:41984
    v_mfma_f32_32x32x16_bf16 v[208:223], v[204:207], v[176:179], v[208:223]
    ds_read_b128 v[196:199], v8 offset:43008
    s_waitcnt lgkmcnt(3)
    v_mfma_f32_32x32x16_bf16 v[224:239], v[180:183], v[32:35], 0
    ds_read_b128 v[200:203], v8 offset:44032
    v_mfma_f32_32x32x16_bf16 v[224:239], v[184:187], v[36:39], v[224:239]
    ds_read_b128 v[204:207], v8 offset:45056
    s_waitcnt lgkmcnt(3)
    v_mfma_f32_32x32x16_bf16 v[224:239], v[188:191], v[40:43], v[224:239]
    ds_read_b128 v[180:183], v8 offset:46080
    v_mfma_f32_32x32x16_bf16 v[224:239], v[192:195], v[44:47], v[224:239]
    ds_read_b128 v[184:187], v8 offset:47104
    s_waitcnt lgkmcnt(3)
    v_mfma_f32_32x32x16_bf16 v[224:239], v[196:199], v[48:51], v[224:239]
    ds_read_b128 v[188:191], v8 offset:48128
    s_nop 1
    v_mfma_f32_32x32x16_bf16 v[224:239], v[200:203], v[52:55], v[224:239]
    ds_read_b128 v[192:195], v8 offset:49152
    v_mul_f32 v240, v208, v29
    v_mul_f32 v241, v209, v29
    v_mul_f32 v242, v210, v29
    v_mul_f32 v243, v211, v29
    s_waitcnt lgkmcnt(3)
    v_mfma_f32_32x32x16_bf16 v[224:239], v[204:207], v[56:59], v[224:239]
    ds_read_b128 v[196:199], v8 offset:50176
    v_cvt_pk_bf16_f32 v16, v240, v241
    v_cvt_pk_bf16_f32 v17, v242, v243
    v_mul_f32 v244, v216, v29
    v_mul_f32 v245, v217, v29
    v_mfma_f32_32x32x16_bf16 v[224:239], v[180:183], v[60:63], v[224:239]
    ds_read_b128 v[200:203], v8 offset:51200
    v_mul_f32 v246, v218, v29
    v_mul_f32 v247, v219, v29
    v_cvt_pk_bf16_f32 v18, v244, v245
    s_waitcnt lgkmcnt(3)
    v_mfma_f32_32x32x16_bf16 v[224:239], v[184:187], v[64:67], v[224:239]
    ds_read_b128 v[204:207], v8 offset:52224
    v_cvt_pk_bf16_f32 v19, v246, v247
    ds_write_b128 v7, v[16:19] offset:0
    v_mul_f32 v248, v212, v29
    v_mfma_f32_32x32x16_bf16 v[224:239], v[188:191], v[68:71], v[224:239]
    ds_read_b128 v[180:183], v8 offset:53248
    v_mul_f32 v249, v213, v29
    v_mul_f32 v250, v214, v29
    v_mul_f32 v251, v215, v29
    s_waitcnt lgkmcnt(4)
    v_mfma_f32_32x32x16_bf16 v[224:239], v[192:195], v[72:75], v[224:239]
    ds_read_b128 v[184:187], v8 offset:54272
    v_cvt_pk_bf16_f32 v20, v248, v249
    v_cvt_pk_bf16_f32 v21, v250, v251
    v_mul_f32 v252, v220, v29
    v_mfma_f32_32x32x16_bf16 v[224:239], v[196:199], v[76:79], v[224:239]
    ds_read_b128 v[188:191], v8 offset:55296
    v_mul_f32 v253, v221, v29
    v_mul_f32 v254, v222, v29
    v_mul_f32 v255, v223, v29
    s_waitcnt lgkmcnt(4)
    v_mfma_f32_32x32x16_bf16 v[224:239], v[200:203], v[80:83], v[224:239]
    ds_read_b128 v[192:195], v8 offset:56320
    v_cvt_pk_bf16_f32 v22, v252, v253
    v_cvt_pk_bf16_f32 v23, v254, v255
    ds_write_b128 v7, v[20:23] offset:1024
    v_mfma_f32_32x32x16_bf16 v[224:239], v[204:207], v[84:87], v[224:239]
    s_waitcnt lgkmcnt(3)
    v_mfma_f32_32x32x16_bf16 v[224:239], v[180:183], v[88:91], v[224:239]
    s_waitcnt lgkmcnt(0)
    s_barrier
    ds_read_b128 v[196:199], v4 offset:0
    ds_read_b128 v[200:203], v4 offset:1024
    v_mov_b32 v24, s100
    v_mov_b32 v25, 0
    s_waitcnt vmcnt(0)
    s_mov_b64 exec, 1
    buffer_store_dword v24, v25, s[96:99], s34 offen sc1
    s_mov_b64 exec, -1
    s_nop 3
    v_mfma_f32_32x32x16_bf16 v[224:239], v[184:187], v[92:95], v[224:239]
    ds_read_b128 v[204:207], v4 offset:2048
    v_mfma_f32_32x32x16_bf16 v[224:239], v[188:191], v[96:99], v[224:239]
    ds_read_b128 v[180:183], v4 offset:3072
    v_mfma_f32_32x32x16_bf16 v[224:239], v[192:195], v[100:103], v[224:239]
    ds_read_b128 v[184:187], v4 offset:4096
    s_waitcnt lgkmcnt(3)
    v_mfma_f32_32x32x16_bf16 v[224:239], v[196:199], v[104:107], v[224:239]
    ds_read_b128 v[188:191], v4 offset:5120
    v_mfma_f32_32x32x16_bf16 v[224:239], v[200:203], v[108:111], v[224:239]
    ds_read_b128 v[192:195], v4 offset:6144
    s_waitcnt lgkmcnt(3)
    v_mfma_f32_32x32x16_bf16 v[224:239], v[204:207], v[112:115], v[224:239]
    ds_read_b128 v[196:199], v4 offset:7168
    v_mfma_f32_32x32x16_bf16 v[224:239], v[180:183], v[116:119], v[224:239]
    ds_read_b128 v[200:203], v4 offset:8192
    s_waitcnt lgkmcnt(3)
    v_mfma_f32_32x32x16_bf16 v[224:239], v[184:187], v[120:123], v[224:239]
    ds_read_b128 v[204:207], v4 offset:9216
    v_mfma_f32_32x32x16_bf16 v[224:239], v[188:191], v[124:127], v[224:239]
    ds_read_b128 v[180:183], v4 offset:10240
    s_waitcnt lgkmcnt(3)
    v_mfma_f32_32x32x16_bf16 v[224:239], v[192:195], v[128:131], v[224:239]
    ds_read_b128 v[184:187], v4 offset:11264
    v_mfma_f32_32x32x16_bf16 v[224:239], v[196:199], v[132:135], v[224:239]
    ds_read_b128 v[188:191], v4 offset:12288
    s_waitcnt lgkmcnt(3)
    v_mfma_f32_32x32x16_bf16 v[224:239], v[200:203], v[136:139], v[224:239]
    ds_read_b128 v[192:195], v4 offset:13312
    v_mfma_f32_32x32x16_bf16 v[224:239], v[204:207], v[140:143], v[224:239]
    ds_read_b128 v[196:199], v4 offset:14336
    s_waitcnt lgkmcnt(3)
    v_mfma_f32_32x32x16_bf16 v[224:239], v[180:183], v[144:147], v[224:239]
    ds_read_b128 v[200:203], v4 offset:15360
    v_mfma_f32_32x32x16_bf16 v[224:239], v[184:187], v[148:151], v[224:239]
    ds_read_b128 v[204:207], v4 offset:16384
    s_waitcnt lgkmcnt(3)
    v_mfma_f32_32x32x16_bf16 v[224:239], v[188:191], v[152:155], v[224:239]
    ds_read_b128 v[180:183], v4 offset:17408
    v_mfma_f32_32x32x16_bf16 v[224:239], v[192:195], v[156:159], v[224:239]
    ds_read_b128 v[184:187], v4 offset:18432
    s_waitcnt lgkmcnt(3)
    v_mfma_f32_32x32x16_bf16 v[224:239], v[196:199], v[160:163], v[224:239]
    ds_read_b128 v[188:191], v4 offset:19456
    v_mfma_f32_32x32x16_bf16 v[224:239], v[200:203], v[164:167], v[224:239]
    ds_read_b128 v[192:195], v4 offset:20480
    s_waitcnt lgkmcnt(3)
    v_mfma_f32_32x32x16_bf16 v[224:239], v[204:207], v[168:171], v[224:239]
    ds_read_b128 v[196:199], v4 offset:21504
    v_mfma_f32_32x32x16_bf16 v[224:239], v[180:183], v[172:175], v[224:239]
    ds_read_b128 v[200:203], v4 offset:22528
    s_waitcnt lgkmcnt(3)
    v_mfma_f32_32x32x16_bf16 v[224:239], v[184:187], v[176:179], v[224:239]
    ds_read_b128 v[204:207], v4 offset:23552
    v_mfma_f32_32x32x16_bf16 v[208:223], v[188:191], v[32:35], 0
    ds_read_b128 v[180:183], v4 offset:24576
    s_waitcnt lgkmcnt(3)
    v_mfma_f32_32x32x16_bf16 v[208:223], v[192:195], v[36:39], v[208:223]
    ds_read_b128 v[184:187], v4 offset:25600
    v_mfma_f32_32x32x16_bf16 v[208:223], v[196:199], v[40:43], v[208:223]
    ds_read_b128 v[188:191], v4 offset:26624
    s_waitcnt lgkmcnt(3)
    v_mfma_f32_32x32x16_bf16 v[208:223], v[200:203], v[44:47], v[208:223]
    ds_read_b128 v[192:195], v4 offset:27648
    v_mfma_f32_32x32x16_bf16 v[208:223], v[204:207], v[48:51], v[208:223]
    ds_read_b128 v[196:199], v4 offset:28672
    s_nop 1
    s_waitcnt lgkmcnt(3)
    v_mfma_f32_32x32x16_bf16 v[208:223], v[180:183], v[52:55], v[208:223]
    ds_read_b128 v[200:203], v4 offset:29696
    v_mul_f32 v240, v224, v29
    v_mul_f32 v241, v225, v29
    v_mul_f32 v242, v226, v29
    v_mul_f32 v243, v227, v29
    v_mfma_f32_32x32x16_bf16 v[208:223], v[184:187], v[56:59], v[208:223]
    ds_read_b128 v[204:207], v4 offset:30720
    v_cvt_pk_bf16_f32 v16, v240, v241
    v_cvt_pk_bf16_f32 v17, v242, v243
    v_mul_f32 v244, v232, v29
    v_mul_f32 v245, v233, v29
    s_waitcnt lgkmcnt(3)
    v_mfma_f32_32x32x16_bf16 v[208:223], v[188:191], v[60:63], v[208:223]
    ds_read_b128 v[180:183], v4 offset:31744
    v_mul_f32 v246, v234, v29
    v_mul_f32 v247, v235, v29
    v_cvt_pk_bf16_f32 v18, v244, v245
    v_mfma_f32_32x32x16_bf16 v[208:223], v[192:195], v[64:67], v[208:223]
    ds_read_b128 v[184:187], v4 offset:32768
    v_cvt_pk_bf16_f32 v19, v246, v247
    ds_write_b128 v9, v[16:19] offset:8192
    v_mul_f32 v248, v228, v29
    s_waitcnt lgkmcnt(4)
    v_mfma_f32_32x32x16_bf16 v[208:223], v[196:199], v[68:71], v[208:223]
    ds_read_b128 v[188:191], v4 offset:33792
    v_mul_f32 v249, v229, v29
    v_mul_f32 v250, v230, v29
    v_mul_f32 v251, v231, v29
    v_mfma_f32_32x32x16_bf16 v[208:223], v[200:203], v[72:75], v[208:223]
    ds_read_b128 v[192:195], v4 offset:34816
    v_cvt_pk_bf16_f32 v20, v248, v249
    v_cvt_pk_bf16_f32 v21, v250, v251
    v_mul_f32 v252, v236, v29
    s_waitcnt lgkmcnt(4)
    v_mfma_f32_32x32x16_bf16 v[208:223], v[204:207], v[76:79], v[208:223]
    ds_read_b128 v[196:199], v4 offset:35840
    v_mul_f32 v253, v237, v29
    v_mul_f32 v254, v238, v29
    v_mul_f32 v255, v239, v29
    v_mfma_f32_32x32x16_bf16 v[208:223], v[180:183], v[80:83], v[208:223]
    ds_read_b128 v[200:203], v4 offset:36864
    v_cvt_pk_bf16_f32 v22, v252, v253
    v_cvt_pk_bf16_f32 v23, v254, v255
    ds_write_b128 v9, v[20:23] offset:9216
    s_waitcnt lgkmcnt(4)
    v_mfma_f32_32x32x16_bf16 v[208:223], v[184:187], v[84:87], v[208:223]
    v_mfma_f32_32x32x16_bf16 v[208:223], v[188:191], v[88:91], v[208:223]
    ds_read_b128 v[204:207], v4 offset:38912
    ds_read_b128 v[180:183], v4 offset:39936
    s_waitcnt lgkmcnt(4)
    v_mfma_f32_32x32x16_bf16 v[208:223], v[192:195], v[92:95], v[208:223]
    ds_read_b128 v[184:187], v4 offset:40960
    v_mfma_f32_32x32x16_bf16 v[208:223], v[196:199], v[96:99], v[208:223]
    ds_read_b128 v[188:191], v4 offset:41984
    s_waitcnt lgkmcnt(3)
    v_mfma_f32_32x32x16_bf16 v[208:223], v[200:203], v[100:103], v[208:223]
    ds_read_b128 v[192:195], v4 offset:43008
    v_mfma_f32_32x32x16_bf16 v[208:223], v[204:207], v[104:107], v[208:223]
    ds_read_b128 v[196:199], v4 offset:44032
    s_waitcnt lgkmcnt(3)
    v_mfma_f32_32x32x16_bf16 v[208:223], v[180:183], v[108:111], v[208:223]
    ds_read_b128 v[200:203], v4 offset:45056
    v_mfma_f32_32x32x16_bf16 v[208:223], v[184:187], v[112:115], v[208:223]
    ds_read_b128 v[204:207], v4 offset:46080
    s_waitcnt lgkmcnt(3)
    v_mfma_f32_32x32x16_bf16 v[208:223], v[188:191], v[116:119], v[208:223]
    ds_read_b128 v[180:183], v4 offset:47104
    v_mfma_f32_32x32x16_bf16 v[208:223], v[192:195], v[120:123], v[208:223]
    ds_read_b128 v[184:187], v4 offset:48128
    s_waitcnt lgkmcnt(3)
    v_mfma_f32_32x32x16_bf16 v[208:223], v[196:199], v[124:127], v[208:223]
    ds_read_b128 v[188:191], v4 offset:49152
    v_mfma_f32_32x32x16_bf16 v[208:223], v[200:203], v[128:131], v[208:223]
    ds_read_b128 v[192:195], v4 offset:50176
    s_waitcnt lgkmcnt(3)
    v_mfma_f32_32x32x16_bf16 v[208:223], v[204:207], v[132:135], v[208:223]
    ds_read_b128 v[196:199], v4 offset:51200
    v_mfma_f32_32x32x16_bf16 v[208:223], v[180:183], v[136:139], v[208:223]
    ds_read_b128 v[200:203], v4 offset:52224
    s_waitcnt lgkmcnt(3)
    v_mfma_f32_32x32x16_bf16 v[208:223], v[184:187], v[140:143], v[208:223]
    ds_read_b128 v[204:207], v4 offset:53248
    v_mfma_f32_32x32x16_bf16 v[208:223], v[188:191], v[144:147], v[208:223]
    ds_read_b128 v[180:183], v4 offset:54272
    s_waitcnt lgkmcnt(3)
    v_mfma_f32_32x32x16_bf16 v[208:223], v[192:195], v[148:151], v[208:223]
    ds_read_b128 v[184:187], v4 offset:55296
    v_mfma_f32_32x32x16_bf16 v[208:223], v[196:199], v[152:155], v[208:223]
    ds_read_b128 v[188:191], v4 offset:56320
    s_waitcnt lgkmcnt(3)
    v_mfma_f32_32x32x16_bf16 v[208:223], v[200:203], v[156:159], v[208:223]
    ds_read_b128 v[192:195], v4 offset:57344
    v_mfma_f32_32x32x16_bf16 v[208:223], v[204:207], v[160:163], v[208:223]
    s_waitcnt lgkmcnt(2)
    v_mfma_f32_32x32x16_bf16 v[208:223], v[180:183], v[164:167], v[208:223]
    v_mfma_f32_32x32x16_bf16 v[208:223], v[184:187], v[168:171], v[208:223]
    s_waitcnt lgkmcnt(0)
    v_mfma_f32_32x32x16_bf16 v[208:223], v[188:191], v[172:175], v[208:223]
    v_mfma_f32_32x32x16_bf16 v[208:223], v[192:195], v[176:179], v[208:223]
    s_nop 7
    s_nop 4
    v_mul_f32 v240, v208, v29
    v_mul_f32 v241, v209, v29
    v_mul_f32 v242, v210, v29
    v_mul_f32 v243, v211, v29
    v_cvt_pk_bf16_f32 v16, v240, v241
    v_cvt_pk_bf16_f32 v17, v242, v243
    v_mul_f32 v244, v216, v29
    v_mul_f32 v245, v217, v29
    v_mul_f32 v246, v218, v29
    v_mul_f32 v247, v219, v29
    v_cvt_pk_bf16_f32 v18, v244, v245
    v_cvt_pk_bf16_f32 v19, v246, v247
    ds_write_b128 v9, v[16:19] offset:0
    v_mul_f32 v248, v212, v29
    v_mul_f32 v249, v213, v29
    v_mul_f32 v250, v214, v29
    v_mul_f32 v251, v215, v29
    v_cvt_pk_bf16_f32 v20, v248, v249
    v_cvt_pk_bf16_f32 v21, v250, v251
    v_mul_f32 v252, v220, v29
    v_mul_f32 v253, v221, v29
    v_mul_f32 v254, v222, v29
    v_mul_f32 v255, v223, v29
    v_cvt_pk_bf16_f32 v22, v252, v253
    v_cvt_pk_bf16_f32 v23, v254, v255
    ds_write_b128 v9, v[20:23] offset:1024
    s_setprio 0
    s_waitcnt vmcnt(0) lgkmcnt(0)
    s_barrier
    s_barrier
    s_branch P2
Lg1h:
    s_add_u32 s23, s21, 72
    s_mul_i32 s28, s23, 37888
    s_mul_i32 s29, s22, 37888
    s_mul_i32 s76, s14, 4608
    s_mul_i32 s77, s14, 4864
    s_mov_b32 s78, -1
    s_mov_b32 s79, 0
    s_mov_b32 s80, -1
    s_mov_b32 s81, 0xffff
    v_min_u32 v24, 19, v2
    v_mov_b32 v25, s23
    v_mov_b32 v26, s22
    v_cmp_eq_u32 vcc, 0, v3
    s_add_u32 s34, s34, 49360896
    s_mov_b32 s33, 49352704
    v_cndmask_b32 v25, v26, v25, vcc
    v_lshl_add_u32 v24, v25, 2, v24
    v_min_u32 v24, 575, v24
    v_lshlrev_b32 v24, 2, v24
    s_load_dwordx2 s[56:57], s[0:1], 88
    s_waitcnt lgkmcnt(0)
    s_mov_b32 s60, s56
    s_and_b32 s61, s57, 0xffff
    s_mov_b32 s62, 8388608
    s_mov_b32 s63, 0x20000
    s_lshl_b32 s56, s2, 2
    s_add_u32 s56, s56, s14
    s_lshl_b32 s56, s56, 13
    s_add_u32 s57, s56, 4096
    s_mov_b32 s90, 0
Lpl24:
    buffer_load_dword v28, v24, s[96:99], s33 offen sc1
    s_waitcnt vmcnt(0)
    v_cmp_ne_u32 vcc, s100, v28
    s_add_u32 s90, s90, 1
    s_cmp_eq_u64 vcc, 0
    s_cbranch_scc1 Lok25
    s_sleep 16
    s_cmp_lt_u32 s90, 0x20000
    s_cbranch_scc1 Lpl24
Lok25:
    s_cmp_eq_u32 s32, 1
    s_cbranch_scc1 Lg1o
    s_add_u32 s82, s28, s76
    s_add_u32 m0, s76, 0
    s_add_u32 s82, s82, 0
    buffer_load_dwordx4 v8, s[96:99], s82 offen sc1 lds
    buffer_load_dwordx4 v8, s[96:99], s82 offen offset:1024 sc1 lds
    buffer_load_dwordx4 v8, s[96:99], s82 offen offset:2048 sc1 lds
    buffer_load_dwordx4 v8, s[96:99], s82 offen offset:3072 sc1 lds
    s_add_u32 m0, s76, 4096
    s_add_u32 s82, s82, 4096
    s_mov_b64 exec, s[78:79]
    buffer_load_dwordx4 v8, s[96:99], s82 offen sc1 lds
    s_mov_b64 exec, -1
    s_add_u32 s82, s28, s77
    s_add_u32 m0, s77, 19456
    s_add_u32 s82, s82, 18432
    buffer_load_dwordx4 v8, s[96:99], s82 offen sc1 lds
    buffer_load_dwordx4 v8, s[96:99], s82 offen offset:1024 sc1 lds
    buffer_load_dwordx4 v8, s[96:99], s82 offen offset:2048 sc1 lds
    buffer_load_dwordx4 v8, s[96:99], s82 offen offset:3072 sc1 lds
    s_add_u32 m0, s77, 23552
    s_add_u32 s82, s82, 4096
    s_mov_b64 exec, s[80:81]
    buffer_load_dwordx4 v8, s[96:99], s82 offen sc1 lds
    s_mov_b64 exec, -1
    s_add_u32 s82, s28, s76
    s_add_u32 m0, s76, 38912
    s_add_u32 s82, s82, 37888
    buffer_load_dwordx4 v8, s[96:99], s82 offen sc1 lds
    buffer_load_dwordx4 v8, s[96:99], s82 offen offset:1024 sc1 lds
    buffer_load_dwordx4 v8, s[96:99], s82 offen offset:2048 sc1 lds
    buffer_load_dwordx4 v8, s[96:99], s82 offen offset:3072 sc1 lds
    s_add_u32 m0, s76, 43008
    s_add_u32 s82, s82, 4096
    s_mov_b64 exec, s[78:79]
    buffer_load_dwordx4 v8, s[96:99], s82 offen sc1 lds
    s_mov_b64 exec, -1
    s_lshl_b32 s33, s18, 13
    s_add_u32 s37, s33, 48234496
    s_add_u32 s38, s37, 4096
    s_lshl_b32 s33, s13, 9
    s_add_u32 s39, s37, s33
    v_lshrrev_b32 v16, 4, v1
    v_lshlrev_b32 v16, 9, v16
    v_and_b32 v17, 15, v1
    v_lshl_add_u32 v16, v17, 4, v16
    s_lshl_b32 s33, s14, 11
    v_add_u32 v16, s33, v16
    v_add_u32 v18, 116736, v16
    s_lshl_b32 s33, s14, 10
    s_add_u32 s33, s33, 133120
    v_lshlrev_b32 v17, 4, v17
    v_add_u32 v17, s33, v17
    s_lshl_b32 s33, s14, 12
    s_add_u32 s33, s33, 19456
    v_lshlrev_b32 v9, 5, v2
    v_lshl_add_u32 v9, v3, 3, v9
    v_add_u32 v9, s33, v9
    v_lshrrev_b32 v10, 4, v1
    v_lshlrev_b32 v10, 8, v10
    v_bfe_u32 v20, v1, 2, 2
    v_lshl_add_u32 v10, v20, 5, v10
    v_and_b32 v20, 3, v1
    v_lshl_add_u32 v10, v20, 3, v10
    v_add_u32 v10, s33, v10
    s_lshl_b32 s33, s13, 6
    s_add_u32 s33, s33, s18
    s_mul_i32 s36, s33, 9216
    s_add_u32 s36, s36, 27262976
    v_mov_b32 v24, 0
    v_mov_b32 v25, 0
    v_mov_b32 v26, 0
    v_mov_b32 v27, 0
    v_mov_b32 v12, 0xc0135761
    v_mov_b32 v13, 0xbdd2d3e8
    s_barrier
    s_waitcnt vmcnt(10)
    s_barrier
    s_waitcnt vmcnt(0)
    s_barrier
    s_add_u32 s82, s28, s77
    s_add_u32 m0, s77, 58368
    s_add_u32 s82, s82, 56320
    buffer_load_dwordx4 v8, s[96:99], s82 offen sc1 lds
    buffer_load_dwordx4 v8, s[96:99], s82 offen offset:1024 sc1 lds
    buffer_load_dwordx4 v8, s[96:99], s82 offen offset:2048 sc1 lds
    buffer_load_dwordx4 v8, s[96:99], s82 offen offset:3072 sc1 lds
    s_add_u32 m0, s77, 62464
    s_add_u32 s82, s82, 4096
    s_mov_b64 exec, s[80:81]
    buffer_load_dwordx4 v8, s[96:99], s82 offen sc1 lds
    s_mov_b64 exec, -1
    s_add_u32 s82, s28, s76
    s_add_u32 m0, s76, 77824
    s_add_u32 s82, s82, 75776
    buffer_load_dwordx4 v8, s[96:99], s82 offen sc1 lds
    buffer_load_dwordx4 v8, s[96:99], s82 offen offset:1024 sc1 lds
    buffer_load_dwordx4 v8, s[96:99], s82 offen offset:2048 sc1 lds
    buffer_load_dwordx4 v8, s[96:99], s82 offen offset:3072 sc1 lds
    s_add_u32 m0, s76, 81920
    s_add_u32 s82, s82, 4096
    s_mov_b64 exec, s[78:79]
    buffer_load_dwordx4 v8, s[96:99], s82 offen sc1 lds
    s_mov_b64 exec, -1
    s_add_u32 s82, s28, s77
    s_add_u32 m0, s77, 97280
    s_add_u32 s82, s82, 94208
    buffer_load_dwordx4 v8, s[96:99], s82 offen sc1 lds
    buffer_load_dwordx4 v8, s[96:99], s82 offen offset:1024 sc1 lds
    buffer_load_dwordx4 v8, s[96:99], s82 offen offset:2048 sc1 lds
    buffer_load_dwordx4 v8, s[96:99], s82 offen offset:3072 sc1 lds
    s_add_u32 m0, s77, 101376
    s_add_u32 s82, s82, 4096
    s_mov_b64 exec, s[80:81]
    buffer_load_dwordx4 v8, s[96:99], s82 offen sc1 lds
    s_mov_b64 exec, -1
    s_add_u32 s82, s28, s76
    s_add_u32 m0, s76, 0
    s_add_u32 s82, s82, 113664
    buffer_load_dwordx4 v8, s[96:99], s82 offen sc1 lds
    buffer_load_dwordx4 v8, s[96:99], s82 offen offset:1024 sc1 lds
    buffer_load_dwordx4 v8, s[96:99], s82 offen offset:2048 sc1 lds
    buffer_load_dwordx4 v8, s[96:99], s82 offen offset:3072 sc1 lds
    s_add_u32 m0, s76, 4096
    s_add_u32 s82, s82, 4096
    s_mov_b64 exec, s[78:79]
    buffer_load_dwordx4 v8, s[96:99], s82 offen sc1 lds
    s_mov_b64 exec, -1
    s_waitcnt vmcnt(10)
    s_barrier
    ds_read_b128 v[32:35], v7 offset:0
    ds_read_b128 v[36:39], v7 offset:1024
    s_add_u32 s82, s28, s77
    s_add_u32 m0, s77, 19456
    s_add_u32 s82, s82, 132096
    buffer_load_dwordx4 v8, s[96:99], s82 offen sc1 lds
    buffer_load_dwordx4 v8, s[96:99], s82 offen offset:1024 sc1 lds
    buffer_load_dwordx4 v8, s[96:99], s82 offen offset:2048 sc1 lds
    s_waitcnt lgkmcnt(0)
    v_lshlrev_b32 v40, 16, v32
    v_and_b32 v41, 0xffff0000, v32
    v_lshlrev_b32 v42, 16, v33
    v_and_b32 v43, 0xffff0000, v33
    v_mul_f32 v56, v40, v40
    v_mul_f32 v57, v41, v41
    v_mul_f32 v58, v42, v42
    v_mul_f32 v59, v43, v43
    v_fma_f32 v56, v56, v13, v12
    v_fma_f32 v57, v57, v13, v12
    v_fma_f32 v58, v58, v13, v12
    v_fma_f32 v59, v59, v13, v12
    v_mul_f32 v56, v56, v40
    v_mul_f32 v57, v57, v41
    v_mul_f32 v58, v58, v42
    v_mul_f32 v59, v59, v43
    v_exp_f32 v56, v56
    v_exp_f32 v57, v57
    v_exp_f32 v58, v58
    v_exp_f32 v59, v59
    buffer_load_dwordx4 v8, s[96:99], s82 offen offset:3072 sc1 lds
    v_add_f32 v56, 1.0, v56
    v_add_f32 v57, 1.0, v57
    v_add_f32 v58, 1.0, v58
    v_add_f32 v59, 1.0, v59
    v_rcp_f32 v56, v56
    v_rcp_f32 v57, v57
    v_rcp_f32 v58, v58
    v_rcp_f32 v59, v59
    v_mul_f32 v60, v40, v56
    v_mul_f32 v61, v41, v57
    v_mul_f32 v62, v42, v58
    v_mul_f32 v63, v43, v59
    v_cvt_pk_bf16_f32 v80, v60, v61
    v_cvt_pk_bf16_f32 v81, v62, v63
    v_add_f32 v24, v24, v60
    v_fmac_f32 v25, v60, v60
    v_add_f32 v26, v26, v61
    v_fmac_f32 v27, v61, v61
    v_add_f32 v24, v24, v62
    v_fmac_f32 v25, v62, v62
    v_add_f32 v26, v26, v63
    s_add_u32 m0, s77, 23552
    s_add_u32 s82, s82, 4096
    s_mov_b64 exec, s[80:81]
    buffer_load_dwordx4 v8, s[96:99], s82 offen sc1 lds
    s_mov_b64 exec, -1
    v_fmac_f32 v27, v63, v63
    v_lshlrev_b32 v48, 16, v34
    v_and_b32 v49, 0xffff0000, v34
    v_lshlrev_b32 v50, 16, v35
    v_and_b32 v51, 0xffff0000, v35
    v_mul_f32 v64, v48, v48
    v_mul_f32 v65, v49, v49
    v_mul_f32 v66, v50, v50
    v_mul_f32 v67, v51, v51
    v_fma_f32 v64, v64, v13, v12
    v_fma_f32 v65, v65, v13, v12
    v_fma_f32 v66, v66, v13, v12
    v_fma_f32 v67, v67, v13, v12
    v_mul_f32 v64, v64, v48
    v_mul_f32 v65, v65, v49
    v_mul_f32 v66, v66, v50
    v_mul_f32 v67, v67, v51
    v_exp_f32 v64, v64
    v_exp_f32 v65, v65
    v_exp_f32 v66, v66
    v_exp_f32 v67, v67
    s_add_u32 s82, s28, s76
    s_add_u32 m0, s76, 38912
    s_add_u32 s82, s82, 151552
    buffer_load_dwordx4 v8, s[96:99], s82 offen sc1 lds
    v_add_f32 v64, 1.0, v64
    v_add_f32 v65, 1.0, v65
    v_add_f32 v66, 1.0, v66
    v_add_f32 v67, 1.0, v67
    v_rcp_f32 v64, v64
    v_rcp_f32 v65, v65
    v_rcp_f32 v66, v66
    v_rcp_f32 v67, v67
    v_mul_f32 v68, v48, v64
    v_mul_f32 v69, v49, v65
    v_mul_f32 v70, v50, v66
    v_mul_f32 v71, v51, v67
    v_cvt_pk_bf16_f32 v82, v68, v69
    v_cvt_pk_bf16_f32 v83, v70, v71
    v_add_f32 v24, v24, v68
    v_fmac_f32 v25, v68, v68
    v_add_f32 v26, v26, v69
    v_fmac_f32 v27, v69, v69
    v_add_f32 v24, v24, v70
    v_fmac_f32 v25, v70, v70
    v_add_f32 v26, v26, v71
    buffer_load_dwordx4 v8, s[96:99], s82 offen offset:1024 sc1 lds
    v_fmac_f32 v27, v71, v71
    v_lshlrev_b32 v40, 16, v36
    v_and_b32 v41, 0xffff0000, v36
    v_lshlrev_b32 v42, 16, v37
    v_and_b32 v43, 0xffff0000, v37
    v_mul_f32 v56, v40, v40
    v_mul_f32 v57, v41, v41
    v_mul_f32 v58, v42, v42
    v_mul_f32 v59, v43, v43
    v_fma_f32 v56, v56, v13, v12
    v_fma_f32 v57, v57, v13, v12
    v_fma_f32 v58, v58, v13, v12
    v_fma_f32 v59, v59, v13, v12
    v_mul_f32 v56, v56, v40
    v_mul_f32 v57, v57, v41
    v_mul_f32 v58, v58, v42
    v_mul_f32 v59, v59, v43
    v_exp_f32 v56, v56
    v_exp_f32 v57, v57
    v_exp_f32 v58, v58
    v_exp_f32 v59, v59
    buffer_load_dwordx4 v8, s[96:99], s82 offen offset:2048 sc1 lds
    v_add_f32 v56, 1.0, v56
    v_add_f32 v57, 1.0, v57
    v_add_f32 v58, 1.0, v58
    v_add_f32 v59, 1.0, v59
    v_rcp_f32 v56, v56
    v_rcp_f32 v57, v57
    v_rcp_f32 v58, v58
    v_rcp_f32 v59, v59
    v_mul_f32 v60, v40, v56
    v_mul_f32 v61, v41, v57
    v_mul_f32 v62, v42, v58
    v_mul_f32 v63, v43, v59
    v_cvt_pk_bf16_f32 v84, v60, v61
    v_cvt_pk_bf16_f32 v85, v62, v63
    v_add_f32 v24, v24, v60
    v_fmac_f32 v25, v60, v60
    v_add_f32 v26, v26, v61
    v_fmac_f32 v27, v61, v61
    v_add_f32 v24, v24, v62
    v_fmac_f32 v25, v62, v62
    v_add_f32 v26, v26, v63
    buffer_load_dwordx4 v8, s[96:99], s82 offen offset:3072 sc1 lds
    v_fmac_f32 v27, v63, v63
    v_lshlrev_b32 v48, 16, v38
    v_and_b32 v49, 0xffff0000, v38
    v_lshlrev_b32 v50, 16, v39
    v_and_b32 v51, 0xffff0000, v39
    v_mul_f32 v64, v48, v48
    v_mul_f32 v65, v49, v49
    v_mul_f32 v66, v50, v50
    v_mul_f32 v67, v51, v51
    v_fma_f32 v64, v64, v13, v12
    v_fma_f32 v65, v65, v13, v12
    v_fma_f32 v66, v66, v13, v12
    v_fma_f32 v67, v67, v13, v12
    v_mul_f32 v64, v64, v48
    v_mul_f32 v65, v65, v49
    v_mul_f32 v66, v66, v50
    v_mul_f32 v67, v67, v51
    v_exp_f32 v64, v64
    v_exp_f32 v65, v65
    v_exp_f32 v66, v66
    v_exp_f32 v67, v67
    s_add_u32 m0, s76, 43008
    s_add_u32 s82, s82, 4096
    s_mov_b64 exec, s[78:79]
    buffer_load_dwordx4 v8, s[96:99], s82 offen sc1 lds
    s_mov_b64 exec, -1
    v_add_f32 v64, 1.0, v64
    v_add_f32 v65, 1.0, v65
    v_add_f32 v66, 1.0, v66
    v_add_f32 v67, 1.0, v67
    v_rcp_f32 v64, v64
    v_rcp_f32 v65, v65
    v_rcp_f32 v66, v66
    v_rcp_f32 v67, v67
    v_mul_f32 v68, v48, v64
    v_mul_f32 v69, v49, v65
    v_mul_f32 v70, v50, v66
    v_mul_f32 v71, v51, v67
    v_cvt_pk_bf16_f32 v86, v68, v69
    v_cvt_pk_bf16_f32 v87, v70, v71
    v_add_f32 v24, v24, v68
    v_fmac_f32 v25, v68, v68
    v_add_f32 v26, v26, v69
    v_fmac_f32 v27, v69, v69
    v_add_f32 v24, v24, v70
    v_fmac_f32 v25, v70, v70
    v_add_f32 v26, v26, v71
    v_fmac_f32 v27, v71, v71
    s_waitcnt vmcnt(10)
    s_barrier
    ds_read_b128 v[32:35], v7 offset:8192
    ds_read_b128 v[36:39], v7 offset:9216
    s_add_u32 s82, s28, s77
    s_add_u32 m0, s77, 58368
    s_add_u32 s82, s82, 169984
    buffer_load_dwordx4 v8, s[96:99], s82 offen sc1 lds
    buffer_load_dwordx4 v8, s[96:99], s82 offen offset:1024 sc1 lds
    buffer_load_dwordx4 v8, s[96:99], s82 offen offset:2048 sc1 lds
    s_waitcnt lgkmcnt(0)
    v_lshlrev_b32 v40, 16, v32
    v_and_b32 v41, 0xffff0000, v32
    v_lshlrev_b32 v42, 16, v33
    v_and_b32 v43, 0xffff0000, v33
    v_mul_f32 v56, v40, v40
    v_mul_f32 v57, v41, v41
    v_mul_f32 v58, v42, v42
    v_mul_f32 v59, v43, v43
    v_fma_f32 v56, v56, v13, v12
    v_fma_f32 v57, v57, v13, v12
    v_fma_f32 v58, v58, v13, v12
    v_fma_f32 v59, v59, v13, v12
    v_mul_f32 v56, v56, v40
    v_mul_f32 v57, v57, v41
    v_mul_f32 v58, v58, v42
    v_mul_f32 v59, v59, v43
    v_exp_f32 v56, v56
    v_exp_f32 v57, v57
    v_exp_f32 v58, v58
    v_exp_f32 v59, v59
    buffer_load_dwordx4 v8, s[96:99], s82 offen offset:3072 sc1 lds
    v_add_f32 v56, 1.0, v56
    v_add_f32 v57, 1.0, v57
    v_add_f32 v58, 1.0, v58
    v_add_f32 v59, 1.0, v59
    v_rcp_f32 v56, v56
    v_rcp_f32 v57, v57
    v_rcp_f32 v58, v58
    v_rcp_f32 v59, v59
    v_mul_f32 v60, v40, v56
    v_mul_f32 v61, v41, v57
    v_mul_f32 v62, v42, v58
    v_mul_f32 v63, v43, v59
    v_cvt_pk_bf16_f32 v88, v60, v61
    v_cvt_pk_bf16_f32 v89, v62, v63
    v_add_f32 v24, v24, v60
    v_fmac_f32 v25, v60, v60
    v_add_f32 v26, v26, v61
    v_fmac_f32 v27, v61, v61
    v_add_f32 v24, v24, v62
    v_fmac_f32 v25, v62, v62
    v_add_f32 v26, v26, v63
    s_add_u32 m0, s77, 62464
    s_add_u32 s82, s82, 4096
    s_mov_b64 exec, s[80:81]
    buffer_load_dwordx4 v8, s[96:99], s82 offen sc1 lds
    s_mov_b64 exec, -1
    v_fmac_f32 v27, v63, v63
    v_lshlrev_b32 v48, 16, v34
    v_and_b32 v49, 0xffff0000, v34
    v_lshlrev_b32 v50, 16, v35
    v_and_b32 v51, 0xffff0000, v35
    v_mul_f32 v64, v48, v48
    v_mul_f32 v65, v49, v49
    v_mul_f32 v66, v50, v50
    v_mul_f32 v67, v51, v51
    v_fma_f32 v64, v64, v13, v12
    v_fma_f32 v65, v65, v13, v12
    v_fma_f32 v66, v66, v13, v12
    v_fma_f32 v67, v67, v13, v12
    v_mul_f32 v64, v64, v48
    v_mul_f32 v65, v65, v49
    v_mul_f32 v66, v66, v50
    v_mul_f32 v67, v67, v51
    v_exp_f32 v64, v64
    v_exp_f32 v65, v65
    v_exp_f32 v66, v66
    v_exp_f32 v67, v67
    s_add_u32 s82, s29, s76
    s_add_u32 m0, s76, 77824
    s_add_u32 s82, s82, 0
    buffer_load_dwordx4 v8, s[96:99], s82 offen sc1 lds
    v_add_f32 v64, 1.0, v64
    v_add_f32 v65, 1.0, v65
    v_add_f32 v66, 1.0, v66
    v_add_f32 v67, 1.0, v67
    v_rcp_f32 v64, v64
    v_rcp_f32 v65, v65
    v_rcp_f32 v66, v66
    v_rcp_f32 v67, v67
    v_mul_f32 v68, v48, v64
    v_mul_f32 v69, v49, v65
    v_mul_f32 v70, v50, v66
    v_mul_f32 v71, v51, v67
    v_cvt_pk_bf16_f32 v90, v68, v69
    v_cvt_pk_bf16_f32 v91, v70, v71
    v_add_f32 v24, v24, v68
    v_fmac_f32 v25, v68, v68
    v_add_f32 v26, v26, v69
    v_fmac_f32 v27, v69, v69
    v_add_f32 v24, v24, v70
    v_fmac_f32 v25, v70, v70
    v_add_f32 v26, v26, v71
    buffer_load_dwordx4 v8, s[96:99], s82 offen offset:1024 sc1 lds
    v_fmac_f32 v27, v71, v71
    v_lshlrev_b32 v40, 16, v36
    v_and_b32 v41, 0xffff0000, v36
    v_lshlrev_b32 v42, 16, v37
    v_and_b32 v43, 0xffff0000, v37
    v_mul_f32 v56, v40, v40
    v_mul_f32 v57, v41, v41
    v_mul_f32 v58, v42, v42
    v_mul_f32 v59, v43, v43
    v_fma_f32 v56, v56, v13, v12
    v_fma_f32 v57, v57, v13, v12
    v_fma_f32 v58, v58, v13, v12
    v_fma_f32 v59, v59, v13, v12
    v_mul_f32 v56, v56, v40
    v_mul_f32 v57, v57, v41
    v_mul_f32 v58, v58, v42
    v_mul_f32 v59, v59, v43
    v_exp_f32 v56, v56
    v_exp_f32 v57, v57
    v_exp_f32 v58, v58
    v_exp_f32 v59, v59
    buffer_load_dwordx4 v8, s[96:99], s82 offen offset:2048 sc1 lds
    v_add_f32 v56, 1.0, v56
    v_add_f32 v57, 1.0, v57
    v_add_f32 v58, 1.0, v58
    v_add_f32 v59, 1.0, v59
    v_rcp_f32 v56, v56
    v_rcp_f32 v57, v57
    v_rcp_f32 v58, v58
    v_rcp_f32 v59, v59
    v_mul_f32 v60, v40, v56
    v_mul_f32 v61, v41, v57
    v_mul_f32 v62, v42, v58
    v_mul_f32 v63, v43, v59
    v_cvt_pk_bf16_f32 v92, v60, v61
    v_cvt_pk_bf16_f32 v93, v62, v63
    v_add_f32 v24, v24, v60
    v_fmac_f32 v25, v60, v60
    v_add_f32 v26, v26, v61
    v_fmac_f32 v27, v61, v61
    v_add_f32 v24, v24, v62
    v_fmac_f32 v25, v62, v62
    v_add_f32 v26, v26, v63
    buffer_load_dwordx4 v8, s[96:99], s82 offen offset:3072 sc1 lds
    v_fmac_f32 v27, v63, v63
    v_lshlrev_b32 v48, 16, v38
    v_and_b32 v49, 0xffff0000, v38
    v_lshlrev_b32 v50, 16, v39
    v_and_b32 v51, 0xffff0000, v39
    v_mul_f32 v64, v48, v48
    v_mul_f32 v65, v49, v49
    v_mul_f32 v66, v50, v50
    v_mul_f32 v67, v51, v51
    v_fma_f32 v64, v64, v13, v12
    v_fma_f32 v65, v65, v13, v12
    v_fma_f32 v66, v66, v13, v12
    v_fma_f32 v67, v67, v13, v12
    v_mul_f32 v64, v64, v48
    v_mul_f32 v65, v65, v49
    v_mul_f32 v66, v66, v50
    v_mul_f32 v67, v67, v51
    v_exp_f32 v64, v64
    v_exp_f32 v65, v65
    v_exp_f32 v66, v66
    v_exp_f32 v67, v67
    s_add_u32 m0, s76, 81920
    s_add_u32 s82, s82, 4096
    s_mov_b64 exec, s[78:79]
    buffer_load_dwordx4 v8, s[96:99], s82 offen sc1 lds
    s_mov_b64 exec, -1
    v_add_f32 v64, 1.0, v64
    v_add_f32 v65, 1.0, v65
    v_add_f32 v66, 1.0, v66
    v_add_f32 v67, 1.0, v67
    v_rcp_f32 v64, v64
    v_rcp_f32 v65, v65
    v_rcp_f32 v66, v66
    v_rcp_f32 v67, v67
    v_mul_f32 v68, v48, v64
    v_mul_f32 v69, v49, v65
    v_mul_f32 v70, v50, v66
    v_mul_f32 v71, v51, v67
    v_cvt_pk_bf16_f32 v94, v68, v69
    v_cvt_pk_bf16_f32 v95, v70, v71
    v_add_f32 v24, v24, v68
    v_fmac_f32 v25, v68, v68
    v_add_f32 v26, v26, v69
    v_fmac_f32 v27, v69, v69
    v_add_f32 v24, v24, v70
    v_fmac_f32 v25, v70, v70
    v_add_f32 v26, v26, v71
    v_fmac_f32 v27, v71, v71
    s_waitcnt vmcnt(10)
    s_barrier
    ds_read_b128 v[32:35], v7 offset:0
    ds_read_b128 v[36:39], v7 offset:1024
    s_add_u32 s82, s29, s77
    s_add_u32 m0, s77, 97280
    s_add_u32 s82, s82, 18432
    buffer_load_dwordx4 v8, s[96:99], s82 offen sc1 lds
    buffer_load_dwordx4 v8, s[96:99], s82 offen offset:1024 sc1 lds
    buffer_load_dwordx4 v8, s[96:99], s82 offen offset:2048 sc1 lds
    s_waitcnt lgkmcnt(0)
    v_lshlrev_b32 v40, 16, v32
    v_and_b32 v41, 0xffff0000, v32
    v_lshlrev_b32 v42, 16, v33
    v_and_b32 v43, 0xffff0000, v33
    v_mul_f32 v56, v40, v40
    v_mul_f32 v57, v41, v41
    v_mul_f32 v58, v42, v42
    v_mul_f32 v59, v43, v43
    v_fma_f32 v56, v56, v13, v12
    v_fma_f32 v57, v57, v13, v12
    v_fma_f32 v58, v58, v13, v12
    v_fma_f32 v59, v59, v13, v12
    v_mul_f32 v56, v56, v40
    v_mul_f32 v57, v57, v41
    v_mul_f32 v58, v58, v42
    v_mul_f32 v59, v59, v43
    v_exp_f32 v56, v56
    v_exp_f32 v57, v57
    v_exp_f32 v58, v58
    v_exp_f32 v59, v59
    buffer_load_dwordx4 v8, s[96:99], s82 offen offset:3072 sc1 lds
    v_add_f32 v56, 1.0, v56
    v_add_f32 v57, 1.0, v57
    v_add_f32 v58, 1.0, v58
    v_add_f32 v59, 1.0, v59
    v_rcp_f32 v56, v56
    v_rcp_f32 v57, v57
    v_rcp_f32 v58, v58
    v_rcp_f32 v59, v59
    v_mul_f32 v60, v40, v56
    v_mul_f32 v61, v41, v57
    v_mul_f32 v62, v42, v58
    v_mul_f32 v63, v43, v59
    v_cvt_pk_bf16_f32 v96, v60, v61
    v_cvt_pk_bf16_f32 v97, v62, v63
    v_add_f32 v24, v24, v60
    v_fmac_f32 v25, v60, v60
    v_add_f32 v26, v26, v61
    v_fmac_f32 v27, v61, v61
    v_add_f32 v24, v24, v62
    v_fmac_f32 v25, v62, v62
    v_add_f32 v26, v26, v63
    s_add_u32 m0, s77, 101376
    s_add_u32 s82, s82, 4096
    s_mov_b64 exec, s[80:81]
    buffer_load_dwordx4 v8, s[96:99], s82 offen sc1 lds
    s_mov_b64 exec, -1
    v_fmac_f32 v27, v63, v63
    v_lshlrev_b32 v48, 16, v34
    v_and_b32 v49, 0xffff0000, v34
    v_lshlrev_b32 v50, 16, v35
    v_and_b32 v51, 0xffff0000, v35
    v_mul_f32 v64, v48, v48
    v_mul_f32 v65, v49, v49
    v_mul_f32 v66, v50, v50
    v_mul_f32 v67, v51, v51
    v_fma_f32 v64, v64, v13, v12
    v_fma_f32 v65, v65, v13, v12
    v_fma_f32 v66, v66, v13, v12
    v_fma_f32 v67, v67, v13, v12
    v_mul_f32 v64, v64, v48
    v_mul_f32 v65, v65, v49
    v_mul_f32 v66, v66, v50
    v_mul_f32 v67, v67, v51
    v_exp_f32 v64, v64
    v_exp_f32 v65, v65
    v_exp_f32 v66, v66
    v_exp_f32 v67, v67
    s_add_u32 s82, s29, s76
    s_add_u32 m0, s76, 0
    s_add_u32 s82, s82, 37888
    buffer_load_dwordx4 v8, s[96:99], s82 offen sc1 lds
    v_add_f32 v64, 1.0, v64
    v_add_f32 v65, 1.0, v65
    v_add_f32 v66, 1.0, v66
    v_add_f32 v67, 1.0, v67
    v_rcp_f32 v64, v64
    v_rcp_f32 v65, v65
    v_rcp_f32 v66, v66
    v_rcp_f32 v67, v67
    v_mul_f32 v68, v48, v64
    v_mul_f32 v69, v49, v65
    v_mul_f32 v70, v50, v66
    v_mul_f32 v71, v51, v67
    v_cvt_pk_bf16_f32 v98, v68, v69
    v_cvt_pk_bf16_f32 v99, v70, v71
    v_add_f32 v24, v24, v68
    v_fmac_f32 v25, v68, v68
    v_add_f32 v26, v26, v69
    v_fmac_f32 v27, v69, v69
    v_add_f32 v24, v24, v70
    v_fmac_f32 v25, v70, v70
    v_add_f32 v26, v26, v71
    buffer_load_dwordx4 v8, s[96:99], s82 offen offset:1024 sc1 lds
    v_fmac_f32 v27, v71, v71
    v_lshlrev_b32 v40, 16, v36
    v_and_b32 v41, 0xffff0000, v36
    v_lshlrev_b32 v42, 16, v37
    v_and_b32 v43, 0xffff0000, v37
    v_mul_f32 v56, v40, v40
    v_mul_f32 v57, v41, v41
    v_mul_f32 v58, v42, v42
    v_mul_f32 v59, v43, v43
    v_fma_f32 v56, v56, v13, v12
    v_fma_f32 v57, v57, v13, v12
    v_fma_f32 v58, v58, v13, v12
    v_fma_f32 v59, v59, v13, v12
    v_mul_f32 v56, v56, v40
    v_mul_f32 v57, v57, v41
    v_mul_f32 v58, v58, v42
    v_mul_f32 v59, v59, v43
    v_exp_f32 v56, v56
    v_exp_f32 v57, v57
    v_exp_f32 v58, v58
    v_exp_f32 v59, v59
    buffer_load_dwordx4 v8, s[96:99], s82 offen offset:2048 sc1 lds
    v_add_f32 v56, 1.0, v56
    v_add_f32 v57, 1.0, v57
    v_add_f32 v58, 1.0, v58
    v_add_f32 v59, 1.0, v59
    v_rcp_f32 v56, v56
    v_rcp_f32 v57, v57
    v_rcp_f32 v58, v58
    v_rcp_f32 v59, v59
    v_mul_f32 v60, v40, v56
    v_mul_f32 v61, v41, v57
    v_mul_f32 v62, v42, v58
    v_mul_f32 v63, v43, v59
    v_cvt_pk_bf16_f32 v100, v60, v61
    v_cvt_pk_bf16_f32 v101, v62, v63
    v_add_f32 v24, v24, v60
    v_fmac_f32 v25, v60, v60
    v_add_f32 v26, v26, v61
    v_fmac_f32 v27, v61, v61
    v_add_f32 v24, v24, v62
    v_fmac_f32 v25, v62, v62
    v_add_f32 v26, v26, v63
    buffer_load_dwordx4 v8, s[96:99], s82 offen offset:3072 sc1 lds
    v_fmac_f32 v27, v63, v63
    v_lshlrev_b32 v48, 16, v38
    v_and_b32 v49, 0xffff0000, v38
    v_lshlrev_b32 v50, 16, v39
    v_and_b32 v51, 0xffff0000, v39
    v_mul_f32 v64, v48, v48
    v_mul_f32 v65, v49, v49
    v_mul_f32 v66, v50, v50
    v_mul_f32 v67, v51, v51
    v_fma_f32 v64, v64, v13, v12
    v_fma_f32 v65, v65, v13, v12
    v_fma_f32 v66, v66, v13, v12
    v_fma_f32 v67, v67, v13, v12
    v_mul_f32 v64, v64, v48
    v_mul_f32 v65, v65, v49
    v_mul_f32 v66, v66, v50
    v_mul_f32 v67, v67, v51
    v_exp_f32 v64, v64
    v_exp_f32 v65, v65
    v_exp_f32 v66, v66
    v_exp_f32 v67, v67
    s_add_u32 m0, s76, 4096
    s_add_u32 s82, s82, 4096
    s_mov_b64 exec, s[78:79]
    buffer_load_dwordx4 v8, s[96:99], s82 offen sc1 lds
    s_mov_b64 exec, -1
    v_add_f32 v64, 1.0, v64
    v_add_f32 v65, 1.0, v65
    v_add_f32 v66, 1.0, v66
    v_add_f32 v67, 1.0, v67
    v_rcp_f32 v64, v64
    v_rcp_f32 v65, v65
    v_rcp_f32 v66, v66
    v_rcp_f32 v67, v67
    v_mul_f32 v68, v48, v64
    v_mul_f32 v69, v49, v65
    v_mul_f32 v70, v50, v66
    v_mul_f32 v71, v51, v67
    v_cvt_pk_bf16_f32 v102, v68, v69
    v_cvt_pk_bf16_f32 v103, v70, v71
    v_add_f32 v24, v24, v68
    v_fmac_f32 v25, v68, v68
    v_add_f32 v26, v26, v69
    v_fmac_f32 v27, v69, v69
    v_add_f32 v24, v24, v70
    v_fmac_f32 v25, v70, v70
    v_add_f32 v26, v26, v71
    v_fmac_f32 v27, v71, v71
    s_waitcnt vmcnt(10)
    s_barrier
    ds_read_b128 v[32:35], v7 offset:8192
    ds_read_b128 v[36:39], v7 offset:9216
    s_add_u32 s82, s29, s77
    s_add_u32 m0, s77, 19456
    s_add_u32 s82, s82, 56320
    buffer_load_dwordx4 v8, s[96:99], s82 offen sc1 lds
    buffer_load_dwordx4 v8, s[96:99], s82 offen offset:1024 sc1 lds
    buffer_load_dwordx4 v8, s[96:99], s82 offen offset:2048 sc1 lds
    s_waitcnt lgkmcnt(0)
    v_lshlrev_b32 v40, 16, v32
    v_and_b32 v41, 0xffff0000, v32
    v_lshlrev_b32 v42, 16, v33
    v_and_b32 v43, 0xffff0000, v33
    v_mul_f32 v56, v40, v40
    v_mul_f32 v57, v41, v41
    v_mul_f32 v58, v42, v42
    v_mul_f32 v59, v43, v43
    v_fma_f32 v56, v56, v13, v12
    v_fma_f32 v57, v57, v13, v12
    v_fma_f32 v58, v58, v13, v12
    v_fma_f32 v59, v59, v13, v12
    v_mul_f32 v56, v56, v40
    v_mul_f32 v57, v57, v41
    v_mul_f32 v58, v58, v42
    v_mul_f32 v59, v59, v43
    v_exp_f32 v56, v56
    v_exp_f32 v57, v57
    v_exp_f32 v58, v58
    v_exp_f32 v59, v59
    buffer_load_dwordx4 v8, s[96:99], s82 offen offset:3072 sc1 lds
    v_add_f32 v56, 1.0, v56
    v_add_f32 v57, 1.0, v57
    v_add_f32 v58, 1.0, v58
    v_add_f32 v59, 1.0, v59
    v_rcp_f32 v56, v56
    v_rcp_f32 v57, v57
    v_rcp_f32 v58, v58
    v_rcp_f32 v59, v59
    v_mul_f32 v60, v40, v56
    v_mul_f32 v61, v41, v57
    v_mul_f32 v62, v42, v58
    v_mul_f32 v63, v43, v59
    v_cvt_pk_bf16_f32 v104, v60, v61
    v_cvt_pk_bf16_f32 v105, v62, v63
    v_add_f32 v24, v24, v60
    v_fmac_f32 v25, v60, v60
    v_add_f32 v26, v26, v61
    v_fmac_f32 v27, v61, v61
    v_add_f32 v24, v24, v62
    v_fmac_f32 v25, v62, v62
    v_add_f32 v26, v26, v63
    s_add_u32 m0, s77, 23552
    s_add_u32 s82, s82, 4096
    s_mov_b64 exec, s[80:81]
    buffer_load_dwordx4 v8, s[96:99], s82 offen sc1 lds
    s_mov_b64 exec, -1
    v_fmac_f32 v27, v63, v63
    v_lshlrev_b32 v48, 16, v34
    v_and_b32 v49, 0xffff0000, v34
    v_lshlrev_b32 v50, 16, v35
    v_and_b32 v51, 0xffff0000, v35
    v_mul_f32 v64, v48, v48
    v_mul_f32 v65, v49, v49
    v_mul_f32 v66, v50, v50
    v_mul_f32 v67, v51, v51
    v_fma_f32 v64, v64, v13, v12
    v_fma_f32 v65, v65, v13, v12
    v_fma_f32 v66, v66, v13, v12
    v_fma_f32 v67, v67, v13, v12
    v_mul_f32 v64, v64, v48
    v_mul_f32 v65, v65, v49
    v_mul_f32 v66, v66, v50
    v_mul_f32 v67, v67, v51
    v_exp_f32 v64, v64
    v_exp_f32 v65, v65
    v_exp_f32 v66, v66
    v_exp_f32 v67, v67
    s_add_u32 s82, s29, s76
    s_add_u32 m0, s76, 38912
    s_add_u32 s82, s82, 75776
    buffer_load_dwordx4 v8, s[96:99], s82 offen sc1 lds
    v_add_f32 v64, 1.0, v64
    v_add_f32 v65, 1.0, v65
    v_add_f32 v66, 1.0, v66
    v_add_f32 v67, 1.0, v67
    v_rcp_f32 v64, v64
    v_rcp_f32 v65, v65
    v_rcp_f32 v66, v66
    v_rcp_f32 v67, v67
    v_mul_f32 v68, v48, v64
    v_mul_f32 v69, v49, v65
    v_mul_f32 v70, v50, v66
    v_mul_f32 v71, v51, v67
    v_cvt_pk_bf16_f32 v106, v68, v69
    v_cvt_pk_bf16_f32 v107, v70, v71
    v_add_f32 v24, v24, v68
    v_fmac_f32 v25, v68, v68
    v_add_f32 v26, v26, v69
    v_fmac_f32 v27, v69, v69
    v_add_f32 v24, v24, v70
    v_fmac_f32 v25, v70, v70
    v_add_f32 v26, v26, v71
    buffer_load_dwordx4 v8, s[96:99], s82 offen offset:1024 sc1 lds
    v_fmac_f32 v27, v71, v71
    v_lshlrev_b32 v40, 16, v36
    v_and_b32 v41, 0xffff0000, v36
    v_lshlrev_b32 v42, 16, v37
    v_and_b32 v43, 0xffff0000, v37
    v_mul_f32 v56, v40, v40
    v_mul_f32 v57, v41, v41
    v_mul_f32 v58, v42, v42
    v_mul_f32 v59, v43, v43
    v_fma_f32 v56, v56, v13, v12
    v_fma_f32 v57, v57, v13, v12
    v_fma_f32 v58, v58, v13, v12
    v_fma_f32 v59, v59, v13, v12
    v_mul_f32 v56, v56, v40
    v_mul_f32 v57, v57, v41
    v_mul_f32 v58, v58, v42
    v_mul_f32 v59, v59, v43
    v_exp_f32 v56, v56
    v_exp_f32 v57, v57
    v_exp_f32 v58, v58
    v_exp_f32 v59, v59
    buffer_load_dwordx4 v8, s[96:99], s82 offen offset:2048 sc1 lds
    v_add_f32 v56, 1.0, v56
    v_add_f32 v57, 1.0, v57
    v_add_f32 v58, 1.0, v58
    v_add_f32 v59, 1.0, v59
    v_rcp_f32 v56, v56
    v_rcp_f32 v57, v57
    v_rcp_f32 v58, v58
    v_rcp_f32 v59, v59
    v_mul_f32 v60, v40, v56
    v_mul_f32 v61, v41, v57
    v_mul_f32 v62, v42, v58
    v_mul_f32 v63, v43, v59
    v_cvt_pk_bf16_f32 v108, v60, v61
    v_cvt_pk_bf16_f32 v109, v62, v63
    v_add_f32 v24, v24, v60
    v_fmac_f32 v25, v60, v60
    v_add_f32 v26, v26, v61
    v_fmac_f32 v27, v61, v61
    v_add_f32 v24, v24, v62
    v_fmac_f32 v25, v62, v62
    v_add_f32 v26, v26, v63
    buffer_load_dwordx4 v8, s[96:99], s82 offen offset:3072 sc1 lds
    v_fmac_f32 v27, v63, v63
    v_lshlrev_b32 v48, 16, v38
    v_and_b32 v49, 0xffff0000, v38
    v_lshlrev_b32 v50, 16, v39
    v_and_b32 v51, 0xffff0000, v39
    v_mul_f32 v64, v48, v48
    v_mul_f32 v65, v49, v49
    v_mul_f32 v66, v50, v50
    v_mul_f32 v67, v51, v51
    v_fma_f32 v64, v64, v13, v12
    v_fma_f32 v65, v65, v13, v12
    v_fma_f32 v66, v66, v13, v12
    v_fma_f32 v67, v67, v13, v12
    v_mul_f32 v64, v64, v48
    v_mul_f32 v65, v65, v49
    v_mul_f32 v66, v66, v50
    v_mul_f32 v67, v67, v51
    v_exp_f32 v64, v64
    v_exp_f32 v65, v65
    v_exp_f32 v66, v66
    v_exp_f32 v67, v67
    s_add_u32 m0, s76, 43008
    s_add_u32 s82, s82, 4096
    s_mov_b64 exec, s[78:79]
    buffer_load_dwordx4 v8, s[96:99], s82 offen sc1 lds
    s_mov_b64 exec, -1
    v_add_f32 v64, 1.0, v64
    v_add_f32 v65, 1.0, v65
    v_add_f32 v66, 1.0, v66
    v_add_f32 v67, 1.0, v67
    v_rcp_f32 v64, v64
    v_rcp_f32 v65, v65
    v_rcp_f32 v66, v66
    v_rcp_f32 v67, v67
    v_mul_f32 v68, v48, v64
    v_mul_f32 v69, v49, v65
    v_mul_f32 v70, v50, v66
    v_mul_f32 v71, v51, v67
    v_cvt_pk_bf16_f32 v110, v68, v69
    v_cvt_pk_bf16_f32 v111, v70, v71
    v_add_f32 v24, v24, v68
    v_fmac_f32 v25, v68, v68
    v_add_f32 v26, v26, v69
    v_fmac_f32 v27, v69, v69
    v_add_f32 v24, v24, v70
    v_fmac_f32 v25, v70, v70
    v_add_f32 v26, v26, v71
    v_fmac_f32 v27, v71, v71
    s_waitcnt vmcnt(10)
    s_barrier
    ds_read_b128 v[32:35], v7 offset:0
    ds_read_b128 v[36:39], v7 offset:1024
    s_add_u32 s82, s29, s77
    s_add_u32 m0, s77, 58368
    s_add_u32 s82, s82, 94208
    buffer_load_dwordx4 v8, s[96:99], s82 offen sc1 lds
    buffer_load_dwordx4 v8, s[96:99], s82 offen offset:1024 sc1 lds
    buffer_load_dwordx4 v8, s[96:99], s82 offen offset:2048 sc1 lds
    s_waitcnt lgkmcnt(0)
    v_lshlrev_b32 v40, 16, v32
    v_and_b32 v41, 0xffff0000, v32
    v_lshlrev_b32 v42, 16, v33
    v_and_b32 v43, 0xffff0000, v33
    v_mul_f32 v56, v40, v40
    v_mul_f32 v57, v41, v41
    v_mul_f32 v58, v42, v42
    v_mul_f32 v59, v43, v43
    v_fma_f32 v56, v56, v13, v12
    v_fma_f32 v57, v57, v13, v12
    v_fma_f32 v58, v58, v13, v12
    v_fma_f32 v59, v59, v13, v12
    v_mul_f32 v56, v56, v40
    v_mul_f32 v57, v57, v41
    v_mul_f32 v58, v58, v42
    v_mul_f32 v59, v59, v43
    v_exp_f32 v56, v56
    v_exp_f32 v57, v57
    v_exp_f32 v58, v58
    v_exp_f32 v59, v59
    v_add_f32 v56, 1.0, v56
    buffer_load_dwordx4 v8, s[96:99], s82 offen offset:3072 sc1 lds
    v_add_f32 v57, 1.0, v57
    v_add_f32 v58, 1.0, v58
    v_add_f32 v59, 1.0, v59
    v_rcp_f32 v56, v56
    v_rcp_f32 v57, v57
    v_rcp_f32 v58, v58
    v_rcp_f32 v59, v59
    v_mul_f32 v60, v40, v56
    v_mul_f32 v61, v41, v57
    v_mul_f32 v62, v42, v58
    v_mul_f32 v63, v43, v59
    v_cvt_pk_bf16_f32 v112, v60, v61
    v_cvt_pk_bf16_f32 v113, v62, v63
    v_add_f32 v24, v24, v60
    v_fmac_f32 v25, v60, v60
    v_add_f32 v26, v26, v61
    v_fmac_f32 v27, v61, v61
    v_add_f32 v24, v24, v62
    v_fmac_f32 v25, v62, v62
    v_add_f32 v26, v26, v63
    v_fmac_f32 v27, v63, v63
    v_lshlrev_b32 v48, 16, v34
    s_add_u32 m0, s77, 62464
    s_add_u32 s82, s82, 4096
    s_mov_b64 exec, s[80:81]
    buffer_load_dwordx4 v8, s[96:99], s82 offen sc1 lds
    s_mov_b64 exec, -1
    v_and_b32 v49, 0xffff0000, v34
    v_lshlrev_b32 v50, 16, v35
    v_and_b32 v51, 0xffff0000, v35
    v_mul_f32 v64, v48, v48
    v_mul_f32 v65, v49, v49
    v_mul_f32 v66, v50, v50
    v_mul_f32 v67, v51, v51
    v_fma_f32 v64, v64, v13, v12
    v_fma_f32 v65, v65, v13, v12
    v_fma_f32 v66, v66, v13, v12
    v_fma_f32 v67, v67, v13, v12
    v_mul_f32 v64, v64, v48
    v_mul_f32 v65, v65, v49
    v_mul_f32 v66, v66, v50
    v_mul_f32 v67, v67, v51
    v_exp_f32 v64, v64
    v_exp_f32 v65, v65
    v_exp_f32 v66, v66
    v_exp_f32 v67, v67
    v_add_f32 v64, 1.0, v64
    v_add_f32 v65, 1.0, v65
    v_add_f32 v66, 1.0, v66
    s_add_u32 s82, s29, s76
    s_add_u32 m0, s76, 77824
    s_add_u32 s82, s82, 113664
    buffer_load_dwordx4 v8, s[96:99], s82 offen sc1 lds
    v_add_f32 v67, 1.0, v67
    v_rcp_f32 v64, v64
    v_rcp_f32 v65, v65
    v_rcp_f32 v66, v66
    v_rcp_f32 v67, v67
    v_mul_f32 v68, v48, v64
    v_mul_f32 v69, v49, v65
    v_mul_f32 v70, v50, v66
    v_mul_f32 v71, v51, v67
    v_cvt_pk_bf16_f32 v114, v68, v69
    v_cvt_pk_bf16_f32 v115, v70, v71
    v_add_f32 v24, v24, v68
    v_fmac_f32 v25, v68, v68
    v_add_f32 v26, v26, v69
    v_fmac_f32 v27, v69, v69
    v_add_f32 v24, v24, v70
    v_fmac_f32 v25, v70, v70
    v_add_f32 v26, v26, v71
    v_fmac_f32 v27, v71, v71
    v_lshlrev_b32 v40, 16, v36
    v_and_b32 v41, 0xffff0000, v36
    v_lshlrev_b32 v42, 16, v37
    buffer_load_dwordx4 v8, s[96:99], s82 offen offset:1024 sc1 lds
    v_and_b32 v43, 0xffff0000, v37
    v_mul_f32 v56, v40, v40
    v_mul_f32 v57, v41, v41
    v_mul_f32 v58, v42, v42
    v_mul_f32 v59, v43, v43
    v_fma_f32 v56, v56, v13, v12
    v_fma_f32 v57, v57, v13, v12
    v_fma_f32 v58, v58, v13, v12
    v_fma_f32 v59, v59, v13, v12
    v_mul_f32 v56, v56, v40
    v_mul_f32 v57, v57, v41
    v_mul_f32 v58, v58, v42
    v_mul_f32 v59, v59, v43
    v_exp_f32 v56, v56
    v_exp_f32 v57, v57
    v_exp_f32 v58, v58
    v_exp_f32 v59, v59
    v_add_f32 v56, 1.0, v56
    v_add_f32 v57, 1.0, v57
    v_add_f32 v58, 1.0, v58
    v_add_f32 v59, 1.0, v59
    v_rcp_f32 v56, v56
    buffer_load_dwordx4 v8, s[96:99], s82 offen offset:2048 sc1 lds
    v_rcp_f32 v57, v57
    v_rcp_f32 v58, v58
    v_rcp_f32 v59, v59
    v_mul_f32 v60, v40, v56
    v_mul_f32 v61, v41, v57
    v_mul_f32 v62, v42, v58
    v_mul_f32 v63, v43, v59
    v_cvt_pk_bf16_f32 v116, v60, v61
    v_cvt_pk_bf16_f32 v117, v62, v63
    v_add_f32 v24, v24, v60
    v_fmac_f32 v25, v60, v60
    v_add_f32 v26, v26, v61
    v_fmac_f32 v27, v61, v61
    v_add_f32 v24, v24, v62
    v_fmac_f32 v25, v62, v62
    v_add_f32 v26, v26, v63
    v_fmac_f32 v27, v63, v63
    v_lshlrev_b32 v48, 16, v38
    v_and_b32 v49, 0xffff0000, v38
    v_lshlrev_b32 v50, 16, v39
    v_and_b32 v51, 0xffff0000, v39
    v_mul_f32 v64, v48, v48
    buffer_load_dwordx4 v8, s[96:99], s82 offen offset:3072 sc1 lds
    v_mul_f32 v65, v49, v49
    v_mul_f32 v66, v50, v50
    v_mul_f32 v67, v51, v51
    v_fma_f32 v64, v64, v13, v12
    v_fma_f32 v65, v65, v13, v12
    v_fma_f32 v66, v66, v13, v12
    v_fma_f32 v67, v67, v13, v12
    v_mul_f32 v64, v64, v48
    v_mul_f32 v65, v65, v49
    v_mul_f32 v66, v66, v50
    v_mul_f32 v67, v67, v51
    v_exp_f32 v64, v64
    v_exp_f32 v65, v65
    v_exp_f32 v66, v66
    v_exp_f32 v67, v67
    v_add_f32 v64, 1.0, v64
    v_add_f32 v65, 1.0, v65
    v_add_f32 v66, 1.0, v66
    v_add_f32 v67, 1.0, v67
    v_rcp_f32 v64, v64
    v_rcp_f32 v65, v65
    v_rcp_f32 v66, v66
    s_add_u32 m0, s76, 81920
    s_add_u32 s82, s82, 4096
    s_mov_b64 exec, s[78:79]
    buffer_load_dwordx4 v8, s[96:99], s82 offen sc1 lds
    s_mov_b64 exec, -1
    v_rcp_f32 v67, v67
    v_mul_f32 v68, v48, v64
    v_mul_f32 v69, v49, v65
    v_mul_f32 v70, v50, v66
    v_mul_f32 v71, v51, v67
    v_cvt_pk_bf16_f32 v118, v68, v69
    v_cvt_pk_bf16_f32 v119, v70, v71
    v_add_f32 v24, v24, v68
    v_fmac_f32 v25, v68, v68
    v_add_f32 v26, v26, v69
    v_fmac_f32 v27, v69, v69
    v_add_f32 v24, v24, v70
    v_fmac_f32 v25, v70, v70
    v_add_f32 v26, v26, v71
    v_fmac_f32 v27, v71, v71
    v_add_f32 v24, v24, v26
    v_add_f32 v25, v25, v27
    v_mov_b32 v26, v24
    v_mov_b32 v27, v25
    s_nop 1
    v_permlane32_swap_b32 v24, v26
    v_permlane32_swap_b32 v25, v27
    s_nop 1
    v_add_f32 v24, v24, v26
    v_add_f32 v25, v25, v27
    v_xor_b32 v26, v24, v25
    v_xor_b32 v26, s100, v26
    s_mov_b64 exec, s[78:79]
    buffer_store_dwordx4 v[24:27], v8, s[96:99], s39 offen sc1
    s_mov_b64 exec, -1
    s_waitcnt vmcnt(11)
    s_barrier
    ds_read_b128 v[200:203], v18 offset:8192
    ds_read_b128 v[220:223], v18 offset:8448
    s_add_u32 s82, s29, s77
    s_add_u32 m0, s77, 97280
    s_add_u32 s82, s82, 132096
    buffer_load_dwordx4 v8, s[96:99], s82 offen sc1 lds
    buffer_load_dwordx4 v8, s[96:99], s82 offen offset:1024 sc1 lds
    buffer_load_dwordx4 v8, s[96:99], s82 offen offset:2048 sc1 lds
    s_waitcnt lgkmcnt(0)
    v_lshlrev_b32 v40, 16, v200
    v_and_b32 v41, 0xffff0000, v200
    v_lshlrev_b32 v42, 16, v201
    v_and_b32 v43, 0xffff0000, v201
    v_mul_f32 v56, v40, v40
    v_mul_f32 v57, v41, v41
    v_mul_f32 v58, v42, v42
    v_mul_f32 v59, v43, v43
    v_fma_f32 v56, v56, v13, v12
    v_fma_f32 v57, v57, v13, v12
    v_fma_f32 v58, v58, v13, v12
    buffer_load_dwordx4 v8, s[96:99], s82 offen offset:3072 sc1 lds
    v_fma_f32 v59, v59, v13, v12
    v_mul_f32 v56, v56, v40
    v_mul_f32 v57, v57, v41
    v_mul_f32 v58, v58, v42
    v_mul_f32 v59, v59, v43
    v_exp_f32 v56, v56
    v_exp_f32 v57, v57
    v_exp_f32 v58, v58
    v_exp_f32 v59, v59
    v_add_f32 v56, 1.0, v56
    v_add_f32 v57, 1.0, v57
    v_add_f32 v58, 1.0, v58
    s_add_u32 m0, s77, 101376
    s_add_u32 s82, s82, 4096
    s_mov_b64 exec, s[80:81]
    buffer_load_dwordx4 v8, s[96:99], s82 offen sc1 lds
    s_mov_b64 exec, -1
    v_add_f32 v59, 1.0, v59
    v_rcp_f32 v56, v56
    v_rcp_f32 v57, v57
    v_rcp_f32 v58, v58
    v_rcp_f32 v59, v59
    v_mul_f32 v40, v40, v56
    v_mul_f32 v41, v41, v57
    v_mul_f32 v42, v42, v58
    v_mul_f32 v43, v43, v59
    v_cvt_pk_bf16_f32 v200, v40, v41
    v_cvt_pk_bf16_f32 v201, v42, v43
    v_lshlrev_b32 v48, 16, v220
    buffer_load_dwordx4 v[128:131], v8, s[96:99], s37 offen offset:0 sc1
    v_and_b32 v49, 0xffff0000, v220
    v_lshlrev_b32 v50, 16, v221
    v_and_b32 v51, 0xffff0000, v221
    v_mul_f32 v64, v48, v48
    v_mul_f32 v65, v49, v49
    v_mul_f32 v66, v50, v50
    v_mul_f32 v67, v51, v51
    v_fma_f32 v64, v64, v13, v12
    v_fma_f32 v65, v65, v13, v12
    v_fma_f32 v66, v66, v13, v12
    v_fma_f32 v67, v67, v13, v12
    v_mul_f32 v64, v64, v48
    buffer_load_dwordx4 v[132:135], v8, s[96:99], s37 offen offset:1024 sc1
    v_mul_f32 v65, v65, v49
    v_mul_f32 v66, v66, v50
    v_mul_f32 v67, v67, v51
    v_exp_f32 v64, v64
    v_exp_f32 v65, v65
    v_exp_f32 v66, v66
    v_exp_f32 v67, v67
    v_add_f32 v64, 1.0, v64
    v_add_f32 v65, 1.0, v65
    v_add_f32 v66, 1.0, v66
    v_add_f32 v67, 1.0, v67
    v_rcp_f32 v64, v64
    buffer_load_dwordx4 v[136:139], v8, s[96:99], s37 offen offset:2048 sc1
    v_rcp_f32 v65, v65
    v_rcp_f32 v66, v66
    v_rcp_f32 v67, v67
    v_mul_f32 v48, v48, v64
    v_mul_f32 v49, v49, v65
    v_mul_f32 v50, v50, v66
    v_mul_f32 v51, v51, v67
    v_cvt_pk_bf16_f32 v220, v48, v49
    v_cvt_pk_bf16_f32 v221, v50, v51
    v_lshlrev_b32 v40, 16, v202
    v_and_b32 v41, 0xffff0000, v202
    v_lshlrev_b32 v42, 16, v203
    buffer_load_dwordx4 v[140:143], v8, s[96:99], s37 offen offset:3072 sc1
    v_and_b32 v43, 0xffff0000, v203
    v_mul_f32 v56, v40, v40
    v_mul_f32 v57, v41, v41
    v_mul_f32 v58, v42, v42
    v_mul_f32 v59, v43, v43
    v_fma_f32 v56, v56, v13, v12
    v_fma_f32 v57, v57, v13, v12
    v_fma_f32 v58, v58, v13, v12
    v_fma_f32 v59, v59, v13, v12
    v_mul_f32 v56, v56, v40
    v_mul_f32 v57, v57, v41
    v_mul_f32 v58, v58, v42
    buffer_load_dwordx4 v[144:147], v8, s[96:99], s38 offen offset:0 sc1
    v_mul_f32 v59, v59, v43
    v_exp_f32 v56, v56
    v_exp_f32 v57, v57
    v_exp_f32 v58, v58
    v_exp_f32 v59, v59
    v_add_f32 v56, 1.0, v56
    v_add_f32 v57, 1.0, v57
    v_add_f32 v58, 1.0, v58
    v_add_f32 v59, 1.0, v59
    v_rcp_f32 v56, v56
    v_rcp_f32 v57, v57
    v_rcp_f32 v58, v58
    buffer_load_dwordx4 v[148:151], v8, s[96:99], s38 offen offset:1024 sc1
    v_rcp_f32 v59, v59
    v_mul_f32 v40, v40, v56
    v_mul_f32 v41, v41, v57
    v_mul_f32 v42, v42, v58
    v_mul_f32 v43, v43, v59
    v_cvt_pk_bf16_f32 v202, v40, v41
    v_cvt_pk_bf16_f32 v203, v42, v43
    v_lshlrev_b32 v48, 16, v222
    v_and_b32 v49, 0xffff0000, v222
    v_lshlrev_b32 v50, 16, v223
    v_and_b32 v51, 0xffff0000, v223
    v_mul_f32 v64, v48, v48
    buffer_load_dwordx4 v[152:155], v8, s[96:99], s38 offen offset:2048 sc1
    v_mul_f32 v65, v49, v49
    v_mul_f32 v66, v50, v50
    v_mul_f32 v67, v51, v51
    v_fma_f32 v64, v64, v13, v12
    v_fma_f32 v65, v65, v13, v12
    v_fma_f32 v66, v66, v13, v12
    v_fma_f32 v67, v67, v13, v12
    v_mul_f32 v64, v64, v48
    v_mul_f32 v65, v65, v49
    v_mul_f32 v66, v66, v50
    v_mul_f32 v67, v67, v51
    v_exp_f32 v64, v64
    buffer_load_dwordx4 v[156:159], v8, s[96:99], s38 offen offset:3072 sc1
    v_exp_f32 v65, v65
    v_exp_f32 v66, v66
    v_exp_f32 v67, v67
    v_add_f32 v64, 1.0, v64
    v_add_f32 v65, 1.0, v65
    v_add_f32 v66, 1.0, v66
    v_add_f32 v67, 1.0, v67
    v_rcp_f32 v64, v64
    v_rcp_f32 v65, v65
    v_rcp_f32 v66, v66
    v_rcp_f32 v67, v67
    v_mul_f32 v48, v48, v64
    v_mul_f32 v49, v49, v65
    v_mul_f32 v50, v50, v66
    v_mul_f32 v51, v51, v67
    v_cvt_pk_bf16_f32 v222, v48, v49
    v_cvt_pk_bf16_f32 v223, v50, v51
    s_waitcnt vmcnt(8)
    s_barrier
    ds_read_b128 v[204:207], v18 offset:0
    ds_read_b128 v[224:227], v18 offset:256
    s_setprio 2
    s_mov_b32 s90, 0
    s_branch Lzck28
Lzp26:
    buffer_load_dwordx4 v[128:131], v8, s[96:99], s37 offen offset:0 sc1
    buffer_load_dwordx4 v[132:135], v8, s[96:99], s37 offen offset:1024 sc1
    buffer_load_dwordx4 v[136:139], v8, s[96:99], s37 offen offset:2048 sc1
    buffer_load_dwordx4 v[140:143], v8, s[96:99], s37 offen offset:3072 sc1
    buffer_load_dwordx4 v[144:147], v8, s[96:99], s38 offen offset:0 sc1
    buffer_load_dwordx4 v[148:151], v8, s[96:99], s38 offen offset:1024 sc1
    buffer_load_dwordx4 v[152:155], v8, s[96:99], s38 offen offset:2048 sc1
    buffer_load_dwordx4 v[156:159], v8, s[96:99], s38 offen offset:3072 sc1
Lzck28:
    s_waitcnt vmcnt(0)
    v_xor_b32 v131, v128, v129
    v_xor_b32 v130, s100, v130
    v_xor_b32 v130, v130, v131
    v_xor_b32 v135, v132, v133
    v_xor_b32 v134, s100, v134
    v_xor_b32 v134, v134, v135
    v_or_b32 v130, v130, v134
    v_xor_b32 v139, v136, v137
    v_xor_b32 v138, s100, v138
    v_xor_b32 v138, v138, v139
    v_or_b32 v130, v130, v138
    v_xor_b32 v143, v140, v141
    v_xor_b32 v142, s100, v142
    v_xor_b32 v142, v142, v143
    v_or_b32 v130, v130, v142
    v_xor_b32 v147, v144, v145
    v_xor_b32 v146, s100, v146
    v_xor_b32 v146, v146, v147
    v_or_b32 v130, v130, v146
    v_xor_b32 v151, v148, v149
    v_xor_b32 v150, s100, v150
    v_xor_b32 v150, v150, v151
    v_or_b32 v130, v130, v150
    v_xor_b32 v155, v152, v153
    v_xor_b32 v154, s100, v154
    v_xor_b32 v154, v154, v155
    v_or_b32 v130, v130, v154
    v_xor_b32 v159, v156, v157
    v_xor_b32 v158, s100, v158
    v_xor_b32 v158, v158, v159
    v_or_b32 v130, v130, v158
    v_cmp_ne_u32 vcc, 0, v130
    s_add_u32 s90, s90, 1
    s_cmp_eq_u64 vcc, 0
    s_cbranch_scc1 Lzok27
    s_cmp_lt_u32 s90, 0x20000
    s_cbranch_scc1 Lzp26
Lzok27:
    v_add_f32 v128, v128, v144
    v_add_f32 v129, v129, v145
    v_add_f32 v132, v132, v148
    v_add_f32 v133, v133, v149
    v_add_f32 v136, v136, v152
    v_add_f32 v137, v137, v153
    v_add_f32 v140, v140, v156
    v_add_f32 v141, v141, v157
    v_add_f32 v128, v128, v136
    v_add_f32 v129, v129, v137
    v_add_f32 v132, v132, v140
    v_add_f32 v133, v133, v141
    v_add_f32 v128, v128, v132
    v_add_f32 v129, v129, v133
    v_mov_b32 v130, v128
    v_mov_b32 v131, v129
    s_nop 1
    v_permlane32_swap_b32 v128, v130
    v_permlane32_swap_b32 v129, v131
    s_nop 1
    v_add_f32 v128, v128, v130
    v_add_f32 v129, v129, v131
    v_mul_f32 v128, 0x39e38e39, v128
    v_mul_f32 v129, 0x39e38e39, v129
    v_fma_f32 v129, -v128, v128, v129
    v_max_f32 v129, 0, v129
    v_cvt_pk_bf16_f32 v130, v128, v128
    v_cvt_pk_bf16_f32 v131, v129, v129
    v_and_b32 v130, 0xffff0000, v130
    v_and_b32 v131, 0xffff0000, v131
    v_add_f32 v131, 0x3727c5ac, v131
    v_cvt_pk_bf16_f32 v131, v131, v131
    v_and_b32 v131, 0xffff0000, v131
    v_sqrt_f32 v131, v131
    s_nop 0
    v_cvt_pk_bf16_f32 v131, v131, v131
    v_and_b32 v131, 0xffff0000, v131
    v_rcp_f32 v132, v131
    s_nop 0
    v_mul_f32 v133, -v130, v132
    v_lshlrev_b32 v136, 16, v80
    v_and_b32 v137, 0xffff0000, v80
    v_lshlrev_b32 v138, 16, v81
    v_and_b32 v139, 0xffff0000, v81
    v_lshlrev_b32 v140, 16, v82
    v_and_b32 v141, 0xffff0000, v82
    v_lshlrev_b32 v142, 16, v83
    v_and_b32 v143, 0xffff0000, v83
    v_fma_f32 v136, v136, v132, v133
    v_fma_f32 v137, v137, v132, v133
    v_fma_f32 v138, v138, v132, v133
    v_fma_f32 v139, v139, v132, v133
    v_fma_f32 v140, v140, v132, v133
    v_fma_f32 v141, v141, v132, v133
    v_fma_f32 v142, v142, v132, v133
    v_fma_f32 v143, v143, v132, v133
    v_cvt_pk_bf16_f32 v80, v136, v137
    v_cvt_pk_bf16_f32 v81, v138, v139
    v_cvt_pk_bf16_f32 v82, v140, v141
    v_cvt_pk_bf16_f32 v83, v142, v143
    ds_write_b64 v9, v[80:81] offset:0
    ds_write_b64 v9, v[82:83] offset:1024
    v_lshlrev_b32 v144, 16, v84
    v_and_b32 v145, 0xffff0000, v84
    v_lshlrev_b32 v146, 16, v85
    v_and_b32 v147, 0xffff0000, v85
    v_lshlrev_b32 v148, 16, v86
    v_and_b32 v149, 0xffff0000, v86
    v_lshlrev_b32 v150, 16, v87
    v_and_b32 v151, 0xffff0000, v87
    v_fma_f32 v144, v144, v132, v133
    v_fma_f32 v145, v145, v132, v133
    v_fma_f32 v146, v146, v132, v133
    v_fma_f32 v147, v147, v132, v133
    v_fma_f32 v148, v148, v132, v133
    v_fma_f32 v149, v149, v132, v133
    v_fma_f32 v150, v150, v132, v133
    v_fma_f32 v151, v151, v132, v133
    v_cvt_pk_bf16_f32 v84, v144, v145
    v_cvt_pk_bf16_f32 v85, v146, v147
    v_cvt_pk_bf16_f32 v86, v148, v149
    v_cvt_pk_bf16_f32 v87, v150, v151
    ds_write_b64 v9, v[84:85] offset:16
    ds_write_b64 v9, v[86:87] offset:1040
    ds_read_b64_tr_b16 v[160:161], v10 offset:0
    ds_read_b64_tr_b16 v[162:163], v10 offset:128
    ds_read_b64_tr_b16 v[164:165], v10 offset:1024
    ds_read_b64_tr_b16 v[166:167], v10 offset:1152
    v_lshlrev_b32 v136, 16, v88
    v_and_b32 v137, 0xffff0000, v88
    v_lshlrev_b32 v138, 16, v89
    v_and_b32 v139, 0xffff0000, v89
    v_lshlrev_b32 v140, 16, v90
    v_and_b32 v141, 0xffff0000, v90
    v_lshlrev_b32 v142, 16, v91
    v_and_b32 v143, 0xffff0000, v91
    v_fma_f32 v136, v136, v132, v133
    v_fma_f32 v137, v137, v132, v133
    v_fma_f32 v138, v138, v132, v133
    v_fma_f32 v139, v139, v132, v133
    v_fma_f32 v140, v140, v132, v133
    v_fma_f32 v141, v141, v132, v133
    v_fma_f32 v142, v142, v132, v133
    v_fma_f32 v143, v143, v132, v133
    v_cvt_pk_bf16_f32 v88, v136, v137
    v_cvt_pk_bf16_f32 v89, v138, v139
    v_cvt_pk_bf16_f32 v90, v140, v141
    v_cvt_pk_bf16_f32 v91, v142, v143
    ds_write_b64 v9, v[88:89] offset:2048
    ds_write_b64 v9, v[90:91] offset:3072
    v_lshlrev_b32 v144, 16, v92
    v_and_b32 v145, 0xffff0000, v92
    v_lshlrev_b32 v146, 16, v93
    v_and_b32 v147, 0xffff0000, v93
    v_lshlrev_b32 v148, 16, v94
    v_and_b32 v149, 0xffff0000, v94
    v_lshlrev_b32 v150, 16, v95
    v_and_b32 v151, 0xffff0000, v95
    v_fma_f32 v144, v144, v132, v133
    v_fma_f32 v145, v145, v132, v133
    v_fma_f32 v146, v146, v132, v133
    v_fma_f32 v147, v147, v132, v133
    v_fma_f32 v148, v148, v132, v133
    v_fma_f32 v149, v149, v132, v133
    v_fma_f32 v150, v150, v132, v133
    v_fma_f32 v151, v151, v132, v133
    v_cvt_pk_bf16_f32 v92, v144, v145
    v_cvt_pk_bf16_f32 v93, v146, v147
    v_cvt_pk_bf16_f32 v94, v148, v149
    v_cvt_pk_bf16_f32 v95, v150, v151
    ds_write_b64 v9, v[92:93] offset:2064
    ds_write_b64 v9, v[94:95] offset:3088
    ds_read_b64_tr_b16 v[168:169], v10 offset:2048
    ds_read_b64_tr_b16 v[170:171], v10 offset:2176
    ds_read_b64_tr_b16 v[172:173], v10 offset:3072
    ds_read_b64_tr_b16 v[174:175], v10 offset:3200
    s_waitcnt lgkmcnt(8)
    buffer_store_dwordx4 v[160:163], v8, s[96:99], s36 offen sc1
    buffer_store_dwordx4 v[164:167], v8, s[96:99], s36 offen offset:1024 sc1
    s_add_u32 s36, s36, 2048
    v_lshlrev_b32 v136, 16, v96
    v_and_b32 v137, 0xffff0000, v96
    v_lshlrev_b32 v138, 16, v97
    v_and_b32 v139, 0xffff0000, v97
    v_lshlrev_b32 v140, 16, v98
    v_and_b32 v141, 0xffff0000, v98
    v_lshlrev_b32 v142, 16, v99
    v_and_b32 v143, 0xffff0000, v99
    v_fma_f32 v136, v136, v132, v133
    v_fma_f32 v137, v137, v132, v133
    v_fma_f32 v138, v138, v132, v133
    v_fma_f32 v139, v139, v132, v133
    v_fma_f32 v140, v140, v132, v133
    v_fma_f32 v141, v141, v132, v133
    v_fma_f32 v142, v142, v132, v133
    v_fma_f32 v143, v143, v132, v133
    v_cvt_pk_bf16_f32 v96, v136, v137
    v_cvt_pk_bf16_f32 v97, v138, v139
    v_cvt_pk_bf16_f32 v98, v140, v141
    v_cvt_pk_bf16_f32 v99, v142, v143
    ds_write_b64 v9, v[96:97] offset:0
    ds_write_b64 v9, v[98:99] offset:1024
    v_lshlrev_b32 v144, 16, v100
    v_and_b32 v145, 0xffff0000, v100
    v_lshlrev_b32 v146, 16, v101
    v_and_b32 v147, 0xffff0000, v101
    v_lshlrev_b32 v148, 16, v102
    v_and_b32 v149, 0xffff0000, v102
    v_lshlrev_b32 v150, 16, v103
    v_and_b32 v151, 0xffff0000, v103
    v_fma_f32 v144, v144, v132, v133
    v_fma_f32 v145, v145, v132, v133
    v_fma_f32 v146, v146, v132, v133
    v_fma_f32 v147, v147, v132, v133
    v_fma_f32 v148, v148, v132, v133
    v_fma_f32 v149, v149, v132, v133
    v_fma_f32 v150, v150, v132, v133
    v_fma_f32 v151, v151, v132, v133
    v_cvt_pk_bf16_f32 v100, v144, v145
    v_cvt_pk_bf16_f32 v101, v146, v147
    v_cvt_pk_bf16_f32 v102, v148, v149
    v_cvt_pk_bf16_f32 v103, v150, v151
    ds_write_b64 v9, v[100:101] offset:16
    ds_write_b64 v9, v[102:103] offset:1040
    ds_read_b64_tr_b16 v[176:177], v10 offset:0
    ds_read_b64_tr_b16 v[178:179], v10 offset:128
    ds_read_b64_tr_b16 v[180:181], v10 offset:1024
    ds_read_b64_tr_b16 v[182:183], v10 offset:1152
    s_waitcnt lgkmcnt(8)
    buffer_store_dwordx4 v[168:171], v8, s[96:99], s36 offen sc1
    buffer_store_dwordx4 v[172:175], v8, s[96:99], s36 offen offset:1024 sc1
    s_add_u32 s36, s36, 2048
    v_lshlrev_b32 v136, 16, v104
    v_and_b32 v137, 0xffff0000, v104
    v_lshlrev_b32 v138, 16, v105
    v_and_b32 v139, 0xffff0000, v105
    v_lshlrev_b32 v140, 16, v106
    v_and_b32 v141, 0xffff0000, v106
    v_lshlrev_b32 v142, 16, v107
    v_and_b32 v143, 0xffff0000, v107
    v_fma_f32 v136, v136, v132, v133
    v_fma_f32 v137, v137, v132, v133
    v_fma_f32 v138, v138, v132, v133
    v_fma_f32 v139, v139, v132, v133
    v_fma_f32 v140, v140, v132, v133
    v_fma_f32 v141, v141, v132, v133
    v_fma_f32 v142, v142, v132, v133
    v_fma_f32 v143, v143, v132, v133
    v_cvt_pk_bf16_f32 v104, v136, v137
    v_cvt_pk_bf16_f32 v105, v138, v139
    v_cvt_pk_bf16_f32 v106, v140, v141
    v_cvt_pk_bf16_f32 v107, v142, v143
    ds_write_b64 v9, v[104:105] offset:2048
    ds_write_b64 v9, v[106:107] offset:3072
    v_lshlrev_b32 v144, 16, v108
    v_and_b32 v145, 0xffff0000, v108
    v_lshlrev_b32 v146, 16, v109
    v_and_b32 v147, 0xffff0000, v109
    v_lshlrev_b32 v148, 16, v110
    v_and_b32 v149, 0xffff0000, v110
    v_lshlrev_b32 v150, 16, v111
    v_and_b32 v151, 0xffff0000, v111
    v_fma_f32 v144, v144, v132, v133
    v_fma_f32 v145, v145, v132, v133
    v_fma_f32 v146, v146, v132, v133
    v_fma_f32 v147, v147, v132, v133
    v_fma_f32 v148, v148, v132, v133
    v_fma_f32 v149, v149, v132, v133
    v_fma_f32 v150, v150, v132, v133
    v_fma_f32 v151, v151, v132, v133
    v_cvt_pk_bf16_f32 v108, v144, v145
    v_cvt_pk_bf16_f32 v109, v146, v147
    v_cvt_pk_bf16_f32 v110, v148, v149
    v_cvt_pk_bf16_f32 v111, v150, v151
    ds_write_b64 v9, v[108:109] offset:2064
    ds_write_b64 v9, v[110:111] offset:3088
    ds_read_b64_tr_b16 v[184:185], v10 offset:2048
    ds_read_b64_tr_b16 v[186:187], v10 offset:2176
    ds_read_b64_tr_b16 v[188:189], v10 offset:3072
    ds_read_b64_tr_b16 v[190:191], v10 offset:3200
    s_waitcnt lgkmcnt(8)
    buffer_store_dwordx4 v[176:179], v8, s[96:99], s36 offen sc1
    buffer_store_dwordx4 v[180:183], v8, s[96:99], s36 offen offset:1024 sc1
    s_add_u32 s36, s36, 2048
    v_lshlrev_b32 v136, 16, v112
    v_and_b32 v137, 0xffff0000, v112
    v_lshlrev_b32 v138, 16, v113
    v_and_b32 v139, 0xffff0000, v113
    v_lshlrev_b32 v140, 16, v114
    v_and_b32 v141, 0xffff0000, v114
    v_lshlrev_b32 v142, 16, v115
    v_and_b32 v143, 0xffff0000, v115
    v_fma_f32 v136, v136, v132, v133
    v_fma_f32 v137, v137, v132, v133
    v_fma_f32 v138, v138, v132, v133
    v_fma_f32 v139, v139, v132, v133
    v_fma_f32 v140, v140, v132, v133
    v_fma_f32 v141, v141, v132, v133
    v_fma_f32 v142, v142, v132, v133
    v_fma_f32 v143, v143, v132, v133
    v_cvt_pk_bf16_f32 v112, v136, v137
    v_cvt_pk_bf16_f32 v113, v138, v139
    v_cvt_pk_bf16_f32 v114, v140, v141
    v_cvt_pk_bf16_f32 v115, v142, v143
    ds_write_b64 v9, v[112:113] offset:0
    ds_write_b64 v9, v[114:115] offset:1024
    v_lshlrev_b32 v144, 16, v116
    v_and_b32 v145, 0xffff0000, v116
    v_lshlrev_b32 v146, 16, v117
    v_and_b32 v147, 0xffff0000, v117
    v_lshlrev_b32 v148, 16, v118
    v_and_b32 v149, 0xffff0000, v118
    v_lshlrev_b32 v150, 16, v119
    v_and_b32 v151, 0xffff0000, v119
    v_fma_f32 v144, v144, v132, v133
    v_fma_f32 v145, v145, v132, v133
    v_fma_f32 v146, v146, v132, v133
    v_fma_f32 v147, v147, v132, v133
    v_fma_f32 v148, v148, v132, v133
    v_fma_f32 v149, v149, v132, v133
    v_fma_f32 v150, v150, v132, v133
    v_fma_f32 v151, v151, v132, v133
    v_cvt_pk_bf16_f32 v116, v144, v145
    v_cvt_pk_bf16_f32 v117, v146, v147
    v_cvt_pk_bf16_f32 v118, v148, v149
    v_cvt_pk_bf16_f32 v119, v150, v151
    ds_write_b64 v9, v[116:117] offset:16
    ds_write_b64 v9, v[118:119] offset:1040
    ds_read_b64_tr_b16 v[192:193], v10 offset:0
    ds_read_b64_tr_b16 v[194:195], v10 offset:128
    ds_read_b64_tr_b16 v[196:197], v10 offset:1024
    ds_read_b64_tr_b16 v[198:199], v10 offset:1152
    s_waitcnt lgkmcnt(8)
    buffer_store_dwordx4 v[184:187], v8, s[96:99], s36 offen sc1
    buffer_store_dwordx4 v[188:191], v8, s[96:99], s36 offen offset:1024 sc1
    s_add_u32 s36, s36, 2048
    s_waitcnt lgkmcnt(0)
    buffer_store_dwordx4 v[192:195], v8, s[96:99], s36 offen sc1
    s_add_u32 s36, s36, 581632
    buffer_store_dwordx4 v[196:199], v8, s[96:99], s36 offen sc1
    s_add_u32 s36, s36, 2048
    s_or_b32 s47, s13, 1
    s_lshl_b32 s47, s47, 8
    s_lshl_b32 s46, s18, 2
    s_add_u32 s46, s46, s47
    s_add_u32 s46, s46, 49364992
    v_mov_b32 v20, 0
    buffer_load_dword v21, v20, s[96:99], s46 offen sc1
    v_lshlrev_b32 v40, 16, v204
    v_and_b32 v41, 0xffff0000, v204
    v_lshlrev_b32 v42, 16, v205
    v_and_b32 v43, 0xffff0000, v205
    v_mul_f32 v56, v40, v40
    v_mul_f32 v57, v41, v41
    v_mul_f32 v58, v42, v42
    v_mul_f32 v59, v43, v43
    v_fma_f32 v56, v56, v13, v12
    v_fma_f32 v57, v57, v13, v12
    v_fma_f32 v58, v58, v13, v12
    v_fma_f32 v59, v59, v13, v12
    v_mul_f32 v56, v56, v40
    v_mul_f32 v57, v57, v41
    v_mul_f32 v58, v58, v42
    v_mul_f32 v59, v59, v43
    v_exp_f32 v56, v56
    v_exp_f32 v57, v57
    v_exp_f32 v58, v58
    v_exp_f32 v59, v59
    v_add_f32 v56, 1.0, v56
    v_add_f32 v57, 1.0, v57
    v_add_f32 v58, 1.0, v58
    v_add_f32 v59, 1.0, v59
    v_rcp_f32 v56, v56
    v_rcp_f32 v57, v57
    v_rcp_f32 v58, v58
    v_rcp_f32 v59, v59
    v_mul_f32 v40, v40, v56
    v_mul_f32 v41, v41, v57
    v_mul_f32 v42, v42, v58
    v_mul_f32 v43, v43, v59
    v_cvt_pk_bf16_f32 v204, v40, v41
    v_cvt_pk_bf16_f32 v205, v42, v43
    v_lshlrev_b32 v48, 16, v224
    v_and_b32 v49, 0xffff0000, v224
    v_lshlrev_b32 v50, 16, v225
    v_and_b32 v51, 0xffff0000, v225
    v_mul_f32 v64, v48, v48
    v_mul_f32 v65, v49, v49
    v_mul_f32 v66, v50, v50
    v_mul_f32 v67, v51, v51
    v_fma_f32 v64, v64, v13, v12
    v_fma_f32 v65, v65, v13, v12
    v_fma_f32 v66, v66, v13, v12
    v_fma_f32 v67, v67, v13, v12
    v_mul_f32 v64, v64, v48
    v_mul_f32 v65, v65, v49
    v_mul_f32 v66, v66, v50
    v_mul_f32 v67, v67, v51
    v_exp_f32 v64, v64
    v_exp_f32 v65, v65
    v_exp_f32 v66, v66
    v_exp_f32 v67, v67
    v_add_f32 v64, 1.0, v64
    v_add_f32 v65, 1.0, v65
    v_add_f32 v66, 1.0, v66
    v_add_f32 v67, 1.0, v67
    v_rcp_f32 v64, v64
    v_rcp_f32 v65, v65
    v_rcp_f32 v66, v66
    v_rcp_f32 v67, v67
    v_mul_f32 v48, v48, v64
    v_mul_f32 v49, v49, v65
    v_mul_f32 v50, v50, v66
    v_mul_f32 v51, v51, v67
    v_cvt_pk_bf16_f32 v224, v48, v49
    v_cvt_pk_bf16_f32 v225, v50, v51
    v_lshlrev_b32 v40, 16, v206
    v_and_b32 v41, 0xffff0000, v206
    v_lshlrev_b32 v42, 16, v207
    v_and_b32 v43, 0xffff0000, v207
    v_mul_f32 v56, v40, v40
    v_mul_f32 v57, v41, v41
    v_mul_f32 v58, v42, v42
    v_mul_f32 v59, v43, v43
    v_fma_f32 v56, v56, v13, v12
    v_fma_f32 v57, v57, v13, v12
    v_fma_f32 v58, v58, v13, v12
    v_fma_f32 v59, v59, v13, v12
    v_mul_f32 v56, v56, v40
    v_mul_f32 v57, v57, v41
    v_mul_f32 v58, v58, v42
    v_mul_f32 v59, v59, v43
    v_exp_f32 v56, v56
    v_exp_f32 v57, v57
    v_exp_f32 v58, v58
    v_exp_f32 v59, v59
    v_add_f32 v56, 1.0, v56
    v_add_f32 v57, 1.0, v57
    v_add_f32 v58, 1.0, v58
    v_add_f32 v59, 1.0, v59
    v_rcp_f32 v56, v56
    v_rcp_f32 v57, v57
    v_rcp_f32 v58, v58
    v_rcp_f32 v59, v59
    v_mul_f32 v40, v40, v56
    v_mul_f32 v41, v41, v57
    v_mul_f32 v42, v42, v58
    v_mul_f32 v43, v43, v59
    v_cvt_pk_bf16_f32 v206, v40, v41
    v_cvt_pk_bf16_f32 v207, v42, v43
    v_lshlrev_b32 v48, 16, v226
    v_and_b32 v49, 0xffff0000, v226
    v_lshlrev_b32 v50, 16, v227
    v_and_b32 v51, 0xffff0000, v227
    v_mul_f32 v64, v48, v48
    v_mul_f32 v65, v49, v49
    v_mul_f32 v66, v50, v50
    v_mul_f32 v67, v51, v51
    v_fma_f32 v64, v64, v13, v12
    v_fma_f32 v65, v65, v13, v12
    v_fma_f32 v66, v66, v13, v12
    v_fma_f32 v67, v67, v13, v12
    v_mul_f32 v64, v64, v48
    v_mul_f32 v65, v65, v49
    v_mul_f32 v66, v66, v50
    v_mul_f32 v67, v67, v51
    v_exp_f32 v64, v64
    v_exp_f32 v65, v65
    v_exp_f32 v66, v66
    v_exp_f32 v67, v67
    v_add_f32 v64, 1.0, v64
    v_add_f32 v65, 1.0, v65
    v_add_f32 v66, 1.0, v66
    v_add_f32 v67, 1.0, v67
    v_rcp_f32 v64, v64
    v_rcp_f32 v65, v65
    v_rcp_f32 v66, v66
    v_rcp_f32 v67, v67
    v_mul_f32 v48, v48, v64
    v_mul_f32 v49, v49, v65
    v_mul_f32 v50, v50, v66
    v_mul_f32 v51, v51, v67
    v_cvt_pk_bf16_f32 v226, v48, v49
    v_cvt_pk_bf16_f32 v227, v50, v51
    v_mov_b32 v24, s100
    v_mov_b32 v25, 0
    s_waitcnt vmcnt(0)
    s_mov_b64 exec, 1
    buffer_store_dword v24, v25, s[96:99], s34 offen sc1
    s_mov_b64 exec, -1
    v_cmp_ne_u32 vcc, s100, v21
    s_nop 0
    s_cmp_eq_u64 vcc, 0
    s_cbranch_scc1 Lzf29
    s_mov_b32 s90, 0
Lpl30:
    buffer_load_dword v21, v20, s[96:99], s46 offen sc1
    s_waitcnt vmcnt(0)
    v_cmp_ne_u32 vcc, s100, v21
    s_add_u32 s90, s90, 1
    s_cmp_eq_u64 vcc, 0
    s_cbranch_scc1 Lok31
    s_sleep 16
    s_cmp_lt_u32 s90, 0x20000
    s_cbranch_scc1 Lpl30
Lok31:
Lzf29:
    s_lshl_b32 s28, s18, 1
    s_mul_i32 s29, s28, 72
    s_add_u32 s29, s29, s22
    s_lshl_b32 s29, s29, 10
    s_add_u32 s44, s29, 16781312
    s_add_u32 s45, s44, 73728
    buffer_load_dwordx4 v[216:219], v8, s[96:99], s44 offen sc1
    buffer_load_dwordx4 v[236:239], v8, s[96:99], s45 offen sc1
    s_setprio 0
    s_barrier
    ds_read_b128 v[208:211], v16 offset:8192
    ds_read_b128 v[228:231], v16 offset:8448
    ds_read_b128 v[212:215], v16 offset:0
    ds_read_b128 v[232:235], v16 offset:256
    s_waitcnt lgkmcnt(0)
    s_barrier
    v_lshlrev_b32 v40, 16, v208
    v_and_b32 v41, 0xffff0000, v208
    v_lshlrev_b32 v42, 16, v209
    v_and_b32 v43, 0xffff0000, v209
    v_mul_f32 v56, v40, v40
    v_mul_f32 v57, v41, v41
    v_mul_f32 v58, v42, v42
    v_mul_f32 v59, v43, v43
    v_fma_f32 v56, v56, v13, v12
    v_fma_f32 v57, v57, v13, v12
    v_fma_f32 v58, v58, v13, v12
    v_fma_f32 v59, v59, v13, v12
    v_mul_f32 v56, v56, v40
    v_mul_f32 v57, v57, v41
    v_mul_f32 v58, v58, v42
    v_mul_f32 v59, v59, v43
    v_exp_f32 v56, v56
    v_exp_f32 v57, v57
    v_exp_f32 v58, v58
    v_exp_f32 v59, v59
    v_add_f32 v56, 1.0, v56
    v_add_f32 v57, 1.0, v57
    v_add_f32 v58, 1.0, v58
    v_add_f32 v59, 1.0, v59
    v_rcp_f32 v56, v56
    v_rcp_f32 v57, v57
    v_rcp_f32 v58, v58
    v_rcp_f32 v59, v59
    v_mul_f32 v40, v40, v56
    v_mul_f32 v41, v41, v57
    v_mul_f32 v42, v42, v58
    v_mul_f32 v43, v43, v59
    v_cvt_pk_bf16_f32 v208, v40, v41
    v_cvt_pk_bf16_f32 v209, v42, v43
    v_lshlrev_b32 v48, 16, v228
    v_and_b32 v49, 0xffff0000, v228
    v_lshlrev_b32 v50, 16, v229
    v_and_b32 v51, 0xffff0000, v229
    v_mul_f32 v64, v48, v48
    v_mul_f32 v65, v49, v49
    v_mul_f32 v66, v50, v50
    v_mul_f32 v67, v51, v51
    v_fma_f32 v64, v64, v13, v12
    v_fma_f32 v65, v65, v13, v12
    v_fma_f32 v66, v66, v13, v12
    v_fma_f32 v67, v67, v13, v12
    v_mul_f32 v64, v64, v48
    v_mul_f32 v65, v65, v49
    v_mul_f32 v66, v66, v50
    v_mul_f32 v67, v67, v51
    v_exp_f32 v64, v64
    v_exp_f32 v65, v65
    v_exp_f32 v66, v66
    v_exp_f32 v67, v67
    v_add_f32 v64, 1.0, v64
    v_add_f32 v65, 1.0, v65
    v_add_f32 v66, 1.0, v66
    v_add_f32 v67, 1.0, v67
    v_rcp_f32 v64, v64
    v_rcp_f32 v65, v65
    v_rcp_f32 v66, v66
    v_rcp_f32 v67, v67
    v_mul_f32 v48, v48, v64
    v_mul_f32 v49, v49, v65
    v_mul_f32 v50, v50, v66
    v_mul_f32 v51, v51, v67
    v_cvt_pk_bf16_f32 v228, v48, v49
    v_cvt_pk_bf16_f32 v229, v50, v51
    v_lshlrev_b32 v40, 16, v210
    v_and_b32 v41, 0xffff0000, v210
    v_lshlrev_b32 v42, 16, v211
    v_and_b32 v43, 0xffff0000, v211
    v_mul_f32 v56, v40, v40
    v_mul_f32 v57, v41, v41
    v_mul_f32 v58, v42, v42
    v_mul_f32 v59, v43, v43
    v_fma_f32 v56, v56, v13, v12
    v_fma_f32 v57, v57, v13, v12
    v_fma_f32 v58, v58, v13, v12
    v_fma_f32 v59, v59, v13, v12
    v_mul_f32 v56, v56, v40
    v_mul_f32 v57, v57, v41
    v_mul_f32 v58, v58, v42
    v_mul_f32 v59, v59, v43
    v_exp_f32 v56, v56
    v_exp_f32 v57, v57
    v_exp_f32 v58, v58
    v_exp_f32 v59, v59
    v_add_f32 v56, 1.0, v56
    v_add_f32 v57, 1.0, v57
    v_add_f32 v58, 1.0, v58
    v_add_f32 v59, 1.0, v59
    v_rcp_f32 v56, v56
    v_rcp_f32 v57, v57
    v_rcp_f32 v58, v58
    v_rcp_f32 v59, v59
    v_mul_f32 v40, v40, v56
    v_mul_f32 v41, v41, v57
    v_mul_f32 v42, v42, v58
    v_mul_f32 v43, v43, v59
    v_cvt_pk_bf16_f32 v210, v40, v41
    v_cvt_pk_bf16_f32 v211, v42, v43
    v_lshlrev_b32 v48, 16, v230
    v_and_b32 v49, 0xffff0000, v230
    v_lshlrev_b32 v50, 16, v231
    v_and_b32 v51, 0xffff0000, v231
    v_mul_f32 v64, v48, v48
    v_mul_f32 v65, v49, v49
    v_mul_f32 v66, v50, v50
    v_mul_f32 v67, v51, v51
    v_fma_f32 v64, v64, v13, v12
    v_fma_f32 v65, v65, v13, v12
    v_fma_f32 v66, v66, v13, v12
    v_fma_f32 v67, v67, v13, v12
    v_mul_f32 v64, v64, v48
    v_mul_f32 v65, v65, v49
    v_mul_f32 v66, v66, v50
    v_mul_f32 v67, v67, v51
    v_exp_f32 v64, v64
    v_exp_f32 v65, v65
    v_exp_f32 v66, v66
    v_exp_f32 v67, v67
    v_add_f32 v64, 1.0, v64
    v_add_f32 v65, 1.0, v65
    v_add_f32 v66, 1.0, v66
    v_add_f32 v67, 1.0, v67
    v_rcp_f32 v64, v64
    v_rcp_f32 v65, v65
    v_rcp_f32 v66, v66
    v_rcp_f32 v67, v67
    v_mul_f32 v48, v48, v64
    v_mul_f32 v49, v49, v65
    v_mul_f32 v50, v50, v66
    v_mul_f32 v51, v51, v67
    v_cvt_pk_bf16_f32 v230, v48, v49
    v_cvt_pk_bf16_f32 v231, v50, v51
    v_lshlrev_b32 v40, 16, v212
    v_and_b32 v41, 0xffff0000, v212
    v_lshlrev_b32 v42, 16, v213
    v_and_b32 v43, 0xffff0000, v213
    v_mul_f32 v56, v40, v40
    v_mul_f32 v57, v41, v41
    v_mul_f32 v58, v42, v42
    v_mul_f32 v59, v43, v43
    v_fma_f32 v56, v56, v13, v12
    v_fma_f32 v57, v57, v13, v12
    v_fma_f32 v58, v58, v13, v12
    v_fma_f32 v59, v59, v13, v12
    v_mul_f32 v56, v56, v40
    v_mul_f32 v57, v57, v41
    v_mul_f32 v58, v58, v42
    v_mul_f32 v59, v59, v43
    v_exp_f32 v56, v56
    v_exp_f32 v57, v57
    v_exp_f32 v58, v58
    v_exp_f32 v59, v59
    v_add_f32 v56, 1.0, v56
    v_add_f32 v57, 1.0, v57
    v_add_f32 v58, 1.0, v58
    v_add_f32 v59, 1.0, v59
    v_rcp_f32 v56, v56
    v_rcp_f32 v57, v57
    v_rcp_f32 v58, v58
    v_rcp_f32 v59, v59
    v_mul_f32 v40, v40, v56
    v_mul_f32 v41, v41, v57
    v_mul_f32 v42, v42, v58
    v_mul_f32 v43, v43, v59
    v_cvt_pk_bf16_f32 v212, v40, v41
    v_cvt_pk_bf16_f32 v213, v42, v43
    v_lshlrev_b32 v48, 16, v232
    v_and_b32 v49, 0xffff0000, v232
    v_lshlrev_b32 v50, 16, v233
    v_and_b32 v51, 0xffff0000, v233
    v_mul_f32 v64, v48, v48
    v_mul_f32 v65, v49, v49
    v_mul_f32 v66, v50, v50
    v_mul_f32 v67, v51, v51
    v_fma_f32 v64, v64, v13, v12
    v_fma_f32 v65, v65, v13, v12
    v_fma_f32 v66, v66, v13, v12
    v_fma_f32 v67, v67, v13, v12
    v_mul_f32 v64, v64, v48
    v_mul_f32 v65, v65, v49
    v_mul_f32 v66, v66, v50
    v_mul_f32 v67, v67, v51
    v_exp_f32 v64, v64
    v_exp_f32 v65, v65
    v_exp_f32 v66, v66
    v_exp_f32 v67, v67
    v_add_f32 v64, 1.0, v64
    v_add_f32 v65, 1.0, v65
    v_add_f32 v66, 1.0, v66
    v_add_f32 v67, 1.0, v67
    v_rcp_f32 v64, v64
    v_rcp_f32 v65, v65
    v_rcp_f32 v66, v66
    v_rcp_f32 v67, v67
    v_mul_f32 v48, v48, v64
    v_mul_f32 v49, v49, v65
    v_mul_f32 v50, v50, v66
    v_mul_f32 v51, v51, v67
    v_cvt_pk_bf16_f32 v232, v48, v49
    v_cvt_pk_bf16_f32 v233, v50, v51
    v_lshlrev_b32 v40, 16, v214
    v_and_b32 v41, 0xffff0000, v214
    v_lshlrev_b32 v42, 16, v215
    v_and_b32 v43, 0xffff0000, v215
    v_mul_f32 v56, v40, v40
    v_mul_f32 v57, v41, v41
    v_mul_f32 v58, v42, v42
    v_mul_f32 v59, v43, v43
    v_fma_f32 v56, v56, v13, v12
    v_fma_f32 v57, v57, v13, v12
    v_fma_f32 v58, v58, v13, v12
    v_fma_f32 v59, v59, v13, v12
    v_mul_f32 v56, v56, v40
    v_mul_f32 v57, v57, v41
    v_mul_f32 v58, v58, v42
    v_mul_f32 v59, v59, v43
    v_exp_f32 v56, v56
    v_exp_f32 v57, v57
    v_exp_f32 v58, v58
    v_exp_f32 v59, v59
    v_add_f32 v56, 1.0, v56
    v_add_f32 v57, 1.0, v57
    v_add_f32 v58, 1.0, v58
    v_add_f32 v59, 1.0, v59
    v_rcp_f32 v56, v56
    v_rcp_f32 v57, v57
    v_rcp_f32 v58, v58
    v_rcp_f32 v59, v59
    v_mul_f32 v40, v40, v56
    v_mul_f32 v41, v41, v57
    v_mul_f32 v42, v42, v58
    v_mul_f32 v43, v43, v59
    v_cvt_pk_bf16_f32 v214, v40, v41
    v_cvt_pk_bf16_f32 v215, v42, v43
    v_lshlrev_b32 v48, 16, v234
    v_and_b32 v49, 0xffff0000, v234
    v_lshlrev_b32 v50, 16, v235
    v_and_b32 v51, 0xffff0000, v235
    v_mul_f32 v64, v48, v48
    v_mul_f32 v65, v49, v49
    v_mul_f32 v66, v50, v50
    v_mul_f32 v67, v51, v51
    v_fma_f32 v64, v64, v13, v12
    v_fma_f32 v65, v65, v13, v12
    v_fma_f32 v66, v66, v13, v12
    v_fma_f32 v67, v67, v13, v12
    v_mul_f32 v64, v64, v48
    v_mul_f32 v65, v65, v49
    v_mul_f32 v66, v66, v50
    v_mul_f32 v67, v67, v51
    v_exp_f32 v64, v64
    v_exp_f32 v65, v65
    v_exp_f32 v66, v66
    v_exp_f32 v67, v67
    v_add_f32 v64, 1.0, v64
    v_add_f32 v65, 1.0, v65
    v_add_f32 v66, 1.0, v66
    v_add_f32 v67, 1.0, v67
    v_rcp_f32 v64, v64
    v_rcp_f32 v65, v65
    v_rcp_f32 v66, v66
    v_rcp_f32 v67, v67
    v_mul_f32 v48, v48, v64
    v_mul_f32 v49, v49, v65
    v_mul_f32 v50, v50, v66
    v_mul_f32 v51, v51, v67
    v_cvt_pk_bf16_f32 v234, v48, v49
    v_cvt_pk_bf16_f32 v235, v50, v51
    s_waitcnt vmcnt(0)
    v_lshlrev_b32 v40, 16, v216
    v_and_b32 v41, 0xffff0000, v216
    v_lshlrev_b32 v42, 16, v217
    v_and_b32 v43, 0xffff0000, v217
    v_mul_f32 v56, v40, v40
    v_mul_f32 v57, v41, v41
    v_mul_f32 v58, v42, v42
    v_mul_f32 v59, v43, v43
    v_fma_f32 v56, v56, v13, v12
    v_fma_f32 v57, v57, v13, v12
    v_fma_f32 v58, v58, v13, v12
    v_fma_f32 v59, v59, v13, v12
    v_mul_f32 v56, v56, v40
    v_mul_f32 v57, v57, v41
    v_mul_f32 v58, v58, v42
    v_mul_f32 v59, v59, v43
    v_exp_f32 v56, v56
    v_exp_f32 v57, v57
    v_exp_f32 v58, v58
    v_exp_f32 v59, v59
    v_add_f32 v56, 1.0, v56
    v_add_f32 v57, 1.0, v57
    v_add_f32 v58, 1.0, v58
    v_add_f32 v59, 1.0, v59
    v_rcp_f32 v56, v56
    v_rcp_f32 v57, v57
    v_rcp_f32 v58, v58
    v_rcp_f32 v59, v59
    v_mul_f32 v40, v40, v56
    v_mul_f32 v41, v41, v57
    v_mul_f32 v42, v42, v58
    v_mul_f32 v43, v43, v59
    v_cvt_pk_bf16_f32 v216, v40, v41
    v_cvt_pk_bf16_f32 v217, v42, v43
    v_lshlrev_b32 v48, 16, v236
    v_and_b32 v49, 0xffff0000, v236
    v_lshlrev_b32 v50, 16, v237
    v_and_b32 v51, 0xffff0000, v237
    v_mul_f32 v64, v48, v48
    v_mul_f32 v65, v49, v49
    v_mul_f32 v66, v50, v50
    v_mul_f32 v67, v51, v51
    v_fma_f32 v64, v64, v13, v12
    v_fma_f32 v65, v65, v13, v12
    v_fma_f32 v66, v66, v13, v12
    v_fma_f32 v67, v67, v13, v12
    v_mul_f32 v64, v64, v48
    v_mul_f32 v65, v65, v49
    v_mul_f32 v66, v66, v50
    v_mul_f32 v67, v67, v51
    v_exp_f32 v64, v64
    v_exp_f32 v65, v65
    v_exp_f32 v66, v66
    v_exp_f32 v67, v67
    v_add_f32 v64, 1.0, v64
    v_add_f32 v65, 1.0, v65
    v_add_f32 v66, 1.0, v66
    v_add_f32 v67, 1.0, v67
    v_rcp_f32 v64, v64
    v_rcp_f32 v65, v65
    v_rcp_f32 v66, v66
    v_rcp_f32 v67, v67
    v_mul_f32 v48, v48, v64
    v_mul_f32 v49, v49, v65
    v_mul_f32 v50, v50, v66
    v_mul_f32 v51, v51, v67
    v_cvt_pk_bf16_f32 v236, v48, v49
    v_cvt_pk_bf16_f32 v237, v50, v51
    s_branch P2
Lg1o:
    s_add_u32 s82, s28, s76
    s_add_u32 m0, s76, 0
    s_add_u32 s82, s82, 0
    buffer_load_dwordx4 v8, s[96:99], s82 offen sc1 lds
    buffer_load_dwordx4 v8, s[96:99], s82 offen offset:1024 sc1 lds
    buffer_load_dwordx4 v8, s[96:99], s82 offen offset:2048 sc1 lds
    buffer_load_dwordx4 v8, s[96:99], s82 offen offset:3072 sc1 lds
    s_add_u32 m0, s76, 4096
    s_add_u32 s82, s82, 4096
    s_mov_b64 exec, s[78:79]
    buffer_load_dwordx4 v8, s[96:99], s82 offen sc1 lds
    s_mov_b64 exec, -1
    s_add_u32 s82, s28, s77
    s_add_u32 m0, s77, 19456
    s_add_u32 s82, s82, 18432
    buffer_load_dwordx4 v8, s[96:99], s82 offen sc1 lds
    buffer_load_dwordx4 v8, s[96:99], s82 offen offset:1024 sc1 lds
    buffer_load_dwordx4 v8, s[96:99], s82 offen offset:2048 sc1 lds
    buffer_load_dwordx4 v8, s[96:99], s82 offen offset:3072 sc1 lds
    s_add_u32 m0, s77, 23552
    s_add_u32 s82, s82, 4096
    s_mov_b64 exec, s[80:81]
    buffer_load_dwordx4 v8, s[96:99], s82 offen sc1 lds
    s_mov_b64 exec, -1
    s_add_u32 s82, s28, s76
    s_add_u32 m0, s76, 38912
    s_add_u32 s82, s82, 37888
    buffer_load_dwordx4 v8, s[96:99], s82 offen sc1 lds
    buffer_load_dwordx4 v8, s[96:99], s82 offen offset:1024 sc1 lds
    buffer_load_dwordx4 v8, s[96:99], s82 offen offset:2048 sc1 lds
    buffer_load_dwordx4 v8, s[96:99], s82 offen offset:3072 sc1 lds
    s_add_u32 m0, s76, 43008
    s_add_u32 s82, s82, 4096
    s_mov_b64 exec, s[78:79]
    buffer_load_dwordx4 v8, s[96:99], s82 offen sc1 lds
    s_mov_b64 exec, -1
    s_lshl_b32 s33, s18, 13
    s_add_u32 s37, s33, 48234496
    s_add_u32 s38, s37, 4096
    s_lshl_b32 s33, s13, 9
    s_add_u32 s39, s37, s33
    v_lshrrev_b32 v16, 4, v1
    v_lshlrev_b32 v16, 9, v16
    v_and_b32 v17, 15, v1
    v_lshl_add_u32 v16, v17, 4, v16
    s_lshl_b32 s33, s14, 11
    v_add_u32 v16, s33, v16
    v_add_u32 v18, 116736, v16
    s_lshl_b32 s33, s14, 10
    s_add_u32 s33, s33, 133120
    v_lshlrev_b32 v17, 4, v17
    v_add_u32 v17, s33, v17
    s_lshl_b32 s33, s14, 12
    s_add_u32 s33, s33, 19456
    v_lshlrev_b32 v9, 5, v2
    v_lshl_add_u32 v9, v3, 3, v9
    v_add_u32 v9, s33, v9
    v_lshrrev_b32 v10, 4, v1
    v_lshlrev_b32 v10, 8, v10
    v_bfe_u32 v20, v1, 2, 2
    v_lshl_add_u32 v10, v20, 5, v10
    v_and_b32 v20, 3, v1
    v_lshl_add_u32 v10, v20, 3, v10
    v_add_u32 v10, s33, v10
    s_lshl_b32 s33, s13, 6
    s_add_u32 s33, s33, s18
    s_mul_i32 s36, s33, 9216
    s_add_u32 s36, s36, 27264000
    v_mov_b32 v24, 0
    v_mov_b32 v25, 0
    v_mov_b32 v26, 0
    v_mov_b32 v27, 0
    v_mov_b32 v12, 0xc0135761
    v_mov_b32 v13, 0xbdd2d3e8
    s_barrier
    s_waitcnt vmcnt(10)
    s_barrier
    s_waitcnt vmcnt(0)
    s_barrier
    s_add_u32 s82, s28, s77
    s_add_u32 m0, s77, 58368
    s_add_u32 s82, s82, 56320
    buffer_load_dwordx4 v8, s[96:99], s82 offen sc1 lds
    buffer_load_dwordx4 v8, s[96:99], s82 offen offset:1024 sc1 lds
    buffer_load_dwordx4 v8, s[96:99], s82 offen offset:2048 sc1 lds
    buffer_load_dwordx4 v8, s[96:99], s82 offen offset:3072 sc1 lds
    s_add_u32 m0, s77, 62464
    s_add_u32 s82, s82, 4096
    s_mov_b64 exec, s[80:81]
    buffer_load_dwordx4 v8, s[96:99], s82 offen sc1 lds
    s_mov_b64 exec, -1
    s_add_u32 s82, s28, s76
    s_add_u32 m0, s76, 77824
    s_add_u32 s82, s82, 75776
    buffer_load_dwordx4 v8, s[96:99], s82 offen sc1 lds
    buffer_load_dwordx4 v8, s[96:99], s82 offen offset:1024 sc1 lds
    buffer_load_dwordx4 v8, s[96:99], s82 offen offset:2048 sc1 lds
    buffer_load_dwordx4 v8, s[96:99], s82 offen offset:3072 sc1 lds
    s_add_u32 m0, s76, 81920
    s_add_u32 s82, s82, 4096
    s_mov_b64 exec, s[78:79]
    buffer_load_dwordx4 v8, s[96:99], s82 offen sc1 lds
    s_mov_b64 exec, -1
    s_add_u32 s82, s28, s77
    s_add_u32 m0, s77, 97280
    s_add_u32 s82, s82, 94208
    buffer_load_dwordx4 v8, s[96:99], s82 offen sc1 lds
    buffer_load_dwordx4 v8, s[96:99], s82 offen offset:1024 sc1 lds
    buffer_load_dwordx4 v8, s[96:99], s82 offen offset:2048 sc1 lds
    buffer_load_dwordx4 v8, s[96:99], s82 offen offset:3072 sc1 lds
    s_add_u32 m0, s77, 101376
    s_add_u32 s82, s82, 4096
    s_mov_b64 exec, s[80:81]
    buffer_load_dwordx4 v8, s[96:99], s82 offen sc1 lds
    s_mov_b64 exec, -1
    s_add_u32 s82, s28, s76
    s_add_u32 m0, s76, 0
    s_add_u32 s82, s82, 113664
    buffer_load_dwordx4 v8, s[96:99], s82 offen sc1 lds
    buffer_load_dwordx4 v8, s[96:99], s82 offen offset:1024 sc1 lds
    buffer_load_dwordx4 v8, s[96:99], s82 offen offset:2048 sc1 lds
    buffer_load_dwordx4 v8, s[96:99], s82 offen offset:3072 sc1 lds
    s_add_u32 m0, s76, 4096
    s_add_u32 s82, s82, 4096
    s_mov_b64 exec, s[78:79]
    buffer_load_dwordx4 v8, s[96:99], s82 offen sc1 lds
    s_mov_b64 exec, -1
    s_waitcnt vmcnt(10)
    s_barrier
    ds_read_b128 v[32:35], v7 offset:0
    ds_read_b128 v[36:39], v7 offset:1024
    s_add_u32 s82, s28, s77
    s_add_u32 m0, s77, 19456
    s_add_u32 s82, s82, 132096
    buffer_load_dwordx4 v8, s[96:99], s82 offen sc1 lds
    buffer_load_dwordx4 v8, s[96:99], s82 offen offset:1024 sc1 lds
    buffer_load_dwordx4 v8, s[96:99], s82 offen offset:2048 sc1 lds
    s_waitcnt lgkmcnt(0)
    v_lshlrev_b32 v40, 16, v32
    v_and_b32 v41, 0xffff0000, v32
    v_lshlrev_b32 v42, 16, v33
    v_and_b32 v43, 0xffff0000, v33
    v_mul_f32 v56, v40, v40
    v_mul_f32 v57, v41, v41
    v_mul_f32 v58, v42, v42
    v_mul_f32 v59, v43, v43
    v_fma_f32 v56, v56, v13, v12
    v_fma_f32 v57, v57, v13, v12
    v_fma_f32 v58, v58, v13, v12
    v_fma_f32 v59, v59, v13, v12
    v_mul_f32 v56, v56, v40
    v_mul_f32 v57, v57, v41
    v_mul_f32 v58, v58, v42
    v_mul_f32 v59, v59, v43
    v_exp_f32 v56, v56
    v_exp_f32 v57, v57
    v_exp_f32 v58, v58
    v_exp_f32 v59, v59
    buffer_load_dwordx4 v8, s[96:99], s82 offen offset:3072 sc1 lds
    v_add_f32 v56, 1.0, v56
    v_add_f32 v57, 1.0, v57
    v_add_f32 v58, 1.0, v58
    v_add_f32 v59, 1.0, v59
    v_rcp_f32 v56, v56
    v_rcp_f32 v57, v57
    v_rcp_f32 v58, v58
    v_rcp_f32 v59, v59
    v_mul_f32 v60, v40, v56
    v_mul_f32 v61, v41, v57
    v_mul_f32 v62, v42, v58
    v_mul_f32 v63, v43, v59
    v_cvt_pk_bf16_f32 v80, v60, v61
    v_cvt_pk_bf16_f32 v81, v62, v63
    v_add_f32 v24, v24, v60
    v_fmac_f32 v25, v60, v60
    v_add_f32 v26, v26, v61
    v_fmac_f32 v27, v61, v61
    v_add_f32 v24, v24, v62
    v_fmac_f32 v25, v62, v62
    v_add_f32 v26, v26, v63
    s_add_u32 m0, s77, 23552
    s_add_u32 s82, s82, 4096
    s_mov_b64 exec, s[80:81]
    buffer_load_dwordx4 v8, s[96:99], s82 offen sc1 lds
    s_mov_b64 exec, -1
    v_fmac_f32 v27, v63, v63
    v_lshlrev_b32 v48, 16, v34
    v_and_b32 v49, 0xffff0000, v34
    v_lshlrev_b32 v50, 16, v35
    v_and_b32 v51, 0xffff0000, v35
    v_mul_f32 v64, v48, v48
    v_mul_f32 v65, v49, v49
    v_mul_f32 v66, v50, v50
    v_mul_f32 v67, v51, v51
    v_fma_f32 v64, v64, v13, v12
    v_fma_f32 v65, v65, v13, v12
    v_fma_f32 v66, v66, v13, v12
    v_fma_f32 v67, v67, v13, v12
    v_mul_f32 v64, v64, v48
    v_mul_f32 v65, v65, v49
    v_mul_f32 v66, v66, v50
    v_mul_f32 v67, v67, v51
    v_exp_f32 v64, v64
    v_exp_f32 v65, v65
    v_exp_f32 v66, v66
    v_exp_f32 v67, v67
    s_add_u32 s82, s29, s76
    s_add_u32 m0, s76, 38912
    s_add_u32 s82, s82, 0
    buffer_load_dwordx4 v8, s[96:99], s82 offen sc1 lds
    v_add_f32 v64, 1.0, v64
    v_add_f32 v65, 1.0, v65
    v_add_f32 v66, 1.0, v66
    v_add_f32 v67, 1.0, v67
    v_rcp_f32 v64, v64
    v_rcp_f32 v65, v65
    v_rcp_f32 v66, v66
    v_rcp_f32 v67, v67
    v_mul_f32 v68, v48, v64
    v_mul_f32 v69, v49, v65
    v_mul_f32 v70, v50, v66
    v_mul_f32 v71, v51, v67
    v_cvt_pk_bf16_f32 v82, v68, v69
    v_cvt_pk_bf16_f32 v83, v70, v71
    v_add_f32 v24, v24, v68
    v_fmac_f32 v25, v68, v68
    v_add_f32 v26, v26, v69
    v_fmac_f32 v27, v69, v69
    v_add_f32 v24, v24, v70
    v_fmac_f32 v25, v70, v70
    v_add_f32 v26, v26, v71
    buffer_load_dwordx4 v8, s[96:99], s82 offen offset:1024 sc1 lds
    v_fmac_f32 v27, v71, v71
    v_lshlrev_b32 v40, 16, v36
    v_and_b32 v41, 0xffff0000, v36
    v_lshlrev_b32 v42, 16, v37
    v_and_b32 v43, 0xffff0000, v37
    v_mul_f32 v56, v40, v40
    v_mul_f32 v57, v41, v41
    v_mul_f32 v58, v42, v42
    v_mul_f32 v59, v43, v43
    v_fma_f32 v56, v56, v13, v12
    v_fma_f32 v57, v57, v13, v12
    v_fma_f32 v58, v58, v13, v12
    v_fma_f32 v59, v59, v13, v12
    v_mul_f32 v56, v56, v40
    v_mul_f32 v57, v57, v41
    v_mul_f32 v58, v58, v42
    v_mul_f32 v59, v59, v43
    v_exp_f32 v56, v56
    v_exp_f32 v57, v57
    v_exp_f32 v58, v58
    v_exp_f32 v59, v59
    buffer_load_dwordx4 v8, s[96:99], s82 offen offset:2048 sc1 lds
    v_add_f32 v56, 1.0, v56
    v_add_f32 v57, 1.0, v57
    v_add_f32 v58, 1.0, v58
    v_add_f32 v59, 1.0, v59
    v_rcp_f32 v56, v56
    v_rcp_f32 v57, v57
    v_rcp_f32 v58, v58
    v_rcp_f32 v59, v59
    v_mul_f32 v60, v40, v56
    v_mul_f32 v61, v41, v57
    v_mul_f32 v62, v42, v58
    v_mul_f32 v63, v43, v59
    v_cvt_pk_bf16_f32 v84, v60, v61
    v_cvt_pk_bf16_f32 v85, v62, v63
    v_add_f32 v24, v24, v60
    v_fmac_f32 v25, v60, v60
    v_add_f32 v26, v26, v61
    v_fmac_f32 v27, v61, v61
    v_add_f32 v24, v24, v62
    v_fmac_f32 v25, v62, v62
    v_add_f32 v26, v26, v63
    buffer_load_dwordx4 v8, s[96:99], s82 offen offset:3072 sc1 lds
    v_fmac_f32 v27, v63, v63
    v_lshlrev_b32 v48, 16, v38
    v_and_b32 v49, 0xffff0000, v38
    v_lshlrev_b32 v50, 16, v39
    v_and_b32 v51, 0xffff0000, v39
    v_mul_f32 v64, v48, v48
    v_mul_f32 v65, v49, v49
    v_mul_f32 v66, v50, v50
    v_mul_f32 v67, v51, v51
    v_fma_f32 v64, v64, v13, v12
    v_fma_f32 v65, v65, v13, v12
    v_fma_f32 v66, v66, v13, v12
    v_fma_f32 v67, v67, v13, v12
    v_mul_f32 v64, v64, v48
    v_mul_f32 v65, v65, v49
    v_mul_f32 v66, v66, v50
    v_mul_f32 v67, v67, v51
    v_exp_f32 v64, v64
    v_exp_f32 v65, v65
    v_exp_f32 v66, v66
    v_exp_f32 v67, v67
    s_add_u32 m0, s76, 43008
    s_add_u32 s82, s82, 4096
    s_mov_b64 exec, s[78:79]
    buffer_load_dwordx4 v8, s[96:99], s82 offen sc1 lds
    s_mov_b64 exec, -1
    v_add_f32 v64, 1.0, v64
    v_add_f32 v65, 1.0, v65
    v_add_f32 v66, 1.0, v66
    v_add_f32 v67, 1.0, v67
    v_rcp_f32 v64, v64
    v_rcp_f32 v65, v65
    v_rcp_f32 v66, v66
    v_rcp_f32 v67, v67
    v_mul_f32 v68, v48, v64
    v_mul_f32 v69, v49, v65
    v_mul_f32 v70, v50, v66
    v_mul_f32 v71, v51, v67
    v_cvt_pk_bf16_f32 v86, v68, v69
    v_cvt_pk_bf16_f32 v87, v70, v71
    v_add_f32 v24, v24, v68
    v_fmac_f32 v25, v68, v68
    v_add_f32 v26, v26, v69
    v_fmac_f32 v27, v69, v69
    v_add_f32 v24, v24, v70
    v_fmac_f32 v25, v70, v70
    v_add_f32 v26, v26, v71
    v_fmac_f32 v27, v71, v71
    s_waitcnt vmcnt(10)
    s_barrier
    ds_read_b128 v[32:35], v7 offset:8192
    ds_read_b128 v[36:39], v7 offset:9216
    s_add_u32 s82, s29, s77
    s_add_u32 m0, s77, 58368
    s_add_u32 s82, s82, 18432
    buffer_load_dwordx4 v8, s[96:99], s82 offen sc1 lds
    buffer_load_dwordx4 v8, s[96:99], s82 offen offset:1024 sc1 lds
    buffer_load_dwordx4 v8, s[96:99], s82 offen offset:2048 sc1 lds
    s_waitcnt lgkmcnt(0)
    v_lshlrev_b32 v40, 16, v32
    v_and_b32 v41, 0xffff0000, v32
    v_lshlrev_b32 v42, 16, v33
    v_and_b32 v43, 0xffff0000, v33
    v_mul_f32 v56, v40, v40
    v_mul_f32 v57, v41, v41
    v_mul_f32 v58, v42, v42
    v_mul_f32 v59, v43, v43
    v_fma_f32 v56, v56, v13, v12
    v_fma_f32 v57, v57, v13, v12
    v_fma_f32 v58, v58, v13, v12
    v_fma_f32 v59, v59, v13, v12
    v_mul_f32 v56, v56, v40
    v_mul_f32 v57, v57, v41
    v_mul_f32 v58, v58, v42
    v_mul_f32 v59, v59, v43
    v_exp_f32 v56, v56
    v_exp_f32 v57, v57
    v_exp_f32 v58, v58
    v_exp_f32 v59, v59
    buffer_load_dwordx4 v8, s[96:99], s82 offen offset:3072 sc1 lds
    v_add_f32 v56, 1.0, v56
    v_add_f32 v57, 1.0, v57
    v_add_f32 v58, 1.0, v58
    v_add_f32 v59, 1.0, v59
    v_rcp_f32 v56, v56
    v_rcp_f32 v57, v57
    v_rcp_f32 v58, v58
    v_rcp_f32 v59, v59
    v_mul_f32 v60, v40, v56
    v_mul_f32 v61, v41, v57
    v_mul_f32 v62, v42, v58
    v_mul_f32 v63, v43, v59
    v_cvt_pk_bf16_f32 v88, v60, v61
    v_cvt_pk_bf16_f32 v89, v62, v63
    v_add_f32 v24, v24, v60
    v_fmac_f32 v25, v60, v60
    v_add_f32 v26, v26, v61
    v_fmac_f32 v27, v61, v61
    v_add_f32 v24, v24, v62
    v_fmac_f32 v25, v62, v62
    v_add_f32 v26, v26, v63
    s_add_u32 m0, s77, 62464
    s_add_u32 s82, s82, 4096
    s_mov_b64 exec, s[80:81]
    buffer_load_dwordx4 v8, s[96:99], s82 offen sc1 lds
    s_mov_b64 exec, -1
    v_fmac_f32 v27, v63, v63
    v_lshlrev_b32 v48, 16, v34
    v_and_b32 v49, 0xffff0000, v34
    v_lshlrev_b32 v50, 16, v35
    v_and_b32 v51, 0xffff0000, v35
    v_mul_f32 v64, v48, v48
    v_mul_f32 v65, v49, v49
    v_mul_f32 v66, v50, v50
    v_mul_f32 v67, v51, v51
    v_fma_f32 v64, v64, v13, v12
    v_fma_f32 v65, v65, v13, v12
    v_fma_f32 v66, v66, v13, v12
    v_fma_f32 v67, v67, v13, v12
    v_mul_f32 v64, v64, v48
    v_mul_f32 v65, v65, v49
    v_mul_f32 v66, v66, v50
    v_mul_f32 v67, v67, v51
    v_exp_f32 v64, v64
    v_exp_f32 v65, v65
    v_exp_f32 v66, v66
    v_exp_f32 v67, v67
    s_add_u32 s82, s29, s76
    s_add_u32 m0, s76, 77824
    s_add_u32 s82, s82, 37888
    buffer_load_dwordx4 v8, s[96:99], s82 offen sc1 lds
    v_add_f32 v64, 1.0, v64
    v_add_f32 v65, 1.0, v65
    v_add_f32 v66, 1.0, v66
    v_add_f32 v67, 1.0, v67
    v_rcp_f32 v64, v64
    v_rcp_f32 v65, v65
    v_rcp_f32 v66, v66
    v_rcp_f32 v67, v67
    v_mul_f32 v68, v48, v64
    v_mul_f32 v69, v49, v65
    v_mul_f32 v70, v50, v66
    v_mul_f32 v71, v51, v67
    v_cvt_pk_bf16_f32 v90, v68, v69
    v_cvt_pk_bf16_f32 v91, v70, v71
    v_add_f32 v24, v24, v68
    v_fmac_f32 v25, v68, v68
    v_add_f32 v26, v26, v69
    v_fmac_f32 v27, v69, v69
    v_add_f32 v24, v24, v70
    v_fmac_f32 v25, v70, v70
    v_add_f32 v26, v26, v71
    buffer_load_dwordx4 v8, s[96:99], s82 offen offset:1024 sc1 lds
    v_fmac_f32 v27, v71, v71
    v_lshlrev_b32 v40, 16, v36
    v_and_b32 v41, 0xffff0000, v36
    v_lshlrev_b32 v42, 16, v37
    v_and_b32 v43, 0xffff0000, v37
    v_mul_f32 v56, v40, v40
    v_mul_f32 v57, v41, v41
    v_mul_f32 v58, v42, v42
    v_mul_f32 v59, v43, v43
    v_fma_f32 v56, v56, v13, v12
    v_fma_f32 v57, v57, v13, v12
    v_fma_f32 v58, v58, v13, v12
    v_fma_f32 v59, v59, v13, v12
    v_mul_f32 v56, v56, v40
    v_mul_f32 v57, v57, v41
    v_mul_f32 v58, v58, v42
    v_mul_f32 v59, v59, v43
    v_exp_f32 v56, v56
    v_exp_f32 v57, v57
    v_exp_f32 v58, v58
    v_exp_f32 v59, v59
    buffer_load_dwordx4 v8, s[96:99], s82 offen offset:2048 sc1 lds
    v_add_f32 v56, 1.0, v56
    v_add_f32 v57, 1.0, v57
    v_add_f32 v58, 1.0, v58
    v_add_f32 v59, 1.0, v59
    v_rcp_f32 v56, v56
    v_rcp_f32 v57, v57
    v_rcp_f32 v58, v58
    v_rcp_f32 v59, v59
    v_mul_f32 v60, v40, v56
    v_mul_f32 v61, v41, v57
    v_mul_f32 v62, v42, v58
    v_mul_f32 v63, v43, v59
    v_cvt_pk_bf16_f32 v92, v60, v61
    v_cvt_pk_bf16_f32 v93, v62, v63
    v_add_f32 v24, v24, v60
    v_fmac_f32 v25, v60, v60
    v_add_f32 v26, v26, v61
    v_fmac_f32 v27, v61, v61
    v_add_f32 v24, v24, v62
    v_fmac_f32 v25, v62, v62
    v_add_f32 v26, v26, v63
    buffer_load_dwordx4 v8, s[96:99], s82 offen offset:3072 sc1 lds
    v_fmac_f32 v27, v63, v63
    v_lshlrev_b32 v48, 16, v38
    v_and_b32 v49, 0xffff0000, v38
    v_lshlrev_b32 v50, 16, v39
    v_and_b32 v51, 0xffff0000, v39
    v_mul_f32 v64, v48, v48
    v_mul_f32 v65, v49, v49
    v_mul_f32 v66, v50, v50
    v_mul_f32 v67, v51, v51
    v_fma_f32 v64, v64, v13, v12
    v_fma_f32 v65, v65, v13, v12
    v_fma_f32 v66, v66, v13, v12
    v_fma_f32 v67, v67, v13, v12
    v_mul_f32 v64, v64, v48
    v_mul_f32 v65, v65, v49
    v_mul_f32 v66, v66, v50
    v_mul_f32 v67, v67, v51
    v_exp_f32 v64, v64
    v_exp_f32 v65, v65
    v_exp_f32 v66, v66
    v_exp_f32 v67, v67
    s_add_u32 m0, s76, 81920
    s_add_u32 s82, s82, 4096
    s_mov_b64 exec, s[78:79]
    buffer_load_dwordx4 v8, s[96:99], s82 offen sc1 lds
    s_mov_b64 exec, -1
    v_add_f32 v64, 1.0, v64
    v_add_f32 v65, 1.0, v65
    v_add_f32 v66, 1.0, v66
    v_add_f32 v67, 1.0, v67
    v_rcp_f32 v64, v64
    v_rcp_f32 v65, v65
    v_rcp_f32 v66, v66
    v_rcp_f32 v67, v67
    v_mul_f32 v68, v48, v64
    v_mul_f32 v69, v49, v65
    v_mul_f32 v70, v50, v66
    v_mul_f32 v71, v51, v67
    v_cvt_pk_bf16_f32 v94, v68, v69
    v_cvt_pk_bf16_f32 v95, v70, v71
    v_add_f32 v24, v24, v68
    v_fmac_f32 v25, v68, v68
    v_add_f32 v26, v26, v69
    v_fmac_f32 v27, v69, v69
    v_add_f32 v24, v24, v70
    v_fmac_f32 v25, v70, v70
    v_add_f32 v26, v26, v71
    v_fmac_f32 v27, v71, v71
    s_waitcnt vmcnt(10)
    s_barrier
    ds_read_b128 v[32:35], v7 offset:0
    ds_read_b128 v[36:39], v7 offset:1024
    s_add_u32 s82, s29, s77
    s_add_u32 m0, s77, 97280
    s_add_u32 s82, s82, 56320
    buffer_load_dwordx4 v8, s[96:99], s82 offen sc1 lds
    buffer_load_dwordx4 v8, s[96:99], s82 offen offset:1024 sc1 lds
    buffer_load_dwordx4 v8, s[96:99], s82 offen offset:2048 sc1 lds
    s_waitcnt lgkmcnt(0)
    v_lshlrev_b32 v40, 16, v32
    v_and_b32 v41, 0xffff0000, v32
    v_lshlrev_b32 v42, 16, v33
    v_and_b32 v43, 0xffff0000, v33
    v_mul_f32 v56, v40, v40
    v_mul_f32 v57, v41, v41
    v_mul_f32 v58, v42, v42
    v_mul_f32 v59, v43, v43
    v_fma_f32 v56, v56, v13, v12
    v_fma_f32 v57, v57, v13, v12
    v_fma_f32 v58, v58, v13, v12
    v_fma_f32 v59, v59, v13, v12
    v_mul_f32 v56, v56, v40
    v_mul_f32 v57, v57, v41
    v_mul_f32 v58, v58, v42
    v_mul_f32 v59, v59, v43
    v_exp_f32 v56, v56
    v_exp_f32 v57, v57
    v_exp_f32 v58, v58
    v_exp_f32 v59, v59
    buffer_load_dwordx4 v8, s[96:99], s82 offen offset:3072 sc1 lds
    v_add_f32 v56, 1.0, v56
    v_add_f32 v57, 1.0, v57
    v_add_f32 v58, 1.0, v58
    v_add_f32 v59, 1.0, v59
    v_rcp_f32 v56, v56
    v_rcp_f32 v57, v57
    v_rcp_f32 v58, v58
    v_rcp_f32 v59, v59
    v_mul_f32 v60, v40, v56
    v_mul_f32 v61, v41, v57
    v_mul_f32 v62, v42, v58
    v_mul_f32 v63, v43, v59
    v_cvt_pk_bf16_f32 v96, v60, v61
    v_cvt_pk_bf16_f32 v97, v62, v63
    v_add_f32 v24, v24, v60
    v_fmac_f32 v25, v60, v60
    v_add_f32 v26, v26, v61
    v_fmac_f32 v27, v61, v61
    v_add_f32 v24, v24, v62
    v_fmac_f32 v25, v62, v62
    v_add_f32 v26, v26, v63
    s_add_u32 m0, s77, 101376
    s_add_u32 s82, s82, 4096
    s_mov_b64 exec, s[80:81]
    buffer_load_dwordx4 v8, s[96:99], s82 offen sc1 lds
    s_mov_b64 exec, -1
    v_fmac_f32 v27, v63, v63
    v_lshlrev_b32 v48, 16, v34
    v_and_b32 v49, 0xffff0000, v34
    v_lshlrev_b32 v50, 16, v35
    v_and_b32 v51, 0xffff0000, v35
    v_mul_f32 v64, v48, v48
    v_mul_f32 v65, v49, v49
    v_mul_f32 v66, v50, v50
    v_mul_f32 v67, v51, v51
    v_fma_f32 v64, v64, v13, v12
    v_fma_f32 v65, v65, v13, v12
    v_fma_f32 v66, v66, v13, v12
    v_fma_f32 v67, v67, v13, v12
    v_mul_f32 v64, v64, v48
    v_mul_f32 v65, v65, v49
    v_mul_f32 v66, v66, v50
    v_mul_f32 v67, v67, v51
    v_exp_f32 v64, v64
    v_exp_f32 v65, v65
    v_exp_f32 v66, v66
    v_exp_f32 v67, v67
    s_add_u32 s82, s29, s76
    s_add_u32 m0, s76, 0
    s_add_u32 s82, s82, 75776
    buffer_load_dwordx4 v8, s[96:99], s82 offen sc1 lds
    v_add_f32 v64, 1.0, v64
    v_add_f32 v65, 1.0, v65
    v_add_f32 v66, 1.0, v66
    v_add_f32 v67, 1.0, v67
    v_rcp_f32 v64, v64
    v_rcp_f32 v65, v65
    v_rcp_f32 v66, v66
    v_rcp_f32 v67, v67
    v_mul_f32 v68, v48, v64
    v_mul_f32 v69, v49, v65
    v_mul_f32 v70, v50, v66
    v_mul_f32 v71, v51, v67
    v_cvt_pk_bf16_f32 v98, v68, v69
    v_cvt_pk_bf16_f32 v99, v70, v71
    v_add_f32 v24, v24, v68
    v_fmac_f32 v25, v68, v68
    v_add_f32 v26, v26, v69
    v_fmac_f32 v27, v69, v69
    v_add_f32 v24, v24, v70
    v_fmac_f32 v25, v70, v70
    v_add_f32 v26, v26, v71
    buffer_load_dwordx4 v8, s[96:99], s82 offen offset:1024 sc1 lds
    v_fmac_f32 v27, v71, v71
    v_lshlrev_b32 v40, 16, v36
    v_and_b32 v41, 0xffff0000, v36
    v_lshlrev_b32 v42, 16, v37
    v_and_b32 v43, 0xffff0000, v37
    v_mul_f32 v56, v40, v40
    v_mul_f32 v57, v41, v41
    v_mul_f32 v58, v42, v42
    v_mul_f32 v59, v43, v43
    v_fma_f32 v56, v56, v13, v12
    v_fma_f32 v57, v57, v13, v12
    v_fma_f32 v58, v58, v13, v12
    v_fma_f32 v59, v59, v13, v12
    v_mul_f32 v56, v56, v40
    v_mul_f32 v57, v57, v41
    v_mul_f32 v58, v58, v42
    v_mul_f32 v59, v59, v43
    v_exp_f32 v56, v56
    v_exp_f32 v57, v57
    v_exp_f32 v58, v58
    v_exp_f32 v59, v59
    buffer_load_dwordx4 v8, s[96:99], s82 offen offset:2048 sc1 lds
    v_add_f32 v56, 1.0, v56
    v_add_f32 v57, 1.0, v57
    v_add_f32 v58, 1.0, v58
    v_add_f32 v59, 1.0, v59
    v_rcp_f32 v56, v56
    v_rcp_f32 v57, v57
    v_rcp_f32 v58, v58
    v_rcp_f32 v59, v59
    v_mul_f32 v60, v40, v56
    v_mul_f32 v61, v41, v57
    v_mul_f32 v62, v42, v58
    v_mul_f32 v63, v43, v59
    v_cvt_pk_bf16_f32 v100, v60, v61
    v_cvt_pk_bf16_f32 v101, v62, v63
    v_add_f32 v24, v24, v60
    v_fmac_f32 v25, v60, v60
    v_add_f32 v26, v26, v61
    v_fmac_f32 v27, v61, v61
    v_add_f32 v24, v24, v62
    v_fmac_f32 v25, v62, v62
    v_add_f32 v26, v26, v63
    buffer_load_dwordx4 v8, s[96:99], s82 offen offset:3072 sc1 lds
    v_fmac_f32 v27, v63, v63
    v_lshlrev_b32 v48, 16, v38
    v_and_b32 v49, 0xffff0000, v38
    v_lshlrev_b32 v50, 16, v39
    v_and_b32 v51, 0xffff0000, v39
    v_mul_f32 v64, v48, v48
    v_mul_f32 v65, v49, v49
    v_mul_f32 v66, v50, v50
    v_mul_f32 v67, v51, v51
    v_fma_f32 v64, v64, v13, v12
    v_fma_f32 v65, v65, v13, v12
    v_fma_f32 v66, v66, v13, v12
    v_fma_f32 v67, v67, v13, v12
    v_mul_f32 v64, v64, v48
    v_mul_f32 v65, v65, v49
    v_mul_f32 v66, v66, v50
    v_mul_f32 v67, v67, v51
    v_exp_f32 v64, v64
    v_exp_f32 v65, v65
    v_exp_f32 v66, v66
    v_exp_f32 v67, v67
    s_add_u32 m0, s76, 4096
    s_add_u32 s82, s82, 4096
    s_mov_b64 exec, s[78:79]
    buffer_load_dwordx4 v8, s[96:99], s82 offen sc1 lds
    s_mov_b64 exec, -1
    v_add_f32 v64, 1.0, v64
    v_add_f32 v65, 1.0, v65
    v_add_f32 v66, 1.0, v66
    v_add_f32 v67, 1.0, v67
    v_rcp_f32 v64, v64
    v_rcp_f32 v65, v65
    v_rcp_f32 v66, v66
    v_rcp_f32 v67, v67
    v_mul_f32 v68, v48, v64
    v_mul_f32 v69, v49, v65
    v_mul_f32 v70, v50, v66
    v_mul_f32 v71, v51, v67
    v_cvt_pk_bf16_f32 v102, v68, v69
    v_cvt_pk_bf16_f32 v103, v70, v71
    v_add_f32 v24, v24, v68
    v_fmac_f32 v25, v68, v68
    v_add_f32 v26, v26, v69
    v_fmac_f32 v27, v69, v69
    v_add_f32 v24, v24, v70
    v_fmac_f32 v25, v70, v70
    v_add_f32 v26, v26, v71
    v_fmac_f32 v27, v71, v71
    s_waitcnt vmcnt(10)
    s_barrier
    ds_read_b128 v[32:35], v7 offset:8192
    ds_read_b128 v[36:39], v7 offset:9216
    s_add_u32 s82, s29, s77
    s_add_u32 m0, s77, 19456
    s_add_u32 s82, s82, 94208
    buffer_load_dwordx4 v8, s[96:99], s82 offen sc1 lds
    buffer_load_dwordx4 v8, s[96:99], s82 offen offset:1024 sc1 lds
    buffer_load_dwordx4 v8, s[96:99], s82 offen offset:2048 sc1 lds
    s_waitcnt lgkmcnt(0)
    v_lshlrev_b32 v40, 16, v32
    v_and_b32 v41, 0xffff0000, v32
    v_lshlrev_b32 v42, 16, v33
    v_and_b32 v43, 0xffff0000, v33
    v_mul_f32 v56, v40, v40
    v_mul_f32 v57, v41, v41
    v_mul_f32 v58, v42, v42
    v_mul_f32 v59, v43, v43
    v_fma_f32 v56, v56, v13, v12
    v_fma_f32 v57, v57, v13, v12
    v_fma_f32 v58, v58, v13, v12
    v_fma_f32 v59, v59, v13, v12
    v_mul_f32 v56, v56, v40
    v_mul_f32 v57, v57, v41
    v_mul_f32 v58, v58, v42
    v_mul_f32 v59, v59, v43
    v_exp_f32 v56, v56
    v_exp_f32 v57, v57
    v_exp_f32 v58, v58
    v_exp_f32 v59, v59
    v_add_f32 v56, 1.0, v56
    buffer_load_dwordx4 v8, s[96:99], s82 offen offset:3072 sc1 lds
    v_add_f32 v57, 1.0, v57
    v_add_f32 v58, 1.0, v58
    v_add_f32 v59, 1.0, v59
    v_rcp_f32 v56, v56
    v_rcp_f32 v57, v57
    v_rcp_f32 v58, v58
    v_rcp_f32 v59, v59
    v_mul_f32 v60, v40, v56
    v_mul_f32 v61, v41, v57
    v_mul_f32 v62, v42, v58
    v_mul_f32 v63, v43, v59
    v_cvt_pk_bf16_f32 v104, v60, v61
    v_cvt_pk_bf16_f32 v105, v62, v63
    v_add_f32 v24, v24, v60
    v_fmac_f32 v25, v60, v60
    v_add_f32 v26, v26, v61
    v_fmac_f32 v27, v61, v61
    v_add_f32 v24, v24, v62
    v_fmac_f32 v25, v62, v62
    v_add_f32 v26, v26, v63
    v_fmac_f32 v27, v63, v63
    v_lshlrev_b32 v48, 16, v34
    s_add_u32 m0, s77, 23552
    s_add_u32 s82, s82, 4096
    s_mov_b64 exec, s[80:81]
    buffer_load_dwordx4 v8, s[96:99], s82 offen sc1 lds
    s_mov_b64 exec, -1
    v_and_b32 v49, 0xffff0000, v34
    v_lshlrev_b32 v50, 16, v35
    v_and_b32 v51, 0xffff0000, v35
    v_mul_f32 v64, v48, v48
    v_mul_f32 v65, v49, v49
    v_mul_f32 v66, v50, v50
    v_mul_f32 v67, v51, v51
    v_fma_f32 v64, v64, v13, v12
    v_fma_f32 v65, v65, v13, v12
    v_fma_f32 v66, v66, v13, v12
    v_fma_f32 v67, v67, v13, v12
    v_mul_f32 v64, v64, v48
    v_mul_f32 v65, v65, v49
    v_mul_f32 v66, v66, v50
    v_mul_f32 v67, v67, v51
    v_exp_f32 v64, v64
    v_exp_f32 v65, v65
    v_exp_f32 v66, v66
    v_exp_f32 v67, v67
    v_add_f32 v64, 1.0, v64
    v_add_f32 v65, 1.0, v65
    v_add_f32 v66, 1.0, v66
    s_add_u32 s82, s29, s76
    s_add_u32 m0, s76, 38912
    s_add_u32 s82, s82, 113664
    buffer_load_dwordx4 v8, s[96:99], s82 offen sc1 lds
    v_add_f32 v67, 1.0, v67
    v_rcp_f32 v64, v64
    v_rcp_f32 v65, v65
    v_rcp_f32 v66, v66
    v_rcp_f32 v67, v67
    v_mul_f32 v68, v48, v64
    v_mul_f32 v69, v49, v65
    v_mul_f32 v70, v50, v66
    v_mul_f32 v71, v51, v67
    v_cvt_pk_bf16_f32 v106, v68, v69
    v_cvt_pk_bf16_f32 v107, v70, v71
    v_add_f32 v24, v24, v68
    v_fmac_f32 v25, v68, v68
    v_add_f32 v26, v26, v69
    v_fmac_f32 v27, v69, v69
    v_add_f32 v24, v24, v70
    v_fmac_f32 v25, v70, v70
    v_add_f32 v26, v26, v71
    v_fmac_f32 v27, v71, v71
    v_lshlrev_b32 v40, 16, v36
    v_and_b32 v41, 0xffff0000, v36
    v_lshlrev_b32 v42, 16, v37
    buffer_load_dwordx4 v8, s[96:99], s82 offen offset:1024 sc1 lds
    v_and_b32 v43, 0xffff0000, v37
    v_mul_f32 v56, v40, v40
    v_mul_f32 v57, v41, v41
    v_mul_f32 v58, v42, v42
    v_mul_f32 v59, v43, v43
    v_fma_f32 v56, v56, v13, v12
    v_fma_f32 v57, v57, v13, v12
    v_fma_f32 v58, v58, v13, v12
    v_fma_f32 v59, v59, v13, v12
    v_mul_f32 v56, v56, v40
    v_mul_f32 v57, v57, v41
    v_mul_f32 v58, v58, v42
    v_mul_f32 v59, v59, v43
    v_exp_f32 v56, v56
    v_exp_f32 v57, v57
    v_exp_f32 v58, v58
    v_exp_f32 v59, v59
    v_add_f32 v56, 1.0, v56
    v_add_f32 v57, 1.0, v57
    v_add_f32 v58, 1.0, v58
    v_add_f32 v59, 1.0, v59
    v_rcp_f32 v56, v56
    buffer_load_dwordx4 v8, s[96:99], s82 offen offset:2048 sc1 lds
    v_rcp_f32 v57, v57
    v_rcp_f32 v58, v58
    v_rcp_f32 v59, v59
    v_mul_f32 v60, v40, v56
    v_mul_f32 v61, v41, v57
    v_mul_f32 v62, v42, v58
    v_mul_f32 v63, v43, v59
    v_cvt_pk_bf16_f32 v108, v60, v61
    v_cvt_pk_bf16_f32 v109, v62, v63
    v_add_f32 v24, v24, v60
    v_fmac_f32 v25, v60, v60
    v_add_f32 v26, v26, v61
    v_fmac_f32 v27, v61, v61
    v_add_f32 v24, v24, v62
    v_fmac_f32 v25, v62, v62
    v_add_f32 v26, v26, v63
    v_fmac_f32 v27, v63, v63
    v_lshlrev_b32 v48, 16, v38
    v_and_b32 v49, 0xffff0000, v38
    v_lshlrev_b32 v50, 16, v39
    v_and_b32 v51, 0xffff0000, v39
    v_mul_f32 v64, v48, v48
    buffer_load_dwordx4 v8, s[96:99], s82 offen offset:3072 sc1 lds
    v_mul_f32 v65, v49, v49
    v_mul_f32 v66, v50, v50
    v_mul_f32 v67, v51, v51
    v_fma_f32 v64, v64, v13, v12
    v_fma_f32 v65, v65, v13, v12
    v_fma_f32 v66, v66, v13, v12
    v_fma_f32 v67, v67, v13, v12
    v_mul_f32 v64, v64, v48
    v_mul_f32 v65, v65, v49
    v_mul_f32 v66, v66, v50
    v_mul_f32 v67, v67, v51
    v_exp_f32 v64, v64
    v_exp_f32 v65, v65
    v_exp_f32 v66, v66
    v_exp_f32 v67, v67
    v_add_f32 v64, 1.0, v64
    v_add_f32 v65, 1.0, v65
    v_add_f32 v66, 1.0, v66
    v_add_f32 v67, 1.0, v67
    v_rcp_f32 v64, v64
    v_rcp_f32 v65, v65
    v_rcp_f32 v66, v66
    s_add_u32 m0, s76, 43008
    s_add_u32 s82, s82, 4096
    s_mov_b64 exec, s[78:79]
    buffer_load_dwordx4 v8, s[96:99], s82 offen sc1 lds
    s_mov_b64 exec, -1
    v_rcp_f32 v67, v67
    v_mul_f32 v68, v48, v64
    v_mul_f32 v69, v49, v65
    v_mul_f32 v70, v50, v66
    v_mul_f32 v71, v51, v67
    v_cvt_pk_bf16_f32 v110, v68, v69
    v_cvt_pk_bf16_f32 v111, v70, v71
    v_add_f32 v24, v24, v68
    v_fmac_f32 v25, v68, v68
    v_add_f32 v26, v26, v69
    v_fmac_f32 v27, v69, v69
    v_add_f32 v24, v24, v70
    v_fmac_f32 v25, v70, v70
    v_add_f32 v26, v26, v71
    v_fmac_f32 v27, v71, v71
    v_add_f32 v24, v24, v26
    v_add_f32 v25, v25, v27
    v_mov_b32 v26, v24
    v_mov_b32 v27, v25
    s_nop 1
    v_permlane32_swap_b32 v24, v26
    v_permlane32_swap_b32 v25, v27
    s_nop 1
    v_add_f32 v24, v24, v26
    v_add_f32 v25, v25, v27
    v_xor_b32 v26, v24, v25
    v_xor_b32 v26, s100, v26
    s_mov_b64 exec, s[78:79]
    buffer_store_dwordx4 v[24:27], v8, s[96:99], s39 offen sc1
    s_mov_b64 exec, -1
    s_waitcnt vmcnt(11)
    s_barrier
    ds_read_b128 v[200:203], v18 offset:0
    ds_read_b128 v[220:223], v18 offset:256
    s_add_u32 s82, s29, s77
    s_add_u32 m0, s77, 58368
    s_add_u32 s82, s82, 132096
    buffer_load_dwordx4 v8, s[96:99], s82 offen sc1 lds
    buffer_load_dwordx4 v8, s[96:99], s82 offen offset:1024 sc1 lds
    buffer_load_dwordx4 v8, s[96:99], s82 offen offset:2048 sc1 lds
    s_waitcnt lgkmcnt(0)
    v_lshlrev_b32 v40, 16, v200
    v_and_b32 v41, 0xffff0000, v200
    v_lshlrev_b32 v42, 16, v201
    v_and_b32 v43, 0xffff0000, v201
    v_mul_f32 v56, v40, v40
    v_mul_f32 v57, v41, v41
    v_mul_f32 v58, v42, v42
    v_mul_f32 v59, v43, v43
    v_fma_f32 v56, v56, v13, v12
    v_fma_f32 v57, v57, v13, v12
    v_fma_f32 v58, v58, v13, v12
    v_fma_f32 v59, v59, v13, v12
    v_mul_f32 v56, v56, v40
    v_mul_f32 v57, v57, v41
    v_mul_f32 v58, v58, v42
    v_mul_f32 v59, v59, v43
    buffer_load_dwordx4 v8, s[96:99], s82 offen offset:3072 sc1 lds
    v_exp_f32 v56, v56
    v_exp_f32 v57, v57
    v_exp_f32 v58, v58
    v_exp_f32 v59, v59
    v_add_f32 v56, 1.0, v56
    v_add_f32 v57, 1.0, v57
    v_add_f32 v58, 1.0, v58
    v_add_f32 v59, 1.0, v59
    v_rcp_f32 v56, v56
    v_rcp_f32 v57, v57
    v_rcp_f32 v58, v58
    v_rcp_f32 v59, v59
    v_mul_f32 v40, v40, v56
    v_mul_f32 v41, v41, v57
    v_mul_f32 v42, v42, v58
    v_mul_f32 v43, v43, v59
    v_cvt_pk_bf16_f32 v200, v40, v41
    s_add_u32 m0, s77, 62464
    s_add_u32 s82, s82, 4096
    s_mov_b64 exec, s[80:81]
    buffer_load_dwordx4 v8, s[96:99], s82 offen sc1 lds
    s_mov_b64 exec, -1
    v_cvt_pk_bf16_f32 v201, v42, v43
    v_lshlrev_b32 v48, 16, v220
    v_and_b32 v49, 0xffff0000, v220
    v_lshlrev_b32 v50, 16, v221
    v_and_b32 v51, 0xffff0000, v221
    v_mul_f32 v64, v48, v48
    v_mul_f32 v65, v49, v49
    v_mul_f32 v66, v50, v50
    v_mul_f32 v67, v51, v51
    v_fma_f32 v64, v64, v13, v12
    v_fma_f32 v65, v65, v13, v12
    v_fma_f32 v66, v66, v13, v12
    v_fma_f32 v67, v67, v13, v12
    v_mul_f32 v64, v64, v48
    v_mul_f32 v65, v65, v49
    v_mul_f32 v66, v66, v50
    v_mul_f32 v67, v67, v51
    s_add_u32 s82, s29, s76
    s_add_u32 m0, s76, 77824
    s_add_u32 s82, s82, 151552
    buffer_load_dwordx4 v8, s[96:99], s82 offen sc1 lds
    v_exp_f32 v64, v64
    v_exp_f32 v65, v65
    v_exp_f32 v66, v66
    v_exp_f32 v67, v67
    v_add_f32 v64, 1.0, v64
    v_add_f32 v65, 1.0, v65
    v_add_f32 v66, 1.0, v66
    v_add_f32 v67, 1.0, v67
    v_rcp_f32 v64, v64
    v_rcp_f32 v65, v65
    v_rcp_f32 v66, v66
    v_rcp_f32 v67, v67
    v_mul_f32 v48, v48, v64
    v_mul_f32 v49, v49, v65
    v_mul_f32 v50, v50, v66
    v_mul_f32 v51, v51, v67
    v_cvt_pk_bf16_f32 v220, v48, v49
    buffer_load_dwordx4 v8, s[96:99], s82 offen offset:1024 sc1 lds
    v_cvt_pk_bf16_f32 v221, v50, v51
    v_lshlrev_b32 v40, 16, v202
    v_and_b32 v41, 0xffff0000, v202
    v_lshlrev_b32 v42, 16, v203
    v_and_b32 v43, 0xffff0000, v203
    v_mul_f32 v56, v40, v40
    v_mul_f32 v57, v41, v41
    v_mul_f32 v58, v42, v42
    v_mul_f32 v59, v43, v43
    v_fma_f32 v56, v56, v13, v12
    v_fma_f32 v57, v57, v13, v12
    v_fma_f32 v58, v58, v13, v12
    v_fma_f32 v59, v59, v13, v12
    v_mul_f32 v56, v56, v40
    v_mul_f32 v57, v57, v41
    v_mul_f32 v58, v58, v42
    v_mul_f32 v59, v59, v43
    buffer_load_dwordx4 v8, s[96:99], s82 offen offset:2048 sc1 lds
    v_exp_f32 v56, v56
    v_exp_f32 v57, v57
    v_exp_f32 v58, v58
    v_exp_f32 v59, v59
    v_add_f32 v56, 1.0, v56
    v_add_f32 v57, 1.0, v57
    v_add_f32 v58, 1.0, v58
    v_add_f32 v59, 1.0, v59
    v_rcp_f32 v56, v56
    v_rcp_f32 v57, v57
    v_rcp_f32 v58, v58
    v_rcp_f32 v59, v59
    v_mul_f32 v40, v40, v56
    v_mul_f32 v41, v41, v57
    v_mul_f32 v42, v42, v58
    v_mul_f32 v43, v43, v59
    v_cvt_pk_bf16_f32 v202, v40, v41
    buffer_load_dwordx4 v8, s[96:99], s82 offen offset:3072 sc1 lds
    v_cvt_pk_bf16_f32 v203, v42, v43
    v_lshlrev_b32 v48, 16, v222
    v_and_b32 v49, 0xffff0000, v222
    v_lshlrev_b32 v50, 16, v223
    v_and_b32 v51, 0xffff0000, v223
    v_mul_f32 v64, v48, v48
    v_mul_f32 v65, v49, v49
    v_mul_f32 v66, v50, v50
    v_mul_f32 v67, v51, v51
    v_fma_f32 v64, v64, v13, v12
    v_fma_f32 v65, v65, v13, v12
    v_fma_f32 v66, v66, v13, v12
    v_fma_f32 v67, v67, v13, v12
    v_mul_f32 v64, v64, v48
    v_mul_f32 v65, v65, v49
    v_mul_f32 v66, v66, v50
    v_mul_f32 v67, v67, v51
    s_add_u32 m0, s76, 81920
    s_add_u32 s82, s82, 4096
    s_mov_b64 exec, s[78:79]
    buffer_load_dwordx4 v8, s[96:99], s82 offen sc1 lds
    s_mov_b64 exec, -1
    v_exp_f32 v64, v64
    v_exp_f32 v65, v65
    v_exp_f32 v66, v66
    v_exp_f32 v67, v67
    v_add_f32 v64, 1.0, v64
    v_add_f32 v65, 1.0, v65
    v_add_f32 v66, 1.0, v66
    v_add_f32 v67, 1.0, v67
    v_rcp_f32 v64, v64
    v_rcp_f32 v65, v65
    v_rcp_f32 v66, v66
    v_rcp_f32 v67, v67
    v_mul_f32 v48, v48, v64
    v_mul_f32 v49, v49, v65
    v_mul_f32 v50, v50, v66
    v_mul_f32 v51, v51, v67
    v_cvt_pk_bf16_f32 v222, v48, v49
    v_cvt_pk_bf16_f32 v223, v50, v51
    s_waitcnt vmcnt(11)
    s_barrier
    ds_read_b128 v[204:207], v18 offset:8192
    ds_read_b128 v[224:227], v18 offset:8448
    s_add_u32 s82, s29, s77
    s_add_u32 m0, s77, 97280
    s_add_u32 s82, s82, 169984
    buffer_load_dwordx4 v8, s[96:99], s82 offen sc1 lds
    buffer_load_dwordx4 v8, s[96:99], s82 offen offset:1024 sc1 lds
    buffer_load_dwordx4 v8, s[96:99], s82 offen offset:2048 sc1 lds
    s_waitcnt lgkmcnt(0)
    v_lshlrev_b32 v40, 16, v204
    v_and_b32 v41, 0xffff0000, v204
    v_lshlrev_b32 v42, 16, v205
    v_and_b32 v43, 0xffff0000, v205
    v_mul_f32 v56, v40, v40
    v_mul_f32 v57, v41, v41
    v_mul_f32 v58, v42, v42
    v_mul_f32 v59, v43, v43
    v_fma_f32 v56, v56, v13, v12
    v_fma_f32 v57, v57, v13, v12
    v_fma_f32 v58, v58, v13, v12
    buffer_load_dwordx4 v8, s[96:99], s82 offen offset:3072 sc1 lds
    v_fma_f32 v59, v59, v13, v12
    v_mul_f32 v56, v56, v40
    v_mul_f32 v57, v57, v41
    v_mul_f32 v58, v58, v42
    v_mul_f32 v59, v59, v43
    v_exp_f32 v56, v56
    v_exp_f32 v57, v57
    v_exp_f32 v58, v58
    v_exp_f32 v59, v59
    v_add_f32 v56, 1.0, v56
    v_add_f32 v57, 1.0, v57
    v_add_f32 v58, 1.0, v58
    s_add_u32 m0, s77, 101376
    s_add_u32 s82, s82, 4096
    s_mov_b64 exec, s[80:81]
    buffer_load_dwordx4 v8, s[96:99], s82 offen sc1 lds
    s_mov_b64 exec, -1
    v_add_f32 v59, 1.0, v59
    v_rcp_f32 v56, v56
    v_rcp_f32 v57, v57
    v_rcp_f32 v58, v58
    v_rcp_f32 v59, v59
    v_mul_f32 v40, v40, v56
    v_mul_f32 v41, v41, v57
    v_mul_f32 v42, v42, v58
    v_mul_f32 v43, v43, v59
    v_cvt_pk_bf16_f32 v204, v40, v41
    v_cvt_pk_bf16_f32 v205, v42, v43
    v_lshlrev_b32 v48, 16, v224
    buffer_load_dwordx4 v[128:131], v8, s[96:99], s37 offen offset:0 sc1
    v_and_b32 v49, 0xffff0000, v224
    v_lshlrev_b32 v50, 16, v225
    v_and_b32 v51, 0xffff0000, v225
    v_mul_f32 v64, v48, v48
    v_mul_f32 v65, v49, v49
    v_mul_f32 v66, v50, v50
    v_mul_f32 v67, v51, v51
    v_fma_f32 v64, v64, v13, v12
    v_fma_f32 v65, v65, v13, v12
    v_fma_f32 v66, v66, v13, v12
    v_fma_f32 v67, v67, v13, v12
    v_mul_f32 v64, v64, v48
    buffer_load_dwordx4 v[132:135], v8, s[96:99], s37 offen offset:1024 sc1
    v_mul_f32 v65, v65, v49
    v_mul_f32 v66, v66, v50
    v_mul_f32 v67, v67, v51
    v_exp_f32 v64, v64
    v_exp_f32 v65, v65
    v_exp_f32 v66, v66
    v_exp_f32 v67, v67
    v_add_f32 v64, 1.0, v64
    v_add_f32 v65, 1.0, v65
    v_add_f32 v66, 1.0, v66
    v_add_f32 v67, 1.0, v67
    v_rcp_f32 v64, v64
    buffer_load_dwordx4 v[136:139], v8, s[96:99], s37 offen offset:2048 sc1
    v_rcp_f32 v65, v65
    v_rcp_f32 v66, v66
    v_rcp_f32 v67, v67
    v_mul_f32 v48, v48, v64
    v_mul_f32 v49, v49, v65
    v_mul_f32 v50, v50, v66
    v_mul_f32 v51, v51, v67
    v_cvt_pk_bf16_f32 v224, v48, v49
    v_cvt_pk_bf16_f32 v225, v50, v51
    v_lshlrev_b32 v40, 16, v206
    v_and_b32 v41, 0xffff0000, v206
    v_lshlrev_b32 v42, 16, v207
    buffer_load_dwordx4 v[140:143], v8, s[96:99], s37 offen offset:3072 sc1
    v_and_b32 v43, 0xffff0000, v207
    v_mul_f32 v56, v40, v40
    v_mul_f32 v57, v41, v41
    v_mul_f32 v58, v42, v42
    v_mul_f32 v59, v43, v43
    v_fma_f32 v56, v56, v13, v12
    v_fma_f32 v57, v57, v13, v12
    v_fma_f32 v58, v58, v13, v12
    v_fma_f32 v59, v59, v13, v12
    v_mul_f32 v56, v56, v40
    v_mul_f32 v57, v57, v41
    v_mul_f32 v58, v58, v42
    buffer_load_dwordx4 v[144:147], v8, s[96:99], s38 offen offset:0 sc1
    v_mul_f32 v59, v59, v43
    v_exp_f32 v56, v56
    v_exp_f32 v57, v57
    v_exp_f32 v58, v58
    v_exp_f32 v59, v59
    v_add_f32 v56, 1.0, v56
    v_add_f32 v57, 1.0, v57
    v_add_f32 v58, 1.0, v58
    v_add_f32 v59, 1.0, v59
    v_rcp_f32 v56, v56
    v_rcp_f32 v57, v57
    v_rcp_f32 v58, v58
    buffer_load_dwordx4 v[148:151], v8, s[96:99], s38 offen offset:1024 sc1
    v_rcp_f32 v59, v59
    v_mul_f32 v40, v40, v56
    v_mul_f32 v41, v41, v57
    v_mul_f32 v42, v42, v58
    v_mul_f32 v43, v43, v59
    v_cvt_pk_bf16_f32 v206, v40, v41
    v_cvt_pk_bf16_f32 v207, v42, v43
    v_lshlrev_b32 v48, 16, v226
    v_and_b32 v49, 0xffff0000, v226
    v_lshlrev_b32 v50, 16, v227
    v_and_b32 v51, 0xffff0000, v227
    v_mul_f32 v64, v48, v48
    buffer_load_dwordx4 v[152:155], v8, s[96:99], s38 offen offset:2048 sc1
    v_mul_f32 v65, v49, v49
    v_mul_f32 v66, v50, v50
    v_mul_f32 v67, v51, v51
    v_fma_f32 v64, v64, v13, v12
    v_fma_f32 v65, v65, v13, v12
    v_fma_f32 v66, v66, v13, v12
    v_fma_f32 v67, v67, v13, v12
    v_mul_f32 v64, v64, v48
    v_mul_f32 v65, v65, v49
    v_mul_f32 v66, v66, v50
    v_mul_f32 v67, v67, v51
    v_exp_f32 v64, v64
    buffer_load_dwordx4 v[156:159], v8, s[96:99], s38 offen offset:3072 sc1
    v_exp_f32 v65, v65
    v_exp_f32 v66, v66
    v_exp_f32 v67, v67
    v_add_f32 v64, 1.0, v64
    v_add_f32 v65, 1.0, v65
    v_add_f32 v66, 1.0, v66
    v_add_f32 v67, 1.0, v67
    v_rcp_f32 v64, v64
    v_rcp_f32 v65, v65
    v_rcp_f32 v66, v66
    v_rcp_f32 v67, v67
    v_mul_f32 v48, v48, v64
    v_mul_f32 v49, v49, v65
    v_mul_f32 v50, v50, v66
    v_mul_f32 v51, v51, v67
    v_cvt_pk_bf16_f32 v226, v48, v49
    v_cvt_pk_bf16_f32 v227, v50, v51
    s_waitcnt vmcnt(8)
    s_barrier
    ds_read_b128 v[208:211], v18 offset:0
    ds_read_b128 v[228:231], v18 offset:256
    s_setprio 2
    s_mov_b32 s90, 0
    s_branch Lzck34
Lzp32:
    buffer_load_dwordx4 v[128:131], v8, s[96:99], s37 offen offset:0 sc1
    buffer_load_dwordx4 v[132:135], v8, s[96:99], s37 offen offset:1024 sc1
    buffer_load_dwordx4 v[136:139], v8, s[96:99], s37 offen offset:2048 sc1
    buffer_load_dwordx4 v[140:143], v8, s[96:99], s37 offen offset:3072 sc1
    buffer_load_dwordx4 v[144:147], v8, s[96:99], s38 offen offset:0 sc1
    buffer_load_dwordx4 v[148:151], v8, s[96:99], s38 offen offset:1024 sc1
    buffer_load_dwordx4 v[152:155], v8, s[96:99], s38 offen offset:2048 sc1
    buffer_load_dwordx4 v[156:159], v8, s[96:99], s38 offen offset:3072 sc1
Lzck34:
    s_waitcnt vmcnt(0)
    v_xor_b32 v131, v128, v129
    v_xor_b32 v130, s100, v130
    v_xor_b32 v130, v130, v131
    v_xor_b32 v135, v132, v133
    v_xor_b32 v134, s100, v134
    v_xor_b32 v134, v134, v135
    v_or_b32 v130, v130, v134
    v_xor_b32 v139, v136, v137
    v_xor_b32 v138, s100, v138
    v_xor_b32 v138, v138, v139
    v_or_b32 v130, v130, v138
    v_xor_b32 v143, v140, v141
    v_xor_b32 v142, s100, v142
    v_xor_b32 v142, v142, v143
    v_or_b32 v130, v130, v142
    v_xor_b32 v147, v144, v145
    v_xor_b32 v146, s100, v146
    v_xor_b32 v146, v146, v147
    v_or_b32 v130, v130, v146
    v_xor_b32 v151, v148, v149
    v_xor_b32 v150, s100, v150
    v_xor_b32 v150, v150, v151
    v_or_b32 v130, v130, v150
    v_xor_b32 v155, v152, v153
    v_xor_b32 v154, s100, v154
    v_xor_b32 v154, v154, v155
    v_or_b32 v130, v130, v154
    v_xor_b32 v159, v156, v157
    v_xor_b32 v158, s100, v158
    v_xor_b32 v158, v158, v159
    v_or_b32 v130, v130, v158
    v_cmp_ne_u32 vcc, 0, v130
    s_add_u32 s90, s90, 1
    s_cmp_eq_u64 vcc, 0
    s_cbranch_scc1 Lzok33
    s_cmp_lt_u32 s90, 0x20000
    s_cbranch_scc1 Lzp32
Lzok33:
    v_add_f32 v128, v128, v144
    v_add_f32 v129, v129, v145
    v_add_f32 v132, v132, v148
    v_add_f32 v133, v133, v149
    v_add_f32 v136, v136, v152
    v_add_f32 v137, v137, v153
    v_add_f32 v140, v140, v156
    v_add_f32 v141, v141, v157
    v_add_f32 v128, v128, v136
    v_add_f32 v129, v129, v137
    v_add_f32 v132, v132, v140
    v_add_f32 v133, v133, v141
    v_add_f32 v128, v128, v132
    v_add_f32 v129, v129, v133
    v_mov_b32 v130, v128
    v_mov_b32 v131, v129
    s_nop 1
    v_permlane32_swap_b32 v128, v130
    v_permlane32_swap_b32 v129, v131
    s_nop 1
    v_add_f32 v128, v128, v130
    v_add_f32 v129, v129, v131
    v_mul_f32 v128, 0x39e38e39, v128
    v_mul_f32 v129, 0x39e38e39, v129
    v_fma_f32 v129, -v128, v128, v129
    v_max_f32 v129, 0, v129
    v_cvt_pk_bf16_f32 v130, v128, v128
    v_cvt_pk_bf16_f32 v131, v129, v129
    v_and_b32 v130, 0xffff0000, v130
    v_and_b32 v131, 0xffff0000, v131
    v_add_f32 v131, 0x3727c5ac, v131
    v_cvt_pk_bf16_f32 v131, v131, v131
    v_and_b32 v131, 0xffff0000, v131
    v_sqrt_f32 v131, v131
    s_nop 0
    v_cvt_pk_bf16_f32 v131, v131, v131
    v_and_b32 v131, 0xffff0000, v131
    v_rcp_f32 v132, v131
    s_nop 0
    v_mul_f32 v133, -v130, v132
    v_lshlrev_b32 v136, 16, v80
    v_and_b32 v137, 0xffff0000, v80
    v_lshlrev_b32 v138, 16, v81
    v_and_b32 v139, 0xffff0000, v81
    v_lshlrev_b32 v140, 16, v82
    v_and_b32 v141, 0xffff0000, v82
    v_lshlrev_b32 v142, 16, v83
    v_and_b32 v143, 0xffff0000, v83
    v_fma_f32 v136, v136, v132, v133
    v_fma_f32 v137, v137, v132, v133
    v_fma_f32 v138, v138, v132, v133
    v_fma_f32 v139, v139, v132, v133
    v_fma_f32 v140, v140, v132, v133
    v_fma_f32 v141, v141, v132, v133
    v_fma_f32 v142, v142, v132, v133
    v_fma_f32 v143, v143, v132, v133
    v_cvt_pk_bf16_f32 v80, v136, v137
    v_cvt_pk_bf16_f32 v81, v138, v139
    v_cvt_pk_bf16_f32 v82, v140, v141
    v_cvt_pk_bf16_f32 v83, v142, v143
    ds_write_b64 v9, v[80:81] offset:0
    ds_write_b64 v9, v[82:83] offset:1024
    v_lshlrev_b32 v144, 16, v84
    v_and_b32 v145, 0xffff0000, v84
    v_lshlrev_b32 v146, 16, v85
    v_and_b32 v147, 0xffff0000, v85
    v_lshlrev_b32 v148, 16, v86
    v_and_b32 v149, 0xffff0000, v86
    v_lshlrev_b32 v150, 16, v87
    v_and_b32 v151, 0xffff0000, v87
    v_fma_f32 v144, v144, v132, v133
    v_fma_f32 v145, v145, v132, v133
    v_fma_f32 v146, v146, v132, v133
    v_fma_f32 v147, v147, v132, v133
    v_fma_f32 v148, v148, v132, v133
    v_fma_f32 v149, v149, v132, v133
    v_fma_f32 v150, v150, v132, v133
    v_fma_f32 v151, v151, v132, v133
    v_cvt_pk_bf16_f32 v84, v144, v145
    v_cvt_pk_bf16_f32 v85, v146, v147
    v_cvt_pk_bf16_f32 v86, v148, v149
    v_cvt_pk_bf16_f32 v87, v150, v151
    ds_write_b64 v9, v[84:85] offset:16
    ds_write_b64 v9, v[86:87] offset:1040
    ds_read_b64_tr_b16 v[160:161], v10 offset:0
    ds_read_b64_tr_b16 v[162:163], v10 offset:128
    ds_read_b64_tr_b16 v[164:165], v10 offset:1024
    ds_read_b64_tr_b16 v[166:167], v10 offset:1152
    v_lshlrev_b32 v136, 16, v88
    v_and_b32 v137, 0xffff0000, v88
    v_lshlrev_b32 v138, 16, v89
    v_and_b32 v139, 0xffff0000, v89
    v_lshlrev_b32 v140, 16, v90
    v_and_b32 v141, 0xffff0000, v90
    v_lshlrev_b32 v142, 16, v91
    v_and_b32 v143, 0xffff0000, v91
    v_fma_f32 v136, v136, v132, v133
    v_fma_f32 v137, v137, v132, v133
    v_fma_f32 v138, v138, v132, v133
    v_fma_f32 v139, v139, v132, v133
    v_fma_f32 v140, v140, v132, v133
    v_fma_f32 v141, v141, v132, v133
    v_fma_f32 v142, v142, v132, v133
    v_fma_f32 v143, v143, v132, v133
    v_cvt_pk_bf16_f32 v88, v136, v137
    v_cvt_pk_bf16_f32 v89, v138, v139
    v_cvt_pk_bf16_f32 v90, v140, v141
    v_cvt_pk_bf16_f32 v91, v142, v143
    ds_write_b64 v9, v[88:89] offset:2048
    ds_write_b64 v9, v[90:91] offset:3072
    v_lshlrev_b32 v144, 16, v92
    v_and_b32 v145, 0xffff0000, v92
    v_lshlrev_b32 v146, 16, v93
    v_and_b32 v147, 0xffff0000, v93
    v_lshlrev_b32 v148, 16, v94
    v_and_b32 v149, 0xffff0000, v94
    v_lshlrev_b32 v150, 16, v95
    v_and_b32 v151, 0xffff0000, v95
    v_fma_f32 v144, v144, v132, v133
    v_fma_f32 v145, v145, v132, v133
    v_fma_f32 v146, v146, v132, v133
    v_fma_f32 v147, v147, v132, v133
    v_fma_f32 v148, v148, v132, v133
    v_fma_f32 v149, v149, v132, v133
    v_fma_f32 v150, v150, v132, v133
    v_fma_f32 v151, v151, v132, v133
    v_cvt_pk_bf16_f32 v92, v144, v145
    v_cvt_pk_bf16_f32 v93, v146, v147
    v_cvt_pk_bf16_f32 v94, v148, v149
    v_cvt_pk_bf16_f32 v95, v150, v151
    ds_write_b64 v9, v[92:93] offset:2064
    ds_write_b64 v9, v[94:95] offset:3088
    ds_read_b64_tr_b16 v[168:169], v10 offset:2048
    ds_read_b64_tr_b16 v[170:171], v10 offset:2176
    ds_read_b64_tr_b16 v[172:173], v10 offset:3072
    ds_read_b64_tr_b16 v[174:175], v10 offset:3200
    s_waitcnt lgkmcnt(8)
    buffer_store_dwordx4 v[160:163], v8, s[96:99], s36 offen sc1
    buffer_store_dwordx4 v[164:167], v8, s[96:99], s36 offen offset:1024 sc1
    s_add_u32 s36, s36, 2048
    v_lshlrev_b32 v136, 16, v96
    v_and_b32 v137, 0xffff0000, v96
    v_lshlrev_b32 v138, 16, v97
    v_and_b32 v139, 0xffff0000, v97
    v_lshlrev_b32 v140, 16, v98
    v_and_b32 v141, 0xffff0000, v98
    v_lshlrev_b32 v142, 16, v99
    v_and_b32 v143, 0xffff0000, v99
    v_fma_f32 v136, v136, v132, v133
    v_fma_f32 v137, v137, v132, v133
    v_fma_f32 v138, v138, v132, v133
    v_fma_f32 v139, v139, v132, v133
    v_fma_f32 v140, v140, v132, v133
    v_fma_f32 v141, v141, v132, v133
    v_fma_f32 v142, v142, v132, v133
    v_fma_f32 v143, v143, v132, v133
    v_cvt_pk_bf16_f32 v96, v136, v137
    v_cvt_pk_bf16_f32 v97, v138, v139
    v_cvt_pk_bf16_f32 v98, v140, v141
    v_cvt_pk_bf16_f32 v99, v142, v143
    ds_write_b64 v9, v[96:97] offset:0
    ds_write_b64 v9, v[98:99] offset:1024
    v_lshlrev_b32 v144, 16, v100
    v_and_b32 v145, 0xffff0000, v100
    v_lshlrev_b32 v146, 16, v101
    v_and_b32 v147, 0xffff0000, v101
    v_lshlrev_b32 v148, 16, v102
    v_and_b32 v149, 0xffff0000, v102
    v_lshlrev_b32 v150, 16, v103
    v_and_b32 v151, 0xffff0000, v103
    v_fma_f32 v144, v144, v132, v133
    v_fma_f32 v145, v145, v132, v133
    v_fma_f32 v146, v146, v132, v133
    v_fma_f32 v147, v147, v132, v133
    v_fma_f32 v148, v148, v132, v133
    v_fma_f32 v149, v149, v132, v133
    v_fma_f32 v150, v150, v132, v133
    v_fma_f32 v151, v151, v132, v133
    v_cvt_pk_bf16_f32 v100, v144, v145
    v_cvt_pk_bf16_f32 v101, v146, v147
    v_cvt_pk_bf16_f32 v102, v148, v149
    v_cvt_pk_bf16_f32 v103, v150, v151
    ds_write_b64 v9, v[100:101] offset:16
    ds_write_b64 v9, v[102:103] offset:1040
    ds_read_b64_tr_b16 v[176:177], v10 offset:0
    ds_read_b64_tr_b16 v[178:179], v10 offset:128
    ds_read_b64_tr_b16 v[180:181], v10 offset:1024
    ds_read_b64_tr_b16 v[182:183], v10 offset:1152
    s_waitcnt lgkmcnt(8)
    buffer_store_dwordx4 v[168:171], v8, s[96:99], s36 offen sc1
    buffer_store_dwordx4 v[172:175], v8, s[96:99], s36 offen offset:1024 sc1
    s_add_u32 s36, s36, 2048
    v_lshlrev_b32 v136, 16, v104
    v_and_b32 v137, 0xffff0000, v104
    v_lshlrev_b32 v138, 16, v105
    v_and_b32 v139, 0xffff0000, v105
    v_lshlrev_b32 v140, 16, v106
    v_and_b32 v141, 0xffff0000, v106
    v_lshlrev_b32 v142, 16, v107
    v_and_b32 v143, 0xffff0000, v107
    v_fma_f32 v136, v136, v132, v133
    v_fma_f32 v137, v137, v132, v133
    v_fma_f32 v138, v138, v132, v133
    v_fma_f32 v139, v139, v132, v133
    v_fma_f32 v140, v140, v132, v133
    v_fma_f32 v141, v141, v132, v133
    v_fma_f32 v142, v142, v132, v133
    v_fma_f32 v143, v143, v132, v133
    v_cvt_pk_bf16_f32 v104, v136, v137
    v_cvt_pk_bf16_f32 v105, v138, v139
    v_cvt_pk_bf16_f32 v106, v140, v141
    v_cvt_pk_bf16_f32 v107, v142, v143
    ds_write_b64 v9, v[104:105] offset:2048
    ds_write_b64 v9, v[106:107] offset:3072
    v_lshlrev_b32 v144, 16, v108
    v_and_b32 v145, 0xffff0000, v108
    v_lshlrev_b32 v146, 16, v109
    v_and_b32 v147, 0xffff0000, v109
    v_lshlrev_b32 v148, 16, v110
    v_and_b32 v149, 0xffff0000, v110
    v_lshlrev_b32 v150, 16, v111
    v_and_b32 v151, 0xffff0000, v111
    v_fma_f32 v144, v144, v132, v133
    v_fma_f32 v145, v145, v132, v133
    v_fma_f32 v146, v146, v132, v133
    v_fma_f32 v147, v147, v132, v133
    v_fma_f32 v148, v148, v132, v133
    v_fma_f32 v149, v149, v132, v133
    v_fma_f32 v150, v150, v132, v133
    v_fma_f32 v151, v151, v132, v133
    v_cvt_pk_bf16_f32 v108, v144, v145
    v_cvt_pk_bf16_f32 v109, v146, v147
    v_cvt_pk_bf16_f32 v110, v148, v149
    v_cvt_pk_bf16_f32 v111, v150, v151
    ds_write_b64 v9, v[108:109] offset:2064
    ds_write_b64 v9, v[110:111] offset:3088
    ds_read_b64_tr_b16 v[184:185], v10 offset:2048
    ds_read_b64_tr_b16 v[186:187], v10 offset:2176
    ds_read_b64_tr_b16 v[188:189], v10 offset:3072
    ds_read_b64_tr_b16 v[190:191], v10 offset:3200
    s_waitcnt lgkmcnt(8)
    buffer_store_dwordx4 v[176:179], v8, s[96:99], s36 offen sc1
    buffer_store_dwordx4 v[180:183], v8, s[96:99], s36 offen offset:1024 sc1
    s_add_u32 s36, s36, 2048
    s_waitcnt lgkmcnt(0)
    buffer_store_dwordx4 v[184:187], v8, s[96:99], s36 offen sc1
    buffer_store_dwordx4 v[188:191], v8, s[96:99], s36 offen offset:1024 sc1
    s_add_u32 s36, s36, 2048
    s_or_b32 s47, s13, 1
    s_lshl_b32 s47, s47, 8
    s_lshl_b32 s46, s18, 2
    s_add_u32 s46, s46, s47
    s_add_u32 s46, s46, 49364992
    v_mov_b32 v20, 0
    v_lshlrev_b32 v40, 16, v208
    v_and_b32 v41, 0xffff0000, v208
    v_lshlrev_b32 v42, 16, v209
    v_and_b32 v43, 0xffff0000, v209
    v_mul_f32 v56, v40, v40
    v_mul_f32 v57, v41, v41
    v_mul_f32 v58, v42, v42
    v_mul_f32 v59, v43, v43
    v_fma_f32 v56, v56, v13, v12
    v_fma_f32 v57, v57, v13, v12
    v_fma_f32 v58, v58, v13, v12
    v_fma_f32 v59, v59, v13, v12
    v_mul_f32 v56, v56, v40
    v_mul_f32 v57, v57, v41
    v_mul_f32 v58, v58, v42
    v_mul_f32 v59, v59, v43
    v_exp_f32 v56, v56
    v_exp_f32 v57, v57
    v_exp_f32 v58, v58
    v_exp_f32 v59, v59
    v_add_f32 v56, 1.0, v56
    v_add_f32 v57, 1.0, v57
    v_add_f32 v58, 1.0, v58
    v_add_f32 v59, 1.0, v59
    v_rcp_f32 v56, v56
    v_rcp_f32 v57, v57
    v_rcp_f32 v58, v58
    v_rcp_f32 v59, v59
    v_mul_f32 v40, v40, v56
    v_mul_f32 v41, v41, v57
    v_mul_f32 v42, v42, v58
    v_mul_f32 v43, v43, v59
    v_cvt_pk_bf16_f32 v208, v40, v41
    v_cvt_pk_bf16_f32 v209, v42, v43
    v_lshlrev_b32 v48, 16, v228
    v_and_b32 v49, 0xffff0000, v228
    v_lshlrev_b32 v50, 16, v229
    v_and_b32 v51, 0xffff0000, v229
    v_mul_f32 v64, v48, v48
    v_mul_f32 v65, v49, v49
    v_mul_f32 v66, v50, v50
    v_mul_f32 v67, v51, v51
    v_fma_f32 v64, v64, v13, v12
    v_fma_f32 v65, v65, v13, v12
    v_fma_f32 v66, v66, v13, v12
    v_fma_f32 v67, v67, v13, v12
    v_mul_f32 v64, v64, v48
    v_mul_f32 v65, v65, v49
    v_mul_f32 v66, v66, v50
    v_mul_f32 v67, v67, v51
    v_exp_f32 v64, v64
    v_exp_f32 v65, v65
    v_exp_f32 v66, v66
    v_exp_f32 v67, v67
    v_add_f32 v64, 1.0, v64
    v_add_f32 v65, 1.0, v65
    v_add_f32 v66, 1.0, v66
    v_add_f32 v67, 1.0, v67
    v_rcp_f32 v64, v64
    v_rcp_f32 v65, v65
    v_rcp_f32 v66, v66
    v_rcp_f32 v67, v67
    v_mul_f32 v48, v48, v64
    v_mul_f32 v49, v49, v65
    v_mul_f32 v50, v50, v66
    v_mul_f32 v51, v51, v67
    v_cvt_pk_bf16_f32 v228, v48, v49
    v_cvt_pk_bf16_f32 v229, v50, v51
    v_lshlrev_b32 v40, 16, v210
    v_and_b32 v41, 0xffff0000, v210
    v_lshlrev_b32 v42, 16, v211
    v_and_b32 v43, 0xffff0000, v211
    v_mul_f32 v56, v40, v40
    v_mul_f32 v57, v41, v41
    v_mul_f32 v58, v42, v42
    v_mul_f32 v59, v43, v43
    v_fma_f32 v56, v56, v13, v12
    v_fma_f32 v57, v57, v13, v12
    v_fma_f32 v58, v58, v13, v12
    v_fma_f32 v59, v59, v13, v12
    v_mul_f32 v56, v56, v40
    v_mul_f32 v57, v57, v41
    v_mul_f32 v58, v58, v42
    v_mul_f32 v59, v59, v43
    v_exp_f32 v56, v56
    v_exp_f32 v57, v57
    v_exp_f32 v58, v58
    v_exp_f32 v59, v59
    v_add_f32 v56, 1.0, v56
    v_add_f32 v57, 1.0, v57
    v_add_f32 v58, 1.0, v58
    v_add_f32 v59, 1.0, v59
    v_rcp_f32 v56, v56
    v_rcp_f32 v57, v57
    v_rcp_f32 v58, v58
    v_rcp_f32 v59, v59
    v_mul_f32 v40, v40, v56
    v_mul_f32 v41, v41, v57
    v_mul_f32 v42, v42, v58
    v_mul_f32 v43, v43, v59
    v_cvt_pk_bf16_f32 v210, v40, v41
    v_cvt_pk_bf16_f32 v211, v42, v43
    v_lshlrev_b32 v48, 16, v230
    v_and_b32 v49, 0xffff0000, v230
    v_lshlrev_b32 v50, 16, v231
    v_and_b32 v51, 0xffff0000, v231
    v_mul_f32 v64, v48, v48
    v_mul_f32 v65, v49, v49
    v_mul_f32 v66, v50, v50
    v_mul_f32 v67, v51, v51
    v_fma_f32 v64, v64, v13, v12
    v_fma_f32 v65, v65, v13, v12
    v_fma_f32 v66, v66, v13, v12
    v_fma_f32 v67, v67, v13, v12
    v_mul_f32 v64, v64, v48
    v_mul_f32 v65, v65, v49
    v_mul_f32 v66, v66, v50
    v_mul_f32 v67, v67, v51
    v_exp_f32 v64, v64
    v_exp_f32 v65, v65
    v_exp_f32 v66, v66
    v_exp_f32 v67, v67
    v_add_f32 v64, 1.0, v64
    v_add_f32 v65, 1.0, v65
    v_add_f32 v66, 1.0, v66
    v_add_f32 v67, 1.0, v67
    v_rcp_f32 v64, v64
    v_rcp_f32 v65, v65
    v_rcp_f32 v66, v66
    v_rcp_f32 v67, v67
    v_mul_f32 v48, v48, v64
    v_mul_f32 v49, v49, v65
    v_mul_f32 v50, v50, v66
    v_mul_f32 v51, v51, v67
    v_cvt_pk_bf16_f32 v230, v48, v49
    v_cvt_pk_bf16_f32 v231, v50, v51
    v_mov_b32 v24, s100
    v_mov_b32 v25, 0
    s_waitcnt vmcnt(0)
    s_mov_b64 exec, 1
    buffer_store_dword v24, v25, s[96:99], s34 offen sc1
    s_mov_b64 exec, -1
    s_setprio 0
    s_barrier
    ds_read_b128 v[212:215], v16 offset:8192
    ds_read_b128 v[232:235], v16 offset:8448
    ds_read_b128 v[216:219], v16 offset:0
    ds_read_b128 v[236:239], v16 offset:256
    s_waitcnt lgkmcnt(0)
    s_barrier
    v_lshlrev_b32 v40, 16, v212
    v_and_b32 v41, 0xffff0000, v212
    v_lshlrev_b32 v42, 16, v213
    v_and_b32 v43, 0xffff0000, v213
    v_mul_f32 v56, v40, v40
    v_mul_f32 v57, v41, v41
    v_mul_f32 v58, v42, v42
    v_mul_f32 v59, v43, v43
    v_fma_f32 v56, v56, v13, v12
    v_fma_f32 v57, v57, v13, v12
    v_fma_f32 v58, v58, v13, v12
    v_fma_f32 v59, v59, v13, v12
    v_mul_f32 v56, v56, v40
    v_mul_f32 v57, v57, v41
    v_mul_f32 v58, v58, v42
    v_mul_f32 v59, v59, v43
    v_exp_f32 v56, v56
    v_exp_f32 v57, v57
    v_exp_f32 v58, v58
    v_exp_f32 v59, v59
    v_add_f32 v56, 1.0, v56
    v_add_f32 v57, 1.0, v57
    v_add_f32 v58, 1.0, v58
    v_add_f32 v59, 1.0, v59
    v_rcp_f32 v56, v56
    v_rcp_f32 v57, v57
    v_rcp_f32 v58, v58
    v_rcp_f32 v59, v59
    v_mul_f32 v40, v40, v56
    v_mul_f32 v41, v41, v57
    v_mul_f32 v42, v42, v58
    v_mul_f32 v43, v43, v59
    v_cvt_pk_bf16_f32 v212, v40, v41
    v_cvt_pk_bf16_f32 v213, v42, v43
    v_lshlrev_b32 v48, 16, v232
    v_and_b32 v49, 0xffff0000, v232
    v_lshlrev_b32 v50, 16, v233
    v_and_b32 v51, 0xffff0000, v233
    v_mul_f32 v64, v48, v48
    v_mul_f32 v65, v49, v49
    v_mul_f32 v66, v50, v50
    v_mul_f32 v67, v51, v51
    v_fma_f32 v64, v64, v13, v12
    v_fma_f32 v65, v65, v13, v12
    v_fma_f32 v66, v66, v13, v12
    v_fma_f32 v67, v67, v13, v12
    v_mul_f32 v64, v64, v48
    v_mul_f32 v65, v65, v49
    v_mul_f32 v66, v66, v50
    v_mul_f32 v67, v67, v51
    v_exp_f32 v64, v64
    v_exp_f32 v65, v65
    v_exp_f32 v66, v66
    v_exp_f32 v67, v67
    v_add_f32 v64, 1.0, v64
    v_add_f32 v65, 1.0, v65
    v_add_f32 v66, 1.0, v66
    v_add_f32 v67, 1.0, v67
    v_rcp_f32 v64, v64
    v_rcp_f32 v65, v65
    v_rcp_f32 v66, v66
    v_rcp_f32 v67, v67
    v_mul_f32 v48, v48, v64
    v_mul_f32 v49, v49, v65
    v_mul_f32 v50, v50, v66
    v_mul_f32 v51, v51, v67
    v_cvt_pk_bf16_f32 v232, v48, v49
    v_cvt_pk_bf16_f32 v233, v50, v51
    v_lshlrev_b32 v40, 16, v214
    v_and_b32 v41, 0xffff0000, v214
    v_lshlrev_b32 v42, 16, v215
    v_and_b32 v43, 0xffff0000, v215
    v_mul_f32 v56, v40, v40
    v_mul_f32 v57, v41, v41
    v_mul_f32 v58, v42, v42
    v_mul_f32 v59, v43, v43
    v_fma_f32 v56, v56, v13, v12
    v_fma_f32 v57, v57, v13, v12
    v_fma_f32 v58, v58, v13, v12
    v_fma_f32 v59, v59, v13, v12
    v_mul_f32 v56, v56, v40
    v_mul_f32 v57, v57, v41
    v_mul_f32 v58, v58, v42
    v_mul_f32 v59, v59, v43
    v_exp_f32 v56, v56
    v_exp_f32 v57, v57
    v_exp_f32 v58, v58
    v_exp_f32 v59, v59
    v_add_f32 v56, 1.0, v56
    v_add_f32 v57, 1.0, v57
    v_add_f32 v58, 1.0, v58
    v_add_f32 v59, 1.0, v59
    v_rcp_f32 v56, v56
    v_rcp_f32 v57, v57
    v_rcp_f32 v58, v58
    v_rcp_f32 v59, v59
    v_mul_f32 v40, v40, v56
    v_mul_f32 v41, v41, v57
    v_mul_f32 v42, v42, v58
    v_mul_f32 v43, v43, v59
    v_cvt_pk_bf16_f32 v214, v40, v41
    v_cvt_pk_bf16_f32 v215, v42, v43
    v_lshlrev_b32 v48, 16, v234
    v_and_b32 v49, 0xffff0000, v234
    v_lshlrev_b32 v50, 16, v235
    v_and_b32 v51, 0xffff0000, v235
    v_mul_f32 v64, v48, v48
    v_mul_f32 v65, v49, v49
    v_mul_f32 v66, v50, v50
    v_mul_f32 v67, v51, v51
    v_fma_f32 v64, v64, v13, v12
    v_fma_f32 v65, v65, v13, v12
    v_fma_f32 v66, v66, v13, v12
    v_fma_f32 v67, v67, v13, v12
    v_mul_f32 v64, v64, v48
    v_mul_f32 v65, v65, v49
    v_mul_f32 v66, v66, v50
    v_mul_f32 v67, v67, v51
    v_exp_f32 v64, v64
    v_exp_f32 v65, v65
    v_exp_f32 v66, v66
    v_exp_f32 v67, v67
    v_add_f32 v64, 1.0, v64
    v_add_f32 v65, 1.0, v65
    v_add_f32 v66, 1.0, v66
    v_add_f32 v67, 1.0, v67
    v_rcp_f32 v64, v64
    v_rcp_f32 v65, v65
    v_rcp_f32 v66, v66
    v_rcp_f32 v67, v67
    v_mul_f32 v48, v48, v64
    v_mul_f32 v49, v49, v65
    v_mul_f32 v50, v50, v66
    v_mul_f32 v51, v51, v67
    v_cvt_pk_bf16_f32 v234, v48, v49
    v_cvt_pk_bf16_f32 v235, v50, v51
    v_lshlrev_b32 v40, 16, v216
    v_and_b32 v41, 0xffff0000, v216
    v_lshlrev_b32 v42, 16, v217
    v_and_b32 v43, 0xffff0000, v217
    v_mul_f32 v56, v40, v40
    v_mul_f32 v57, v41, v41
    v_mul_f32 v58, v42, v42
    v_mul_f32 v59, v43, v43
    v_fma_f32 v56, v56, v13, v12
    v_fma_f32 v57, v57, v13, v12
    v_fma_f32 v58, v58, v13, v12
    v_fma_f32 v59, v59, v13, v12
    v_mul_f32 v56, v56, v40
    v_mul_f32 v57, v57, v41
    v_mul_f32 v58, v58, v42
    v_mul_f32 v59, v59, v43
    v_exp_f32 v56, v56
    v_exp_f32 v57, v57
    v_exp_f32 v58, v58
    v_exp_f32 v59, v59
    v_add_f32 v56, 1.0, v56
    v_add_f32 v57, 1.0, v57
    v_add_f32 v58, 1.0, v58
    v_add_f32 v59, 1.0, v59
    v_rcp_f32 v56, v56
    v_rcp_f32 v57, v57
    v_rcp_f32 v58, v58
    v_rcp_f32 v59, v59
    v_mul_f32 v40, v40, v56
    v_mul_f32 v41, v41, v57
    v_mul_f32 v42, v42, v58
    v_mul_f32 v43, v43, v59
    v_cvt_pk_bf16_f32 v216, v40, v41
    v_cvt_pk_bf16_f32 v217, v42, v43
    v_lshlrev_b32 v48, 16, v236
    v_and_b32 v49, 0xffff0000, v236
    v_lshlrev_b32 v50, 16, v237
    v_and_b32 v51, 0xffff0000, v237
    v_mul_f32 v64, v48, v48
    v_mul_f32 v65, v49, v49
    v_mul_f32 v66, v50, v50
    v_mul_f32 v67, v51, v51
    v_fma_f32 v64, v64, v13, v12
    v_fma_f32 v65, v65, v13, v12
    v_fma_f32 v66, v66, v13, v12
    v_fma_f32 v67, v67, v13, v12
    v_mul_f32 v64, v64, v48
    v_mul_f32 v65, v65, v49
    v_mul_f32 v66, v66, v50
    v_mul_f32 v67, v67, v51
    v_exp_f32 v64, v64
    v_exp_f32 v65, v65
    v_exp_f32 v66, v66
    v_exp_f32 v67, v67
    v_add_f32 v64, 1.0, v64
    v_add_f32 v65, 1.0, v65
    v_add_f32 v66, 1.0, v66
    v_add_f32 v67, 1.0, v67
    v_rcp_f32 v64, v64
    v_rcp_f32 v65, v65
    v_rcp_f32 v66, v66
    v_rcp_f32 v67, v67
    v_mul_f32 v48, v48, v64
    v_mul_f32 v49, v49, v65
    v_mul_f32 v50, v50, v66
    v_mul_f32 v51, v51, v67
    v_cvt_pk_bf16_f32 v236, v48, v49
    v_cvt_pk_bf16_f32 v237, v50, v51
    v_lshlrev_b32 v40, 16, v218
    v_and_b32 v41, 0xffff0000, v218
    v_lshlrev_b32 v42, 16, v219
    v_and_b32 v43, 0xffff0000, v219
    v_mul_f32 v56, v40, v40
    v_mul_f32 v57, v41, v41
    v_mul_f32 v58, v42, v42
    v_mul_f32 v59, v43, v43
    v_fma_f32 v56, v56, v13, v12
    v_fma_f32 v57, v57, v13, v12
    v_fma_f32 v58, v58, v13, v12
    v_fma_f32 v59, v59, v13, v12
    v_mul_f32 v56, v56, v40
    v_mul_f32 v57, v57, v41
    v_mul_f32 v58, v58, v42
    v_mul_f32 v59, v59, v43
    v_exp_f32 v56, v56
    v_exp_f32 v57, v57
    v_exp_f32 v58, v58
    v_exp_f32 v59, v59
    v_add_f32 v56, 1.0, v56
    v_add_f32 v57, 1.0, v57
    v_add_f32 v58, 1.0, v58
    v_add_f32 v59, 1.0, v59
    v_rcp_f32 v56, v56
    v_rcp_f32 v57, v57
    v_rcp_f32 v58, v58
    v_rcp_f32 v59, v59
    v_mul_f32 v40, v40, v56
    v_mul_f32 v41, v41, v57
    v_mul_f32 v42, v42, v58
    v_mul_f32 v43, v43, v59
    v_cvt_pk_bf16_f32 v218, v40, v41
    v_cvt_pk_bf16_f32 v219, v42, v43
    v_lshlrev_b32 v48, 16, v238
    v_and_b32 v49, 0xffff0000, v238
    v_lshlrev_b32 v50, 16, v239
    v_and_b32 v51, 0xffff0000, v239
    v_mul_f32 v64, v48, v48
    v_mul_f32 v65, v49, v49
    v_mul_f32 v66, v50, v50
    v_mul_f32 v67, v51, v51
    v_fma_f32 v64, v64, v13, v12
    v_fma_f32 v65, v65, v13, v12
    v_fma_f32 v66, v66, v13, v12
    v_fma_f32 v67, v67, v13, v12
    v_mul_f32 v64, v64, v48
    v_mul_f32 v65, v65, v49
    v_mul_f32 v66, v66, v50
    v_mul_f32 v67, v67, v51
    v_exp_f32 v64, v64
    v_exp_f32 v65, v65
    v_exp_f32 v66, v66
    v_exp_f32 v67, v67
    v_add_f32 v64, 1.0, v64
    v_add_f32 v65, 1.0, v65
    v_add_f32 v66, 1.0, v66
    v_add_f32 v67, 1.0, v67
    v_rcp_f32 v64, v64
    v_rcp_f32 v65, v65
    v_rcp_f32 v66, v66
    v_rcp_f32 v67, v67
    v_mul_f32 v48, v48, v64
    v_mul_f32 v49, v49, v65
    v_mul_f32 v50, v50, v66
    v_mul_f32 v51, v51, v67
    v_cvt_pk_bf16_f32 v238, v48, v49
    v_cvt_pk_bf16_f32 v239, v50, v51
    s_branch P2
P2:
    s_load_dwordx4 s[4:7], s[0:1], 88
    s_cmp_eq_u32 s83, 0
    s_cbranch_scc1 Ldf35
    v_mov_b32 v2, s100
    v_mov_b32 v3, 0
    s_mov_b64 exec, 1
    buffer_store_dword v2, v3, s[96:99], s83 offen sc1
    s_mov_b64 exec, -1
Ldf35:
    s_and_b32 s10, s91, 7
    s_lshr_b32 s11, s91, 3
    s_and_b32 s12, s10, 1
    s_lshl_b32 s12, s12, 3
    s_and_b32 s13, s11, 7
    s_add_u32 s12, s12, s13
    s_lshr_b32 s13, s10, 1
    s_lshl_b32 s13, s13, 2
    s_lshr_b32 s14, s11, 3
    s_add_u32 s13, s13, s14
    s_and_b32 s14, s101, 3
    v_and_b32 v2, 63, v0
    v_lshlrev_b32 v5, 4, v2
    s_lshl_b32 s28, s12, 3
    s_lshl_b32 s29, s14, 1
    s_add_u32 s28, s28, s29
    s_mul_i32 s29, s28, 72
    s_mul_i32 s30, s13, 9
    s_lshr_b32 s30, s30, 1
    s_add_u32 s29, s29, s30
    s_lshl_b32 s29, s29, 10
    s_mul_i32 s37, s14, 10240
    v_add_u32 v24, s37, v5
    s_waitcnt lgkmcnt(0)
    s_mov_b32 s16, s4
    s_and_b32 s17, s5, 0xffff
    s_mov_b32 s18, 8388608
    s_mov_b32 s19, 0x20000
    s_mov_b32 s20, s6
    s_and_b32 s21, s7, 0xffff
    s_mov_b32 s22, 4096
    s_mov_b32 s23, 0x20000
    s_cmp_ge_u32 s101, 4
    s_cbranch_scc1 Lg2l
    v_and_b32 v3, 15, v2
    v_lshrrev_b32 v4, 4, v2
    s_add_u32 s32, s29, 16777216
    s_add_u32 s33, s32, 73728
    s_add_u32 s40, s29, 37748736
    s_add_u32 s41, s40, 73728
    s_lshl_b32 s36, s28, 5
    v_lshlrev_b32 v6, 1, v3
    buffer_load_ushort v7, v6, s[20:23], s36 offen
    buffer_load_ushort v8, v6, s[20:23], s36 offen offset:32
    v_add_u32 v11, 69632, v5
    s_lshl_b32 s37, s14, 12
    v_lshrrev_b32 v9, 1, v3
    v_xor_b32 v9, v9, v4
    v_lshlrev_b32 v9, 4, v9
    v_lshl_add_u32 v9, v3, 7, v9
    v_add_u32 v12, s37, v9
    v_xor_b32 v13, 64, v12
    v_add_u32 v14, 69632, v12
    v_add_u32 v15, 69632, v13
    v_add_u32 v23, 4096, v5
    v_lshlrev_b32 v22, 3, v2
    v_add_u32 v25, 4096, v22
    s_lshl_b32 s34, s28, 5
    s_lshl_b32 s35, s13, 2
    s_add_u32 s34, s34, s35
    s_add_u32 s34, s34, 49369088
    s_waitcnt vmcnt(0)
    v_lshlrev_b32 v7, 16, v7
    v_lshlrev_b32 v8, 16, v8
    v_mov_b32 v128, v7
    v_mov_b32 v129, v7
    v_mov_b32 v130, v7
    v_mov_b32 v131, v7
    v_mov_b32 v132, v8
    v_mov_b32 v133, v8
    v_mov_b32 v134, v8
    v_mov_b32 v135, v8
    v_mov_b32 v136, v7
    v_mov_b32 v137, v7
    v_mov_b32 v138, v7
    v_mov_b32 v139, v7
    v_mov_b32 v140, v8
    v_mov_b32 v141, v8
    v_mov_b32 v142, v8
    v_mov_b32 v143, v8
    v_mov_b32 v144, v7
    v_mov_b32 v145, v7
    v_mov_b32 v146, v7
    v_mov_b32 v147, v7
    v_mov_b32 v148, v8
    v_mov_b32 v149, v8
    v_mov_b32 v150, v8
    v_mov_b32 v151, v8
    v_mov_b32 v152, v7
    v_mov_b32 v153, v7
    v_mov_b32 v154, v7
    v_mov_b32 v155, v7
    v_mov_b32 v156, v8
    v_mov_b32 v157, v8
    v_mov_b32 v158, v8
    v_mov_b32 v159, v8
    v_mov_b32 v160, v7
    v_mov_b32 v161, v7
    v_mov_b32 v162, v7
    v_mov_b32 v163, v7
    v_mov_b32 v164, v8
    v_mov_b32 v165, v8
    v_mov_b32 v166, v8
    v_mov_b32 v167, v8
    v_mov_b32 v168, v7
    v_mov_b32 v169, v7
    v_mov_b32 v170, v7
    v_mov_b32 v171, v7
    v_mov_b32 v172, v8
    v_mov_b32 v173, v8
    v_mov_b32 v174, v8
    v_mov_b32 v175, v8
    v_mov_b32 v176, v7
    v_mov_b32 v177, v7
    v_mov_b32 v178, v7
    v_mov_b32 v179, v7
    v_mov_b32 v180, v8
    v_mov_b32 v181, v8
    v_mov_b32 v182, v8
    v_mov_b32 v183, v8
    v_mov_b32 v184, v7
    v_mov_b32 v185, v7
    v_mov_b32 v186, v7
    v_mov_b32 v187, v7
    v_mov_b32 v188, v8
    v_mov_b32 v189, v8
    v_mov_b32 v190, v8
    v_mov_b32 v191, v8
    v_mov_b32 v192, v7
    v_mov_b32 v193, v7
    v_mov_b32 v194, v7
    v_mov_b32 v195, v7
    v_mov_b32 v196, v8
    v_mov_b32 v197, v8
    v_mov_b32 v198, v8
    v_mov_b32 v199, v8
    s_barrier
    ds_read_b128 v[32:35], v12 offset:18432
    ds_read_b128 v[40:43], v5 offset:0
    ds_read_b128 v[36:39], v12 offset:20480
    ds_read_b128 v[44:47], v5 offset:1024
    ds_read_b128 v[48:51], v5 offset:2048
    ds_read_b128 v[52:55], v5 offset:3072
    ds_read_b128 v[56:59], v5 offset:4096
    ds_read_b128 v[60:63], v5 offset:5120
    ds_read_b128 v[64:67], v5 offset:6144
    ds_read_b128 v[68:71], v5 offset:7168
    ds_read_b128 v[72:75], v5 offset:8192
    s_waitcnt lgkmcnt(0)
    s_mov_b32 s38, 0
Lg2c:
    v_mfma_f32_16x16x32_bf16 v[128:131], v[40:43], v[32:35], v[128:131]
    ds_read_b128 v[76:79], v13 offset:18432
    v_mfma_f32_16x16x32_bf16 v[132:135], v[40:43], v[36:39], v[132:135]
    ds_read_b128 v[84:87], v5 offset:9216
    v_mfma_f32_16x16x32_bf16 v[136:139], v[44:47], v[32:35], v[136:139]
    ds_read_b128 v[80:83], v13 offset:20480
    v_mfma_f32_16x16x32_bf16 v[140:143], v[44:47], v[36:39], v[140:143]
    ds_read_b128 v[88:91], v5 offset:10240
    v_mfma_f32_16x16x32_bf16 v[144:147], v[48:51], v[32:35], v[144:147]
    ds_read_b128 v[92:95], v5 offset:11264
    v_mfma_f32_16x16x32_bf16 v[148:151], v[48:51], v[36:39], v[148:151]
    ds_read_b128 v[96:99], v5 offset:12288
    v_mfma_f32_16x16x32_bf16 v[152:155], v[52:55], v[32:35], v[152:155]
    ds_read_b128 v[100:103], v5 offset:13312
    v_mfma_f32_16x16x32_bf16 v[156:159], v[52:55], v[36:39], v[156:159]
    ds_read_b128 v[104:107], v5 offset:14336
    v_mfma_f32_16x16x32_bf16 v[160:163], v[56:59], v[32:35], v[160:163]
    ds_read_b128 v[108:111], v5 offset:15360
    v_mfma_f32_16x16x32_bf16 v[164:167], v[56:59], v[36:39], v[164:167]
    ds_read_b128 v[112:115], v5 offset:16384
    v_mfma_f32_16x16x32_bf16 v[168:171], v[60:63], v[32:35], v[168:171]
    ds_read_b128 v[116:119], v5 offset:17408
    v_mfma_f32_16x16x32_bf16 v[172:175], v[60:63], v[36:39], v[172:175]
    v_mfma_f32_16x16x32_bf16 v[176:179], v[64:67], v[32:35], v[176:179]
    v_mfma_f32_16x16x32_bf16 v[180:183], v[64:67], v[36:39], v[180:183]
    v_mfma_f32_16x16x32_bf16 v[184:187], v[68:71], v[32:35], v[184:187]
    v_mfma_f32_16x16x32_bf16 v[188:191], v[68:71], v[36:39], v[188:191]
    v_mfma_f32_16x16x32_bf16 v[192:195], v[72:75], v[32:35], v[192:195]
    v_mfma_f32_16x16x32_bf16 v[196:199], v[72:75], v[36:39], v[196:199]
    s_waitcnt lgkmcnt(0)
    s_barrier
    v_mfma_f32_16x16x32_bf16 v[128:131], v[84:87], v[76:79], v[128:131]
    ds_read_b128 v[32:35], v12 offset:53248
    v_mfma_f32_16x16x32_bf16 v[132:135], v[84:87], v[80:83], v[132:135]
    ds_read_b128 v[40:43], v5 offset:34816
    v_mfma_f32_16x16x32_bf16 v[136:139], v[88:91], v[76:79], v[136:139]
    ds_read_b128 v[36:39], v12 offset:55296
    v_mfma_f32_16x16x32_bf16 v[140:143], v[88:91], v[80:83], v[140:143]
    ds_read_b128 v[44:47], v5 offset:35840
    v_mfma_f32_16x16x32_bf16 v[144:147], v[92:95], v[76:79], v[144:147]
    ds_read_b128 v[48:51], v5 offset:36864
    v_mfma_f32_16x16x32_bf16 v[148:151], v[92:95], v[80:83], v[148:151]
    ds_read_b128 v[52:55], v5 offset:37888
    v_mfma_f32_16x16x32_bf16 v[152:155], v[96:99], v[76:79], v[152:155]
    ds_read_b128 v[56:59], v5 offset:38912
    v_mfma_f32_16x16x32_bf16 v[156:159], v[96:99], v[80:83], v[156:159]
    ds_read_b128 v[60:63], v5 offset:39936
    v_mfma_f32_16x16x32_bf16 v[160:163], v[100:103], v[76:79], v[160:163]
    ds_read_b128 v[64:67], v5 offset:40960
    v_mfma_f32_16x16x32_bf16 v[164:167], v[100:103], v[80:83], v[164:167]
    ds_read_b128 v[68:71], v5 offset:41984
    v_mfma_f32_16x16x32_bf16 v[168:171], v[104:107], v[76:79], v[168:171]
    ds_read_b128 v[72:75], v5 offset:43008
    v_mfma_f32_16x16x32_bf16 v[172:175], v[104:107], v[80:83], v[172:175]
    v_mfma_f32_16x16x32_bf16 v[176:179], v[108:111], v[76:79], v[176:179]
    v_mfma_f32_16x16x32_bf16 v[180:183], v[108:111], v[80:83], v[180:183]
    v_mfma_f32_16x16x32_bf16 v[184:187], v[112:115], v[76:79], v[184:187]
    v_mfma_f32_16x16x32_bf16 v[188:191], v[112:115], v[80:83], v[188:191]
    v_mfma_f32_16x16x32_bf16 v[192:195], v[116:119], v[76:79], v[192:195]
    v_mfma_f32_16x16x32_bf16 v[196:199], v[116:119], v[80:83], v[196:199]
    s_waitcnt lgkmcnt(0)
    v_mfma_f32_16x16x32_bf16 v[128:131], v[40:43], v[32:35], v[128:131]
    ds_read_b128 v[76:79], v13 offset:53248
    v_mfma_f32_16x16x32_bf16 v[132:135], v[40:43], v[36:39], v[132:135]
    ds_read_b128 v[84:87], v5 offset:44032
    v_mfma_f32_16x16x32_bf16 v[136:139], v[44:47], v[32:35], v[136:139]
    ds_read_b128 v[80:83], v13 offset:55296
    v_mfma_f32_16x16x32_bf16 v[140:143], v[44:47], v[36:39], v[140:143]
    ds_read_b128 v[88:91], v5 offset:45056
    v_mfma_f32_16x16x32_bf16 v[144:147], v[48:51], v[32:35], v[144:147]
    ds_read_b128 v[92:95], v5 offset:46080
    v_mfma_f32_16x16x32_bf16 v[148:151], v[48:51], v[36:39], v[148:151]
    ds_read_b128 v[96:99], v5 offset:47104
    v_mfma_f32_16x16x32_bf16 v[152:155], v[52:55], v[32:35], v[152:155]
    ds_read_b128 v[100:103], v5 offset:48128
    v_mfma_f32_16x16x32_bf16 v[156:159], v[52:55], v[36:39], v[156:159]
    ds_read_b128 v[104:107], v5 offset:49152
    v_mfma_f32_16x16x32_bf16 v[160:163], v[56:59], v[32:35], v[160:163]
    ds_read_b128 v[108:111], v5 offset:50176
    v_mfma_f32_16x16x32_bf16 v[164:167], v[56:59], v[36:39], v[164:167]
    ds_read_b128 v[112:115], v5 offset:51200
    v_mfma_f32_16x16x32_bf16 v[168:171], v[60:63], v[32:35], v[168:171]
    ds_read_b128 v[116:119], v5 offset:52224
    v_mfma_f32_16x16x32_bf16 v[172:175], v[60:63], v[36:39], v[172:175]
    v_mfma_f32_16x16x32_bf16 v[176:179], v[64:67], v[32:35], v[176:179]
    v_mfma_f32_16x16x32_bf16 v[180:183], v[64:67], v[36:39], v[180:183]
    v_mfma_f32_16x16x32_bf16 v[184:187], v[68:71], v[32:35], v[184:187]
    v_mfma_f32_16x16x32_bf16 v[188:191], v[68:71], v[36:39], v[188:191]
    v_mfma_f32_16x16x32_bf16 v[192:195], v[72:75], v[32:35], v[192:195]
    v_mfma_f32_16x16x32_bf16 v[196:199], v[72:75], v[36:39], v[196:199]
    s_waitcnt lgkmcnt(0)
    s_barrier
    v_mfma_f32_16x16x32_bf16 v[128:131], v[84:87], v[76:79], v[128:131]
    ds_read_b128 v[32:35], v14 offset:18432
    v_mfma_f32_16x16x32_bf16 v[132:135], v[84:87], v[80:83], v[132:135]
    ds_read_b128 v[40:43], v11 offset:0
    v_mfma_f32_16x16x32_bf16 v[136:139], v[88:91], v[76:79], v[136:139]
    ds_read_b128 v[36:39], v14 offset:20480
    v_mfma_f32_16x16x32_bf16 v[140:143], v[88:91], v[80:83], v[140:143]
    ds_read_b128 v[44:47], v11 offset:1024
    v_mfma_f32_16x16x32_bf16 v[144:147], v[92:95], v[76:79], v[144:147]
    ds_read_b128 v[48:51], v11 offset:2048
    v_mfma_f32_16x16x32_bf16 v[148:151], v[92:95], v[80:83], v[148:151]
    ds_read_b128 v[52:55], v11 offset:3072
    v_mfma_f32_16x16x32_bf16 v[152:155], v[96:99], v[76:79], v[152:155]
    ds_read_b128 v[56:59], v11 offset:4096
    v_mfma_f32_16x16x32_bf16 v[156:159], v[96:99], v[80:83], v[156:159]
    ds_read_b128 v[60:63], v11 offset:5120
    v_mfma_f32_16x16x32_bf16 v[160:163], v[100:103], v[76:79], v[160:163]
    ds_read_b128 v[64:67], v11 offset:6144
    v_mfma_f32_16x16x32_bf16 v[164:167], v[100:103], v[80:83], v[164:167]
    ds_read_b128 v[68:71], v11 offset:7168
    v_mfma_f32_16x16x32_bf16 v[168:171], v[104:107], v[76:79], v[168:171]
    ds_read_b128 v[72:75], v11 offset:8192
    v_mfma_f32_16x16x32_bf16 v[172:175], v[104:107], v[80:83], v[172:175]
    v_mfma_f32_16x16x32_bf16 v[176:179], v[108:111], v[76:79], v[176:179]
    v_mfma_f32_16x16x32_bf16 v[180:183], v[108:111], v[80:83], v[180:183]
    v_mfma_f32_16x16x32_bf16 v[184:187], v[112:115], v[76:79], v[184:187]
    v_mfma_f32_16x16x32_bf16 v[188:191], v[112:115], v[80:83], v[188:191]
    v_mfma_f32_16x16x32_bf16 v[192:195], v[116:119], v[76:79], v[192:195]
    v_mfma_f32_16x16x32_bf16 v[196:199], v[116:119], v[80:83], v[196:199]
    s_waitcnt lgkmcnt(0)
    v_mfma_f32_16x16x32_bf16 v[128:131], v[40:43], v[32:35], v[128:131]
    ds_read_b128 v[76:79], v15 offset:18432
    v_mfma_f32_16x16x32_bf16 v[132:135], v[40:43], v[36:39], v[132:135]
    ds_read_b128 v[84:87], v11 offset:9216
    v_mfma_f32_16x16x32_bf16 v[136:139], v[44:47], v[32:35], v[136:139]
    ds_read_b128 v[80:83], v15 offset:20480
    v_mfma_f32_16x16x32_bf16 v[140:143], v[44:47], v[36:39], v[140:143]
    ds_read_b128 v[88:91], v11 offset:10240
    v_mfma_f32_16x16x32_bf16 v[144:147], v[48:51], v[32:35], v[144:147]
    ds_read_b128 v[92:95], v11 offset:11264
    v_mfma_f32_16x16x32_bf16 v[148:151], v[48:51], v[36:39], v[148:151]
    ds_read_b128 v[96:99], v11 offset:12288
    v_mfma_f32_16x16x32_bf16 v[152:155], v[52:55], v[32:35], v[152:155]
    ds_read_b128 v[100:103], v11 offset:13312
    v_mfma_f32_16x16x32_bf16 v[156:159], v[52:55], v[36:39], v[156:159]
    ds_read_b128 v[104:107], v11 offset:14336
    v_mfma_f32_16x16x32_bf16 v[160:163], v[56:59], v[32:35], v[160:163]
    ds_read_b128 v[108:111], v11 offset:15360
    v_mfma_f32_16x16x32_bf16 v[164:167], v[56:59], v[36:39], v[164:167]
    ds_read_b128 v[112:115], v11 offset:16384
    v_mfma_f32_16x16x32_bf16 v[168:171], v[60:63], v[32:35], v[168:171]
    ds_read_b128 v[116:119], v11 offset:17408
    v_mfma_f32_16x16x32_bf16 v[172:175], v[60:63], v[36:39], v[172:175]
    v_mfma_f32_16x16x32_bf16 v[176:179], v[64:67], v[32:35], v[176:179]
    v_mfma_f32_16x16x32_bf16 v[180:183], v[64:67], v[36:39], v[180:183]
    v_mfma_f32_16x16x32_bf16 v[184:187], v[68:71], v[32:35], v[184:187]
    v_mfma_f32_16x16x32_bf16 v[188:191], v[68:71], v[36:39], v[188:191]
    v_mfma_f32_16x16x32_bf16 v[192:195], v[72:75], v[32:35], v[192:195]
    v_mfma_f32_16x16x32_bf16 v[196:199], v[72:75], v[36:39], v[196:199]
    s_waitcnt lgkmcnt(0)
    s_barrier
    v_mfma_f32_16x16x32_bf16 v[128:131], v[84:87], v[76:79], v[128:131]
    ds_read_b128 v[32:35], v14 offset:53248
    v_mfma_f32_16x16x32_bf16 v[132:135], v[84:87], v[80:83], v[132:135]
    ds_read_b128 v[40:43], v11 offset:34816
    v_mfma_f32_16x16x32_bf16 v[136:139], v[88:91], v[76:79], v[136:139]
    ds_read_b128 v[36:39], v14 offset:55296
    v_mfma_f32_16x16x32_bf16 v[140:143], v[88:91], v[80:83], v[140:143]
    ds_read_b128 v[44:47], v11 offset:35840
    v_mfma_f32_16x16x32_bf16 v[144:147], v[92:95], v[76:79], v[144:147]
    ds_read_b128 v[48:51], v11 offset:36864
    v_mfma_f32_16x16x32_bf16 v[148:151], v[92:95], v[80:83], v[148:151]
    ds_read_b128 v[52:55], v11 offset:37888
    v_mfma_f32_16x16x32_bf16 v[152:155], v[96:99], v[76:79], v[152:155]
    ds_read_b128 v[56:59], v11 offset:38912
    v_mfma_f32_16x16x32_bf16 v[156:159], v[96:99], v[80:83], v[156:159]
    ds_read_b128 v[60:63], v11 offset:39936
    v_mfma_f32_16x16x32_bf16 v[160:163], v[100:103], v[76:79], v[160:163]
    ds_read_b128 v[64:67], v11 offset:40960
    v_mfma_f32_16x16x32_bf16 v[164:167], v[100:103], v[80:83], v[164:167]
    ds_read_b128 v[68:71], v11 offset:41984
    v_mfma_f32_16x16x32_bf16 v[168:171], v[104:107], v[76:79], v[168:171]
    ds_read_b128 v[72:75], v11 offset:43008
    v_mfma_f32_16x16x32_bf16 v[172:175], v[104:107], v[80:83], v[172:175]
    v_mfma_f32_16x16x32_bf16 v[176:179], v[108:111], v[76:79], v[176:179]
    v_mfma_f32_16x16x32_bf16 v[180:183], v[108:111], v[80:83], v[180:183]
    v_mfma_f32_16x16x32_bf16 v[184:187], v[112:115], v[76:79], v[184:187]
    v_mfma_f32_16x16x32_bf16 v[188:191], v[112:115], v[80:83], v[188:191]
    v_mfma_f32_16x16x32_bf16 v[192:195], v[116:119], v[76:79], v[192:195]
    v_mfma_f32_16x16x32_bf16 v[196:199], v[116:119], v[80:83], v[196:199]
    s_waitcnt lgkmcnt(0)
    v_mfma_f32_16x16x32_bf16 v[128:131], v[40:43], v[32:35], v[128:131]
    ds_read_b128 v[76:79], v15 offset:53248
    v_mfma_f32_16x16x32_bf16 v[132:135], v[40:43], v[36:39], v[132:135]
    ds_read_b128 v[84:87], v11 offset:44032
    v_mfma_f32_16x16x32_bf16 v[136:139], v[44:47], v[32:35], v[136:139]
    ds_read_b128 v[80:83], v15 offset:55296
    v_mfma_f32_16x16x32_bf16 v[140:143], v[44:47], v[36:39], v[140:143]
    ds_read_b128 v[88:91], v11 offset:45056
    v_mfma_f32_16x16x32_bf16 v[144:147], v[48:51], v[32:35], v[144:147]
    ds_read_b128 v[92:95], v11 offset:46080
    v_mfma_f32_16x16x32_bf16 v[148:151], v[48:51], v[36:39], v[148:151]
    ds_read_b128 v[96:99], v11 offset:47104
    v_mfma_f32_16x16x32_bf16 v[152:155], v[52:55], v[32:35], v[152:155]
    ds_read_b128 v[100:103], v11 offset:48128
    v_mfma_f32_16x16x32_bf16 v[156:159], v[52:55], v[36:39], v[156:159]
    ds_read_b128 v[104:107], v11 offset:49152
    v_mfma_f32_16x16x32_bf16 v[160:163], v[56:59], v[32:35], v[160:163]
    ds_read_b128 v[108:111], v11 offset:50176
    v_mfma_f32_16x16x32_bf16 v[164:167], v[56:59], v[36:39], v[164:167]
    ds_read_b128 v[112:115], v11 offset:51200
    v_mfma_f32_16x16x32_bf16 v[168:171], v[60:63], v[32:35], v[168:171]
    ds_read_b128 v[116:119], v11 offset:52224
    v_mfma_f32_16x16x32_bf16 v[172:175], v[60:63], v[36:39], v[172:175]
    v_mfma_f32_16x16x32_bf16 v[176:179], v[64:67], v[32:35], v[176:179]
    v_mfma_f32_16x16x32_bf16 v[180:183], v[64:67], v[36:39], v[180:183]
    v_mfma_f32_16x16x32_bf16 v[184:187], v[68:71], v[32:35], v[184:187]
    v_mfma_f32_16x16x32_bf16 v[188:191], v[68:71], v[36:39], v[188:191]
    v_mfma_f32_16x16x32_bf16 v[192:195], v[72:75], v[32:35], v[192:195]
    v_mfma_f32_16x16x32_bf16 v[196:199], v[72:75], v[36:39], v[196:199]
    s_waitcnt lgkmcnt(0)
    s_barrier
    v_mfma_f32_16x16x32_bf16 v[128:131], v[84:87], v[76:79], v[128:131]
    ds_read_b128 v[32:35], v12 offset:18432
    v_mfma_f32_16x16x32_bf16 v[132:135], v[84:87], v[80:83], v[132:135]
    ds_read_b128 v[40:43], v5 offset:0
    v_mfma_f32_16x16x32_bf16 v[136:139], v[88:91], v[76:79], v[136:139]
    ds_read_b128 v[36:39], v12 offset:20480
    v_mfma_f32_16x16x32_bf16 v[140:143], v[88:91], v[80:83], v[140:143]
    ds_read_b128 v[44:47], v5 offset:1024
    v_mfma_f32_16x16x32_bf16 v[144:147], v[92:95], v[76:79], v[144:147]
    ds_read_b128 v[48:51], v5 offset:2048
    v_mfma_f32_16x16x32_bf16 v[148:151], v[92:95], v[80:83], v[148:151]
    ds_read_b128 v[52:55], v5 offset:3072
    v_mfma_f32_16x16x32_bf16 v[152:155], v[96:99], v[76:79], v[152:155]
    ds_read_b128 v[56:59], v5 offset:4096
    v_mfma_f32_16x16x32_bf16 v[156:159], v[96:99], v[80:83], v[156:159]
    ds_read_b128 v[60:63], v5 offset:5120
    v_mfma_f32_16x16x32_bf16 v[160:163], v[100:103], v[76:79], v[160:163]
    ds_read_b128 v[64:67], v5 offset:6144
    v_mfma_f32_16x16x32_bf16 v[164:167], v[100:103], v[80:83], v[164:167]
    ds_read_b128 v[68:71], v5 offset:7168
    v_mfma_f32_16x16x32_bf16 v[168:171], v[104:107], v[76:79], v[168:171]
    ds_read_b128 v[72:75], v5 offset:8192
    v_mfma_f32_16x16x32_bf16 v[172:175], v[104:107], v[80:83], v[172:175]
    v_mfma_f32_16x16x32_bf16 v[176:179], v[108:111], v[76:79], v[176:179]
    v_mfma_f32_16x16x32_bf16 v[180:183], v[108:111], v[80:83], v[180:183]
    v_mfma_f32_16x16x32_bf16 v[184:187], v[112:115], v[76:79], v[184:187]
    v_mfma_f32_16x16x32_bf16 v[188:191], v[112:115], v[80:83], v[188:191]
    v_mfma_f32_16x16x32_bf16 v[192:195], v[116:119], v[76:79], v[192:195]
    v_mfma_f32_16x16x32_bf16 v[196:199], v[116:119], v[80:83], v[196:199]
    s_waitcnt lgkmcnt(0)
    s_add_u32 s38, s38, 1
    s_cmp_lt_u32 s38, 8
    s_cbranch_scc1 Lg2c
    s_nop 7
    s_and_b32 s39, s13, 1
    s_cmp_eq_u32 s39, 1
    s_cbranch_scc1 Lg2eo
    v_lshlrev_b32 v32, 16, v200
    v_and_b32 v33, 0xffff0000, v200
    v_lshlrev_b32 v34, 16, v201
    v_and_b32 v35, 0xffff0000, v201
    v_mul_f32 v32, v32, v128
    v_mul_f32 v33, v33, v129
    v_mul_f32 v34, v34, v130
    v_mul_f32 v35, v35, v131
    v_cvt_pk_bf16_f32 v40, v32, v33
    v_cvt_pk_bf16_f32 v41, v34, v35
    v_lshlrev_b32 v32, 16, v202
    v_and_b32 v33, 0xffff0000, v202
    v_lshlrev_b32 v34, 16, v203
    v_and_b32 v35, 0xffff0000, v203
    v_mul_f32 v32, v32, v136
    v_mul_f32 v33, v33, v137
    v_mul_f32 v34, v34, v138
    v_mul_f32 v35, v35, v139
    v_cvt_pk_bf16_f32 v42, v32, v33
    v_cvt_pk_bf16_f32 v43, v34, v35
    buffer_store_dwordx4 v[40:43], v5, s[96:99], s32 offen offset:0 sc1
    v_lshlrev_b32 v48, 16, v204
    v_and_b32 v49, 0xffff0000, v204
    v_lshlrev_b32 v50, 16, v205
    v_and_b32 v51, 0xffff0000, v205
    v_mul_f32 v48, v48, v144
    v_mul_f32 v49, v49, v145
    v_mul_f32 v50, v50, v146
    v_mul_f32 v51, v51, v147
    v_cvt_pk_bf16_f32 v56, v48, v49
    v_cvt_pk_bf16_f32 v57, v50, v51
    v_lshlrev_b32 v48, 16, v206
    v_and_b32 v49, 0xffff0000, v206
    v_lshlrev_b32 v50, 16, v207
    v_and_b32 v51, 0xffff0000, v207
    v_mul_f32 v48, v48, v152
    v_mul_f32 v49, v49, v153
    v_mul_f32 v50, v50, v154
    v_mul_f32 v51, v51, v155
    v_cvt_pk_bf16_f32 v58, v48, v49
    v_cvt_pk_bf16_f32 v59, v50, v51
    buffer_store_dwordx4 v[56:59], v5, s[96:99], s32 offen offset:1024 sc1
    v_lshlrev_b32 v32, 16, v208
    v_and_b32 v33, 0xffff0000, v208
    v_lshlrev_b32 v34, 16, v209
    v_and_b32 v35, 0xffff0000, v209
    v_mul_f32 v32, v32, v160
    v_mul_f32 v33, v33, v161
    v_mul_f32 v34, v34, v162
    v_mul_f32 v35, v35, v163
    v_cvt_pk_bf16_f32 v40, v32, v33
    v_cvt_pk_bf16_f32 v41, v34, v35
    v_lshlrev_b32 v32, 16, v210
    v_and_b32 v33, 0xffff0000, v210
    v_lshlrev_b32 v34, 16, v211
    v_and_b32 v35, 0xffff0000, v211
    v_mul_f32 v32, v32, v168
    v_mul_f32 v33, v33, v169
    v_mul_f32 v34, v34, v170
    v_mul_f32 v35, v35, v171
    v_cvt_pk_bf16_f32 v42, v32, v33
    v_cvt_pk_bf16_f32 v43, v34, v35
    buffer_store_dwordx4 v[40:43], v5, s[96:99], s32 offen offset:2048 sc1
    v_lshlrev_b32 v48, 16, v212
    v_and_b32 v49, 0xffff0000, v212
    v_lshlrev_b32 v50, 16, v213
    v_and_b32 v51, 0xffff0000, v213
    v_mul_f32 v48, v48, v176
    v_mul_f32 v49, v49, v177
    v_mul_f32 v50, v50, v178
    v_mul_f32 v51, v51, v179
    v_cvt_pk_bf16_f32 v56, v48, v49
    v_cvt_pk_bf16_f32 v57, v50, v51
    v_lshlrev_b32 v48, 16, v214
    v_and_b32 v49, 0xffff0000, v214
    v_lshlrev_b32 v50, 16, v215
    v_and_b32 v51, 0xffff0000, v215
    v_mul_f32 v48, v48, v184
    v_mul_f32 v49, v49, v185
    v_mul_f32 v50, v50, v186
    v_mul_f32 v51, v51, v187
    v_cvt_pk_bf16_f32 v58, v48, v49
    v_cvt_pk_bf16_f32 v59, v50, v51
    buffer_store_dwordx4 v[56:59], v5, s[96:99], s32 offen offset:3072 sc1
    v_lshlrev_b32 v32, 16, v216
    v_and_b32 v33, 0xffff0000, v216
    v_lshlrev_b32 v34, 16, v217
    v_and_b32 v35, 0xffff0000, v217
    v_mul_f32 v32, v32, v192
    v_mul_f32 v33, v33, v193
    v_mul_f32 v34, v34, v194
    v_mul_f32 v35, v35, v195
    v_cvt_pk_bf16_f32 v40, v32, v33
    v_cvt_pk_bf16_f32 v41, v34, v35
    buffer_store_dwordx2 v[40:41], v25, s[96:99], s40 offen sc1
    v_lshlrev_b32 v64, 16, v220
    v_and_b32 v65, 0xffff0000, v220
    v_lshlrev_b32 v66, 16, v221
    v_and_b32 v67, 0xffff0000, v221
    v_mul_f32 v64, v64, v132
    v_mul_f32 v65, v65, v133
    v_mul_f32 v66, v66, v134
    v_mul_f32 v67, v67, v135
    v_cvt_pk_bf16_f32 v72, v64, v65
    v_cvt_pk_bf16_f32 v73, v66, v67
    v_lshlrev_b32 v64, 16, v222
    v_and_b32 v65, 0xffff0000, v222
    v_lshlrev_b32 v66, 16, v223
    v_and_b32 v67, 0xffff0000, v223
    v_mul_f32 v64, v64, v140
    v_mul_f32 v65, v65, v141
    v_mul_f32 v66, v66, v142
    v_mul_f32 v67, v67, v143
    v_cvt_pk_bf16_f32 v74, v64, v65
    v_cvt_pk_bf16_f32 v75, v66, v67
    buffer_store_dwordx4 v[72:75], v5, s[96:99], s33 offen offset:0 sc1
    v_lshlrev_b32 v80, 16, v224
    v_and_b32 v81, 0xffff0000, v224
    v_lshlrev_b32 v82, 16, v225
    v_and_b32 v83, 0xffff0000, v225
    v_mul_f32 v80, v80, v148
    v_mul_f32 v81, v81, v149
    v_mul_f32 v82, v82, v150
    v_mul_f32 v83, v83, v151
    v_cvt_pk_bf16_f32 v88, v80, v81
    v_cvt_pk_bf16_f32 v89, v82, v83
    v_lshlrev_b32 v80, 16, v226
    v_and_b32 v81, 0xffff0000, v226
    v_lshlrev_b32 v82, 16, v227
    v_and_b32 v83, 0xffff0000, v227
    v_mul_f32 v80, v80, v156
    v_mul_f32 v81, v81, v157
    v_mul_f32 v82, v82, v158
    v_mul_f32 v83, v83, v159
    v_cvt_pk_bf16_f32 v90, v80, v81
    v_cvt_pk_bf16_f32 v91, v82, v83
    buffer_store_dwordx4 v[88:91], v5, s[96:99], s33 offen offset:1024 sc1
    v_lshlrev_b32 v64, 16, v228
    v_and_b32 v65, 0xffff0000, v228
    v_lshlrev_b32 v66, 16, v229
    v_and_b32 v67, 0xffff0000, v229
    v_mul_f32 v64, v64, v164
    v_mul_f32 v65, v65, v165
    v_mul_f32 v66, v66, v166
    v_mul_f32 v67, v67, v167
    v_cvt_pk_bf16_f32 v72, v64, v65
    v_cvt_pk_bf16_f32 v73, v66, v67
    v_lshlrev_b32 v64, 16, v230
    v_and_b32 v65, 0xffff0000, v230
    v_lshlrev_b32 v66, 16, v231
    v_and_b32 v67, 0xffff0000, v231
    v_mul_f32 v64, v64, v172
    v_mul_f32 v65, v65, v173
    v_mul_f32 v66, v66, v174
    v_mul_f32 v67, v67, v175
    v_cvt_pk_bf16_f32 v74, v64, v65
    v_cvt_pk_bf16_f32 v75, v66, v67
    buffer_store_dwordx4 v[72:75], v5, s[96:99], s33 offen offset:2048 sc1
    v_lshlrev_b32 v80, 16, v232
    v_and_b32 v81, 0xffff0000, v232
    v_lshlrev_b32 v82, 16, v233
    v_and_b32 v83, 0xffff0000, v233
    v_mul_f32 v80, v80, v180
    v_mul_f32 v81, v81, v181
    v_mul_f32 v82, v82, v182
    v_mul_f32 v83, v83, v183
    v_cvt_pk_bf16_f32 v88, v80, v81
    v_cvt_pk_bf16_f32 v89, v82, v83
    v_lshlrev_b32 v80, 16, v234
    v_and_b32 v81, 0xffff0000, v234
    v_lshlrev_b32 v82, 16, v235
    v_and_b32 v83, 0xffff0000, v235
    v_mul_f32 v80, v80, v188
    v_mul_f32 v81, v81, v189
    v_mul_f32 v82, v82, v190
    v_mul_f32 v83, v83, v191
    v_cvt_pk_bf16_f32 v90, v80, v81
    v_cvt_pk_bf16_f32 v91, v82, v83
    buffer_store_dwordx4 v[88:91], v5, s[96:99], s33 offen offset:3072 sc1
    v_lshlrev_b32 v64, 16, v236
    v_and_b32 v65, 0xffff0000, v236
    v_lshlrev_b32 v66, 16, v237
    v_and_b32 v67, 0xffff0000, v237
    v_mul_f32 v64, v64, v196
    v_mul_f32 v65, v65, v197
    v_mul_f32 v66, v66, v198
    v_mul_f32 v67, v67, v199
    v_cvt_pk_bf16_f32 v72, v64, v65
    v_cvt_pk_bf16_f32 v73, v66, v67
    buffer_store_dwordx2 v[72:73], v25, s[96:99], s41 offen sc1
    v_mov_b32 v26, s100
    v_mov_b32 v27, 0
    s_waitcnt vmcnt(0)
    s_mov_b64 exec, 1
    buffer_store_dword v26, v27, s[96:99], s34 offen sc1
    s_mov_b64 exec, -1
    s_endpgm
Lg2eo:
    v_lshlrev_b32 v32, 16, v202
    v_and_b32 v33, 0xffff0000, v202
    v_lshlrev_b32 v34, 16, v203
    v_and_b32 v35, 0xffff0000, v203
    v_mul_f32 v32, v32, v128
    v_mul_f32 v33, v33, v129
    v_mul_f32 v34, v34, v130
    v_mul_f32 v35, v35, v131
    v_cvt_pk_bf16_f32 v42, v32, v33
    v_cvt_pk_bf16_f32 v43, v34, v35
    buffer_store_dwordx2 v[42:43], v22, s[96:99], s40 offen offset:512 sc1
    v_lshlrev_b32 v48, 16, v204
    v_and_b32 v49, 0xffff0000, v204
    v_lshlrev_b32 v50, 16, v205
    v_and_b32 v51, 0xffff0000, v205
    v_mul_f32 v48, v48, v136
    v_mul_f32 v49, v49, v137
    v_mul_f32 v50, v50, v138
    v_mul_f32 v51, v51, v139
    v_cvt_pk_bf16_f32 v56, v48, v49
    v_cvt_pk_bf16_f32 v57, v50, v51
    v_lshlrev_b32 v48, 16, v206
    v_and_b32 v49, 0xffff0000, v206
    v_lshlrev_b32 v50, 16, v207
    v_and_b32 v51, 0xffff0000, v207
    v_mul_f32 v48, v48, v144
    v_mul_f32 v49, v49, v145
    v_mul_f32 v50, v50, v146
    v_mul_f32 v51, v51, v147
    v_cvt_pk_bf16_f32 v58, v48, v49
    v_cvt_pk_bf16_f32 v59, v50, v51
    buffer_store_dwordx4 v[56:59], v5, s[96:99], s32 offen offset:1024 sc1
    v_lshlrev_b32 v32, 16, v208
    v_and_b32 v33, 0xffff0000, v208
    v_lshlrev_b32 v34, 16, v209
    v_and_b32 v35, 0xffff0000, v209
    v_mul_f32 v32, v32, v152
    v_mul_f32 v33, v33, v153
    v_mul_f32 v34, v34, v154
    v_mul_f32 v35, v35, v155
    v_cvt_pk_bf16_f32 v40, v32, v33
    v_cvt_pk_bf16_f32 v41, v34, v35
    v_lshlrev_b32 v32, 16, v210
    v_and_b32 v33, 0xffff0000, v210
    v_lshlrev_b32 v34, 16, v211
    v_and_b32 v35, 0xffff0000, v211
    v_mul_f32 v32, v32, v160
    v_mul_f32 v33, v33, v161
    v_mul_f32 v34, v34, v162
    v_mul_f32 v35, v35, v163
    v_cvt_pk_bf16_f32 v42, v32, v33
    v_cvt_pk_bf16_f32 v43, v34, v35
    buffer_store_dwordx4 v[40:43], v5, s[96:99], s32 offen offset:2048 sc1
    v_lshlrev_b32 v48, 16, v212
    v_and_b32 v49, 0xffff0000, v212
    v_lshlrev_b32 v50, 16, v213
    v_and_b32 v51, 0xffff0000, v213
    v_mul_f32 v48, v48, v168
    v_mul_f32 v49, v49, v169
    v_mul_f32 v50, v50, v170
    v_mul_f32 v51, v51, v171
    v_cvt_pk_bf16_f32 v56, v48, v49
    v_cvt_pk_bf16_f32 v57, v50, v51
    v_lshlrev_b32 v48, 16, v214
    v_and_b32 v49, 0xffff0000, v214
    v_lshlrev_b32 v50, 16, v215
    v_and_b32 v51, 0xffff0000, v215
    v_mul_f32 v48, v48, v176
    v_mul_f32 v49, v49, v177
    v_mul_f32 v50, v50, v178
    v_mul_f32 v51, v51, v179
    v_cvt_pk_bf16_f32 v58, v48, v49
    v_cvt_pk_bf16_f32 v59, v50, v51
    buffer_store_dwordx4 v[56:59], v5, s[96:99], s32 offen offset:3072 sc1
    v_lshlrev_b32 v32, 16, v216
    v_and_b32 v33, 0xffff0000, v216
    v_lshlrev_b32 v34, 16, v217
    v_and_b32 v35, 0xffff0000, v217
    v_mul_f32 v32, v32, v184
    v_mul_f32 v33, v33, v185
    v_mul_f32 v34, v34, v186
    v_mul_f32 v35, v35, v187
    v_cvt_pk_bf16_f32 v40, v32, v33
    v_cvt_pk_bf16_f32 v41, v34, v35
    v_lshlrev_b32 v32, 16, v218
    v_and_b32 v33, 0xffff0000, v218
    v_lshlrev_b32 v34, 16, v219
    v_and_b32 v35, 0xffff0000, v219
    v_mul_f32 v32, v32, v192
    v_mul_f32 v33, v33, v193
    v_mul_f32 v34, v34, v194
    v_mul_f32 v35, v35, v195
    v_cvt_pk_bf16_f32 v42, v32, v33
    v_cvt_pk_bf16_f32 v43, v34, v35
    buffer_store_dwordx4 v[40:43], v23, s[96:99], s32 offen offset:0 sc1
    v_lshlrev_b32 v64, 16, v222
    v_and_b32 v65, 0xffff0000, v222
    v_lshlrev_b32 v66, 16, v223
    v_and_b32 v67, 0xffff0000, v223
    v_mul_f32 v64, v64, v132
    v_mul_f32 v65, v65, v133
    v_mul_f32 v66, v66, v134
    v_mul_f32 v67, v67, v135
    v_cvt_pk_bf16_f32 v74, v64, v65
    v_cvt_pk_bf16_f32 v75, v66, v67
    buffer_store_dwordx2 v[74:75], v22, s[96:99], s41 offen offset:512 sc1
    v_lshlrev_b32 v80, 16, v224
    v_and_b32 v81, 0xffff0000, v224
    v_lshlrev_b32 v82, 16, v225
    v_and_b32 v83, 0xffff0000, v225
    v_mul_f32 v80, v80, v140
    v_mul_f32 v81, v81, v141
    v_mul_f32 v82, v82, v142
    v_mul_f32 v83, v83, v143
    v_cvt_pk_bf16_f32 v88, v80, v81
    v_cvt_pk_bf16_f32 v89, v82, v83
    v_lshlrev_b32 v80, 16, v226
    v_and_b32 v81, 0xffff0000, v226
    v_lshlrev_b32 v82, 16, v227
    v_and_b32 v83, 0xffff0000, v227
    v_mul_f32 v80, v80, v148
    v_mul_f32 v81, v81, v149
    v_mul_f32 v82, v82, v150
    v_mul_f32 v83, v83, v151
    v_cvt_pk_bf16_f32 v90, v80, v81
    v_cvt_pk_bf16_f32 v91, v82, v83
    buffer_store_dwordx4 v[88:91], v5, s[96:99], s33 offen offset:1024 sc1
    v_lshlrev_b32 v64, 16, v228
    v_and_b32 v65, 0xffff0000, v228
    v_lshlrev_b32 v66, 16, v229
    v_and_b32 v67, 0xffff0000, v229
    v_mul_f32 v64, v64, v156
    v_mul_f32 v65, v65, v157
    v_mul_f32 v66, v66, v158
    v_mul_f32 v67, v67, v159
    v_cvt_pk_bf16_f32 v72, v64, v65
    v_cvt_pk_bf16_f32 v73, v66, v67
    v_lshlrev_b32 v64, 16, v230
    v_and_b32 v65, 0xffff0000, v230
    v_lshlrev_b32 v66, 16, v231
    v_and_b32 v67, 0xffff0000, v231
    v_mul_f32 v64, v64, v164
    v_mul_f32 v65, v65, v165
    v_mul_f32 v66, v66, v166
    v_mul_f32 v67, v67, v167
    v_cvt_pk_bf16_f32 v74, v64, v65
    v_cvt_pk_bf16_f32 v75, v66, v67
    buffer_store_dwordx4 v[72:75], v5, s[96:99], s33 offen offset:2048 sc1
    v_lshlrev_b32 v80, 16, v232
    v_and_b32 v81, 0xffff0000, v232
    v_lshlrev_b32 v82, 16, v233
    v_and_b32 v83, 0xffff0000, v233
    v_mul_f32 v80, v80, v172
    v_mul_f32 v81, v81, v173
    v_mul_f32 v82, v82, v174
    v_mul_f32 v83, v83, v175
    v_cvt_pk_bf16_f32 v88, v80, v81
    v_cvt_pk_bf16_f32 v89, v82, v83
    v_lshlrev_b32 v80, 16, v234
    v_and_b32 v81, 0xffff0000, v234
    v_lshlrev_b32 v82, 16, v235
    v_and_b32 v83, 0xffff0000, v235
    v_mul_f32 v80, v80, v180
    v_mul_f32 v81, v81, v181
    v_mul_f32 v82, v82, v182
    v_mul_f32 v83, v83, v183
    v_cvt_pk_bf16_f32 v90, v80, v81
    v_cvt_pk_bf16_f32 v91, v82, v83
    buffer_store_dwordx4 v[88:91], v5, s[96:99], s33 offen offset:3072 sc1
    v_lshlrev_b32 v64, 16, v236
    v_and_b32 v65, 0xffff0000, v236
    v_lshlrev_b32 v66, 16, v237
    v_and_b32 v67, 0xffff0000, v237
    v_mul_f32 v64, v64, v188
    v_mul_f32 v65, v65, v189
    v_mul_f32 v66, v66, v190
    v_mul_f32 v67, v67, v191
    v_cvt_pk_bf16_f32 v72, v64, v65
    v_cvt_pk_bf16_f32 v73, v66, v67
    v_lshlrev_b32 v64, 16, v238
    v_and_b32 v65, 0xffff0000, v238
    v_lshlrev_b32 v66, 16, v239
    v_and_b32 v67, 0xffff0000, v239
    v_mul_f32 v64, v64, v196
    v_mul_f32 v65, v65, v197
    v_mul_f32 v66, v66, v198
    v_mul_f32 v67, v67, v199
    v_cvt_pk_bf16_f32 v74, v64, v65
    v_cvt_pk_bf16_f32 v75, v66, v67
    buffer_store_dwordx4 v[72:75], v23, s[96:99], s33 offen offset:0 sc1
    v_mov_b32 v26, s100
    v_mov_b32 v27, 0
    s_waitcnt vmcnt(0)
    s_mov_b64 exec, 1
    buffer_store_dword v26, v27, s[96:99], s34 offen sc1
    s_mov_b64 exec, -1
    s_endpgm
Lg2l:
    v_lshrrev_b32 v3, 3, v2
    v_and_b32 v4, 7, v2
    v_lshrrev_b32 v9, 4, v2
    s_lshl_b32 s34, s12, 7
    s_lshl_b32 s35, s14, 5
    s_add_u32 s34, s34, s35
    s_lshl_b32 s34, s34, 12
    v_add_u32 v6, 0, v9
    v_and_b32 v6, 7, v6
    v_xor_b32 v6, v6, v4
    v_lshlrev_b32 v6, 4, v6
    v_add_u32 v7, 0, v3
    v_lshl_add_u32 v6, v7, 12, v6
    v_add_u32 v6, s34, v6
    v_subrev_u32 v10, 0, v6
    v_add_u32 v6, 4, v9
    v_and_b32 v6, 7, v6
    v_xor_b32 v6, v6, v4
    v_lshlrev_b32 v6, 4, v6
    v_add_u32 v7, 8, v3
    v_lshl_add_u32 v6, v7, 12, v6
    v_add_u32 v6, s34, v6
    v_subrev_u32 v11, 1024, v6
    v_add_u32 v6, 8, v9
    v_and_b32 v6, 7, v6
    v_xor_b32 v6, v6, v4
    v_lshlrev_b32 v6, 4, v6
    v_add_u32 v7, 16, v3
    v_lshl_add_u32 v6, v7, 12, v6
    v_add_u32 v6, s34, v6
    v_subrev_u32 v12, 2048, v6
    v_add_u32 v6, 12, v9
    v_and_b32 v6, 7, v6
    v_xor_b32 v6, v6, v4
    v_lshlrev_b32 v6, 4, v6
    v_add_u32 v7, 24, v3
    v_lshl_add_u32 v6, v7, 12, v6
    v_add_u32 v6, s34, v6
    v_subrev_u32 v13, 3072, v6
    v_add_u32 v15, 4096, v5
    s_mul_i32 s30, s13, 589824
    s_mul_i32 s31, s14, 4608
    s_add_u32 s30, s30, s31
    s_add_u32 s30, s30, 27262976
    s_mov_b32 s32, 0
    s_lshl_b32 s33, s14, 12
    s_add_u32 s33, s33, 18432
    s_mov_b32 s42, -1
    s_mov_b32 s43, 0
    s_lshr_b32 s48, s11, 3
    s_add_u32 s48, s48, s11
    s_and_b32 s48, s48, 3
    s_add_u32 m0, s33, 0
    s_cmp_eq_u32 s48, 0
    s_mov_b32 s32, 0
    s_cselect_b32 s32, 512, s32
    buffer_load_dwordx4 v10, s[16:19], s32 offen offset:0 lds
    buffer_load_dwordx4 v11, s[16:19], s32 offen offset:1024 lds
    buffer_load_dwordx4 v12, s[16:19], s32 offen offset:2048 lds
    buffer_load_dwordx4 v13, s[16:19], s32 offen offset:3072 lds
    s_add_u32 m0, s33, 34816
    s_cmp_eq_u32 s48, 1
    s_mov_b32 s32, 128
    s_cselect_b32 s32, 640, s32
    buffer_load_dwordx4 v10, s[16:19], s32 offen offset:0 lds
    buffer_load_dwordx4 v11, s[16:19], s32 offen offset:1024 lds
    buffer_load_dwordx4 v12, s[16:19], s32 offen offset:2048 lds
    buffer_load_dwordx4 v13, s[16:19], s32 offen offset:3072 lds
    s_add_u32 m0, s33, 69632
    s_cmp_eq_u32 s48, 2
    s_mov_b32 s32, 256
    s_cselect_b32 s32, 768, s32
    buffer_load_dwordx4 v10, s[16:19], s32 offen offset:0 lds
    buffer_load_dwordx4 v11, s[16:19], s32 offen offset:1024 lds
    buffer_load_dwordx4 v12, s[16:19], s32 offen offset:2048 lds
    buffer_load_dwordx4 v13, s[16:19], s32 offen offset:3072 lds
    s_add_u32 m0, s33, 104448
    s_cmp_eq_u32 s48, 3
    s_mov_b32 s32, 384
    s_cselect_b32 s32, 896, s32
    buffer_load_dwordx4 v10, s[16:19], s32 offen offset:0 lds
    buffer_load_dwordx4 v11, s[16:19], s32 offen offset:1024 lds
    buffer_load_dwordx4 v12, s[16:19], s32 offen offset:2048 lds
    buffer_load_dwordx4 v13, s[16:19], s32 offen offset:3072 lds
    v_lshlrev_b32 v16, 2, v2
    s_lshl_b32 s44, s13, 8
    s_add_u32 s44, s44, 49360896
    s_and_b32 s45, s13, 14
    s_lshl_b32 s45, s45, 8
    s_add_u32 s45, s45, 49360896
    s_mov_b32 s90, 0
Lpl36:
    buffer_load_dword v17, v16, s[96:99], s44 offen sc1
    buffer_load_dword v18, v16, s[96:99], s45 offen sc1
    s_waitcnt vmcnt(0)
    v_cmp_ne_u32 vcc, s100, v17
    v_cmp_ne_u32 s[88:89], s100, v18
    s_or_b64 vcc, vcc, s[88:89]
    s_add_u32 s90, s90, 1
    s_cmp_eq_u64 vcc, 0
    s_cbranch_scc1 Lok37
    s_sleep 8
    s_cmp_lt_u32 s90, 0x20000
    s_cbranch_scc1 Lpl36
Lok37:
    s_add_u32 m0, s31, 0
    s_cmp_eq_u32 s48, 0
    s_mov_b32 s49, 0
    s_cselect_b32 s49, 73728, s49
    s_add_u32 s49, s49, s30
    buffer_load_dwordx4 v5, s[96:99], s49 offen offset:0 sc1 lds
    buffer_load_dwordx4 v5, s[96:99], s49 offen offset:1024 sc1 lds
    buffer_load_dwordx4 v5, s[96:99], s49 offen offset:2048 sc1 lds
    buffer_load_dwordx4 v5, s[96:99], s49 offen offset:3072 sc1 lds
    s_add_u32 m0, s31, 4096
    s_mov_b64 exec, s[42:43]
    buffer_load_dwordx4 v15, s[96:99], s49 offen sc1 lds
    s_mov_b64 exec, -1
    s_add_u32 m0, s31, 34816
    s_cmp_eq_u32 s48, 1
    s_mov_b32 s49, 18432
    s_cselect_b32 s49, 92160, s49
    s_add_u32 s49, s49, s30
    buffer_load_dwordx4 v5, s[96:99], s49 offen offset:0 sc1 lds
    buffer_load_dwordx4 v5, s[96:99], s49 offen offset:1024 sc1 lds
    buffer_load_dwordx4 v5, s[96:99], s49 offen offset:2048 sc1 lds
    buffer_load_dwordx4 v5, s[96:99], s49 offen offset:3072 sc1 lds
    s_add_u32 m0, s31, 38912
    s_mov_b64 exec, s[42:43]
    buffer_load_dwordx4 v15, s[96:99], s49 offen sc1 lds
    s_mov_b64 exec, -1
    s_waitcnt vmcnt(5)
    s_barrier
    s_add_u32 m0, s31, 69632
    s_cmp_eq_u32 s48, 2
    s_mov_b32 s49, 36864
    s_cselect_b32 s49, 110592, s49
    s_add_u32 s49, s49, s30
    buffer_load_dwordx4 v5, s[96:99], s49 offen offset:0 sc1 lds
    buffer_load_dwordx4 v5, s[96:99], s49 offen offset:1024 sc1 lds
    buffer_load_dwordx4 v5, s[96:99], s49 offen offset:2048 sc1 lds
    buffer_load_dwordx4 v5, s[96:99], s49 offen offset:3072 sc1 lds
    s_add_u32 m0, s31, 73728
    s_mov_b64 exec, s[42:43]
    buffer_load_dwordx4 v15, s[96:99], s49 offen sc1 lds
    s_mov_b64 exec, -1
    s_add_u32 m0, s31, 104448
    s_cmp_eq_u32 s48, 3
    s_mov_b32 s49, 55296
    s_cselect_b32 s49, 129024, s49
    s_add_u32 s49, s49, s30
    buffer_load_dwordx4 v5, s[96:99], s49 offen offset:0 sc1 lds
    buffer_load_dwordx4 v5, s[96:99], s49 offen offset:1024 sc1 lds
    buffer_load_dwordx4 v5, s[96:99], s49 offen offset:2048 sc1 lds
    buffer_load_dwordx4 v5, s[96:99], s49 offen offset:3072 sc1 lds
    s_add_u32 m0, s31, 108544
    s_mov_b64 exec, s[42:43]
    buffer_load_dwordx4 v15, s[96:99], s49 offen sc1 lds
    s_mov_b64 exec, -1
    s_add_u32 s44, s29, 16777216
    s_add_u32 s45, s44, 73728
    v_mov_b32 v20, 0xc0135761
    v_mov_b32 v21, 0xbdd2d3e8
    s_lshl_b32 s46, s13, 8
    s_or_b32 s47, s13, 1
    s_lshl_b32 s47, s47, 8
    v_mov_b32 v16, s46
    v_mov_b32 v17, s47
    v_cmp_gt_u32 vcc, 32, v2
    s_lshl_b32 s46, s28, 1
    s_add_u32 s46, s46, 49364992
    v_cndmask_b32 v16, v17, v16, vcc
    s_waitcnt vmcnt(10)
    s_barrier
    s_add_u32 m0, s33, 0
    s_cmp_eq_u32 s48, 0
    s_mov_b32 s32, 512
    s_cselect_b32 s32, 1024, s32
    buffer_load_dwordx4 v10, s[16:19], s32 offen offset:0 lds
    buffer_load_dwordx4 v11, s[16:19], s32 offen offset:1024 lds
    buffer_load_dwordx4 v12, s[16:19], s32 offen offset:2048 lds
    buffer_load_dwordx4 v13, s[16:19], s32 offen offset:3072 lds
    s_add_u32 m0, s31, 0
    s_cmp_eq_u32 s48, 0
    s_mov_b32 s49, 73728
    s_cselect_b32 s49, 147456, s49
    s_add_u32 s49, s49, s30
    buffer_load_dwordx4 v5, s[96:99], s49 offen offset:0 sc1 lds
    buffer_load_dwordx4 v5, s[96:99], s49 offen offset:1024 sc1 lds
    buffer_load_dwordx4 v5, s[96:99], s49 offen offset:2048 sc1 lds
    buffer_load_dwordx4 v5, s[96:99], s49 offen offset:3072 sc1 lds
    s_add_u32 m0, s31, 4096
    s_mov_b64 exec, s[42:43]
    buffer_load_dwordx4 v15, s[96:99], s49 offen sc1 lds
    s_mov_b64 exec, -1
    s_waitcnt vmcnt(14)
    s_barrier
    s_add_u32 m0, s33, 34816
    s_cmp_eq_u32 s48, 1
    s_mov_b32 s32, 640
    s_cselect_b32 s32, 1152, s32
    buffer_load_dwordx4 v10, s[16:19], s32 offen offset:0 lds
    buffer_load_dwordx4 v11, s[16:19], s32 offen offset:1024 lds
    buffer_load_dwordx4 v12, s[16:19], s32 offen offset:2048 lds
    buffer_load_dwordx4 v13, s[16:19], s32 offen offset:3072 lds
    s_add_u32 m0, s31, 34816
    s_cmp_eq_u32 s48, 1
    s_mov_b32 s49, 92160
    s_cselect_b32 s49, 165888, s49
    s_add_u32 s49, s49, s30
    buffer_load_dwordx4 v5, s[96:99], s49 offen offset:0 sc1 lds
    buffer_load_dwordx4 v5, s[96:99], s49 offen offset:1024 sc1 lds
    buffer_load_dwordx4 v5, s[96:99], s49 offen offset:2048 sc1 lds
    buffer_load_dwordx4 v5, s[96:99], s49 offen offset:3072 sc1 lds
    s_add_u32 m0, s31, 38912
    s_mov_b64 exec, s[42:43]
    buffer_load_dwordx4 v15, s[96:99], s49 offen sc1 lds
    s_mov_b64 exec, -1
    s_waitcnt vmcnt(18)
    s_barrier
    s_add_u32 m0, s33, 69632
    s_cmp_eq_u32 s48, 2
    s_mov_b32 s32, 768
    s_cselect_b32 s32, 1280, s32
    buffer_load_dwordx4 v10, s[16:19], s32 offen offset:0 lds
    buffer_load_dwordx4 v11, s[16:19], s32 offen offset:1024 lds
    buffer_load_dwordx4 v12, s[16:19], s32 offen offset:2048 lds
    buffer_load_dwordx4 v13, s[16:19], s32 offen offset:3072 lds
    s_add_u32 m0, s31, 69632
    s_cmp_eq_u32 s48, 2
    s_mov_b32 s49, 110592
    s_cselect_b32 s49, 184320, s49
    s_add_u32 s49, s49, s30
    buffer_load_dwordx4 v5, s[96:99], s49 offen offset:0 sc1 lds
    buffer_load_dwordx4 v5, s[96:99], s49 offen offset:1024 sc1 lds
    buffer_load_dwordx4 v5, s[96:99], s49 offen offset:2048 sc1 lds
    buffer_load_dwordx4 v5, s[96:99], s49 offen offset:3072 sc1 lds
    s_add_u32 m0, s31, 73728
    s_mov_b64 exec, s[42:43]
    buffer_load_dwordx4 v15, s[96:99], s49 offen sc1 lds
    s_mov_b64 exec, -1
    s_waitcnt vmcnt(18)
    s_barrier
    s_add_u32 m0, s33, 104448
    s_cmp_eq_u32 s48, 3
    s_mov_b32 s32, 896
    s_cselect_b32 s32, 1408, s32
    buffer_load_dwordx4 v10, s[16:19], s32 offen offset:0 lds
    buffer_load_dwordx4 v11, s[16:19], s32 offen offset:1024 lds
    buffer_load_dwordx4 v12, s[16:19], s32 offen offset:2048 lds
    buffer_load_dwordx4 v13, s[16:19], s32 offen offset:3072 lds
    s_add_u32 m0, s31, 104448
    s_cmp_eq_u32 s48, 3
    s_mov_b32 s49, 129024
    s_cselect_b32 s49, 202752, s49
    s_add_u32 s49, s49, s30
    buffer_load_dwordx4 v5, s[96:99], s49 offen offset:0 sc1 lds
    buffer_load_dwordx4 v5, s[96:99], s49 offen offset:1024 sc1 lds
    buffer_load_dwordx4 v5, s[96:99], s49 offen offset:2048 sc1 lds
    buffer_load_dwordx4 v5, s[96:99], s49 offen offset:3072 sc1 lds
    s_add_u32 m0, s31, 108544
    s_mov_b64 exec, s[42:43]
    buffer_load_dwordx4 v15, s[96:99], s49 offen sc1 lds
    s_mov_b64 exec, -1
    s_waitcnt vmcnt(18)
    s_barrier
    s_add_u32 m0, s33, 0
    s_cmp_eq_u32 s48, 0
    s_mov_b32 s32, 1024
    s_cselect_b32 s32, 1536, s32
    buffer_load_dwordx4 v10, s[16:19], s32 offen offset:0 lds
    buffer_load_dwordx4 v11, s[16:19], s32 offen offset:1024 lds
    buffer_load_dwordx4 v12, s[16:19], s32 offen offset:2048 lds
    buffer_load_dwordx4 v13, s[16:19], s32 offen offset:3072 lds
    s_add_u32 m0, s31, 0
    s_cmp_eq_u32 s48, 0
    s_mov_b32 s49, 147456
    s_cselect_b32 s49, 221184, s49
    s_add_u32 s49, s49, s30
    buffer_load_dwordx4 v5, s[96:99], s49 offen offset:0 sc1 lds
    buffer_load_dwordx4 v5, s[96:99], s49 offen offset:1024 sc1 lds
    buffer_load_dwordx4 v5, s[96:99], s49 offen offset:2048 sc1 lds
    buffer_load_dwordx4 v5, s[96:99], s49 offen offset:3072 sc1 lds
    s_add_u32 m0, s31, 4096
    s_mov_b64 exec, s[42:43]
    buffer_load_dwordx4 v15, s[96:99], s49 offen sc1 lds
    s_mov_b64 exec, -1
    s_waitcnt vmcnt(18)
    s_barrier
    s_add_u32 m0, s33, 34816
    s_cmp_eq_u32 s48, 1
    s_mov_b32 s32, 1152
    s_cselect_b32 s32, 1664, s32
    buffer_load_dwordx4 v10, s[16:19], s32 offen offset:0 lds
    buffer_load_dwordx4 v11, s[16:19], s32 offen offset:1024 lds
    buffer_load_dwordx4 v12, s[16:19], s32 offen offset:2048 lds
    buffer_load_dwordx4 v13, s[16:19], s32 offen offset:3072 lds
    s_add_u32 m0, s31, 34816
    s_cmp_eq_u32 s48, 1
    s_mov_b32 s49, 165888
    s_cselect_b32 s49, 239616, s49
    s_add_u32 s49, s49, s30
    buffer_load_dwordx4 v5, s[96:99], s49 offen offset:0 sc1 lds
    buffer_load_dwordx4 v5, s[96:99], s49 offen offset:1024 sc1 lds
    buffer_load_dwordx4 v5, s[96:99], s49 offen offset:2048 sc1 lds
    buffer_load_dwordx4 v5, s[96:99], s49 offen offset:3072 sc1 lds
    s_add_u32 m0, s31, 38912
    s_mov_b64 exec, s[42:43]
    buffer_load_dwordx4 v15, s[96:99], s49 offen sc1 lds
    s_mov_b64 exec, -1
    s_waitcnt vmcnt(18)
    s_barrier
    s_add_u32 m0, s33, 69632
    s_cmp_eq_u32 s48, 2
    s_mov_b32 s32, 1280
    s_cselect_b32 s32, 1792, s32
    buffer_load_dwordx4 v10, s[16:19], s32 offen offset:0 lds
    buffer_load_dwordx4 v11, s[16:19], s32 offen offset:1024 lds
    buffer_load_dwordx4 v12, s[16:19], s32 offen offset:2048 lds
    buffer_load_dwordx4 v13, s[16:19], s32 offen offset:3072 lds
    s_add_u32 m0, s31, 69632
    s_cmp_eq_u32 s48, 2
    s_mov_b32 s49, 184320
    s_cselect_b32 s49, 258048, s49
    s_add_u32 s49, s49, s30
    buffer_load_dwordx4 v5, s[96:99], s49 offen offset:0 sc1 lds
    buffer_load_dwordx4 v5, s[96:99], s49 offen offset:1024 sc1 lds
    buffer_load_dwordx4 v5, s[96:99], s49 offen offset:2048 sc1 lds
    buffer_load_dwordx4 v5, s[96:99], s49 offen offset:3072 sc1 lds
    s_add_u32 m0, s31, 73728
    s_mov_b64 exec, s[42:43]
    buffer_load_dwordx4 v15, s[96:99], s49 offen sc1 lds
    s_mov_b64 exec, -1
    s_waitcnt vmcnt(18)
    s_barrier
    s_add_u32 m0, s33, 104448
    s_cmp_eq_u32 s48, 3
    s_mov_b32 s32, 1408
    s_cselect_b32 s32, 1920, s32
    buffer_load_dwordx4 v10, s[16:19], s32 offen offset:0 lds
    buffer_load_dwordx4 v11, s[16:19], s32 offen offset:1024 lds
    buffer_load_dwordx4 v12, s[16:19], s32 offen offset:2048 lds
    buffer_load_dwordx4 v13, s[16:19], s32 offen offset:3072 lds
    s_add_u32 m0, s31, 104448
    s_cmp_eq_u32 s48, 3
    s_mov_b32 s49, 202752
    s_cselect_b32 s49, 276480, s49
    s_add_u32 s49, s49, s30
    buffer_load_dwordx4 v5, s[96:99], s49 offen offset:0 sc1 lds
    buffer_load_dwordx4 v5, s[96:99], s49 offen offset:1024 sc1 lds
    buffer_load_dwordx4 v5, s[96:99], s49 offen offset:2048 sc1 lds
    buffer_load_dwordx4 v5, s[96:99], s49 offen offset:3072 sc1 lds
    s_add_u32 m0, s31, 108544
    s_mov_b64 exec, s[42:43]
    buffer_load_dwordx4 v15, s[96:99], s49 offen sc1 lds
    s_mov_b64 exec, -1
    s_waitcnt vmcnt(18)
    s_barrier
    s_add_u32 m0, s33, 0
    s_cmp_eq_u32 s48, 0
    s_mov_b32 s32, 1536
    s_cselect_b32 s32, 2048, s32
    buffer_load_dwordx4 v10, s[16:19], s32 offen offset:0 lds
    buffer_load_dwordx4 v11, s[16:19], s32 offen offset:1024 lds
    buffer_load_dwordx4 v12, s[16:19], s32 offen offset:2048 lds
    buffer_load_dwordx4 v13, s[16:19], s32 offen offset:3072 lds
    s_add_u32 m0, s31, 0
    s_cmp_eq_u32 s48, 0
    s_mov_b32 s49, 221184
    s_cselect_b32 s49, 294912, s49
    s_add_u32 s49, s49, s30
    buffer_load_dwordx4 v5, s[96:99], s49 offen offset:0 sc1 lds
    buffer_load_dwordx4 v5, s[96:99], s49 offen offset:1024 sc1 lds
    buffer_load_dwordx4 v5, s[96:99], s49 offen offset:2048 sc1 lds
    buffer_load_dwordx4 v5, s[96:99], s49 offen offset:3072 sc1 lds
    s_add_u32 m0, s31, 4096
    s_mov_b64 exec, s[42:43]
    buffer_load_dwordx4 v15, s[96:99], s49 offen sc1 lds
    s_mov_b64 exec, -1
    s_waitcnt vmcnt(18)
    s_barrier
    s_add_u32 m0, s33, 34816
    s_cmp_eq_u32 s48, 1
    s_mov_b32 s32, 1664
    s_cselect_b32 s32, 2176, s32
    buffer_load_dwordx4 v10, s[16:19], s32 offen offset:0 lds
    buffer_load_dwordx4 v11, s[16:19], s32 offen offset:1024 lds
    buffer_load_dwordx4 v12, s[16:19], s32 offen offset:2048 lds
    buffer_load_dwordx4 v13, s[16:19], s32 offen offset:3072 lds
    s_add_u32 m0, s31, 34816
    s_cmp_eq_u32 s48, 1
    s_mov_b32 s49, 239616
    s_cselect_b32 s49, 313344, s49
    s_add_u32 s49, s49, s30
    buffer_load_dwordx4 v5, s[96:99], s49 offen offset:0 sc1 lds
    buffer_load_dwordx4 v5, s[96:99], s49 offen offset:1024 sc1 lds
    buffer_load_dwordx4 v5, s[96:99], s49 offen offset:2048 sc1 lds
    buffer_load_dwordx4 v5, s[96:99], s49 offen offset:3072 sc1 lds
    s_add_u32 m0, s31, 38912
    s_mov_b64 exec, s[42:43]
    buffer_load_dwordx4 v15, s[96:99], s49 offen sc1 lds
    s_mov_b64 exec, -1
    s_waitcnt vmcnt(18)
    s_barrier
    s_add_u32 m0, s33, 69632
    s_cmp_eq_u32 s48, 2
    s_mov_b32 s32, 1792
    s_cselect_b32 s32, 2304, s32
    buffer_load_dwordx4 v10, s[16:19], s32 offen offset:0 lds
    buffer_load_dwordx4 v11, s[16:19], s32 offen offset:1024 lds
    buffer_load_dwordx4 v12, s[16:19], s32 offen offset:2048 lds
    buffer_load_dwordx4 v13, s[16:19], s32 offen offset:3072 lds
    s_add_u32 m0, s31, 69632
    s_cmp_eq_u32 s48, 2
    s_mov_b32 s49, 258048
    s_cselect_b32 s49, 331776, s49
    s_add_u32 s49, s49, s30
    buffer_load_dwordx4 v5, s[96:99], s49 offen offset:0 sc1 lds
    buffer_load_dwordx4 v5, s[96:99], s49 offen offset:1024 sc1 lds
    buffer_load_dwordx4 v5, s[96:99], s49 offen offset:2048 sc1 lds
    buffer_load_dwordx4 v5, s[96:99], s49 offen offset:3072 sc1 lds
    s_add_u32 m0, s31, 73728
    s_mov_b64 exec, s[42:43]
    buffer_load_dwordx4 v15, s[96:99], s49 offen sc1 lds
    s_mov_b64 exec, -1
    s_waitcnt vmcnt(18)
    s_barrier
    s_add_u32 m0, s33, 104448
    s_cmp_eq_u32 s48, 3
    s_mov_b32 s32, 1920
    s_cselect_b32 s32, 2432, s32
    buffer_load_dwordx4 v10, s[16:19], s32 offen offset:0 lds
    buffer_load_dwordx4 v11, s[16:19], s32 offen offset:1024 lds
    buffer_load_dwordx4 v12, s[16:19], s32 offen offset:2048 lds
    buffer_load_dwordx4 v13, s[16:19], s32 offen offset:3072 lds
    s_add_u32 m0, s31, 104448
    s_cmp_eq_u32 s48, 3
    s_mov_b32 s49, 276480
    s_cselect_b32 s49, 350208, s49
    s_add_u32 s49, s49, s30
    buffer_load_dwordx4 v5, s[96:99], s49 offen offset:0 sc1 lds
    buffer_load_dwordx4 v5, s[96:99], s49 offen offset:1024 sc1 lds
    buffer_load_dwordx4 v5, s[96:99], s49 offen offset:2048 sc1 lds
    buffer_load_dwordx4 v5, s[96:99], s49 offen offset:3072 sc1 lds
    s_add_u32 m0, s31, 108544
    s_mov_b64 exec, s[42:43]
    buffer_load_dwordx4 v15, s[96:99], s49 offen sc1 lds
    s_mov_b64 exec, -1
    s_waitcnt vmcnt(18)
    s_barrier
    s_add_u32 m0, s33, 0
    s_cmp_eq_u32 s48, 0
    s_mov_b32 s32, 2048
    s_cselect_b32 s32, 2560, s32
    buffer_load_dwordx4 v10, s[16:19], s32 offen offset:0 lds
    buffer_load_dwordx4 v11, s[16:19], s32 offen offset:1024 lds
    buffer_load_dwordx4 v12, s[16:19], s32 offen offset:2048 lds
    buffer_load_dwordx4 v13, s[16:19], s32 offen offset:3072 lds
    s_add_u32 m0, s31, 0
    s_cmp_eq_u32 s48, 0
    s_mov_b32 s49, 294912
    s_cselect_b32 s49, 368640, s49
    s_add_u32 s49, s49, s30
    buffer_load_dwordx4 v5, s[96:99], s49 offen offset:0 sc1 lds
    buffer_load_dwordx4 v5, s[96:99], s49 offen offset:1024 sc1 lds
    buffer_load_dwordx4 v5, s[96:99], s49 offen offset:2048 sc1 lds
    buffer_load_dwordx4 v5, s[96:99], s49 offen offset:3072 sc1 lds
    s_add_u32 m0, s31, 4096
    s_mov_b64 exec, s[42:43]
    buffer_load_dwordx4 v15, s[96:99], s49 offen sc1 lds
    s_mov_b64 exec, -1
    s_waitcnt vmcnt(18)
    s_barrier
    s_add_u32 m0, s33, 34816
    s_cmp_eq_u32 s48, 1
    s_mov_b32 s32, 2176
    s_cselect_b32 s32, 2688, s32
    buffer_load_dwordx4 v10, s[16:19], s32 offen offset:0 lds
    buffer_load_dwordx4 v11, s[16:19], s32 offen offset:1024 lds
    buffer_load_dwordx4 v12, s[16:19], s32 offen offset:2048 lds
    buffer_load_dwordx4 v13, s[16:19], s32 offen offset:3072 lds
    s_add_u32 m0, s31, 34816
    s_cmp_eq_u32 s48, 1
    s_mov_b32 s49, 313344
    s_cselect_b32 s49, 387072, s49
    s_add_u32 s49, s49, s30
    buffer_load_dwordx4 v5, s[96:99], s49 offen offset:0 sc1 lds
    buffer_load_dwordx4 v5, s[96:99], s49 offen offset:1024 sc1 lds
    buffer_load_dwordx4 v5, s[96:99], s49 offen offset:2048 sc1 lds
    buffer_load_dwordx4 v5, s[96:99], s49 offen offset:3072 sc1 lds
    s_add_u32 m0, s31, 38912
    s_mov_b64 exec, s[42:43]
    buffer_load_dwordx4 v15, s[96:99], s49 offen sc1 lds
    s_mov_b64 exec, -1
    s_waitcnt vmcnt(18)
    s_barrier
    s_add_u32 m0, s33, 69632
    s_cmp_eq_u32 s48, 2
    s_mov_b32 s32, 2304
    s_cselect_b32 s32, 2816, s32
    buffer_load_dwordx4 v10, s[16:19], s32 offen offset:0 lds
    buffer_load_dwordx4 v11, s[16:19], s32 offen offset:1024 lds
    buffer_load_dwordx4 v12, s[16:19], s32 offen offset:2048 lds
    buffer_load_dwordx4 v13, s[16:19], s32 offen offset:3072 lds
    s_add_u32 m0, s31, 69632
    s_cmp_eq_u32 s48, 2
    s_mov_b32 s49, 331776
    s_cselect_b32 s49, 405504, s49
    s_add_u32 s49, s49, s30
    buffer_load_dwordx4 v5, s[96:99], s49 offen offset:0 sc1 lds
    buffer_load_dwordx4 v5, s[96:99], s49 offen offset:1024 sc1 lds
    buffer_load_dwordx4 v5, s[96:99], s49 offen offset:2048 sc1 lds
    buffer_load_dwordx4 v5, s[96:99], s49 offen offset:3072 sc1 lds
    s_add_u32 m0, s31, 73728
    s_mov_b64 exec, s[42:43]
    buffer_load_dwordx4 v15, s[96:99], s49 offen sc1 lds
    s_mov_b64 exec, -1
    s_waitcnt vmcnt(18)
    s_barrier
    s_add_u32 m0, s33, 104448
    s_cmp_eq_u32 s48, 3
    s_mov_b32 s32, 2432
    s_cselect_b32 s32, 2944, s32
    buffer_load_dwordx4 v10, s[16:19], s32 offen offset:0 lds
    buffer_load_dwordx4 v11, s[16:19], s32 offen offset:1024 lds
    buffer_load_dwordx4 v12, s[16:19], s32 offen offset:2048 lds
    buffer_load_dwordx4 v13, s[16:19], s32 offen offset:3072 lds
    s_add_u32 m0, s31, 104448
    s_cmp_eq_u32 s48, 3
    s_mov_b32 s49, 350208
    s_cselect_b32 s49, 423936, s49
    s_add_u32 s49, s49, s30
    buffer_load_dwordx4 v5, s[96:99], s49 offen offset:0 sc1 lds
    buffer_load_dwordx4 v5, s[96:99], s49 offen offset:1024 sc1 lds
    buffer_load_dwordx4 v5, s[96:99], s49 offen offset:2048 sc1 lds
    buffer_load_dwordx4 v5, s[96:99], s49 offen offset:3072 sc1 lds
    s_add_u32 m0, s31, 108544
    s_mov_b64 exec, s[42:43]
    buffer_load_dwordx4 v15, s[96:99], s49 offen sc1 lds
    s_mov_b64 exec, -1
    s_waitcnt vmcnt(18)
    s_barrier
    s_add_u32 m0, s33, 0
    s_cmp_eq_u32 s48, 0
    s_mov_b32 s32, 2560
    s_cselect_b32 s32, 3072, s32
    buffer_load_dwordx4 v10, s[16:19], s32 offen offset:0 lds
    buffer_load_dwordx4 v11, s[16:19], s32 offen offset:1024 lds
    buffer_load_dwordx4 v12, s[16:19], s32 offen offset:2048 lds
    buffer_load_dwordx4 v13, s[16:19], s32 offen offset:3072 lds
    s_add_u32 m0, s31, 0
    s_cmp_eq_u32 s48, 0
    s_mov_b32 s49, 368640
    s_cselect_b32 s49, 442368, s49
    s_add_u32 s49, s49, s30
    buffer_load_dwordx4 v5, s[96:99], s49 offen offset:0 sc1 lds
    buffer_load_dwordx4 v5, s[96:99], s49 offen offset:1024 sc1 lds
    buffer_load_dwordx4 v5, s[96:99], s49 offen offset:2048 sc1 lds
    buffer_load_dwordx4 v5, s[96:99], s49 offen offset:3072 sc1 lds
    s_add_u32 m0, s31, 4096
    s_mov_b64 exec, s[42:43]
    buffer_load_dwordx4 v15, s[96:99], s49 offen sc1 lds
    s_mov_b64 exec, -1
    s_waitcnt vmcnt(18)
    s_barrier
    s_add_u32 m0, s33, 34816
    s_cmp_eq_u32 s48, 1
    s_mov_b32 s32, 2688
    s_cselect_b32 s32, 3200, s32
    buffer_load_dwordx4 v10, s[16:19], s32 offen offset:0 lds
    buffer_load_dwordx4 v11, s[16:19], s32 offen offset:1024 lds
    buffer_load_dwordx4 v12, s[16:19], s32 offen offset:2048 lds
    buffer_load_dwordx4 v13, s[16:19], s32 offen offset:3072 lds
    s_add_u32 m0, s31, 34816
    s_cmp_eq_u32 s48, 1
    s_mov_b32 s49, 387072
    s_cselect_b32 s49, 460800, s49
    s_add_u32 s49, s49, s30
    buffer_load_dwordx4 v5, s[96:99], s49 offen offset:0 sc1 lds
    buffer_load_dwordx4 v5, s[96:99], s49 offen offset:1024 sc1 lds
    buffer_load_dwordx4 v5, s[96:99], s49 offen offset:2048 sc1 lds
    buffer_load_dwordx4 v5, s[96:99], s49 offen offset:3072 sc1 lds
    s_add_u32 m0, s31, 38912
    s_mov_b64 exec, s[42:43]
    buffer_load_dwordx4 v15, s[96:99], s49 offen sc1 lds
    s_mov_b64 exec, -1
    s_waitcnt vmcnt(18)
    s_barrier
    s_add_u32 m0, s33, 69632
    s_cmp_eq_u32 s48, 2
    s_mov_b32 s32, 2816
    s_cselect_b32 s32, 3328, s32
    buffer_load_dwordx4 v10, s[16:19], s32 offen offset:0 lds
    buffer_load_dwordx4 v11, s[16:19], s32 offen offset:1024 lds
    buffer_load_dwordx4 v12, s[16:19], s32 offen offset:2048 lds
    buffer_load_dwordx4 v13, s[16:19], s32 offen offset:3072 lds
    s_add_u32 m0, s31, 69632
    s_cmp_eq_u32 s48, 2
    s_mov_b32 s49, 405504
    s_cselect_b32 s49, 479232, s49
    s_add_u32 s49, s49, s30
    buffer_load_dwordx4 v5, s[96:99], s49 offen offset:0 sc1 lds
    buffer_load_dwordx4 v5, s[96:99], s49 offen offset:1024 sc1 lds
    buffer_load_dwordx4 v5, s[96:99], s49 offen offset:2048 sc1 lds
    buffer_load_dwordx4 v5, s[96:99], s49 offen offset:3072 sc1 lds
    s_add_u32 m0, s31, 73728
    s_mov_b64 exec, s[42:43]
    buffer_load_dwordx4 v15, s[96:99], s49 offen sc1 lds
    s_mov_b64 exec, -1
    s_waitcnt vmcnt(18)
    s_barrier
    s_add_u32 m0, s33, 104448
    s_cmp_eq_u32 s48, 3
    s_mov_b32 s32, 2944
    s_cselect_b32 s32, 3456, s32
    buffer_load_dwordx4 v10, s[16:19], s32 offen offset:0 lds
    buffer_load_dwordx4 v11, s[16:19], s32 offen offset:1024 lds
    buffer_load_dwordx4 v12, s[16:19], s32 offen offset:2048 lds
    buffer_load_dwordx4 v13, s[16:19], s32 offen offset:3072 lds
    s_add_u32 m0, s31, 104448
    s_cmp_eq_u32 s48, 3
    s_mov_b32 s49, 423936
    s_cselect_b32 s49, 497664, s49
    s_add_u32 s49, s49, s30
    buffer_load_dwordx4 v5, s[96:99], s49 offen offset:0 sc1 lds
    buffer_load_dwordx4 v5, s[96:99], s49 offen offset:1024 sc1 lds
    buffer_load_dwordx4 v5, s[96:99], s49 offen offset:2048 sc1 lds
    buffer_load_dwordx4 v5, s[96:99], s49 offen offset:3072 sc1 lds
    s_add_u32 m0, s31, 108544
    s_mov_b64 exec, s[42:43]
    buffer_load_dwordx4 v15, s[96:99], s49 offen sc1 lds
    s_mov_b64 exec, -1
    s_waitcnt vmcnt(18)
    s_barrier
    s_add_u32 m0, s33, 0
    s_cmp_eq_u32 s48, 0
    s_mov_b32 s32, 3072
    s_cselect_b32 s32, 3584, s32
    buffer_load_dwordx4 v10, s[16:19], s32 offen offset:0 lds
    buffer_load_dwordx4 v11, s[16:19], s32 offen offset:1024 lds
    buffer_load_dwordx4 v12, s[16:19], s32 offen offset:2048 lds
    buffer_load_dwordx4 v13, s[16:19], s32 offen offset:3072 lds
    s_add_u32 m0, s31, 0
    s_cmp_eq_u32 s48, 0
    s_mov_b32 s49, 442368
    s_cselect_b32 s49, 516096, s49
    s_add_u32 s49, s49, s30
    buffer_load_dwordx4 v5, s[96:99], s49 offen offset:0 sc1 lds
    buffer_load_dwordx4 v5, s[96:99], s49 offen offset:1024 sc1 lds
    buffer_load_dwordx4 v5, s[96:99], s49 offen offset:2048 sc1 lds
    buffer_load_dwordx4 v5, s[96:99], s49 offen offset:3072 sc1 lds
    s_add_u32 m0, s31, 4096
    s_mov_b64 exec, s[42:43]
    buffer_load_dwordx4 v15, s[96:99], s49 offen sc1 lds
    s_mov_b64 exec, -1
    s_waitcnt vmcnt(18)
    s_barrier
    s_add_u32 m0, s33, 34816
    s_cmp_eq_u32 s48, 1
    s_mov_b32 s32, 3200
    s_cselect_b32 s32, 3712, s32
    buffer_load_dwordx4 v10, s[16:19], s32 offen offset:0 lds
    buffer_load_dwordx4 v11, s[16:19], s32 offen offset:1024 lds
    buffer_load_dwordx4 v12, s[16:19], s32 offen offset:2048 lds
    buffer_load_dwordx4 v13, s[16:19], s32 offen offset:3072 lds
    s_add_u32 m0, s31, 34816
    s_cmp_eq_u32 s48, 1
    s_mov_b32 s49, 460800
    s_cselect_b32 s49, 534528, s49
    s_add_u32 s49, s49, s30
    buffer_load_dwordx4 v5, s[96:99], s49 offen offset:0 sc1 lds
    buffer_load_dwordx4 v5, s[96:99], s49 offen offset:1024 sc1 lds
    buffer_load_dwordx4 v5, s[96:99], s49 offen offset:2048 sc1 lds
    buffer_load_dwordx4 v5, s[96:99], s49 offen offset:3072 sc1 lds
    s_add_u32 m0, s31, 38912
    s_mov_b64 exec, s[42:43]
    buffer_load_dwordx4 v15, s[96:99], s49 offen sc1 lds
    s_mov_b64 exec, -1
    s_waitcnt vmcnt(18)
    s_barrier
    s_add_u32 m0, s33, 69632
    s_cmp_eq_u32 s48, 2
    s_mov_b32 s32, 3328
    s_cselect_b32 s32, 3840, s32
    buffer_load_dwordx4 v10, s[16:19], s32 offen offset:0 lds
    buffer_load_dwordx4 v11, s[16:19], s32 offen offset:1024 lds
    buffer_load_dwordx4 v12, s[16:19], s32 offen offset:2048 lds
    buffer_load_dwordx4 v13, s[16:19], s32 offen offset:3072 lds
    s_add_u32 m0, s31, 69632
    s_cmp_eq_u32 s48, 2
    s_mov_b32 s49, 479232
    s_cselect_b32 s49, 552960, s49
    s_add_u32 s49, s49, s30
    buffer_load_dwordx4 v5, s[96:99], s49 offen offset:0 sc1 lds
    buffer_load_dwordx4 v5, s[96:99], s49 offen offset:1024 sc1 lds
    buffer_load_dwordx4 v5, s[96:99], s49 offen offset:2048 sc1 lds
    buffer_load_dwordx4 v5, s[96:99], s49 offen offset:3072 sc1 lds
    s_add_u32 m0, s31, 73728
    s_mov_b64 exec, s[42:43]
    buffer_load_dwordx4 v15, s[96:99], s49 offen sc1 lds
    s_mov_b64 exec, -1
    s_waitcnt vmcnt(18)
    s_barrier
    s_add_u32 m0, s33, 104448
    s_cmp_eq_u32 s48, 3
    s_mov_b32 s32, 3456
    s_cselect_b32 s32, 3968, s32
    buffer_load_dwordx4 v10, s[16:19], s32 offen offset:0 lds
    buffer_load_dwordx4 v11, s[16:19], s32 offen offset:1024 lds
    buffer_load_dwordx4 v12, s[16:19], s32 offen offset:2048 lds
    buffer_load_dwordx4 v13, s[16:19], s32 offen offset:3072 lds
    s_add_u32 m0, s31, 104448
    s_cmp_eq_u32 s48, 3
    s_mov_b32 s49, 497664
    s_cselect_b32 s49, 571392, s49
    s_add_u32 s49, s49, s30
    buffer_load_dwordx4 v5, s[96:99], s49 offen offset:0 sc1 lds
    buffer_load_dwordx4 v5, s[96:99], s49 offen offset:1024 sc1 lds
    buffer_load_dwordx4 v5, s[96:99], s49 offen offset:2048 sc1 lds
    buffer_load_dwordx4 v5, s[96:99], s49 offen offset:3072 sc1 lds
    s_add_u32 m0, s31, 108544
    s_mov_b64 exec, s[42:43]
    buffer_load_dwordx4 v15, s[96:99], s49 offen sc1 lds
    s_mov_b64 exec, -1
    s_waitcnt vmcnt(18)
    s_barrier
    s_add_u32 m0, s33, 0
    s_cmp_eq_u32 s48, 0
    s_mov_b32 s32, 3584
    s_cselect_b32 s32, 0, s32
    buffer_load_dwordx4 v10, s[16:19], s32 offen offset:0 lds
    buffer_load_dwordx4 v11, s[16:19], s32 offen offset:1024 lds
    buffer_load_dwordx4 v12, s[16:19], s32 offen offset:2048 lds
    buffer_load_dwordx4 v13, s[16:19], s32 offen offset:3072 lds
    s_add_u32 m0, s31, 0
    s_cmp_eq_u32 s48, 0
    s_mov_b32 s49, 516096
    s_cselect_b32 s49, 0, s49
    s_add_u32 s49, s49, s30
    buffer_load_dwordx4 v5, s[96:99], s49 offen offset:0 sc1 lds
    buffer_load_dwordx4 v5, s[96:99], s49 offen offset:1024 sc1 lds
    buffer_load_dwordx4 v5, s[96:99], s49 offen offset:2048 sc1 lds
    buffer_load_dwordx4 v5, s[96:99], s49 offen offset:3072 sc1 lds
    s_add_u32 m0, s31, 4096
    s_mov_b64 exec, s[42:43]
    buffer_load_dwordx4 v15, s[96:99], s49 offen sc1 lds
    s_mov_b64 exec, -1
    s_waitcnt vmcnt(18)
    s_barrier
    s_add_u32 m0, s33, 34816
    s_cmp_eq_u32 s48, 1
    s_mov_b32 s32, 3712
    s_cselect_b32 s32, 128, s32
    buffer_load_dwordx4 v10, s[16:19], s32 offen offset:0 lds
    buffer_load_dwordx4 v11, s[16:19], s32 offen offset:1024 lds
    buffer_load_dwordx4 v12, s[16:19], s32 offen offset:2048 lds
    buffer_load_dwordx4 v13, s[16:19], s32 offen offset:3072 lds
    s_add_u32 m0, s31, 34816
    s_cmp_eq_u32 s48, 1
    s_mov_b32 s49, 534528
    s_cselect_b32 s49, 18432, s49
    s_add_u32 s49, s49, s30
    buffer_load_dwordx4 v5, s[96:99], s49 offen offset:0 sc1 lds
    buffer_load_dwordx4 v5, s[96:99], s49 offen offset:1024 sc1 lds
    buffer_load_dwordx4 v5, s[96:99], s49 offen offset:2048 sc1 lds
    buffer_load_dwordx4 v5, s[96:99], s49 offen offset:3072 sc1 lds
    s_add_u32 m0, s31, 38912
    s_mov_b64 exec, s[42:43]
    buffer_load_dwordx4 v15, s[96:99], s49 offen sc1 lds
    s_mov_b64 exec, -1
    s_waitcnt vmcnt(18)
    s_barrier
    s_add_u32 m0, s33, 69632
    s_cmp_eq_u32 s48, 2
    s_mov_b32 s32, 3840
    s_cselect_b32 s32, 256, s32
    buffer_load_dwordx4 v10, s[16:19], s32 offen offset:0 lds
    buffer_load_dwordx4 v11, s[16:19], s32 offen offset:1024 lds
    buffer_load_dwordx4 v12, s[16:19], s32 offen offset:2048 lds
    buffer_load_dwordx4 v13, s[16:19], s32 offen offset:3072 lds
    s_add_u32 m0, s31, 69632
    s_cmp_eq_u32 s48, 2
    s_mov_b32 s49, 552960
    s_cselect_b32 s49, 36864, s49
    s_add_u32 s49, s49, s30
    buffer_load_dwordx4 v5, s[96:99], s49 offen offset:0 sc1 lds
    buffer_load_dwordx4 v5, s[96:99], s49 offen offset:1024 sc1 lds
    buffer_load_dwordx4 v5, s[96:99], s49 offen offset:2048 sc1 lds
    buffer_load_dwordx4 v5, s[96:99], s49 offen offset:3072 sc1 lds
    s_add_u32 m0, s31, 73728
    s_mov_b64 exec, s[42:43]
    buffer_load_dwordx4 v15, s[96:99], s49 offen sc1 lds
    s_mov_b64 exec, -1
    s_waitcnt vmcnt(18)
    s_barrier
    s_add_u32 m0, s33, 104448
    s_cmp_eq_u32 s48, 3
    s_mov_b32 s32, 3968
    s_cselect_b32 s32, 384, s32
    buffer_load_dwordx4 v10, s[16:19], s32 offen offset:0 lds
    buffer_load_dwordx4 v11, s[16:19], s32 offen offset:1024 lds
    buffer_load_dwordx4 v12, s[16:19], s32 offen offset:2048 lds
    buffer_load_dwordx4 v13, s[16:19], s32 offen offset:3072 lds
    s_add_u32 m0, s31, 104448
    s_cmp_eq_u32 s48, 3
    s_mov_b32 s49, 571392
    s_cselect_b32 s49, 55296, s49
    s_add_u32 s49, s49, s30
    buffer_load_dwordx4 v5, s[96:99], s49 offen offset:0 sc1 lds
    buffer_load_dwordx4 v5, s[96:99], s49 offen offset:1024 sc1 lds
    buffer_load_dwordx4 v5, s[96:99], s49 offen offset:2048 sc1 lds
    buffer_load_dwordx4 v5, s[96:99], s49 offen offset:3072 sc1 lds
    s_add_u32 m0, s31, 108544
    s_mov_b64 exec, s[42:43]
    buffer_load_dwordx4 v15, s[96:99], s49 offen sc1 lds
    s_mov_b64 exec, -1
    s_waitcnt vmcnt(18)
    s_barrier
    s_waitcnt vmcnt(9)
    s_barrier
    s_waitcnt vmcnt(0)
    s_barrier
    s_waitcnt lgkmcnt(0)
    s_barrier
    s_branch P3
P3:
    s_load_dwordx2 s[4:5], s[0:1], 112
    v_and_b32 v2, 63, v0
    s_and_b32 s3, s101, 3
    s_and_b32 s10, s91, 7
    s_lshr_b32 s11, s91, 3
    s_lshr_b32 s12, s10, 1
    s_lshl_b32 s12, s12, 3
    s_and_b32 s13, s11, 7
    s_add_u32 s12, s12, s13
    s_and_b32 s13, s10, 1
    s_lshl_b32 s13, s13, 2
    s_lshr_b32 s14, s11, 3
    s_add_u32 s13, s13, s14
    s_mul_i32 s14, s13, 9
    s_add_u32 s14, s14, 1
    s_lshr_b32 s14, s14, 1
    v_lshlrev_b32 v5, 4, v2
    s_mul_i32 s15, s12, 294912
    s_add_u32 s15, s15, 16777216
    s_mul_i32 s28, s14, 73728
    s_add_u32 s28, s28, 6291456
    s_mul_i32 s29, s3, 18432
    s_mov_b32 s31, s29
    v_lshlrev_b32 v35, 3, v2
    v_add_u32 v35, 20971520, v35
    v_add_u32 v8, s15, v5
    v_add_u32 v36, s15, v35
    s_add_u32 s15, s15, 73728
    v_add_u32 v9, s15, v5
    v_add_u32 v37, s15, v35
    s_add_u32 s15, s15, 73728
    v_add_u32 v10, s15, v5
    v_add_u32 v38, s15, v35
    s_add_u32 s15, s15, 73728
    v_add_u32 v11, s15, v5
    v_add_u32 v39, s15, v35
    s_add_u32 s15, s15, 73728
    v_add_u32 v12, s28, v5
    s_add_u32 s28, s28, 73728
    v_add_u32 v13, s28, v5
    s_add_u32 s28, s28, 73728
    v_add_u32 v14, s28, v5
    s_add_u32 s28, s28, 73728
    v_add_u32 v15, s28, v5
    s_add_u32 s28, s28, 73728
    v_add_u32 v16, s28, v5
    s_add_u32 s28, s28, 73728
    s_waitcnt lgkmcnt(0)
    s_mov_b32 s16, s4
    s_and_b32 s17, s5, 0xffff
    s_mov_b32 s18, 2359296
    s_mov_b32 s19, 0x20000
    v_and_b32 v3, 15, v2
    v_lshrrev_b32 v4, 4, v2
    s_lshl_b32 s30, s12, 1
    s_lshr_b32 s32, s3, 1
    s_add_u32 s30, s30, s32
    s_mul_i32 s30, s30, 36
    s_add_u32 s30, s30, s14
    s_lshl_b32 s30, s30, 10
    s_add_u32 s30, s30, 12582912
    s_and_b32 s32, s3, 1
    s_lshl_b32 s32, s32, 3
    s_add_u32 s30, s30, s32
    v_mov_b32 v6, v5
    s_lshl_b32 s32, s12, 6
    s_lshl_b32 s33, s3, 4
    s_add_u32 s32, s32, s33
    v_add_u32 v7, s32, v3
    s_movk_i32 s33, 1152
    v_mul_lo_u32 v7, v7, s33
    v_lshl_add_u32 v7, v4, 3, v7
    s_lshl_b32 s33, s14, 5
    v_min_u32 v17, 35, v2
    v_lshlrev_b32 v17, 3, v17
    s_mul_i32 s36, s3, 288
    s_add_u32 s36, s36, 49356800
    v_and_b32 v18, 3, v2
    v_bfe_u32 v19, v2, 2, 1
    v_lshlrev_b32 v18, 2, v18
    v_lshl_add_u32 v18, v19, 6, v18
    s_lshl_b32 s37, s12, 7
    s_lshl_b32 s38, s3, 4
    s_add_u32 s37, s37, s38
    s_add_u32 s37, s37, 49369088
    s_mov_b32 s90, 0
Lpl42:
    buffer_load_dwordx2 v[30:31], v17, s[96:99], s36 offen sc1
    s_waitcnt vmcnt(0)
    v_cmp_ne_u32 vcc, s100, v30
    v_cmp_ne_u32 s[88:89], s100, v31
    s_or_b64 vcc, vcc, s[88:89]
    s_add_u32 s90, s90, 1
    s_cmp_eq_u64 vcc, 0
    s_cbranch_scc1 Lok43
    s_sleep 16
    s_cmp_lt_u32 s90, 0x20000
    s_cbranch_scc1 Lpl42
Lok43:
    s_and_b32 s34, s13, 1
    s_cmp_eq_u32 s34, 1
    s_cbranch_scc1 Lg3b
    buffer_load_dwordx4 v[56:59], v12, s[96:99], s31 offen sc1
    buffer_load_dwordx4 v[60:63], v13, s[96:99], s31 offen sc1
    buffer_load_dwordx4 v[64:67], v14, s[96:99], s31 offen sc1
    buffer_load_dwordx4 v[68:71], v15, s[96:99], s31 offen sc1
    buffer_load_dwordx4 v[72:75], v16, s[96:99], s31 offen sc1
    s_add_u32 s31, s31, 1024
    buffer_load_dwordx4 v[92:95], v12, s[96:99], s31 offen sc1
    buffer_load_dwordx4 v[96:99], v13, s[96:99], s31 offen sc1
    buffer_load_dwordx4 v[100:103], v14, s[96:99], s31 offen sc1
    buffer_load_dwordx4 v[104:107], v15, s[96:99], s31 offen sc1
    buffer_load_dwordx4 v[108:111], v16, s[96:99], s31 offen sc1
    s_add_u32 s31, s31, 1024
    buffer_load_dwordx4 v[128:131], v12, s[96:99], s31 offen sc1
    buffer_load_dwordx4 v[132:135], v13, s[96:99], s31 offen sc1
    buffer_load_dwordx4 v[136:139], v14, s[96:99], s31 offen sc1
    buffer_load_dwordx4 v[140:143], v15, s[96:99], s31 offen sc1
    buffer_load_dwordx4 v[144:147], v16, s[96:99], s31 offen sc1
    s_add_u32 s31, s31, 1024
    s_add_u32 s35, s30, 4096
    buffer_load_dwordx2 v[20:21], v6, s[96:99], s30 offen offset:0 sc1
    buffer_load_dwordx2 v[22:23], v6, s[96:99], s30 offen offset:1024 sc1
    buffer_load_dwordx2 v[24:25], v6, s[96:99], s30 offen offset:2048 sc1
    buffer_load_dwordx2 v[26:27], v6, s[96:99], s30 offen offset:3072 sc1
    buffer_load_dwordx2 v[28:29], v6, s[96:99], s35 offen offset:0 sc1
    s_barrier
    s_mul_i32 s38, s3, 34816
    v_add_u32 v32, s38, v5
    buffer_load_dword v30, v18, s[96:99], s37 offen sc1
    s_add_u32 m0, s38, 0
    s_nop 0
    buffer_load_dwordx4 v12, s[96:99], s31 offen sc1 lds
    s_add_u32 m0, s38, 1024
    s_nop 0
    buffer_load_dwordx4 v13, s[96:99], s31 offen sc1 lds
    s_add_u32 m0, s38, 2048
    s_nop 0
    buffer_load_dwordx4 v14, s[96:99], s31 offen sc1 lds
    s_add_u32 m0, s38, 3072
    s_nop 0
    buffer_load_dwordx4 v15, s[96:99], s31 offen sc1 lds
    s_add_u32 m0, s38, 4096
    s_nop 0
    buffer_load_dwordx4 v16, s[96:99], s31 offen sc1 lds
    s_add_u32 s31, s31, 1024
    s_add_u32 m0, s38, 5120
    s_nop 0
    buffer_load_dwordx4 v12, s[96:99], s31 offen sc1 lds
    s_add_u32 m0, s38, 6144
    s_nop 0
    buffer_load_dwordx4 v13, s[96:99], s31 offen sc1 lds
    s_add_u32 m0, s38, 7168
    s_nop 0
    buffer_load_dwordx4 v14, s[96:99], s31 offen sc1 lds
    s_add_u32 m0, s38, 8192
    s_nop 0
    buffer_load_dwordx4 v15, s[96:99], s31 offen sc1 lds
    s_add_u32 m0, s38, 9216
    s_nop 0
    buffer_load_dwordx4 v16, s[96:99], s31 offen sc1 lds
    s_add_u32 s31, s31, 1024
    s_add_u32 m0, s38, 10240
    s_nop 0
    buffer_load_dwordx4 v12, s[96:99], s31 offen sc1 lds
    s_add_u32 m0, s38, 11264
    s_nop 0
    buffer_load_dwordx4 v13, s[96:99], s31 offen sc1 lds
    s_add_u32 m0, s38, 12288
    s_nop 0
    buffer_load_dwordx4 v14, s[96:99], s31 offen sc1 lds
    s_add_u32 m0, s38, 13312
    s_nop 0
    buffer_load_dwordx4 v15, s[96:99], s31 offen sc1 lds
    s_add_u32 m0, s38, 14336
    s_nop 0
    buffer_load_dwordx4 v16, s[96:99], s31 offen sc1 lds
    s_add_u32 s31, s31, 1024
    s_add_u32 m0, s38, 15360
    s_nop 0
    buffer_load_dwordx4 v12, s[96:99], s31 offen sc1 lds
    s_add_u32 m0, s38, 16384
    s_nop 0
    buffer_load_dwordx4 v13, s[96:99], s31 offen sc1 lds
    s_add_u32 m0, s38, 17408
    s_nop 0
    buffer_load_dwordx4 v14, s[96:99], s31 offen sc1 lds
    s_add_u32 m0, s38, 18432
    s_nop 0
    buffer_load_dwordx4 v15, s[96:99], s31 offen sc1 lds
    s_add_u32 m0, s38, 19456
    s_nop 0
    buffer_load_dwordx4 v16, s[96:99], s31 offen sc1 lds
    s_add_u32 s31, s31, 1024
    s_waitcnt vmcnt(20)
    v_cmp_ne_u32 vcc, s100, v30
    s_nop 0
    s_cmp_eq_u64 vcc, 0
    s_cbranch_scc1 Lg3ok44
    s_mov_b32 s90, 0
Lpl45:
    buffer_load_dword v30, v18, s[96:99], s37 offen sc1
    s_waitcnt vmcnt(0)
    v_cmp_ne_u32 vcc, s100, v30
    s_add_u32 s90, s90, 1
    s_cmp_eq_u64 vcc, 0
    s_cbranch_scc1 Lok46
    s_sleep 8
    s_cmp_lt_u32 s90, 0x20000
    s_cbranch_scc1 Lpl45
Lok46:
Lg3ok44:
    buffer_load_dwordx4 v[40:43], v8, s[96:99], s29 offen sc1
    buffer_load_dwordx4 v[44:47], v9, s[96:99], s29 offen sc1
    buffer_load_dwordx4 v[48:51], v10, s[96:99], s29 offen sc1
    buffer_load_dwordx4 v[52:55], v11, s[96:99], s29 offen sc1
    s_add_u32 s29, s29, 1024
    buffer_load_dwordx4 v[76:79], v8, s[96:99], s29 offen sc1
    buffer_load_dwordx4 v[80:83], v9, s[96:99], s29 offen sc1
    buffer_load_dwordx4 v[84:87], v10, s[96:99], s29 offen sc1
    buffer_load_dwordx4 v[88:91], v11, s[96:99], s29 offen sc1
    s_add_u32 s29, s29, 1024
    buffer_load_dwordx4 v[112:115], v8, s[96:99], s29 offen sc1
    buffer_load_dwordx4 v[116:119], v9, s[96:99], s29 offen sc1
    buffer_load_dwordx4 v[120:123], v10, s[96:99], s29 offen sc1
    buffer_load_dwordx4 v[124:127], v11, s[96:99], s29 offen sc1
    s_add_u32 s29, s29, 1024
    s_waitcnt vmcnt(8)
    v_mfma_f32_16x16x32_bf16 v[160:163], v[56:59], v[40:43], 0
    v_mfma_f32_16x16x32_bf16 v[164:167], v[56:59], v[44:47], 0
    v_mfma_f32_16x16x32_bf16 v[168:171], v[56:59], v[48:51], 0
    v_mfma_f32_16x16x32_bf16 v[172:175], v[56:59], v[52:55], 0
    v_mfma_f32_16x16x32_bf16 v[176:179], v[60:63], v[40:43], 0
    v_mfma_f32_16x16x32_bf16 v[180:183], v[60:63], v[44:47], 0
    v_mfma_f32_16x16x32_bf16 v[184:187], v[60:63], v[48:51], 0
    v_mfma_f32_16x16x32_bf16 v[188:191], v[60:63], v[52:55], 0
    v_mfma_f32_16x16x32_bf16 v[192:195], v[64:67], v[40:43], 0
    v_mfma_f32_16x16x32_bf16 v[196:199], v[64:67], v[44:47], 0
    v_mfma_f32_16x16x32_bf16 v[200:203], v[64:67], v[48:51], 0
    v_mfma_f32_16x16x32_bf16 v[204:207], v[64:67], v[52:55], 0
    v_mfma_f32_16x16x32_bf16 v[208:211], v[68:71], v[40:43], 0
    v_mfma_f32_16x16x32_bf16 v[212:215], v[68:71], v[44:47], 0
    v_mfma_f32_16x16x32_bf16 v[216:219], v[68:71], v[48:51], 0
    v_mfma_f32_16x16x32_bf16 v[220:223], v[68:71], v[52:55], 0
    v_mfma_f32_16x16x32_bf16 v[224:227], v[72:75], v[40:43], 0
    v_mfma_f32_16x16x32_bf16 v[228:231], v[72:75], v[44:47], 0
    v_mfma_f32_16x16x32_bf16 v[232:235], v[72:75], v[48:51], 0
    v_mfma_f32_16x16x32_bf16 v[236:239], v[72:75], v[52:55], 0
    buffer_load_dwordx4 v[40:43], v8, s[96:99], s29 offen sc1
    buffer_load_dwordx4 v[44:47], v9, s[96:99], s29 offen sc1
    buffer_load_dwordx4 v[48:51], v10, s[96:99], s29 offen sc1
    buffer_load_dwordx4 v[52:55], v11, s[96:99], s29 offen sc1
    s_add_u32 s29, s29, 1024
    ds_read_b128 v[56:59], v32 offset:0
    ds_read_b128 v[60:63], v32 offset:1024
    ds_read_b128 v[64:67], v32 offset:2048
    ds_read_b128 v[68:71], v32 offset:3072
    ds_read_b128 v[72:75], v32 offset:4096
    s_waitcnt vmcnt(8)
    v_mfma_f32_16x16x32_bf16 v[160:163], v[92:95], v[76:79], v[160:163]
    v_mfma_f32_16x16x32_bf16 v[164:167], v[92:95], v[80:83], v[164:167]
    v_mfma_f32_16x16x32_bf16 v[168:171], v[92:95], v[84:87], v[168:171]
    v_mfma_f32_16x16x32_bf16 v[172:175], v[92:95], v[88:91], v[172:175]
    v_mfma_f32_16x16x32_bf16 v[176:179], v[96:99], v[76:79], v[176:179]
    v_mfma_f32_16x16x32_bf16 v[180:183], v[96:99], v[80:83], v[180:183]
    v_mfma_f32_16x16x32_bf16 v[184:187], v[96:99], v[84:87], v[184:187]
    v_mfma_f32_16x16x32_bf16 v[188:191], v[96:99], v[88:91], v[188:191]
    v_mfma_f32_16x16x32_bf16 v[192:195], v[100:103], v[76:79], v[192:195]
    v_mfma_f32_16x16x32_bf16 v[196:199], v[100:103], v[80:83], v[196:199]
    v_mfma_f32_16x16x32_bf16 v[200:203], v[100:103], v[84:87], v[200:203]
    v_mfma_f32_16x16x32_bf16 v[204:207], v[100:103], v[88:91], v[204:207]
    v_mfma_f32_16x16x32_bf16 v[208:211], v[104:107], v[76:79], v[208:211]
    v_mfma_f32_16x16x32_bf16 v[212:215], v[104:107], v[80:83], v[212:215]
    v_mfma_f32_16x16x32_bf16 v[216:219], v[104:107], v[84:87], v[216:219]
    v_mfma_f32_16x16x32_bf16 v[220:223], v[104:107], v[88:91], v[220:223]
    v_mfma_f32_16x16x32_bf16 v[224:227], v[108:111], v[76:79], v[224:227]
    v_mfma_f32_16x16x32_bf16 v[228:231], v[108:111], v[80:83], v[228:231]
    v_mfma_f32_16x16x32_bf16 v[232:235], v[108:111], v[84:87], v[232:235]
    v_mfma_f32_16x16x32_bf16 v[236:239], v[108:111], v[88:91], v[236:239]
    buffer_load_dwordx2 v[76:77], v36, s[96:99], s29 offen sc1
    buffer_load_dwordx2 v[78:79], v36, s[96:99], s29 offen offset:512 sc1
    buffer_load_dwordx2 v[80:81], v37, s[96:99], s29 offen sc1
    buffer_load_dwordx2 v[82:83], v37, s[96:99], s29 offen offset:512 sc1
    buffer_load_dwordx2 v[84:85], v38, s[96:99], s29 offen sc1
    buffer_load_dwordx2 v[86:87], v38, s[96:99], s29 offen offset:512 sc1
    buffer_load_dwordx2 v[88:89], v39, s[96:99], s29 offen sc1
    buffer_load_dwordx2 v[90:91], v39, s[96:99], s29 offen offset:512 sc1
    s_add_u32 s29, s29, 1024
    ds_read_b128 v[92:95], v32 offset:5120
    ds_read_b128 v[96:99], v32 offset:6144
    ds_read_b128 v[100:103], v32 offset:7168
    ds_read_b128 v[104:107], v32 offset:8192
    ds_read_b128 v[108:111], v32 offset:9216
    s_waitcnt vmcnt(12)
    v_mfma_f32_16x16x32_bf16 v[160:163], v[128:131], v[112:115], v[160:163]
    v_mfma_f32_16x16x32_bf16 v[164:167], v[128:131], v[116:119], v[164:167]
    v_mfma_f32_16x16x32_bf16 v[168:171], v[128:131], v[120:123], v[168:171]
    v_mfma_f32_16x16x32_bf16 v[172:175], v[128:131], v[124:127], v[172:175]
    v_mfma_f32_16x16x32_bf16 v[176:179], v[132:135], v[112:115], v[176:179]
    v_mfma_f32_16x16x32_bf16 v[180:183], v[132:135], v[116:119], v[180:183]
    v_mfma_f32_16x16x32_bf16 v[184:187], v[132:135], v[120:123], v[184:187]
    v_mfma_f32_16x16x32_bf16 v[188:191], v[132:135], v[124:127], v[188:191]
    v_mfma_f32_16x16x32_bf16 v[192:195], v[136:139], v[112:115], v[192:195]
    v_mfma_f32_16x16x32_bf16 v[196:199], v[136:139], v[116:119], v[196:199]
    v_mfma_f32_16x16x32_bf16 v[200:203], v[136:139], v[120:123], v[200:203]
    v_mfma_f32_16x16x32_bf16 v[204:207], v[136:139], v[124:127], v[204:207]
    v_mfma_f32_16x16x32_bf16 v[208:211], v[140:143], v[112:115], v[208:211]
    v_mfma_f32_16x16x32_bf16 v[212:215], v[140:143], v[116:119], v[212:215]
    v_mfma_f32_16x16x32_bf16 v[216:219], v[140:143], v[120:123], v[216:219]
    v_mfma_f32_16x16x32_bf16 v[220:223], v[140:143], v[124:127], v[220:223]
    v_mfma_f32_16x16x32_bf16 v[224:227], v[144:147], v[112:115], v[224:227]
    v_mfma_f32_16x16x32_bf16 v[228:231], v[144:147], v[116:119], v[228:231]
    v_mfma_f32_16x16x32_bf16 v[232:235], v[144:147], v[120:123], v[232:235]
    v_mfma_f32_16x16x32_bf16 v[236:239], v[144:147], v[124:127], v[236:239]
    buffer_load_dwordx4 v[112:115], v8, s[96:99], s29 offen sc1
    buffer_load_dwordx4 v[116:119], v9, s[96:99], s29 offen sc1
    buffer_load_dwordx4 v[120:123], v10, s[96:99], s29 offen sc1
    buffer_load_dwordx4 v[124:127], v11, s[96:99], s29 offen sc1
    s_add_u32 s29, s29, 1024
    ds_read_b128 v[128:131], v32 offset:10240
    ds_read_b128 v[132:135], v32 offset:11264
    ds_read_b128 v[136:139], v32 offset:12288
    ds_read_b128 v[140:143], v32 offset:13312
    ds_read_b128 v[144:147], v32 offset:14336
    s_waitcnt vmcnt(12)
    s_waitcnt lgkmcnt(10)
    v_mfma_f32_16x16x32_bf16 v[160:163], v[56:59], v[40:43], v[160:163]
    v_mfma_f32_16x16x32_bf16 v[164:167], v[56:59], v[44:47], v[164:167]
    v_mfma_f32_16x16x32_bf16 v[168:171], v[56:59], v[48:51], v[168:171]
    v_mfma_f32_16x16x32_bf16 v[172:175], v[56:59], v[52:55], v[172:175]
    v_mfma_f32_16x16x32_bf16 v[176:179], v[60:63], v[40:43], v[176:179]
    v_mfma_f32_16x16x32_bf16 v[180:183], v[60:63], v[44:47], v[180:183]
    v_mfma_f32_16x16x32_bf16 v[184:187], v[60:63], v[48:51], v[184:187]
    v_mfma_f32_16x16x32_bf16 v[188:191], v[60:63], v[52:55], v[188:191]
    v_mfma_f32_16x16x32_bf16 v[192:195], v[64:67], v[40:43], v[192:195]
    v_mfma_f32_16x16x32_bf16 v[196:199], v[64:67], v[44:47], v[196:199]
    v_mfma_f32_16x16x32_bf16 v[200:203], v[64:67], v[48:51], v[200:203]
    v_mfma_f32_16x16x32_bf16 v[204:207], v[64:67], v[52:55], v[204:207]
    v_mfma_f32_16x16x32_bf16 v[208:211], v[68:71], v[40:43], v[208:211]
    v_mfma_f32_16x16x32_bf16 v[212:215], v[68:71], v[44:47], v[212:215]
    v_mfma_f32_16x16x32_bf16 v[216:219], v[68:71], v[48:51], v[216:219]
    v_mfma_f32_16x16x32_bf16 v[220:223], v[68:71], v[52:55], v[220:223]
    v_mfma_f32_16x16x32_bf16 v[224:227], v[72:75], v[40:43], v[224:227]
    v_mfma_f32_16x16x32_bf16 v[228:231], v[72:75], v[44:47], v[228:231]
    v_mfma_f32_16x16x32_bf16 v[232:235], v[72:75], v[48:51], v[232:235]
    v_mfma_f32_16x16x32_bf16 v[236:239], v[72:75], v[52:55], v[236:239]
    buffer_load_dwordx4 v[40:43], v8, s[96:99], s29 offen sc1
    buffer_load_dwordx4 v[44:47], v9, s[96:99], s29 offen sc1
    buffer_load_dwordx4 v[48:51], v10, s[96:99], s29 offen sc1
    buffer_load_dwordx4 v[52:55], v11, s[96:99], s29 offen sc1
    s_add_u32 s29, s29, 1024
    ds_read_b128 v[56:59], v32 offset:15360
    ds_read_b128 v[60:63], v32 offset:16384
    ds_read_b128 v[64:67], v32 offset:17408
    ds_read_b128 v[68:71], v32 offset:18432
    ds_read_b128 v[72:75], v32 offset:19456
    s_waitcnt vmcnt(8)
    s_waitcnt lgkmcnt(10)
    v_mfma_f32_16x16x32_bf16 v[160:163], v[92:95], v[76:79], v[160:163]
    v_mfma_f32_16x16x32_bf16 v[164:167], v[92:95], v[80:83], v[164:167]
    v_mfma_f32_16x16x32_bf16 v[168:171], v[92:95], v[84:87], v[168:171]
    v_mfma_f32_16x16x32_bf16 v[172:175], v[92:95], v[88:91], v[172:175]
    v_mfma_f32_16x16x32_bf16 v[176:179], v[96:99], v[76:79], v[176:179]
    v_mfma_f32_16x16x32_bf16 v[180:183], v[96:99], v[80:83], v[180:183]
    v_mfma_f32_16x16x32_bf16 v[184:187], v[96:99], v[84:87], v[184:187]
    v_mfma_f32_16x16x32_bf16 v[188:191], v[96:99], v[88:91], v[188:191]
    v_mfma_f32_16x16x32_bf16 v[192:195], v[100:103], v[76:79], v[192:195]
    v_mfma_f32_16x16x32_bf16 v[196:199], v[100:103], v[80:83], v[196:199]
    v_mfma_f32_16x16x32_bf16 v[200:203], v[100:103], v[84:87], v[200:203]
    v_mfma_f32_16x16x32_bf16 v[204:207], v[100:103], v[88:91], v[204:207]
    v_mfma_f32_16x16x32_bf16 v[208:211], v[104:107], v[76:79], v[208:211]
    v_mfma_f32_16x16x32_bf16 v[212:215], v[104:107], v[80:83], v[212:215]
    v_mfma_f32_16x16x32_bf16 v[216:219], v[104:107], v[84:87], v[216:219]
    v_mfma_f32_16x16x32_bf16 v[220:223], v[104:107], v[88:91], v[220:223]
    v_mfma_f32_16x16x32_bf16 v[224:227], v[108:111], v[76:79], v[224:227]
    v_mfma_f32_16x16x32_bf16 v[228:231], v[108:111], v[80:83], v[228:231]
    v_mfma_f32_16x16x32_bf16 v[232:235], v[108:111], v[84:87], v[232:235]
    v_mfma_f32_16x16x32_bf16 v[236:239], v[108:111], v[88:91], v[236:239]
    buffer_load_dwordx4 v[76:79], v8, s[96:99], s29 offen sc1
    buffer_load_dwordx4 v[80:83], v9, s[96:99], s29 offen sc1
    buffer_load_dwordx4 v[84:87], v10, s[96:99], s29 offen sc1
    buffer_load_dwordx4 v[88:91], v11, s[96:99], s29 offen sc1
    s_add_u32 s29, s29, 1024
    buffer_load_dwordx4 v[92:95], v12, s[96:99], s31 offen sc1
    buffer_load_dwordx4 v[96:99], v13, s[96:99], s31 offen sc1
    buffer_load_dwordx4 v[100:103], v14, s[96:99], s31 offen sc1
    buffer_load_dwordx4 v[104:107], v15, s[96:99], s31 offen sc1
    buffer_load_dwordx4 v[108:111], v16, s[96:99], s31 offen sc1
    s_add_u32 s31, s31, 1024
    s_waitcnt vmcnt(13)
    s_waitcnt lgkmcnt(5)
    v_mfma_f32_16x16x32_bf16 v[160:163], v[128:131], v[112:115], v[160:163]
    v_mfma_f32_16x16x32_bf16 v[164:167], v[128:131], v[116:119], v[164:167]
    v_mfma_f32_16x16x32_bf16 v[168:171], v[128:131], v[120:123], v[168:171]
    v_mfma_f32_16x16x32_bf16 v[172:175], v[128:131], v[124:127], v[172:175]
    v_mfma_f32_16x16x32_bf16 v[176:179], v[132:135], v[112:115], v[176:179]
    v_mfma_f32_16x16x32_bf16 v[180:183], v[132:135], v[116:119], v[180:183]
    v_mfma_f32_16x16x32_bf16 v[184:187], v[132:135], v[120:123], v[184:187]
    v_mfma_f32_16x16x32_bf16 v[188:191], v[132:135], v[124:127], v[188:191]
    v_mfma_f32_16x16x32_bf16 v[192:195], v[136:139], v[112:115], v[192:195]
    v_mfma_f32_16x16x32_bf16 v[196:199], v[136:139], v[116:119], v[196:199]
    v_mfma_f32_16x16x32_bf16 v[200:203], v[136:139], v[120:123], v[200:203]
    v_mfma_f32_16x16x32_bf16 v[204:207], v[136:139], v[124:127], v[204:207]
    v_mfma_f32_16x16x32_bf16 v[208:211], v[140:143], v[112:115], v[208:211]
    v_mfma_f32_16x16x32_bf16 v[212:215], v[140:143], v[116:119], v[212:215]
    v_mfma_f32_16x16x32_bf16 v[216:219], v[140:143], v[120:123], v[216:219]
    v_mfma_f32_16x16x32_bf16 v[220:223], v[140:143], v[124:127], v[220:223]
    v_mfma_f32_16x16x32_bf16 v[224:227], v[144:147], v[112:115], v[224:227]
    v_mfma_f32_16x16x32_bf16 v[228:231], v[144:147], v[116:119], v[228:231]
    v_mfma_f32_16x16x32_bf16 v[232:235], v[144:147], v[120:123], v[232:235]
    v_mfma_f32_16x16x32_bf16 v[236:239], v[144:147], v[124:127], v[236:239]
    buffer_load_dwordx4 v[112:115], v8, s[96:99], s29 offen sc1
    buffer_load_dwordx4 v[116:119], v9, s[96:99], s29 offen sc1
    buffer_load_dwordx4 v[120:123], v10, s[96:99], s29 offen sc1
    buffer_load_dwordx4 v[124:127], v11, s[96:99], s29 offen sc1
    s_add_u32 s29, s29, 1024
    buffer_load_dwordx4 v[128:131], v12, s[96:99], s31 offen sc1
    buffer_load_dwordx4 v[132:135], v13, s[96:99], s31 offen sc1
    buffer_load_dwordx4 v[136:139], v14, s[96:99], s31 offen sc1
    buffer_load_dwordx4 v[140:143], v15, s[96:99], s31 offen sc1
    buffer_load_dwordx4 v[144:147], v16, s[96:99], s31 offen sc1
    s_add_u32 s31, s31, 1024
    s_waitcnt vmcnt(18)
    s_waitcnt lgkmcnt(0)
    v_mfma_f32_16x16x32_bf16 v[160:163], v[56:59], v[40:43], v[160:163]
    v_mfma_f32_16x16x32_bf16 v[164:167], v[56:59], v[44:47], v[164:167]
    v_mfma_f32_16x16x32_bf16 v[168:171], v[56:59], v[48:51], v[168:171]
    v_mfma_f32_16x16x32_bf16 v[172:175], v[56:59], v[52:55], v[172:175]
    v_mfma_f32_16x16x32_bf16 v[176:179], v[60:63], v[40:43], v[176:179]
    v_mfma_f32_16x16x32_bf16 v[180:183], v[60:63], v[44:47], v[180:183]
    v_mfma_f32_16x16x32_bf16 v[184:187], v[60:63], v[48:51], v[184:187]
    v_mfma_f32_16x16x32_bf16 v[188:191], v[60:63], v[52:55], v[188:191]
    v_mfma_f32_16x16x32_bf16 v[192:195], v[64:67], v[40:43], v[192:195]
    v_mfma_f32_16x16x32_bf16 v[196:199], v[64:67], v[44:47], v[196:199]
    v_mfma_f32_16x16x32_bf16 v[200:203], v[64:67], v[48:51], v[200:203]
    v_mfma_f32_16x16x32_bf16 v[204:207], v[64:67], v[52:55], v[204:207]
    v_mfma_f32_16x16x32_bf16 v[208:211], v[68:71], v[40:43], v[208:211]
    v_mfma_f32_16x16x32_bf16 v[212:215], v[68:71], v[44:47], v[212:215]
    v_mfma_f32_16x16x32_bf16 v[216:219], v[68:71], v[48:51], v[216:219]
    v_mfma_f32_16x16x32_bf16 v[220:223], v[68:71], v[52:55], v[220:223]
    v_mfma_f32_16x16x32_bf16 v[224:227], v[72:75], v[40:43], v[224:227]
    v_mfma_f32_16x16x32_bf16 v[228:231], v[72:75], v[44:47], v[228:231]
    v_mfma_f32_16x16x32_bf16 v[232:235], v[72:75], v[48:51], v[232:235]
    v_mfma_f32_16x16x32_bf16 v[236:239], v[72:75], v[52:55], v[236:239]
    buffer_load_dwordx4 v[40:43], v8, s[96:99], s29 offen sc1
    buffer_load_dwordx4 v[44:47], v9, s[96:99], s29 offen sc1
    buffer_load_dwordx4 v[48:51], v10, s[96:99], s29 offen sc1
    buffer_load_dwordx4 v[52:55], v11, s[96:99], s29 offen sc1
    s_add_u32 s29, s29, 1024
    buffer_load_dwordx4 v[56:59], v12, s[96:99], s31 offen sc1
    buffer_load_dwordx4 v[60:63], v13, s[96:99], s31 offen sc1
    buffer_load_dwordx4 v[64:67], v14, s[96:99], s31 offen sc1
    buffer_load_dwordx4 v[68:71], v15, s[96:99], s31 offen sc1
    buffer_load_dwordx4 v[72:75], v16, s[96:99], s31 offen sc1
    s_add_u32 s31, s31, 1024
    s_waitcnt vmcnt(18)
    v_mfma_f32_16x16x32_bf16 v[160:163], v[92:95], v[76:79], v[160:163]
    v_mfma_f32_16x16x32_bf16 v[164:167], v[92:95], v[80:83], v[164:167]
    v_mfma_f32_16x16x32_bf16 v[168:171], v[92:95], v[84:87], v[168:171]
    v_mfma_f32_16x16x32_bf16 v[172:175], v[92:95], v[88:91], v[172:175]
    v_mfma_f32_16x16x32_bf16 v[176:179], v[96:99], v[76:79], v[176:179]
    v_mfma_f32_16x16x32_bf16 v[180:183], v[96:99], v[80:83], v[180:183]
    v_mfma_f32_16x16x32_bf16 v[184:187], v[96:99], v[84:87], v[184:187]
    v_mfma_f32_16x16x32_bf16 v[188:191], v[96:99], v[88:91], v[188:191]
    v_mfma_f32_16x16x32_bf16 v[192:195], v[100:103], v[76:79], v[192:195]
    v_mfma_f32_16x16x32_bf16 v[196:199], v[100:103], v[80:83], v[196:199]
    v_mfma_f32_16x16x32_bf16 v[200:203], v[100:103], v[84:87], v[200:203]
    v_mfma_f32_16x16x32_bf16 v[204:207], v[100:103], v[88:91], v[204:207]
    v_mfma_f32_16x16x32_bf16 v[208:211], v[104:107], v[76:79], v[208:211]
    v_mfma_f32_16x16x32_bf16 v[212:215], v[104:107], v[80:83], v[212:215]
    v_mfma_f32_16x16x32_bf16 v[216:219], v[104:107], v[84:87], v[216:219]
    v_mfma_f32_16x16x32_bf16 v[220:223], v[104:107], v[88:91], v[220:223]
    v_mfma_f32_16x16x32_bf16 v[224:227], v[108:111], v[76:79], v[224:227]
    v_mfma_f32_16x16x32_bf16 v[228:231], v[108:111], v[80:83], v[228:231]
    v_mfma_f32_16x16x32_bf16 v[232:235], v[108:111], v[84:87], v[232:235]
    v_mfma_f32_16x16x32_bf16 v[236:239], v[108:111], v[88:91], v[236:239]
    buffer_load_dwordx4 v[76:79], v8, s[96:99], s29 offen sc1
    buffer_load_dwordx4 v[80:83], v9, s[96:99], s29 offen sc1
    buffer_load_dwordx4 v[84:87], v10, s[96:99], s29 offen sc1
    buffer_load_dwordx4 v[88:91], v11, s[96:99], s29 offen sc1
    s_add_u32 s29, s29, 1024
    buffer_load_dwordx4 v[92:95], v12, s[96:99], s31 offen sc1
    buffer_load_dwordx4 v[96:99], v13, s[96:99], s31 offen sc1
    buffer_load_dwordx4 v[100:103], v14, s[96:99], s31 offen sc1
    buffer_load_dwordx4 v[104:107], v15, s[96:99], s31 offen sc1
    buffer_load_dwordx4 v[108:111], v16, s[96:99], s31 offen sc1
    s_add_u32 s31, s31, 1024
    s_waitcnt vmcnt(18)
    v_mfma_f32_16x16x32_bf16 v[160:163], v[128:131], v[112:115], v[160:163]
    v_mfma_f32_16x16x32_bf16 v[164:167], v[128:131], v[116:119], v[164:167]
    v_mfma_f32_16x16x32_bf16 v[168:171], v[128:131], v[120:123], v[168:171]
    v_mfma_f32_16x16x32_bf16 v[172:175], v[128:131], v[124:127], v[172:175]
    v_mfma_f32_16x16x32_bf16 v[176:179], v[132:135], v[112:115], v[176:179]
    v_mfma_f32_16x16x32_bf16 v[180:183], v[132:135], v[116:119], v[180:183]
    v_mfma_f32_16x16x32_bf16 v[184:187], v[132:135], v[120:123], v[184:187]
    v_mfma_f32_16x16x32_bf16 v[188:191], v[132:135], v[124:127], v[188:191]
    v_mfma_f32_16x16x32_bf16 v[192:195], v[136:139], v[112:115], v[192:195]
    v_mfma_f32_16x16x32_bf16 v[196:199], v[136:139], v[116:119], v[196:199]
    v_mfma_f32_16x16x32_bf16 v[200:203], v[136:139], v[120:123], v[200:203]
    v_mfma_f32_16x16x32_bf16 v[204:207], v[136:139], v[124:127], v[204:207]
    v_mfma_f32_16x16x32_bf16 v[208:211], v[140:143], v[112:115], v[208:211]
    v_mfma_f32_16x16x32_bf16 v[212:215], v[140:143], v[116:119], v[212:215]
    v_mfma_f32_16x16x32_bf16 v[216:219], v[140:143], v[120:123], v[216:219]
    v_mfma_f32_16x16x32_bf16 v[220:223], v[140:143], v[124:127], v[220:223]
    v_mfma_f32_16x16x32_bf16 v[224:227], v[144:147], v[112:115], v[224:227]
    v_mfma_f32_16x16x32_bf16 v[228:231], v[144:147], v[116:119], v[228:231]
    v_mfma_f32_16x16x32_bf16 v[232:235], v[144:147], v[120:123], v[232:235]
    v_mfma_f32_16x16x32_bf16 v[236:239], v[144:147], v[124:127], v[236:239]
    buffer_load_dwordx4 v[112:115], v8, s[96:99], s29 offen sc1
    buffer_load_dwordx4 v[116:119], v9, s[96:99], s29 offen sc1
    buffer_load_dwordx4 v[120:123], v10, s[96:99], s29 offen sc1
    buffer_load_dwordx4 v[124:127], v11, s[96:99], s29 offen sc1
    s_add_u32 s29, s29, 1024
    buffer_load_dwordx4 v[128:131], v12, s[96:99], s31 offen sc1
    buffer_load_dwordx4 v[132:135], v13, s[96:99], s31 offen sc1
    buffer_load_dwordx4 v[136:139], v14, s[96:99], s31 offen sc1
    buffer_load_dwordx4 v[140:143], v15, s[96:99], s31 offen sc1
    buffer_load_dwordx4 v[144:147], v16, s[96:99], s31 offen sc1
    s_add_u32 s31, s31, 1024
    s_waitcnt vmcnt(18)
    v_mfma_f32_16x16x32_bf16 v[160:163], v[56:59], v[40:43], v[160:163]
    v_mfma_f32_16x16x32_bf16 v[164:167], v[56:59], v[44:47], v[164:167]
    v_mfma_f32_16x16x32_bf16 v[168:171], v[56:59], v[48:51], v[168:171]
    v_mfma_f32_16x16x32_bf16 v[172:175], v[56:59], v[52:55], v[172:175]
    v_mfma_f32_16x16x32_bf16 v[176:179], v[60:63], v[40:43], v[176:179]
    v_mfma_f32_16x16x32_bf16 v[180:183], v[60:63], v[44:47], v[180:183]
    v_mfma_f32_16x16x32_bf16 v[184:187], v[60:63], v[48:51], v[184:187]
    v_mfma_f32_16x16x32_bf16 v[188:191], v[60:63], v[52:55], v[188:191]
    v_mfma_f32_16x16x32_bf16 v[192:195], v[64:67], v[40:43], v[192:195]
    v_mfma_f32_16x16x32_bf16 v[196:199], v[64:67], v[44:47], v[196:199]
    v_mfma_f32_16x16x32_bf16 v[200:203], v[64:67], v[48:51], v[200:203]
    v_mfma_f32_16x16x32_bf16 v[204:207], v[64:67], v[52:55], v[204:207]
    v_mfma_f32_16x16x32_bf16 v[208:211], v[68:71], v[40:43], v[208:211]
    v_mfma_f32_16x16x32_bf16 v[212:215], v[68:71], v[44:47], v[212:215]
    v_mfma_f32_16x16x32_bf16 v[216:219], v[68:71], v[48:51], v[216:219]
    v_mfma_f32_16x16x32_bf16 v[220:223], v[68:71], v[52:55], v[220:223]
    v_mfma_f32_16x16x32_bf16 v[224:227], v[72:75], v[40:43], v[224:227]
    v_mfma_f32_16x16x32_bf16 v[228:231], v[72:75], v[44:47], v[228:231]
    v_mfma_f32_16x16x32_bf16 v[232:235], v[72:75], v[48:51], v[232:235]
    v_mfma_f32_16x16x32_bf16 v[236:239], v[72:75], v[52:55], v[236:239]
    buffer_load_dwordx4 v[40:43], v8, s[96:99], s29 offen sc1
    buffer_load_dwordx4 v[44:47], v9, s[96:99], s29 offen sc1
    buffer_load_dwordx4 v[48:51], v10, s[96:99], s29 offen sc1
    buffer_load_dwordx4 v[52:55], v11, s[96:99], s29 offen sc1
    s_add_u32 s29, s29, 1024
    buffer_load_dwordx4 v[56:59], v12, s[96:99], s31 offen sc1
    buffer_load_dwordx4 v[60:63], v13, s[96:99], s31 offen sc1
    buffer_load_dwordx4 v[64:67], v14, s[96:99], s31 offen sc1
    buffer_load_dwordx4 v[68:71], v15, s[96:99], s31 offen sc1
    buffer_load_dwordx4 v[72:75], v16, s[96:99], s31 offen sc1
    s_add_u32 s31, s31, 1024
    s_waitcnt vmcnt(18)
    v_mfma_f32_16x16x32_bf16 v[160:163], v[92:95], v[76:79], v[160:163]
    v_mfma_f32_16x16x32_bf16 v[164:167], v[92:95], v[80:83], v[164:167]
    v_mfma_f32_16x16x32_bf16 v[168:171], v[92:95], v[84:87], v[168:171]
    v_mfma_f32_16x16x32_bf16 v[172:175], v[92:95], v[88:91], v[172:175]
    v_mfma_f32_16x16x32_bf16 v[176:179], v[96:99], v[76:79], v[176:179]
    v_mfma_f32_16x16x32_bf16 v[180:183], v[96:99], v[80:83], v[180:183]
    v_mfma_f32_16x16x32_bf16 v[184:187], v[96:99], v[84:87], v[184:187]
    v_mfma_f32_16x16x32_bf16 v[188:191], v[96:99], v[88:91], v[188:191]
    v_mfma_f32_16x16x32_bf16 v[192:195], v[100:103], v[76:79], v[192:195]
    v_mfma_f32_16x16x32_bf16 v[196:199], v[100:103], v[80:83], v[196:199]
    v_mfma_f32_16x16x32_bf16 v[200:203], v[100:103], v[84:87], v[200:203]
    v_mfma_f32_16x16x32_bf16 v[204:207], v[100:103], v[88:91], v[204:207]
    v_mfma_f32_16x16x32_bf16 v[208:211], v[104:107], v[76:79], v[208:211]
    v_mfma_f32_16x16x32_bf16 v[212:215], v[104:107], v[80:83], v[212:215]
    v_mfma_f32_16x16x32_bf16 v[216:219], v[104:107], v[84:87], v[216:219]
    v_mfma_f32_16x16x32_bf16 v[220:223], v[104:107], v[88:91], v[220:223]
    v_mfma_f32_16x16x32_bf16 v[224:227], v[108:111], v[76:79], v[224:227]
    v_mfma_f32_16x16x32_bf16 v[228:231], v[108:111], v[80:83], v[228:231]
    v_mfma_f32_16x16x32_bf16 v[232:235], v[108:111], v[84:87], v[232:235]
    v_mfma_f32_16x16x32_bf16 v[236:239], v[108:111], v[88:91], v[236:239]
    buffer_load_dwordx2 v[76:77], v36, s[96:99], s29 offen sc1
    buffer_load_dwordx2 v[78:79], v36, s[96:99], s29 offen offset:512 sc1
    buffer_load_dwordx2 v[80:81], v37, s[96:99], s29 offen sc1
    buffer_load_dwordx2 v[82:83], v37, s[96:99], s29 offen offset:512 sc1
    buffer_load_dwordx2 v[84:85], v38, s[96:99], s29 offen sc1
    buffer_load_dwordx2 v[86:87], v38, s[96:99], s29 offen offset:512 sc1
    buffer_load_dwordx2 v[88:89], v39, s[96:99], s29 offen sc1
    buffer_load_dwordx2 v[90:91], v39, s[96:99], s29 offen offset:512 sc1
    s_add_u32 s29, s29, 1024
    buffer_load_dwordx4 v[92:95], v12, s[96:99], s31 offen sc1
    buffer_load_dwordx4 v[96:99], v13, s[96:99], s31 offen sc1
    buffer_load_dwordx4 v[100:103], v14, s[96:99], s31 offen sc1
    buffer_load_dwordx4 v[104:107], v15, s[96:99], s31 offen sc1
    buffer_load_dwordx4 v[108:111], v16, s[96:99], s31 offen sc1
    s_add_u32 s31, s31, 1024
    s_waitcnt vmcnt(22)
    v_mfma_f32_16x16x32_bf16 v[160:163], v[128:131], v[112:115], v[160:163]
    v_mfma_f32_16x16x32_bf16 v[164:167], v[128:131], v[116:119], v[164:167]
    v_mfma_f32_16x16x32_bf16 v[168:171], v[128:131], v[120:123], v[168:171]
    v_mfma_f32_16x16x32_bf16 v[172:175], v[128:131], v[124:127], v[172:175]
    v_mfma_f32_16x16x32_bf16 v[176:179], v[132:135], v[112:115], v[176:179]
    v_mfma_f32_16x16x32_bf16 v[180:183], v[132:135], v[116:119], v[180:183]
    v_mfma_f32_16x16x32_bf16 v[184:187], v[132:135], v[120:123], v[184:187]
    v_mfma_f32_16x16x32_bf16 v[188:191], v[132:135], v[124:127], v[188:191]
    v_mfma_f32_16x16x32_bf16 v[192:195], v[136:139], v[112:115], v[192:195]
    v_mfma_f32_16x16x32_bf16 v[196:199], v[136:139], v[116:119], v[196:199]
    v_mfma_f32_16x16x32_bf16 v[200:203], v[136:139], v[120:123], v[200:203]
    v_mfma_f32_16x16x32_bf16 v[204:207], v[136:139], v[124:127], v[204:207]
    v_mfma_f32_16x16x32_bf16 v[208:211], v[140:143], v[112:115], v[208:211]
    v_mfma_f32_16x16x32_bf16 v[212:215], v[140:143], v[116:119], v[212:215]
    v_mfma_f32_16x16x32_bf16 v[216:219], v[140:143], v[120:123], v[216:219]
    v_mfma_f32_16x16x32_bf16 v[220:223], v[140:143], v[124:127], v[220:223]
    v_mfma_f32_16x16x32_bf16 v[224:227], v[144:147], v[112:115], v[224:227]
    v_mfma_f32_16x16x32_bf16 v[228:231], v[144:147], v[116:119], v[228:231]
    v_mfma_f32_16x16x32_bf16 v[232:235], v[144:147], v[120:123], v[232:235]
    v_mfma_f32_16x16x32_bf16 v[236:239], v[144:147], v[124:127], v[236:239]
    buffer_load_dwordx4 v[112:115], v8, s[96:99], s29 offen sc1
    buffer_load_dwordx4 v[116:119], v9, s[96:99], s29 offen sc1
    buffer_load_dwordx4 v[120:123], v10, s[96:99], s29 offen sc1
    buffer_load_dwordx4 v[124:127], v11, s[96:99], s29 offen sc1
    s_add_u32 s29, s29, 1024
    buffer_load_dwordx4 v[128:131], v12, s[96:99], s31 offen sc1
    buffer_load_dwordx4 v[132:135], v13, s[96:99], s31 offen sc1
    buffer_load_dwordx4 v[136:139], v14, s[96:99], s31 offen sc1
    buffer_load_dwordx4 v[140:143], v15, s[96:99], s31 offen sc1
    buffer_load_dwordx4 v[144:147], v16, s[96:99], s31 offen sc1
    s_add_u32 s31, s31, 1024
    s_waitcnt vmcnt(22)
    v_mfma_f32_16x16x32_bf16 v[160:163], v[56:59], v[40:43], v[160:163]
    v_mfma_f32_16x16x32_bf16 v[164:167], v[56:59], v[44:47], v[164:167]
    v_mfma_f32_16x16x32_bf16 v[168:171], v[56:59], v[48:51], v[168:171]
    v_mfma_f32_16x16x32_bf16 v[172:175], v[56:59], v[52:55], v[172:175]
    v_mfma_f32_16x16x32_bf16 v[176:179], v[60:63], v[40:43], v[176:179]
    v_mfma_f32_16x16x32_bf16 v[180:183], v[60:63], v[44:47], v[180:183]
    v_mfma_f32_16x16x32_bf16 v[184:187], v[60:63], v[48:51], v[184:187]
    v_mfma_f32_16x16x32_bf16 v[188:191], v[60:63], v[52:55], v[188:191]
    v_mfma_f32_16x16x32_bf16 v[192:195], v[64:67], v[40:43], v[192:195]
    v_mfma_f32_16x16x32_bf16 v[196:199], v[64:67], v[44:47], v[196:199]
    v_mfma_f32_16x16x32_bf16 v[200:203], v[64:67], v[48:51], v[200:203]
    v_mfma_f32_16x16x32_bf16 v[204:207], v[64:67], v[52:55], v[204:207]
    v_mfma_f32_16x16x32_bf16 v[208:211], v[68:71], v[40:43], v[208:211]
    v_mfma_f32_16x16x32_bf16 v[212:215], v[68:71], v[44:47], v[212:215]
    v_mfma_f32_16x16x32_bf16 v[216:219], v[68:71], v[48:51], v[216:219]
    v_mfma_f32_16x16x32_bf16 v[220:223], v[68:71], v[52:55], v[220:223]
    v_mfma_f32_16x16x32_bf16 v[224:227], v[72:75], v[40:43], v[224:227]
    v_mfma_f32_16x16x32_bf16 v[228:231], v[72:75], v[44:47], v[228:231]
    v_mfma_f32_16x16x32_bf16 v[232:235], v[72:75], v[48:51], v[232:235]
    v_mfma_f32_16x16x32_bf16 v[236:239], v[72:75], v[52:55], v[236:239]
    buffer_load_dwordx4 v[40:43], v8, s[96:99], s29 offen sc1
    buffer_load_dwordx4 v[44:47], v9, s[96:99], s29 offen sc1
    buffer_load_dwordx4 v[48:51], v10, s[96:99], s29 offen sc1
    buffer_load_dwordx4 v[52:55], v11, s[96:99], s29 offen sc1
    s_add_u32 s29, s29, 1024
    buffer_load_dwordx4 v[56:59], v12, s[96:99], s31 offen sc1
    buffer_load_dwordx4 v[60:63], v13, s[96:99], s31 offen sc1
    buffer_load_dwordx4 v[64:67], v14, s[96:99], s31 offen sc1
    buffer_load_dwordx4 v[68:71], v15, s[96:99], s31 offen sc1
    buffer_load_dwordx4 v[72:75], v16, s[96:99], s31 offen sc1
    s_add_u32 s31, s31, 1024
    s_waitcnt vmcnt(18)
    v_mfma_f32_16x16x32_bf16 v[160:163], v[92:95], v[76:79], v[160:163]
    v_mfma_f32_16x16x32_bf16 v[164:167], v[92:95], v[80:83], v[164:167]
    v_mfma_f32_16x16x32_bf16 v[168:171], v[92:95], v[84:87], v[168:171]
    v_mfma_f32_16x16x32_bf16 v[172:175], v[92:95], v[88:91], v[172:175]
    v_mfma_f32_16x16x32_bf16 v[176:179], v[96:99], v[76:79], v[176:179]
    v_mfma_f32_16x16x32_bf16 v[180:183], v[96:99], v[80:83], v[180:183]
    v_mfma_f32_16x16x32_bf16 v[184:187], v[96:99], v[84:87], v[184:187]
    v_mfma_f32_16x16x32_bf16 v[188:191], v[96:99], v[88:91], v[188:191]
    v_mfma_f32_16x16x32_bf16 v[192:195], v[100:103], v[76:79], v[192:195]
    v_mfma_f32_16x16x32_bf16 v[196:199], v[100:103], v[80:83], v[196:199]
    v_mfma_f32_16x16x32_bf16 v[200:203], v[100:103], v[84:87], v[200:203]
    v_mfma_f32_16x16x32_bf16 v[204:207], v[100:103], v[88:91], v[204:207]
    v_mfma_f32_16x16x32_bf16 v[208:211], v[104:107], v[76:79], v[208:211]
    v_mfma_f32_16x16x32_bf16 v[212:215], v[104:107], v[80:83], v[212:215]
    v_mfma_f32_16x16x32_bf16 v[216:219], v[104:107], v[84:87], v[216:219]
    v_mfma_f32_16x16x32_bf16 v[220:223], v[104:107], v[88:91], v[220:223]
    v_mfma_f32_16x16x32_bf16 v[224:227], v[108:111], v[76:79], v[224:227]
    v_mfma_f32_16x16x32_bf16 v[228:231], v[108:111], v[80:83], v[228:231]
    v_mfma_f32_16x16x32_bf16 v[232:235], v[108:111], v[84:87], v[232:235]
    v_mfma_f32_16x16x32_bf16 v[236:239], v[108:111], v[88:91], v[236:239]
    buffer_load_dwordx4 v[76:79], v8, s[96:99], s29 offen sc1
    buffer_load_dwordx4 v[80:83], v9, s[96:99], s29 offen sc1
    buffer_load_dwordx4 v[84:87], v10, s[96:99], s29 offen sc1
    buffer_load_dwordx4 v[88:91], v11, s[96:99], s29 offen sc1
    s_add_u32 s29, s29, 1024
    buffer_load_dwordx4 v[92:95], v12, s[96:99], s31 offen sc1
    buffer_load_dwordx4 v[96:99], v13, s[96:99], s31 offen sc1
    buffer_load_dwordx4 v[100:103], v14, s[96:99], s31 offen sc1
    buffer_load_dwordx4 v[104:107], v15, s[96:99], s31 offen sc1
    buffer_load_dwordx4 v[108:111], v16, s[96:99], s31 offen sc1
    s_add_u32 s31, s31, 1024
    s_waitcnt vmcnt(18)
    v_mfma_f32_16x16x32_bf16 v[160:163], v[128:131], v[112:115], v[160:163]
    v_mfma_f32_16x16x32_bf16 v[164:167], v[128:131], v[116:119], v[164:167]
    v_mfma_f32_16x16x32_bf16 v[168:171], v[128:131], v[120:123], v[168:171]
    v_mfma_f32_16x16x32_bf16 v[172:175], v[128:131], v[124:127], v[172:175]
    v_mfma_f32_16x16x32_bf16 v[176:179], v[132:135], v[112:115], v[176:179]
    v_mfma_f32_16x16x32_bf16 v[180:183], v[132:135], v[116:119], v[180:183]
    v_mfma_f32_16x16x32_bf16 v[184:187], v[132:135], v[120:123], v[184:187]
    v_mfma_f32_16x16x32_bf16 v[188:191], v[132:135], v[124:127], v[188:191]
    v_mfma_f32_16x16x32_bf16 v[192:195], v[136:139], v[112:115], v[192:195]
    v_mfma_f32_16x16x32_bf16 v[196:199], v[136:139], v[116:119], v[196:199]
    v_mfma_f32_16x16x32_bf16 v[200:203], v[136:139], v[120:123], v[200:203]
    v_mfma_f32_16x16x32_bf16 v[204:207], v[136:139], v[124:127], v[204:207]
    v_mfma_f32_16x16x32_bf16 v[208:211], v[140:143], v[112:115], v[208:211]
    v_mfma_f32_16x16x32_bf16 v[212:215], v[140:143], v[116:119], v[212:215]
    v_mfma_f32_16x16x32_bf16 v[216:219], v[140:143], v[120:123], v[216:219]
    v_mfma_f32_16x16x32_bf16 v[220:223], v[140:143], v[124:127], v[220:223]
    v_mfma_f32_16x16x32_bf16 v[224:227], v[144:147], v[112:115], v[224:227]
    v_mfma_f32_16x16x32_bf16 v[228:231], v[144:147], v[116:119], v[228:231]
    v_mfma_f32_16x16x32_bf16 v[232:235], v[144:147], v[120:123], v[232:235]
    v_mfma_f32_16x16x32_bf16 v[236:239], v[144:147], v[124:127], v[236:239]
    buffer_load_dwordx4 v[112:115], v8, s[96:99], s29 offen sc1
    buffer_load_dwordx4 v[116:119], v9, s[96:99], s29 offen sc1
    buffer_load_dwordx4 v[120:123], v10, s[96:99], s29 offen sc1
    buffer_load_dwordx4 v[124:127], v11, s[96:99], s29 offen sc1
    s_add_u32 s29, s29, 1024
    buffer_load_dwordx4 v[128:131], v12, s[96:99], s31 offen sc1
    buffer_load_dwordx4 v[132:135], v13, s[96:99], s31 offen sc1
    buffer_load_dwordx4 v[136:139], v14, s[96:99], s31 offen sc1
    buffer_load_dwordx4 v[140:143], v15, s[96:99], s31 offen sc1
    buffer_load_dwordx4 v[144:147], v16, s[96:99], s31 offen sc1
    s_add_u32 s31, s31, 1024
    s_waitcnt vmcnt(18)
    v_mfma_f32_16x16x32_bf16 v[160:163], v[56:59], v[40:43], v[160:163]
    v_mfma_f32_16x16x32_bf16 v[164:167], v[56:59], v[44:47], v[164:167]
    v_mfma_f32_16x16x32_bf16 v[168:171], v[56:59], v[48:51], v[168:171]
    v_mfma_f32_16x16x32_bf16 v[172:175], v[56:59], v[52:55], v[172:175]
    v_mfma_f32_16x16x32_bf16 v[176:179], v[60:63], v[40:43], v[176:179]
    v_mfma_f32_16x16x32_bf16 v[180:183], v[60:63], v[44:47], v[180:183]
    v_mfma_f32_16x16x32_bf16 v[184:187], v[60:63], v[48:51], v[184:187]
    v_mfma_f32_16x16x32_bf16 v[188:191], v[60:63], v[52:55], v[188:191]
    v_mfma_f32_16x16x32_bf16 v[192:195], v[64:67], v[40:43], v[192:195]
    v_mfma_f32_16x16x32_bf16 v[196:199], v[64:67], v[44:47], v[196:199]
    v_mfma_f32_16x16x32_bf16 v[200:203], v[64:67], v[48:51], v[200:203]
    v_mfma_f32_16x16x32_bf16 v[204:207], v[64:67], v[52:55], v[204:207]
    v_mfma_f32_16x16x32_bf16 v[208:211], v[68:71], v[40:43], v[208:211]
    v_mfma_f32_16x16x32_bf16 v[212:215], v[68:71], v[44:47], v[212:215]
    v_mfma_f32_16x16x32_bf16 v[216:219], v[68:71], v[48:51], v[216:219]
    v_mfma_f32_16x16x32_bf16 v[220:223], v[68:71], v[52:55], v[220:223]
    v_mfma_f32_16x16x32_bf16 v[224:227], v[72:75], v[40:43], v[224:227]
    v_mfma_f32_16x16x32_bf16 v[228:231], v[72:75], v[44:47], v[228:231]
    v_mfma_f32_16x16x32_bf16 v[232:235], v[72:75], v[48:51], v[232:235]
    v_mfma_f32_16x16x32_bf16 v[236:239], v[72:75], v[52:55], v[236:239]
    s_waitcnt vmcnt(9)
    v_mfma_f32_16x16x32_bf16 v[160:163], v[92:95], v[76:79], v[160:163]
    v_mfma_f32_16x16x32_bf16 v[164:167], v[92:95], v[80:83], v[164:167]
    v_mfma_f32_16x16x32_bf16 v[168:171], v[92:95], v[84:87], v[168:171]
    v_mfma_f32_16x16x32_bf16 v[172:175], v[92:95], v[88:91], v[172:175]
    v_mfma_f32_16x16x32_bf16 v[176:179], v[96:99], v[76:79], v[176:179]
    v_mfma_f32_16x16x32_bf16 v[180:183], v[96:99], v[80:83], v[180:183]
    v_mfma_f32_16x16x32_bf16 v[184:187], v[96:99], v[84:87], v[184:187]
    v_mfma_f32_16x16x32_bf16 v[188:191], v[96:99], v[88:91], v[188:191]
    v_mfma_f32_16x16x32_bf16 v[192:195], v[100:103], v[76:79], v[192:195]
    v_mfma_f32_16x16x32_bf16 v[196:199], v[100:103], v[80:83], v[196:199]
    v_mfma_f32_16x16x32_bf16 v[200:203], v[100:103], v[84:87], v[200:203]
    v_mfma_f32_16x16x32_bf16 v[204:207], v[100:103], v[88:91], v[204:207]
    v_mfma_f32_16x16x32_bf16 v[208:211], v[104:107], v[76:79], v[208:211]
    v_mfma_f32_16x16x32_bf16 v[212:215], v[104:107], v[80:83], v[212:215]
    v_mfma_f32_16x16x32_bf16 v[216:219], v[104:107], v[84:87], v[216:219]
    v_mfma_f32_16x16x32_bf16 v[220:223], v[104:107], v[88:91], v[220:223]
    v_mfma_f32_16x16x32_bf16 v[224:227], v[108:111], v[76:79], v[224:227]
    v_mfma_f32_16x16x32_bf16 v[228:231], v[108:111], v[80:83], v[228:231]
    v_mfma_f32_16x16x32_bf16 v[232:235], v[108:111], v[84:87], v[232:235]
    v_mfma_f32_16x16x32_bf16 v[236:239], v[108:111], v[88:91], v[236:239]
    s_waitcnt vmcnt(0)
    v_mfma_f32_16x16x32_bf16 v[160:163], v[128:131], v[112:115], v[160:163]
    v_mfma_f32_16x16x32_bf16 v[164:167], v[128:131], v[116:119], v[164:167]
    v_mfma_f32_16x16x32_bf16 v[168:171], v[128:131], v[120:123], v[168:171]
    v_mfma_f32_16x16x32_bf16 v[172:175], v[128:131], v[124:127], v[172:175]
    v_mfma_f32_16x16x32_bf16 v[176:179], v[132:135], v[112:115], v[176:179]
    v_mfma_f32_16x16x32_bf16 v[180:183], v[132:135], v[116:119], v[180:183]
    v_mfma_f32_16x16x32_bf16 v[184:187], v[132:135], v[120:123], v[184:187]
    v_mfma_f32_16x16x32_bf16 v[188:191], v[132:135], v[124:127], v[188:191]
    v_mfma_f32_16x16x32_bf16 v[192:195], v[136:139], v[112:115], v[192:195]
    v_mfma_f32_16x16x32_bf16 v[196:199], v[136:139], v[116:119], v[196:199]
    v_mfma_f32_16x16x32_bf16 v[200:203], v[136:139], v[120:123], v[200:203]
    v_mfma_f32_16x16x32_bf16 v[204:207], v[136:139], v[124:127], v[204:207]
    v_mfma_f32_16x16x32_bf16 v[208:211], v[140:143], v[112:115], v[208:211]
    v_mfma_f32_16x16x32_bf16 v[212:215], v[140:143], v[116:119], v[212:215]
    v_mfma_f32_16x16x32_bf16 v[216:219], v[140:143], v[120:123], v[216:219]
    v_mfma_f32_16x16x32_bf16 v[220:223], v[140:143], v[124:127], v[220:223]
    v_mfma_f32_16x16x32_bf16 v[224:227], v[144:147], v[112:115], v[224:227]
    v_mfma_f32_16x16x32_bf16 v[228:231], v[144:147], v[116:119], v[228:231]
    v_mfma_f32_16x16x32_bf16 v[232:235], v[144:147], v[120:123], v[232:235]
    v_mfma_f32_16x16x32_bf16 v[236:239], v[144:147], v[124:127], v[236:239]
    s_mul_i32 s36, s3, 34816
    v_add_u32 v18, s36, v5
    s_mul_i32 s36, s3, 5120
    v_add_u32 v19, s36, v5
    v_add_u32 v34, 69632, v19
    s_nop 4
    ds_write_b128 v18, v[160:163] offset:0
    ds_write_b128 v18, v[176:179] offset:1024
    ds_write_b128 v18, v[192:195] offset:2048
    ds_write_b128 v18, v[208:211] offset:3072
    ds_write_b128 v18, v[224:227] offset:4096
    ds_write_b128 v18, v[164:167] offset:5120
    ds_write_b128 v18, v[180:183] offset:6144
    ds_write_b128 v18, v[196:199] offset:7168
    ds_write_b128 v18, v[212:215] offset:8192
    ds_write_b128 v18, v[228:231] offset:9216
    ds_write_b128 v18, v[168:171] offset:10240
    ds_write_b128 v18, v[184:187] offset:11264
    ds_write_b128 v18, v[200:203] offset:12288
    ds_write_b128 v18, v[216:219] offset:13312
    ds_write_b128 v18, v[232:235] offset:14336
    ds_write_b128 v18, v[172:175] offset:15360
    ds_write_b128 v18, v[188:191] offset:16384
    ds_write_b128 v18, v[204:207] offset:17408
    ds_write_b128 v18, v[220:223] offset:18432
    ds_write_b128 v18, v[236:239] offset:19456
    s_waitcnt lgkmcnt(0)
    s_barrier
    ds_read_b128 v[40:43], v19 offset:0
    ds_read_b128 v[44:47], v19 offset:34816
    ds_read_b128 v[48:51], v34 offset:0
    ds_read_b128 v[52:55], v34 offset:34816
    ds_read_b128 v[56:59], v19 offset:1024
    ds_read_b128 v[60:63], v19 offset:35840
    ds_read_b128 v[64:67], v34 offset:1024
    ds_read_b128 v[68:71], v34 offset:35840
    ds_read_b128 v[72:75], v19 offset:2048
    ds_read_b128 v[76:79], v19 offset:36864
    ds_read_b128 v[80:83], v34 offset:2048
    ds_read_b128 v[84:87], v34 offset:36864
    ds_read_b128 v[88:91], v19 offset:3072
    ds_read_b128 v[92:95], v19 offset:37888
    ds_read_b128 v[96:99], v34 offset:3072
    ds_read_b128 v[100:103], v34 offset:37888
    ds_read_b128 v[104:107], v19 offset:4096
    ds_read_b128 v[108:111], v19 offset:38912
    ds_read_b128 v[112:115], v34 offset:4096
    ds_read_b128 v[116:119], v34 offset:38912
    s_waitcnt lgkmcnt(15)
    v_add_f32 v40, v40, v44
    v_add_f32 v48, v48, v52
    v_add_f32 v41, v41, v45
    v_add_f32 v49, v49, v53
    v_add_f32 v42, v42, v46
    v_add_f32 v50, v50, v54
    v_add_f32 v43, v43, v47
    v_add_f32 v51, v51, v55
    v_add_f32 v40, v40, v48
    v_add_f32 v41, v41, v49
    v_add_f32 v42, v42, v50
    v_add_f32 v43, v43, v51
    v_cvt_pk_bf16_f32 v44, v40, v41
    v_cvt_pk_bf16_f32 v45, v42, v43
    v_lshlrev_b32 v48, 16, v20
    v_and_b32 v49, 0xffff0000, v20
    v_lshlrev_b32 v50, 16, v21
    v_and_b32 v51, 0xffff0000, v21
    v_lshlrev_b32 v40, 16, v44
    v_and_b32 v41, 0xffff0000, v44
    v_lshlrev_b32 v42, 16, v45
    v_and_b32 v43, 0xffff0000, v45
    v_add_f32 v40, v40, v48
    v_add_f32 v41, v41, v49
    v_add_f32 v42, v42, v50
    v_add_f32 v43, v43, v51
    v_cvt_pk_bf16_f32 v44, v40, v41
    v_cvt_pk_bf16_f32 v45, v42, v43
    buffer_store_dwordx2 v[44:45], v7, s[16:19], s33 offen offset:0
    s_waitcnt lgkmcnt(12)
    v_add_f32 v56, v56, v60
    v_add_f32 v64, v64, v68
    v_add_f32 v57, v57, v61
    v_add_f32 v65, v65, v69
    v_add_f32 v58, v58, v62
    v_add_f32 v66, v66, v70
    v_add_f32 v59, v59, v63
    v_add_f32 v67, v67, v71
    v_add_f32 v56, v56, v64
    v_add_f32 v57, v57, v65
    v_add_f32 v58, v58, v66
    v_add_f32 v59, v59, v67
    v_cvt_pk_bf16_f32 v60, v56, v57
    v_cvt_pk_bf16_f32 v61, v58, v59
    v_lshlrev_b32 v64, 16, v22
    v_and_b32 v65, 0xffff0000, v22
    v_lshlrev_b32 v66, 16, v23
    v_and_b32 v67, 0xffff0000, v23
    v_lshlrev_b32 v56, 16, v60
    v_and_b32 v57, 0xffff0000, v60
    v_lshlrev_b32 v58, 16, v61
    v_and_b32 v59, 0xffff0000, v61
    v_add_f32 v56, v56, v64
    v_add_f32 v57, v57, v65
    v_add_f32 v58, v58, v66
    v_add_f32 v59, v59, v67
    v_cvt_pk_bf16_f32 v60, v56, v57
    v_cvt_pk_bf16_f32 v61, v58, v59
    buffer_store_dwordx2 v[60:61], v7, s[16:19], s33 offen offset:32
    s_waitcnt lgkmcnt(8)
    v_add_f32 v72, v72, v76
    v_add_f32 v80, v80, v84
    v_add_f32 v73, v73, v77
    v_add_f32 v81, v81, v85
    v_add_f32 v74, v74, v78
    v_add_f32 v82, v82, v86
    v_add_f32 v75, v75, v79
    v_add_f32 v83, v83, v87
    v_add_f32 v72, v72, v80
    v_add_f32 v73, v73, v81
    v_add_f32 v74, v74, v82
    v_add_f32 v75, v75, v83
    v_cvt_pk_bf16_f32 v76, v72, v73
    v_cvt_pk_bf16_f32 v77, v74, v75
    v_lshlrev_b32 v80, 16, v24
    v_and_b32 v81, 0xffff0000, v24
    v_lshlrev_b32 v82, 16, v25
    v_and_b32 v83, 0xffff0000, v25
    v_lshlrev_b32 v72, 16, v76
    v_and_b32 v73, 0xffff0000, v76
    v_lshlrev_b32 v74, 16, v77
    v_and_b32 v75, 0xffff0000, v77
    v_add_f32 v72, v72, v80
    v_add_f32 v73, v73, v81
    v_add_f32 v74, v74, v82
    v_add_f32 v75, v75, v83
    v_cvt_pk_bf16_f32 v76, v72, v73
    v_cvt_pk_bf16_f32 v77, v74, v75
    buffer_store_dwordx2 v[76:77], v7, s[16:19], s33 offen offset:64
    s_waitcnt lgkmcnt(4)
    v_add_f32 v88, v88, v92
    v_add_f32 v96, v96, v100
    v_add_f32 v89, v89, v93
    v_add_f32 v97, v97, v101
    v_add_f32 v90, v90, v94
    v_add_f32 v98, v98, v102
    v_add_f32 v91, v91, v95
    v_add_f32 v99, v99, v103
    v_add_f32 v88, v88, v96
    v_add_f32 v89, v89, v97
    v_add_f32 v90, v90, v98
    v_add_f32 v91, v91, v99
    v_cvt_pk_bf16_f32 v92, v88, v89
    v_cvt_pk_bf16_f32 v93, v90, v91
    v_lshlrev_b32 v96, 16, v26
    v_and_b32 v97, 0xffff0000, v26
    v_lshlrev_b32 v98, 16, v27
    v_and_b32 v99, 0xffff0000, v27
    v_lshlrev_b32 v88, 16, v92
    v_and_b32 v89, 0xffff0000, v92
    v_lshlrev_b32 v90, 16, v93
    v_and_b32 v91, 0xffff0000, v93
    v_add_f32 v88, v88, v96
    v_add_f32 v89, v89, v97
    v_add_f32 v90, v90, v98
    v_add_f32 v91, v91, v99
    v_cvt_pk_bf16_f32 v92, v88, v89
    v_cvt_pk_bf16_f32 v93, v90, v91
    buffer_store_dwordx2 v[92:93], v7, s[16:19], s33 offen offset:96
    s_waitcnt lgkmcnt(0)
    v_add_f32 v104, v104, v108
    v_add_f32 v112, v112, v116
    v_add_f32 v105, v105, v109
    v_add_f32 v113, v113, v117
    v_add_f32 v106, v106, v110
    v_add_f32 v114, v114, v118
    v_add_f32 v107, v107, v111
    v_add_f32 v115, v115, v119
    v_add_f32 v104, v104, v112
    v_add_f32 v105, v105, v113
    v_add_f32 v106, v106, v114
    v_add_f32 v107, v107, v115
    v_cvt_pk_bf16_f32 v108, v104, v105
    v_cvt_pk_bf16_f32 v109, v106, v107
    v_lshlrev_b32 v112, 16, v28
    v_and_b32 v113, 0xffff0000, v28
    v_lshlrev_b32 v114, 16, v29
    v_and_b32 v115, 0xffff0000, v29
    v_lshlrev_b32 v104, 16, v108
    v_and_b32 v105, 0xffff0000, v108
    v_lshlrev_b32 v106, 16, v109
    v_and_b32 v107, 0xffff0000, v109
    v_add_f32 v104, v104, v112
    v_add_f32 v105, v105, v113
    v_add_f32 v106, v106, v114
    v_add_f32 v107, v107, v115
    v_cvt_pk_bf16_f32 v108, v104, v105
    v_cvt_pk_bf16_f32 v109, v106, v107
    buffer_store_dwordx2 v[108:109], v7, s[16:19], s33 offen offset:128
    s_branch Lfin
Lg3b:
    buffer_load_dwordx4 v[56:59], v12, s[96:99], s31 offen sc1
    buffer_load_dwordx4 v[60:63], v13, s[96:99], s31 offen sc1
    buffer_load_dwordx4 v[64:67], v14, s[96:99], s31 offen sc1
    buffer_load_dwordx4 v[68:71], v15, s[96:99], s31 offen sc1
    s_add_u32 s31, s31, 1024
    buffer_load_dwordx4 v[92:95], v12, s[96:99], s31 offen sc1
    buffer_load_dwordx4 v[96:99], v13, s[96:99], s31 offen sc1
    buffer_load_dwordx4 v[100:103], v14, s[96:99], s31 offen sc1
    buffer_load_dwordx4 v[104:107], v15, s[96:99], s31 offen sc1
    s_add_u32 s31, s31, 1024
    buffer_load_dwordx4 v[128:131], v12, s[96:99], s31 offen sc1
    buffer_load_dwordx4 v[132:135], v13, s[96:99], s31 offen sc1
    buffer_load_dwordx4 v[136:139], v14, s[96:99], s31 offen sc1
    buffer_load_dwordx4 v[140:143], v15, s[96:99], s31 offen sc1
    s_add_u32 s31, s31, 1024
    s_add_u32 s35, s30, 4096
    buffer_load_dwordx2 v[20:21], v6, s[96:99], s30 offen offset:0 sc1
    buffer_load_dwordx2 v[22:23], v6, s[96:99], s30 offen offset:1024 sc1
    buffer_load_dwordx2 v[24:25], v6, s[96:99], s30 offen offset:2048 sc1
    buffer_load_dwordx2 v[26:27], v6, s[96:99], s30 offen offset:3072 sc1
    s_barrier
    s_mul_i32 s38, s3, 34816
    v_add_u32 v32, s38, v5
    buffer_load_dword v30, v18, s[96:99], s37 offen sc1
    s_add_u32 m0, s38, 0
    s_nop 0
    buffer_load_dwordx4 v12, s[96:99], s31 offen sc1 lds
    s_add_u32 m0, s38, 1024
    s_nop 0
    buffer_load_dwordx4 v13, s[96:99], s31 offen sc1 lds
    s_add_u32 m0, s38, 2048
    s_nop 0
    buffer_load_dwordx4 v14, s[96:99], s31 offen sc1 lds
    s_add_u32 m0, s38, 3072
    s_nop 0
    buffer_load_dwordx4 v15, s[96:99], s31 offen sc1 lds
    s_add_u32 s31, s31, 1024
    s_add_u32 m0, s38, 5120
    s_nop 0
    buffer_load_dwordx4 v12, s[96:99], s31 offen sc1 lds
    s_add_u32 m0, s38, 6144
    s_nop 0
    buffer_load_dwordx4 v13, s[96:99], s31 offen sc1 lds
    s_add_u32 m0, s38, 7168
    s_nop 0
    buffer_load_dwordx4 v14, s[96:99], s31 offen sc1 lds
    s_add_u32 m0, s38, 8192
    s_nop 0
    buffer_load_dwordx4 v15, s[96:99], s31 offen sc1 lds
    s_add_u32 s31, s31, 1024
    s_add_u32 m0, s38, 10240
    s_nop 0
    buffer_load_dwordx4 v12, s[96:99], s31 offen sc1 lds
    s_add_u32 m0, s38, 11264
    s_nop 0
    buffer_load_dwordx4 v13, s[96:99], s31 offen sc1 lds
    s_add_u32 m0, s38, 12288
    s_nop 0
    buffer_load_dwordx4 v14, s[96:99], s31 offen sc1 lds
    s_add_u32 m0, s38, 13312
    s_nop 0
    buffer_load_dwordx4 v15, s[96:99], s31 offen sc1 lds
    s_add_u32 s31, s31, 1024
    s_add_u32 m0, s38, 15360
    s_nop 0
    buffer_load_dwordx4 v12, s[96:99], s31 offen sc1 lds
    s_add_u32 m0, s38, 16384
    s_nop 0
    buffer_load_dwordx4 v13, s[96:99], s31 offen sc1 lds
    s_add_u32 m0, s38, 17408
    s_nop 0
    buffer_load_dwordx4 v14, s[96:99], s31 offen sc1 lds
    s_add_u32 m0, s38, 18432
    s_nop 0
    buffer_load_dwordx4 v15, s[96:99], s31 offen sc1 lds
    s_add_u32 s31, s31, 1024
    s_waitcnt vmcnt(16)
    v_cmp_ne_u32 vcc, s100, v30
    s_nop 0
    s_cmp_eq_u64 vcc, 0
    s_cbranch_scc1 Lg3ok47
    s_mov_b32 s90, 0
Lpl48:
    buffer_load_dword v30, v18, s[96:99], s37 offen sc1
    s_waitcnt vmcnt(0)
    v_cmp_ne_u32 vcc, s100, v30
    s_add_u32 s90, s90, 1
    s_cmp_eq_u64 vcc, 0
    s_cbranch_scc1 Lok49
    s_sleep 8
    s_cmp_lt_u32 s90, 0x20000
    s_cbranch_scc1 Lpl48
Lok49:
Lg3ok47:
    buffer_load_dwordx4 v[40:43], v8, s[96:99], s29 offen sc1
    buffer_load_dwordx4 v[44:47], v9, s[96:99], s29 offen sc1
    buffer_load_dwordx4 v[48:51], v10, s[96:99], s29 offen sc1
    buffer_load_dwordx4 v[52:55], v11, s[96:99], s29 offen sc1
    s_add_u32 s29, s29, 1024
    buffer_load_dwordx4 v[76:79], v8, s[96:99], s29 offen sc1
    buffer_load_dwordx4 v[80:83], v9, s[96:99], s29 offen sc1
    buffer_load_dwordx4 v[84:87], v10, s[96:99], s29 offen sc1
    buffer_load_dwordx4 v[88:91], v11, s[96:99], s29 offen sc1
    s_add_u32 s29, s29, 1024
    buffer_load_dwordx4 v[112:115], v8, s[96:99], s29 offen sc1
    buffer_load_dwordx4 v[116:119], v9, s[96:99], s29 offen sc1
    buffer_load_dwordx4 v[120:123], v10, s[96:99], s29 offen sc1
    buffer_load_dwordx4 v[124:127], v11, s[96:99], s29 offen sc1
    s_add_u32 s29, s29, 1024
    s_waitcnt vmcnt(8)
    v_mfma_f32_16x16x32_bf16 v[160:163], v[56:59], v[40:43], 0
    v_mfma_f32_16x16x32_bf16 v[164:167], v[56:59], v[44:47], 0
    v_mfma_f32_16x16x32_bf16 v[168:171], v[56:59], v[48:51], 0
    v_mfma_f32_16x16x32_bf16 v[172:175], v[56:59], v[52:55], 0
    v_mfma_f32_16x16x32_bf16 v[176:179], v[60:63], v[40:43], 0
    v_mfma_f32_16x16x32_bf16 v[180:183], v[60:63], v[44:47], 0
    v_mfma_f32_16x16x32_bf16 v[184:187], v[60:63], v[48:51], 0
    v_mfma_f32_16x16x32_bf16 v[188:191], v[60:63], v[52:55], 0
    v_mfma_f32_16x16x32_bf16 v[192:195], v[64:67], v[40:43], 0
    v_mfma_f32_16x16x32_bf16 v[196:199], v[64:67], v[44:47], 0
    v_mfma_f32_16x16x32_bf16 v[200:203], v[64:67], v[48:51], 0
    v_mfma_f32_16x16x32_bf16 v[204:207], v[64:67], v[52:55], 0
    v_mfma_f32_16x16x32_bf16 v[208:211], v[68:71], v[40:43], 0
    v_mfma_f32_16x16x32_bf16 v[212:215], v[68:71], v[44:47], 0
    v_mfma_f32_16x16x32_bf16 v[216:219], v[68:71], v[48:51], 0
    v_mfma_f32_16x16x32_bf16 v[220:223], v[68:71], v[52:55], 0
    buffer_load_dwordx4 v[40:43], v8, s[96:99], s29 offen sc1
    buffer_load_dwordx4 v[44:47], v9, s[96:99], s29 offen sc1
    buffer_load_dwordx4 v[48:51], v10, s[96:99], s29 offen sc1
    buffer_load_dwordx4 v[52:55], v11, s[96:99], s29 offen sc1
    s_add_u32 s29, s29, 1024
    ds_read_b128 v[56:59], v32 offset:0
    ds_read_b128 v[60:63], v32 offset:1024
    ds_read_b128 v[64:67], v32 offset:2048
    ds_read_b128 v[68:71], v32 offset:3072
    s_waitcnt vmcnt(8)
    v_mfma_f32_16x16x32_bf16 v[160:163], v[92:95], v[76:79], v[160:163]
    v_mfma_f32_16x16x32_bf16 v[164:167], v[92:95], v[80:83], v[164:167]
    v_mfma_f32_16x16x32_bf16 v[168:171], v[92:95], v[84:87], v[168:171]
    v_mfma_f32_16x16x32_bf16 v[172:175], v[92:95], v[88:91], v[172:175]
    v_mfma_f32_16x16x32_bf16 v[176:179], v[96:99], v[76:79], v[176:179]
    v_mfma_f32_16x16x32_bf16 v[180:183], v[96:99], v[80:83], v[180:183]
    v_mfma_f32_16x16x32_bf16 v[184:187], v[96:99], v[84:87], v[184:187]
    v_mfma_f32_16x16x32_bf16 v[188:191], v[96:99], v[88:91], v[188:191]
    v_mfma_f32_16x16x32_bf16 v[192:195], v[100:103], v[76:79], v[192:195]
    v_mfma_f32_16x16x32_bf16 v[196:199], v[100:103], v[80:83], v[196:199]
    v_mfma_f32_16x16x32_bf16 v[200:203], v[100:103], v[84:87], v[200:203]
    v_mfma_f32_16x16x32_bf16 v[204:207], v[100:103], v[88:91], v[204:207]
    v_mfma_f32_16x16x32_bf16 v[208:211], v[104:107], v[76:79], v[208:211]
    v_mfma_f32_16x16x32_bf16 v[212:215], v[104:107], v[80:83], v[212:215]
    v_mfma_f32_16x16x32_bf16 v[216:219], v[104:107], v[84:87], v[216:219]
    v_mfma_f32_16x16x32_bf16 v[220:223], v[104:107], v[88:91], v[220:223]
    buffer_load_dwordx2 v[76:77], v36, s[96:99], s29 offen sc1
    buffer_load_dwordx2 v[78:79], v36, s[96:99], s29 offen offset:512 sc1
    buffer_load_dwordx2 v[80:81], v37, s[96:99], s29 offen sc1
    buffer_load_dwordx2 v[82:83], v37, s[96:99], s29 offen offset:512 sc1
    buffer_load_dwordx2 v[84:85], v38, s[96:99], s29 offen sc1
    buffer_load_dwordx2 v[86:87], v38, s[96:99], s29 offen offset:512 sc1
    buffer_load_dwordx2 v[88:89], v39, s[96:99], s29 offen sc1
    buffer_load_dwordx2 v[90:91], v39, s[96:99], s29 offen offset:512 sc1
    s_add_u32 s29, s29, 1024
    ds_read_b128 v[92:95], v32 offset:5120
    ds_read_b128 v[96:99], v32 offset:6144
    ds_read_b128 v[100:103], v32 offset:7168
    ds_read_b128 v[104:107], v32 offset:8192
    s_waitcnt vmcnt(12)
    v_mfma_f32_16x16x32_bf16 v[160:163], v[128:131], v[112:115], v[160:163]
    v_mfma_f32_16x16x32_bf16 v[164:167], v[128:131], v[116:119], v[164:167]
    v_mfma_f32_16x16x32_bf16 v[168:171], v[128:131], v[120:123], v[168:171]
    v_mfma_f32_16x16x32_bf16 v[172:175], v[128:131], v[124:127], v[172:175]
    v_mfma_f32_16x16x32_bf16 v[176:179], v[132:135], v[112:115], v[176:179]
    v_mfma_f32_16x16x32_bf16 v[180:183], v[132:135], v[116:119], v[180:183]
    v_mfma_f32_16x16x32_bf16 v[184:187], v[132:135], v[120:123], v[184:187]
    v_mfma_f32_16x16x32_bf16 v[188:191], v[132:135], v[124:127], v[188:191]
    v_mfma_f32_16x16x32_bf16 v[192:195], v[136:139], v[112:115], v[192:195]
    v_mfma_f32_16x16x32_bf16 v[196:199], v[136:139], v[116:119], v[196:199]
    v_mfma_f32_16x16x32_bf16 v[200:203], v[136:139], v[120:123], v[200:203]
    v_mfma_f32_16x16x32_bf16 v[204:207], v[136:139], v[124:127], v[204:207]
    v_mfma_f32_16x16x32_bf16 v[208:211], v[140:143], v[112:115], v[208:211]
    v_mfma_f32_16x16x32_bf16 v[212:215], v[140:143], v[116:119], v[212:215]
    v_mfma_f32_16x16x32_bf16 v[216:219], v[140:143], v[120:123], v[216:219]
    v_mfma_f32_16x16x32_bf16 v[220:223], v[140:143], v[124:127], v[220:223]
    buffer_load_dwordx4 v[112:115], v8, s[96:99], s29 offen sc1
    buffer_load_dwordx4 v[116:119], v9, s[96:99], s29 offen sc1
    buffer_load_dwordx4 v[120:123], v10, s[96:99], s29 offen sc1
    buffer_load_dwordx4 v[124:127], v11, s[96:99], s29 offen sc1
    s_add_u32 s29, s29, 1024
    ds_read_b128 v[128:131], v32 offset:10240
    ds_read_b128 v[132:135], v32 offset:11264
    ds_read_b128 v[136:139], v32 offset:12288
    ds_read_b128 v[140:143], v32 offset:13312
    s_waitcnt vmcnt(12)
    s_waitcnt lgkmcnt(8)
    v_mfma_f32_16x16x32_bf16 v[160:163], v[56:59], v[40:43], v[160:163]
    v_mfma_f32_16x16x32_bf16 v[164:167], v[56:59], v[44:47], v[164:167]
    v_mfma_f32_16x16x32_bf16 v[168:171], v[56:59], v[48:51], v[168:171]
    v_mfma_f32_16x16x32_bf16 v[172:175], v[56:59], v[52:55], v[172:175]
    v_mfma_f32_16x16x32_bf16 v[176:179], v[60:63], v[40:43], v[176:179]
    v_mfma_f32_16x16x32_bf16 v[180:183], v[60:63], v[44:47], v[180:183]
    v_mfma_f32_16x16x32_bf16 v[184:187], v[60:63], v[48:51], v[184:187]
    v_mfma_f32_16x16x32_bf16 v[188:191], v[60:63], v[52:55], v[188:191]
    v_mfma_f32_16x16x32_bf16 v[192:195], v[64:67], v[40:43], v[192:195]
    v_mfma_f32_16x16x32_bf16 v[196:199], v[64:67], v[44:47], v[196:199]
    v_mfma_f32_16x16x32_bf16 v[200:203], v[64:67], v[48:51], v[200:203]
    v_mfma_f32_16x16x32_bf16 v[204:207], v[64:67], v[52:55], v[204:207]
    v_mfma_f32_16x16x32_bf16 v[208:211], v[68:71], v[40:43], v[208:211]
    v_mfma_f32_16x16x32_bf16 v[212:215], v[68:71], v[44:47], v[212:215]
    v_mfma_f32_16x16x32_bf16 v[216:219], v[68:71], v[48:51], v[216:219]
    v_mfma_f32_16x16x32_bf16 v[220:223], v[68:71], v[52:55], v[220:223]
    buffer_load_dwordx4 v[40:43], v8, s[96:99], s29 offen sc1
    buffer_load_dwordx4 v[44:47], v9, s[96:99], s29 offen sc1
    buffer_load_dwordx4 v[48:51], v10, s[96:99], s29 offen sc1
    buffer_load_dwordx4 v[52:55], v11, s[96:99], s29 offen sc1
    s_add_u32 s29, s29, 1024
    ds_read_b128 v[56:59], v32 offset:15360
    ds_read_b128 v[60:63], v32 offset:16384
    ds_read_b128 v[64:67], v32 offset:17408
    ds_read_b128 v[68:71], v32 offset:18432
    s_waitcnt vmcnt(8)
    s_waitcnt lgkmcnt(8)
    v_mfma_f32_16x16x32_bf16 v[160:163], v[92:95], v[76:79], v[160:163]
    v_mfma_f32_16x16x32_bf16 v[164:167], v[92:95], v[80:83], v[164:167]
    v_mfma_f32_16x16x32_bf16 v[168:171], v[92:95], v[84:87], v[168:171]
    v_mfma_f32_16x16x32_bf16 v[172:175], v[92:95], v[88:91], v[172:175]
    v_mfma_f32_16x16x32_bf16 v[176:179], v[96:99], v[76:79], v[176:179]
    v_mfma_f32_16x16x32_bf16 v[180:183], v[96:99], v[80:83], v[180:183]
    v_mfma_f32_16x16x32_bf16 v[184:187], v[96:99], v[84:87], v[184:187]
    v_mfma_f32_16x16x32_bf16 v[188:191], v[96:99], v[88:91], v[188:191]
    v_mfma_f32_16x16x32_bf16 v[192:195], v[100:103], v[76:79], v[192:195]
    v_mfma_f32_16x16x32_bf16 v[196:199], v[100:103], v[80:83], v[196:199]
    v_mfma_f32_16x16x32_bf16 v[200:203], v[100:103], v[84:87], v[200:203]
    v_mfma_f32_16x16x32_bf16 v[204:207], v[100:103], v[88:91], v[204:207]
    v_mfma_f32_16x16x32_bf16 v[208:211], v[104:107], v[76:79], v[208:211]
    v_mfma_f32_16x16x32_bf16 v[212:215], v[104:107], v[80:83], v[212:215]
    v_mfma_f32_16x16x32_bf16 v[216:219], v[104:107], v[84:87], v[216:219]
    v_mfma_f32_16x16x32_bf16 v[220:223], v[104:107], v[88:91], v[220:223]
    buffer_load_dwordx4 v[76:79], v8, s[96:99], s29 offen sc1
    buffer_load_dwordx4 v[80:83], v9, s[96:99], s29 offen sc1
    buffer_load_dwordx4 v[84:87], v10, s[96:99], s29 offen sc1
    buffer_load_dwordx4 v[88:91], v11, s[96:99], s29 offen sc1
    s_add_u32 s29, s29, 1024
    buffer_load_dwordx4 v[92:95], v12, s[96:99], s31 offen sc1
    buffer_load_dwordx4 v[96:99], v13, s[96:99], s31 offen sc1
    buffer_load_dwordx4 v[100:103], v14, s[96:99], s31 offen sc1
    buffer_load_dwordx4 v[104:107], v15, s[96:99], s31 offen sc1
    s_add_u32 s31, s31, 1024
    s_waitcnt vmcnt(12)
    s_waitcnt lgkmcnt(4)
    v_mfma_f32_16x16x32_bf16 v[160:163], v[128:131], v[112:115], v[160:163]
    v_mfma_f32_16x16x32_bf16 v[164:167], v[128:131], v[116:119], v[164:167]
    v_mfma_f32_16x16x32_bf16 v[168:171], v[128:131], v[120:123], v[168:171]
    v_mfma_f32_16x16x32_bf16 v[172:175], v[128:131], v[124:127], v[172:175]
    v_mfma_f32_16x16x32_bf16 v[176:179], v[132:135], v[112:115], v[176:179]
    v_mfma_f32_16x16x32_bf16 v[180:183], v[132:135], v[116:119], v[180:183]
    v_mfma_f32_16x16x32_bf16 v[184:187], v[132:135], v[120:123], v[184:187]
    v_mfma_f32_16x16x32_bf16 v[188:191], v[132:135], v[124:127], v[188:191]
    v_mfma_f32_16x16x32_bf16 v[192:195], v[136:139], v[112:115], v[192:195]
    v_mfma_f32_16x16x32_bf16 v[196:199], v[136:139], v[116:119], v[196:199]
    v_mfma_f32_16x16x32_bf16 v[200:203], v[136:139], v[120:123], v[200:203]
    v_mfma_f32_16x16x32_bf16 v[204:207], v[136:139], v[124:127], v[204:207]
    v_mfma_f32_16x16x32_bf16 v[208:211], v[140:143], v[112:115], v[208:211]
    v_mfma_f32_16x16x32_bf16 v[212:215], v[140:143], v[116:119], v[212:215]
    v_mfma_f32_16x16x32_bf16 v[216:219], v[140:143], v[120:123], v[216:219]
    v_mfma_f32_16x16x32_bf16 v[220:223], v[140:143], v[124:127], v[220:223]
    buffer_load_dwordx4 v[112:115], v8, s[96:99], s29 offen sc1
    buffer_load_dwordx4 v[116:119], v9, s[96:99], s29 offen sc1
    buffer_load_dwordx4 v[120:123], v10, s[96:99], s29 offen sc1
    buffer_load_dwordx4 v[124:127], v11, s[96:99], s29 offen sc1
    s_add_u32 s29, s29, 1024
    buffer_load_dwordx4 v[128:131], v12, s[96:99], s31 offen sc1
    buffer_load_dwordx4 v[132:135], v13, s[96:99], s31 offen sc1
    buffer_load_dwordx4 v[136:139], v14, s[96:99], s31 offen sc1
    buffer_load_dwordx4 v[140:143], v15, s[96:99], s31 offen sc1
    s_add_u32 s31, s31, 1024
    s_waitcnt vmcnt(16)
    s_waitcnt lgkmcnt(0)
    v_mfma_f32_16x16x32_bf16 v[160:163], v[56:59], v[40:43], v[160:163]
    v_mfma_f32_16x16x32_bf16 v[164:167], v[56:59], v[44:47], v[164:167]
    v_mfma_f32_16x16x32_bf16 v[168:171], v[56:59], v[48:51], v[168:171]
    v_mfma_f32_16x16x32_bf16 v[172:175], v[56:59], v[52:55], v[172:175]
    v_mfma_f32_16x16x32_bf16 v[176:179], v[60:63], v[40:43], v[176:179]
    v_mfma_f32_16x16x32_bf16 v[180:183], v[60:63], v[44:47], v[180:183]
    v_mfma_f32_16x16x32_bf16 v[184:187], v[60:63], v[48:51], v[184:187]
    v_mfma_f32_16x16x32_bf16 v[188:191], v[60:63], v[52:55], v[188:191]
    v_mfma_f32_16x16x32_bf16 v[192:195], v[64:67], v[40:43], v[192:195]
    v_mfma_f32_16x16x32_bf16 v[196:199], v[64:67], v[44:47], v[196:199]
    v_mfma_f32_16x16x32_bf16 v[200:203], v[64:67], v[48:51], v[200:203]
    v_mfma_f32_16x16x32_bf16 v[204:207], v[64:67], v[52:55], v[204:207]
    v_mfma_f32_16x16x32_bf16 v[208:211], v[68:71], v[40:43], v[208:211]
    v_mfma_f32_16x16x32_bf16 v[212:215], v[68:71], v[44:47], v[212:215]
    v_mfma_f32_16x16x32_bf16 v[216:219], v[68:71], v[48:51], v[216:219]
    v_mfma_f32_16x16x32_bf16 v[220:223], v[68:71], v[52:55], v[220:223]
    buffer_load_dwordx4 v[40:43], v8, s[96:99], s29 offen sc1
    buffer_load_dwordx4 v[44:47], v9, s[96:99], s29 offen sc1
    buffer_load_dwordx4 v[48:51], v10, s[96:99], s29 offen sc1
    buffer_load_dwordx4 v[52:55], v11, s[96:99], s29 offen sc1
    s_add_u32 s29, s29, 1024
    buffer_load_dwordx4 v[56:59], v12, s[96:99], s31 offen sc1
    buffer_load_dwordx4 v[60:63], v13, s[96:99], s31 offen sc1
    buffer_load_dwordx4 v[64:67], v14, s[96:99], s31 offen sc1
    buffer_load_dwordx4 v[68:71], v15, s[96:99], s31 offen sc1
    s_add_u32 s31, s31, 1024
    s_waitcnt vmcnt(16)
    v_mfma_f32_16x16x32_bf16 v[160:163], v[92:95], v[76:79], v[160:163]
    v_mfma_f32_16x16x32_bf16 v[164:167], v[92:95], v[80:83], v[164:167]
    v_mfma_f32_16x16x32_bf16 v[168:171], v[92:95], v[84:87], v[168:171]
    v_mfma_f32_16x16x32_bf16 v[172:175], v[92:95], v[88:91], v[172:175]
    v_mfma_f32_16x16x32_bf16 v[176:179], v[96:99], v[76:79], v[176:179]
    v_mfma_f32_16x16x32_bf16 v[180:183], v[96:99], v[80:83], v[180:183]
    v_mfma_f32_16x16x32_bf16 v[184:187], v[96:99], v[84:87], v[184:187]
    v_mfma_f32_16x16x32_bf16 v[188:191], v[96:99], v[88:91], v[188:191]
    v_mfma_f32_16x16x32_bf16 v[192:195], v[100:103], v[76:79], v[192:195]
    v_mfma_f32_16x16x32_bf16 v[196:199], v[100:103], v[80:83], v[196:199]
    v_mfma_f32_16x16x32_bf16 v[200:203], v[100:103], v[84:87], v[200:203]
    v_mfma_f32_16x16x32_bf16 v[204:207], v[100:103], v[88:91], v[204:207]
    v_mfma_f32_16x16x32_bf16 v[208:211], v[104:107], v[76:79], v[208:211]
    v_mfma_f32_16x16x32_bf16 v[212:215], v[104:107], v[80:83], v[212:215]
    v_mfma_f32_16x16x32_bf16 v[216:219], v[104:107], v[84:87], v[216:219]
    v_mfma_f32_16x16x32_bf16 v[220:223], v[104:107], v[88:91], v[220:223]
    buffer_load_dwordx4 v[76:79], v8, s[96:99], s29 offen sc1
    buffer_load_dwordx4 v[80:83], v9, s[96:99], s29 offen sc1
    buffer_load_dwordx4 v[84:87], v10, s[96:99], s29 offen sc1
    buffer_load_dwordx4 v[88:91], v11, s[96:99], s29 offen sc1
    s_add_u32 s29, s29, 1024
    buffer_load_dwordx4 v[92:95], v12, s[96:99], s31 offen sc1
    buffer_load_dwordx4 v[96:99], v13, s[96:99], s31 offen sc1
    buffer_load_dwordx4 v[100:103], v14, s[96:99], s31 offen sc1
    buffer_load_dwordx4 v[104:107], v15, s[96:99], s31 offen sc1
    s_add_u32 s31, s31, 1024
    s_waitcnt vmcnt(16)
    v_mfma_f32_16x16x32_bf16 v[160:163], v[128:131], v[112:115], v[160:163]
    v_mfma_f32_16x16x32_bf16 v[164:167], v[128:131], v[116:119], v[164:167]
    v_mfma_f32_16x16x32_bf16 v[168:171], v[128:131], v[120:123], v[168:171]
    v_mfma_f32_16x16x32_bf16 v[172:175], v[128:131], v[124:127], v[172:175]
    v_mfma_f32_16x16x32_bf16 v[176:179], v[132:135], v[112:115], v[176:179]
    v_mfma_f32_16x16x32_bf16 v[180:183], v[132:135], v[116:119], v[180:183]
    v_mfma_f32_16x16x32_bf16 v[184:187], v[132:135], v[120:123], v[184:187]
    v_mfma_f32_16x16x32_bf16 v[188:191], v[132:135], v[124:127], v[188:191]
    v_mfma_f32_16x16x32_bf16 v[192:195], v[136:139], v[112:115], v[192:195]
    v_mfma_f32_16x16x32_bf16 v[196:199], v[136:139], v[116:119], v[196:199]
    v_mfma_f32_16x16x32_bf16 v[200:203], v[136:139], v[120:123], v[200:203]
    v_mfma_f32_16x16x32_bf16 v[204:207], v[136:139], v[124:127], v[204:207]
    v_mfma_f32_16x16x32_bf16 v[208:211], v[140:143], v[112:115], v[208:211]
    v_mfma_f32_16x16x32_bf16 v[212:215], v[140:143], v[116:119], v[212:215]
    v_mfma_f32_16x16x32_bf16 v[216:219], v[140:143], v[120:123], v[216:219]
    v_mfma_f32_16x16x32_bf16 v[220:223], v[140:143], v[124:127], v[220:223]
    buffer_load_dwordx4 v[112:115], v8, s[96:99], s29 offen sc1
    buffer_load_dwordx4 v[116:119], v9, s[96:99], s29 offen sc1
    buffer_load_dwordx4 v[120:123], v10, s[96:99], s29 offen sc1
    buffer_load_dwordx4 v[124:127], v11, s[96:99], s29 offen sc1
    s_add_u32 s29, s29, 1024
    buffer_load_dwordx4 v[128:131], v12, s[96:99], s31 offen sc1
    buffer_load_dwordx4 v[132:135], v13, s[96:99], s31 offen sc1
    buffer_load_dwordx4 v[136:139], v14, s[96:99], s31 offen sc1
    buffer_load_dwordx4 v[140:143], v15, s[96:99], s31 offen sc1
    s_add_u32 s31, s31, 1024
    s_waitcnt vmcnt(16)
    v_mfma_f32_16x16x32_bf16 v[160:163], v[56:59], v[40:43], v[160:163]
    v_mfma_f32_16x16x32_bf16 v[164:167], v[56:59], v[44:47], v[164:167]
    v_mfma_f32_16x16x32_bf16 v[168:171], v[56:59], v[48:51], v[168:171]
    v_mfma_f32_16x16x32_bf16 v[172:175], v[56:59], v[52:55], v[172:175]
    v_mfma_f32_16x16x32_bf16 v[176:179], v[60:63], v[40:43], v[176:179]
    v_mfma_f32_16x16x32_bf16 v[180:183], v[60:63], v[44:47], v[180:183]
    v_mfma_f32_16x16x32_bf16 v[184:187], v[60:63], v[48:51], v[184:187]
    v_mfma_f32_16x16x32_bf16 v[188:191], v[60:63], v[52:55], v[188:191]
    v_mfma_f32_16x16x32_bf16 v[192:195], v[64:67], v[40:43], v[192:195]
    v_mfma_f32_16x16x32_bf16 v[196:199], v[64:67], v[44:47], v[196:199]
    v_mfma_f32_16x16x32_bf16 v[200:203], v[64:67], v[48:51], v[200:203]
    v_mfma_f32_16x16x32_bf16 v[204:207], v[64:67], v[52:55], v[204:207]
    v_mfma_f32_16x16x32_bf16 v[208:211], v[68:71], v[40:43], v[208:211]
    v_mfma_f32_16x16x32_bf16 v[212:215], v[68:71], v[44:47], v[212:215]
    v_mfma_f32_16x16x32_bf16 v[216:219], v[68:71], v[48:51], v[216:219]
    v_mfma_f32_16x16x32_bf16 v[220:223], v[68:71], v[52:55], v[220:223]
    buffer_load_dwordx4 v[40:43], v8, s[96:99], s29 offen sc1
    buffer_load_dwordx4 v[44:47], v9, s[96:99], s29 offen sc1
    buffer_load_dwordx4 v[48:51], v10, s[96:99], s29 offen sc1
    buffer_load_dwordx4 v[52:55], v11, s[96:99], s29 offen sc1
    s_add_u32 s29, s29, 1024
    buffer_load_dwordx4 v[56:59], v12, s[96:99], s31 offen sc1
    buffer_load_dwordx4 v[60:63], v13, s[96:99], s31 offen sc1
    buffer_load_dwordx4 v[64:67], v14, s[96:99], s31 offen sc1
    buffer_load_dwordx4 v[68:71], v15, s[96:99], s31 offen sc1
    s_add_u32 s31, s31, 1024
    s_waitcnt vmcnt(16)
    v_mfma_f32_16x16x32_bf16 v[160:163], v[92:95], v[76:79], v[160:163]
    v_mfma_f32_16x16x32_bf16 v[164:167], v[92:95], v[80:83], v[164:167]
    v_mfma_f32_16x16x32_bf16 v[168:171], v[92:95], v[84:87], v[168:171]
    v_mfma_f32_16x16x32_bf16 v[172:175], v[92:95], v[88:91], v[172:175]
    v_mfma_f32_16x16x32_bf16 v[176:179], v[96:99], v[76:79], v[176:179]
    v_mfma_f32_16x16x32_bf16 v[180:183], v[96:99], v[80:83], v[180:183]
    v_mfma_f32_16x16x32_bf16 v[184:187], v[96:99], v[84:87], v[184:187]
    v_mfma_f32_16x16x32_bf16 v[188:191], v[96:99], v[88:91], v[188:191]
    v_mfma_f32_16x16x32_bf16 v[192:195], v[100:103], v[76:79], v[192:195]
    v_mfma_f32_16x16x32_bf16 v[196:199], v[100:103], v[80:83], v[196:199]
    v_mfma_f32_16x16x32_bf16 v[200:203], v[100:103], v[84:87], v[200:203]
    v_mfma_f32_16x16x32_bf16 v[204:207], v[100:103], v[88:91], v[204:207]
    v_mfma_f32_16x16x32_bf16 v[208:211], v[104:107], v[76:79], v[208:211]
    v_mfma_f32_16x16x32_bf16 v[212:215], v[104:107], v[80:83], v[212:215]
    v_mfma_f32_16x16x32_bf16 v[216:219], v[104:107], v[84:87], v[216:219]
    v_mfma_f32_16x16x32_bf16 v[220:223], v[104:107], v[88:91], v[220:223]
    buffer_load_dwordx2 v[76:77], v36, s[96:99], s29 offen sc1
    buffer_load_dwordx2 v[78:79], v36, s[96:99], s29 offen offset:512 sc1
    buffer_load_dwordx2 v[80:81], v37, s[96:99], s29 offen sc1
    buffer_load_dwordx2 v[82:83], v37, s[96:99], s29 offen offset:512 sc1
    buffer_load_dwordx2 v[84:85], v38, s[96:99], s29 offen sc1
    buffer_load_dwordx2 v[86:87], v38, s[96:99], s29 offen offset:512 sc1
    buffer_load_dwordx2 v[88:89], v39, s[96:99], s29 offen sc1
    buffer_load_dwordx2 v[90:91], v39, s[96:99], s29 offen offset:512 sc1
    s_add_u32 s29, s29, 1024
    buffer_load_dwordx4 v[92:95], v12, s[96:99], s31 offen sc1
    buffer_load_dwordx4 v[96:99], v13, s[96:99], s31 offen sc1
    buffer_load_dwordx4 v[100:103], v14, s[96:99], s31 offen sc1
    buffer_load_dwordx4 v[104:107], v15, s[96:99], s31 offen sc1
    s_add_u32 s31, s31, 1024
    s_waitcnt vmcnt(20)
    v_mfma_f32_16x16x32_bf16 v[160:163], v[128:131], v[112:115], v[160:163]
    v_mfma_f32_16x16x32_bf16 v[164:167], v[128:131], v[116:119], v[164:167]
    v_mfma_f32_16x16x32_bf16 v[168:171], v[128:131], v[120:123], v[168:171]
    v_mfma_f32_16x16x32_bf16 v[172:175], v[128:131], v[124:127], v[172:175]
    v_mfma_f32_16x16x32_bf16 v[176:179], v[132:135], v[112:115], v[176:179]
    v_mfma_f32_16x16x32_bf16 v[180:183], v[132:135], v[116:119], v[180:183]
    v_mfma_f32_16x16x32_bf16 v[184:187], v[132:135], v[120:123], v[184:187]
    v_mfma_f32_16x16x32_bf16 v[188:191], v[132:135], v[124:127], v[188:191]
    v_mfma_f32_16x16x32_bf16 v[192:195], v[136:139], v[112:115], v[192:195]
    v_mfma_f32_16x16x32_bf16 v[196:199], v[136:139], v[116:119], v[196:199]
    v_mfma_f32_16x16x32_bf16 v[200:203], v[136:139], v[120:123], v[200:203]
    v_mfma_f32_16x16x32_bf16 v[204:207], v[136:139], v[124:127], v[204:207]
    v_mfma_f32_16x16x32_bf16 v[208:211], v[140:143], v[112:115], v[208:211]
    v_mfma_f32_16x16x32_bf16 v[212:215], v[140:143], v[116:119], v[212:215]
    v_mfma_f32_16x16x32_bf16 v[216:219], v[140:143], v[120:123], v[216:219]
    v_mfma_f32_16x16x32_bf16 v[220:223], v[140:143], v[124:127], v[220:223]
    buffer_load_dwordx4 v[112:115], v8, s[96:99], s29 offen sc1
    buffer_load_dwordx4 v[116:119], v9, s[96:99], s29 offen sc1
    buffer_load_dwordx4 v[120:123], v10, s[96:99], s29 offen sc1
    buffer_load_dwordx4 v[124:127], v11, s[96:99], s29 offen sc1
    s_add_u32 s29, s29, 1024
    buffer_load_dwordx4 v[128:131], v12, s[96:99], s31 offen sc1
    buffer_load_dwordx4 v[132:135], v13, s[96:99], s31 offen sc1
    buffer_load_dwordx4 v[136:139], v14, s[96:99], s31 offen sc1
    buffer_load_dwordx4 v[140:143], v15, s[96:99], s31 offen sc1
    s_add_u32 s31, s31, 1024
    s_waitcnt vmcnt(20)
    v_mfma_f32_16x16x32_bf16 v[160:163], v[56:59], v[40:43], v[160:163]
    v_mfma_f32_16x16x32_bf16 v[164:167], v[56:59], v[44:47], v[164:167]
    v_mfma_f32_16x16x32_bf16 v[168:171], v[56:59], v[48:51], v[168:171]
    v_mfma_f32_16x16x32_bf16 v[172:175], v[56:59], v[52:55], v[172:175]
    v_mfma_f32_16x16x32_bf16 v[176:179], v[60:63], v[40:43], v[176:179]
    v_mfma_f32_16x16x32_bf16 v[180:183], v[60:63], v[44:47], v[180:183]
    v_mfma_f32_16x16x32_bf16 v[184:187], v[60:63], v[48:51], v[184:187]
    v_mfma_f32_16x16x32_bf16 v[188:191], v[60:63], v[52:55], v[188:191]
    v_mfma_f32_16x16x32_bf16 v[192:195], v[64:67], v[40:43], v[192:195]
    v_mfma_f32_16x16x32_bf16 v[196:199], v[64:67], v[44:47], v[196:199]
    v_mfma_f32_16x16x32_bf16 v[200:203], v[64:67], v[48:51], v[200:203]
    v_mfma_f32_16x16x32_bf16 v[204:207], v[64:67], v[52:55], v[204:207]
    v_mfma_f32_16x16x32_bf16 v[208:211], v[68:71], v[40:43], v[208:211]
    v_mfma_f32_16x16x32_bf16 v[212:215], v[68:71], v[44:47], v[212:215]
    v_mfma_f32_16x16x32_bf16 v[216:219], v[68:71], v[48:51], v[216:219]
    v_mfma_f32_16x16x32_bf16 v[220:223], v[68:71], v[52:55], v[220:223]
    buffer_load_dwordx4 v[40:43], v8, s[96:99], s29 offen sc1
    buffer_load_dwordx4 v[44:47], v9, s[96:99], s29 offen sc1
    buffer_load_dwordx4 v[48:51], v10, s[96:99], s29 offen sc1
    buffer_load_dwordx4 v[52:55], v11, s[96:99], s29 offen sc1
    s_add_u32 s29, s29, 1024
    buffer_load_dwordx4 v[56:59], v12, s[96:99], s31 offen sc1
    buffer_load_dwordx4 v[60:63], v13, s[96:99], s31 offen sc1
    buffer_load_dwordx4 v[64:67], v14, s[96:99], s31 offen sc1
    buffer_load_dwordx4 v[68:71], v15, s[96:99], s31 offen sc1
    s_add_u32 s31, s31, 1024
    s_waitcnt vmcnt(16)
    v_mfma_f32_16x16x32_bf16 v[160:163], v[92:95], v[76:79], v[160:163]
    v_mfma_f32_16x16x32_bf16 v[164:167], v[92:95], v[80:83], v[164:167]
    v_mfma_f32_16x16x32_bf16 v[168:171], v[92:95], v[84:87], v[168:171]
    v_mfma_f32_16x16x32_bf16 v[172:175], v[92:95], v[88:91], v[172:175]
    v_mfma_f32_16x16x32_bf16 v[176:179], v[96:99], v[76:79], v[176:179]
    v_mfma_f32_16x16x32_bf16 v[180:183], v[96:99], v[80:83], v[180:183]
    v_mfma_f32_16x16x32_bf16 v[184:187], v[96:99], v[84:87], v[184:187]
    v_mfma_f32_16x16x32_bf16 v[188:191], v[96:99], v[88:91], v[188:191]
    v_mfma_f32_16x16x32_bf16 v[192:195], v[100:103], v[76:79], v[192:195]
    v_mfma_f32_16x16x32_bf16 v[196:199], v[100:103], v[80:83], v[196:199]
    v_mfma_f32_16x16x32_bf16 v[200:203], v[100:103], v[84:87], v[200:203]
    v_mfma_f32_16x16x32_bf16 v[204:207], v[100:103], v[88:91], v[204:207]
    v_mfma_f32_16x16x32_bf16 v[208:211], v[104:107], v[76:79], v[208:211]
    v_mfma_f32_16x16x32_bf16 v[212:215], v[104:107], v[80:83], v[212:215]
    v_mfma_f32_16x16x32_bf16 v[216:219], v[104:107], v[84:87], v[216:219]
    v_mfma_f32_16x16x32_bf16 v[220:223], v[104:107], v[88:91], v[220:223]
    buffer_load_dwordx4 v[76:79], v8, s[96:99], s29 offen sc1
    buffer_load_dwordx4 v[80:83], v9, s[96:99], s29 offen sc1
    buffer_load_dwordx4 v[84:87], v10, s[96:99], s29 offen sc1
    buffer_load_dwordx4 v[88:91], v11, s[96:99], s29 offen sc1
    s_add_u32 s29, s29, 1024
    buffer_load_dwordx4 v[92:95], v12, s[96:99], s31 offen sc1
    buffer_load_dwordx4 v[96:99], v13, s[96:99], s31 offen sc1
    buffer_load_dwordx4 v[100:103], v14, s[96:99], s31 offen sc1
    buffer_load_dwordx4 v[104:107], v15, s[96:99], s31 offen sc1
    s_add_u32 s31, s31, 1024
    s_waitcnt vmcnt(16)
    v_mfma_f32_16x16x32_bf16 v[160:163], v[128:131], v[112:115], v[160:163]
    v_mfma_f32_16x16x32_bf16 v[164:167], v[128:131], v[116:119], v[164:167]
    v_mfma_f32_16x16x32_bf16 v[168:171], v[128:131], v[120:123], v[168:171]
    v_mfma_f32_16x16x32_bf16 v[172:175], v[128:131], v[124:127], v[172:175]
    v_mfma_f32_16x16x32_bf16 v[176:179], v[132:135], v[112:115], v[176:179]
    v_mfma_f32_16x16x32_bf16 v[180:183], v[132:135], v[116:119], v[180:183]
    v_mfma_f32_16x16x32_bf16 v[184:187], v[132:135], v[120:123], v[184:187]
    v_mfma_f32_16x16x32_bf16 v[188:191], v[132:135], v[124:127], v[188:191]
    v_mfma_f32_16x16x32_bf16 v[192:195], v[136:139], v[112:115], v[192:195]
    v_mfma_f32_16x16x32_bf16 v[196:199], v[136:139], v[116:119], v[196:199]
    v_mfma_f32_16x16x32_bf16 v[200:203], v[136:139], v[120:123], v[200:203]
    v_mfma_f32_16x16x32_bf16 v[204:207], v[136:139], v[124:127], v[204:207]
    v_mfma_f32_16x16x32_bf16 v[208:211], v[140:143], v[112:115], v[208:211]
    v_mfma_f32_16x16x32_bf16 v[212:215], v[140:143], v[116:119], v[212:215]
    v_mfma_f32_16x16x32_bf16 v[216:219], v[140:143], v[120:123], v[216:219]
    v_mfma_f32_16x16x32_bf16 v[220:223], v[140:143], v[124:127], v[220:223]
    buffer_load_dwordx4 v[112:115], v8, s[96:99], s29 offen sc1
    buffer_load_dwordx4 v[116:119], v9, s[96:99], s29 offen sc1
    buffer_load_dwordx4 v[120:123], v10, s[96:99], s29 offen sc1
    buffer_load_dwordx4 v[124:127], v11, s[96:99], s29 offen sc1
    s_add_u32 s29, s29, 1024
    buffer_load_dwordx4 v[128:131], v12, s[96:99], s31 offen sc1
    buffer_load_dwordx4 v[132:135], v13, s[96:99], s31 offen sc1
    buffer_load_dwordx4 v[136:139], v14, s[96:99], s31 offen sc1
    buffer_load_dwordx4 v[140:143], v15, s[96:99], s31 offen sc1
    s_add_u32 s31, s31, 1024
    s_waitcnt vmcnt(16)
    v_mfma_f32_16x16x32_bf16 v[160:163], v[56:59], v[40:43], v[160:163]
    v_mfma_f32_16x16x32_bf16 v[164:167], v[56:59], v[44:47], v[164:167]
    v_mfma_f32_16x16x32_bf16 v[168:171], v[56:59], v[48:51], v[168:171]
    v_mfma_f32_16x16x32_bf16 v[172:175], v[56:59], v[52:55], v[172:175]
    v_mfma_f32_16x16x32_bf16 v[176:179], v[60:63], v[40:43], v[176:179]
    v_mfma_f32_16x16x32_bf16 v[180:183], v[60:63], v[44:47], v[180:183]
    v_mfma_f32_16x16x32_bf16 v[184:187], v[60:63], v[48:51], v[184:187]
    v_mfma_f32_16x16x32_bf16 v[188:191], v[60:63], v[52:55], v[188:191]
    v_mfma_f32_16x16x32_bf16 v[192:195], v[64:67], v[40:43], v[192:195]
    v_mfma_f32_16x16x32_bf16 v[196:199], v[64:67], v[44:47], v[196:199]
    v_mfma_f32_16x16x32_bf16 v[200:203], v[64:67], v[48:51], v[200:203]
    v_mfma_f32_16x16x32_bf16 v[204:207], v[64:67], v[52:55], v[204:207]
    v_mfma_f32_16x16x32_bf16 v[208:211], v[68:71], v[40:43], v[208:211]
    v_mfma_f32_16x16x32_bf16 v[212:215], v[68:71], v[44:47], v[212:215]
    v_mfma_f32_16x16x32_bf16 v[216:219], v[68:71], v[48:51], v[216:219]
    v_mfma_f32_16x16x32_bf16 v[220:223], v[68:71], v[52:55], v[220:223]
    s_waitcnt vmcnt(8)
    v_mfma_f32_16x16x32_bf16 v[160:163], v[92:95], v[76:79], v[160:163]
    v_mfma_f32_16x16x32_bf16 v[164:167], v[92:95], v[80:83], v[164:167]
    v_mfma_f32_16x16x32_bf16 v[168:171], v[92:95], v[84:87], v[168:171]
    v_mfma_f32_16x16x32_bf16 v[172:175], v[92:95], v[88:91], v[172:175]
    v_mfma_f32_16x16x32_bf16 v[176:179], v[96:99], v[76:79], v[176:179]
    v_mfma_f32_16x16x32_bf16 v[180:183], v[96:99], v[80:83], v[180:183]
    v_mfma_f32_16x16x32_bf16 v[184:187], v[96:99], v[84:87], v[184:187]
    v_mfma_f32_16x16x32_bf16 v[188:191], v[96:99], v[88:91], v[188:191]
    v_mfma_f32_16x16x32_bf16 v[192:195], v[100:103], v[76:79], v[192:195]
    v_mfma_f32_16x16x32_bf16 v[196:199], v[100:103], v[80:83], v[196:199]
    v_mfma_f32_16x16x32_bf16 v[200:203], v[100:103], v[84:87], v[200:203]
    v_mfma_f32_16x16x32_bf16 v[204:207], v[100:103], v[88:91], v[204:207]
    v_mfma_f32_16x16x32_bf16 v[208:211], v[104:107], v[76:79], v[208:211]
    v_mfma_f32_16x16x32_bf16 v[212:215], v[104:107], v[80:83], v[212:215]
    v_mfma_f32_16x16x32_bf16 v[216:219], v[104:107], v[84:87], v[216:219]
    v_mfma_f32_16x16x32_bf16 v[220:223], v[104:107], v[88:91], v[220:223]
    s_waitcnt vmcnt(0)
    v_mfma_f32_16x16x32_bf16 v[160:163], v[128:131], v[112:115], v[160:163]
    v_mfma_f32_16x16x32_bf16 v[164:167], v[128:131], v[116:119], v[164:167]
    v_mfma_f32_16x16x32_bf16 v[168:171], v[128:131], v[120:123], v[168:171]
    v_mfma_f32_16x16x32_bf16 v[172:175], v[128:131], v[124:127], v[172:175]
    v_mfma_f32_16x16x32_bf16 v[176:179], v[132:135], v[112:115], v[176:179]
    v_mfma_f32_16x16x32_bf16 v[180:183], v[132:135], v[116:119], v[180:183]
    v_mfma_f32_16x16x32_bf16 v[184:187], v[132:135], v[120:123], v[184:187]
    v_mfma_f32_16x16x32_bf16 v[188:191], v[132:135], v[124:127], v[188:191]
    v_mfma_f32_16x16x32_bf16 v[192:195], v[136:139], v[112:115], v[192:195]
    v_mfma_f32_16x16x32_bf16 v[196:199], v[136:139], v[116:119], v[196:199]
    v_mfma_f32_16x16x32_bf16 v[200:203], v[136:139], v[120:123], v[200:203]
    v_mfma_f32_16x16x32_bf16 v[204:207], v[136:139], v[124:127], v[204:207]
    v_mfma_f32_16x16x32_bf16 v[208:211], v[140:143], v[112:115], v[208:211]
    v_mfma_f32_16x16x32_bf16 v[212:215], v[140:143], v[116:119], v[212:215]
    v_mfma_f32_16x16x32_bf16 v[216:219], v[140:143], v[120:123], v[216:219]
    v_mfma_f32_16x16x32_bf16 v[220:223], v[140:143], v[124:127], v[220:223]
    s_mul_i32 s36, s3, 34816
    v_add_u32 v18, s36, v5
    s_mul_i32 s36, s3, 5120
    v_add_u32 v19, s36, v5
    v_add_u32 v34, 69632, v19
    s_nop 4
    ds_write_b128 v18, v[160:163] offset:0
    ds_write_b128 v18, v[176:179] offset:1024
    ds_write_b128 v18, v[192:195] offset:2048
    ds_write_b128 v18, v[208:211] offset:3072
    ds_write_b128 v18, v[164:167] offset:5120
    ds_write_b128 v18, v[180:183] offset:6144
    ds_write_b128 v18, v[196:199] offset:7168
    ds_write_b128 v18, v[212:215] offset:8192
    ds_write_b128 v18, v[168:171] offset:10240
    ds_write_b128 v18, v[184:187] offset:11264
    ds_write_b128 v18, v[200:203] offset:12288
    ds_write_b128 v18, v[216:219] offset:13312
    ds_write_b128 v18, v[172:175] offset:15360
    ds_write_b128 v18, v[188:191] offset:16384
    ds_write_b128 v18, v[204:207] offset:17408
    ds_write_b128 v18, v[220:223] offset:18432
    s_waitcnt lgkmcnt(0)
    s_barrier
    ds_read_b128 v[40:43], v19 offset:0
    ds_read_b128 v[44:47], v19 offset:34816
    ds_read_b128 v[48:51], v34 offset:0
    ds_read_b128 v[52:55], v34 offset:34816
    ds_read_b128 v[56:59], v19 offset:1024
    ds_read_b128 v[60:63], v19 offset:35840
    ds_read_b128 v[64:67], v34 offset:1024
    ds_read_b128 v[68:71], v34 offset:35840
    ds_read_b128 v[72:75], v19 offset:2048
    ds_read_b128 v[76:79], v19 offset:36864
    ds_read_b128 v[80:83], v34 offset:2048
    ds_read_b128 v[84:87], v34 offset:36864
    ds_read_b128 v[88:91], v19 offset:3072
    ds_read_b128 v[92:95], v19 offset:37888
    ds_read_b128 v[96:99], v34 offset:3072
    ds_read_b128 v[100:103], v34 offset:37888
    s_waitcnt lgkmcnt(12)
    v_add_f32 v40, v40, v44
    v_add_f32 v48, v48, v52
    v_add_f32 v41, v41, v45
    v_add_f32 v49, v49, v53
    v_add_f32 v42, v42, v46
    v_add_f32 v50, v50, v54
    v_add_f32 v43, v43, v47
    v_add_f32 v51, v51, v55
    v_add_f32 v40, v40, v48
    v_add_f32 v41, v41, v49
    v_add_f32 v42, v42, v50
    v_add_f32 v43, v43, v51
    v_cvt_pk_bf16_f32 v44, v40, v41
    v_cvt_pk_bf16_f32 v45, v42, v43
    v_lshlrev_b32 v48, 16, v20
    v_and_b32 v49, 0xffff0000, v20
    v_lshlrev_b32 v50, 16, v21
    v_and_b32 v51, 0xffff0000, v21
    v_lshlrev_b32 v40, 16, v44
    v_and_b32 v41, 0xffff0000, v44
    v_lshlrev_b32 v42, 16, v45
    v_and_b32 v43, 0xffff0000, v45
    v_add_f32 v40, v40, v48
    v_add_f32 v41, v41, v49
    v_add_f32 v42, v42, v50
    v_add_f32 v43, v43, v51
    v_cvt_pk_bf16_f32 v44, v40, v41
    v_cvt_pk_bf16_f32 v45, v42, v43
    buffer_store_dwordx2 v[44:45], v7, s[16:19], s33 offen offset:0
    s_waitcnt lgkmcnt(8)
    v_add_f32 v56, v56, v60
    v_add_f32 v64, v64, v68
    v_add_f32 v57, v57, v61
    v_add_f32 v65, v65, v69
    v_add_f32 v58, v58, v62
    v_add_f32 v66, v66, v70
    v_add_f32 v59, v59, v63
    v_add_f32 v67, v67, v71
    v_add_f32 v56, v56, v64
    v_add_f32 v57, v57, v65
    v_add_f32 v58, v58, v66
    v_add_f32 v59, v59, v67
    v_cvt_pk_bf16_f32 v60, v56, v57
    v_cvt_pk_bf16_f32 v61, v58, v59
    v_lshlrev_b32 v64, 16, v22
    v_and_b32 v65, 0xffff0000, v22
    v_lshlrev_b32 v66, 16, v23
    v_and_b32 v67, 0xffff0000, v23
    v_lshlrev_b32 v56, 16, v60
    v_and_b32 v57, 0xffff0000, v60
    v_lshlrev_b32 v58, 16, v61
    v_and_b32 v59, 0xffff0000, v61
    v_add_f32 v56, v56, v64
    v_add_f32 v57, v57, v65
    v_add_f32 v58, v58, v66
    v_add_f32 v59, v59, v67
    v_cvt_pk_bf16_f32 v60, v56, v57
    v_cvt_pk_bf16_f32 v61, v58, v59
    buffer_store_dwordx2 v[60:61], v7, s[16:19], s33 offen offset:32
    s_waitcnt lgkmcnt(4)
    v_add_f32 v72, v72, v76
    v_add_f32 v80, v80, v84
    v_add_f32 v73, v73, v77
    v_add_f32 v81, v81, v85
    v_add_f32 v74, v74, v78
    v_add_f32 v82, v82, v86
    v_add_f32 v75, v75, v79
    v_add_f32 v83, v83, v87
    v_add_f32 v72, v72, v80
    v_add_f32 v73, v73, v81
    v_add_f32 v74, v74, v82
    v_add_f32 v75, v75, v83
    v_cvt_pk_bf16_f32 v76, v72, v73
    v_cvt_pk_bf16_f32 v77, v74, v75
    v_lshlrev_b32 v80, 16, v24
    v_and_b32 v81, 0xffff0000, v24
    v_lshlrev_b32 v82, 16, v25
    v_and_b32 v83, 0xffff0000, v25
    v_lshlrev_b32 v72, 16, v76
    v_and_b32 v73, 0xffff0000, v76
    v_lshlrev_b32 v74, 16, v77
    v_and_b32 v75, 0xffff0000, v77
    v_add_f32 v72, v72, v80
    v_add_f32 v73, v73, v81
    v_add_f32 v74, v74, v82
    v_add_f32 v75, v75, v83
    v_cvt_pk_bf16_f32 v76, v72, v73
    v_cvt_pk_bf16_f32 v77, v74, v75
    buffer_store_dwordx2 v[76:77], v7, s[16:19], s33 offen offset:64
    s_waitcnt lgkmcnt(0)
    v_add_f32 v88, v88, v92
    v_add_f32 v96, v96, v100
    v_add_f32 v89, v89, v93
    v_add_f32 v97, v97, v101
    v_add_f32 v90, v90, v94
    v_add_f32 v98, v98, v102
    v_add_f32 v91, v91, v95
    v_add_f32 v99, v99, v103
    v_add_f32 v88, v88, v96
    v_add_f32 v89, v89, v97
    v_add_f32 v90, v90, v98
    v_add_f32 v91, v91, v99
    v_cvt_pk_bf16_f32 v92, v88, v89
    v_cvt_pk_bf16_f32 v93, v90, v91
    v_lshlrev_b32 v96, 16, v26
    v_and_b32 v97, 0xffff0000, v26
    v_lshlrev_b32 v98, 16, v27
    v_and_b32 v99, 0xffff0000, v27
    v_lshlrev_b32 v88, 16, v92
    v_and_b32 v89, 0xffff0000, v92
    v_lshlrev_b32 v90, 16, v93
    v_and_b32 v91, 0xffff0000, v93
    v_add_f32 v88, v88, v96
    v_add_f32 v89, v89, v97
    v_add_f32 v90, v90, v98
    v_add_f32 v91, v91, v99
    v_cvt_pk_bf16_f32 v92, v88, v89
    v_cvt_pk_bf16_f32 v93, v90, v91
    buffer_store_dwordx2 v[92:93], v7, s[16:19], s33 offen offset:96
    s_branch Lfin
Lfin:
    s_lshl_b32 s3, s3, 8
    s_or_b32 s3, s3, s2
    s_cmp_eq_u32 s3, 0
    s_cbranch_scc0 Lend
    s_mul_i32 s3, s100, 0xe8b2f51
    v_mov_b32 v2, s3
    v_mov_b32 v3, 0
    s_mov_b32 s3, 49315840
    s_mov_b64 exec, 1
    buffer_store_dword v2, v3, s[96:99], s3 offen
Lend:
    s_endpgm

.section .rodata,"a"
.p2align 6
.amdhsa_kernel sequential_preLN__ssm_conv_s4__mixer_gmlp__prompt_kernel
  .amdhsa_next_free_vgpr 256
  .amdhsa_next_free_sgpr 102
  .amdhsa_accum_offset 256
  .amdhsa_group_segment_fixed_size 0
  .amdhsa_kernarg_size 136
  .amdhsa_user_sgpr_count 2
  .amdhsa_user_sgpr_kernarg_segment_ptr 1
  .amdhsa_system_sgpr_workgroup_id_x 1
  .amdhsa_float_denorm_mode_32 3
  .amdhsa_float_denorm_mode_16_64 3
.end_amdhsa_kernel
```
